```python
import torch

def _softmax(x, axis=-1):
    return torch.softmax(x, dim=axis)

def _gelu(x):
    return torch.nn.functional.gelu(x, approximate='tanh')

def _silu(x):
    return torch.nn.functional.silu(x)

def _sigmoid(x):
    return torch.sigmoid(x)

def _layernorm(x, axis=-1, eps=1e-05):
    m = x.mean(dim=axis, keepdim=True)
    v = x.var(dim=axis, keepdim=True, unbiased=False)
    return (x - m) / torch.sqrt(v + eps)

def _scatter_add(tgt, idx, src, axis=0):
    return tgt.clone().index_add_(axis, idx, src)

def _segment_sum(src, seg, n):
    out = torch.zeros((n,) + src.shape[1:], dtype=src.dtype)
    return out.index_add_(0, seg, src)

def _pad(x, pw):
    flat = tuple((v for pair in reversed(pw) for v in pair))
    return torch.nn.functional.pad(x, flat)
kernel_name = 'sequential_preLN__linear_kernel_hedgehog__mixer_gmlp__prompt'

def setup_inputs():

    _w = lambda a: (lambda t: t.to(torch.bfloat16) if t.is_floating_point() else t)(torch.as_tensor(a))

    def _A_setup():
        B, S, D, H = (1, 2048, 576, 32)
        Dh = D // H
        return {'x': _w((lambda *s: torch.randn(*s, dtype=torch.bfloat16) * 0.05)(B, S, D)), 'wqkv': _w((lambda *s: torch.randn(*s, dtype=torch.bfloat16) * 0.2)(D, 3 * D)), 'w_phi': _w((lambda *s: torch.randn(*s, dtype=torch.bfloat16) * 0.2)(H, Dh, Dh) * Dh ** (-0.5)), 'wo': _w((lambda *s: torch.randn(*s, dtype=torch.bfloat16) * 0.05)(D, D))}
    _A_in = _A_setup()

    def _B_setup():
        B, S, D, F = (1, 2048, 576, 4608)
        Fh = F // 2
        return {'x': _w((lambda *s: torch.randn(*s, dtype=torch.bfloat16) * 0.05)(B, S, D)), 'w_in': _w((lambda *s: torch.randn(*s, dtype=torch.bfloat16) * 0.4)(D, 2 * Fh)), 'w_sp': _w(0.01 * (lambda *s: torch.randn(*s, dtype=torch.bfloat16) * 0.4)(S, S)), 'b_sp': _w(1.0 + 0.01 * (lambda *s: torch.randn(*s, dtype=torch.bfloat16) * 0.05)(S)), 'w_out': _w((lambda *s: torch.randn(*s, dtype=torch.bfloat16) * 0.05)(Fh, D))}
    _B_in = _B_setup()
    return {'A_x': _A_in['x'], 'A_wqkv': _A_in['wqkv'], 'A_w_phi': _A_in['w_phi'], 'A_wo': _A_in['wo'], 'B_x': _B_in['x'], 'B_w_in': _B_in['w_in'], 'B_w_sp': _B_in['w_sp'], 'B_b_sp': _B_in['b_sp'], 'B_w_out': _B_in['w_out']}

def reference(A_x, A_wqkv, A_w_phi, A_wo, B_x, B_w_in, B_w_sp, B_b_sp, B_w_out):

    def _A_ref(x, wqkv, w_phi, wo):
        B, S, D = x.shape
        H = 32
        Dh = D // H
        qkv = (lambda x, *d: x.permute(*d))((x @ wqkv).reshape(B, S, 3, H, Dh), 2, 0, 3, 1, 4)
        q, k, v = (qkv[0], qkv[1], qkv[2])
        pq = torch.einsum('bhsd,hdf->bhsf', q, w_phi)
        pk = torch.einsum('bhsd,hdf->bhsf', k, w_phi)
        phi_q = torch.concatenate([_softmax(pq, axis=-1), _softmax(-pq, axis=-1)], axis=-1)
        phi_k = torch.concatenate([_softmax(pk, axis=-1), _softmax(-pk, axis=-1)], axis=-1)
        kv = torch.einsum('bhsf,bhsd->bhfd', phi_k, v)
        z = torch.einsum('bhsf->bhf', phi_k)
        num = torch.einsum('bhqf,bhfd->bhqd', phi_q, kv)
        den = torch.einsum('bhqf,bhf->bhq', phi_q, z)[..., None] + 1e-06
        o = num / den
        return (lambda x, *d: x.permute(*d))(o, 0, 2, 1, 3).reshape(B, S, D) @ wo

    def _B_ref(x, w_in, w_sp, b_sp, w_out):
        B, S, D = x.shape
        F = w_in.shape[-1]
        Fh = F // 2
        z = _gelu(torch.einsum('bsd,df->bsf', x, w_in))
        z1 = z[..., :Fh].clone()
        z2 = _layernorm(z[..., Fh:], axis=-1)
        g = torch.einsum('ts,bsf->btf', w_sp, z2) + b_sp[None, :, None]
        return torch.einsum('bsf,fd->bsd', z1 * g, w_out)
    x = A_x
    h = x + _A_ref(_layernorm(x, axis=-1), A_wqkv, A_w_phi, A_wo)
    h2 = h + _B_ref(_layernorm(h, axis=-1), B_w_in, B_w_sp, B_b_sp, B_w_out)
    return h2
```

```asm
; @launch kernel=a1_kernel grid=(256,1,1) block=(512,1,1) lds=147456
; @launch kernel=kvr_kernel grid=(724,1,1) block=(256,1,1) lds=20480
; @launch kernel=a2_kernel grid=(256,1,1) block=(256,1,1) lds=147968
; @launch kernel=b1_kernel grid=(256,1,1) block=(512,1,1) lds=159744
; @launch kernel=b2_kernel grid=(256,1,1) block=(512,1,1) lds=110592
; @launch kernel=b3_kernel grid=(256,1,1) block=(512,1,1) lds=135168
.amdgcn_target "amdgcn-amd-amdhsa--gfx950"
.text
.globl a1_kernel
.p2align 8
.type a1_kernel,@function
a1_kernel:
    s_cmp_ge_u32 s2, 256
    s_cbranch_scc1 a1_kernel_end
    s_load_dwordx16 s[16:31], s[0:1], 0
    s_load_dwordx8 s[32:39], s[0:1], 64
    v_and_b32 v1, 63, v0
    v_lshrrev_b32 v2, 6, v0
    s_nop 0
    v_readfirstlane_b32 s60, v2
    v_mov_b32 v10, 0
    v_mov_b32 v11, 0
    v_mov_b32 v12, 0
    v_mov_b32 v13, 0
    v_mov_b32 v14, 0
    v_mov_b32 v15, 0
    v_mov_b32 v16, 0
    v_mov_b32 v17, 0
    v_mov_b32 v18, 0
    s_and_b32 s70, s60, 1
    s_lshr_b32 s71, s60, 1
    s_and_b32 s75, s60, 3
    s_lshr_b32 s73, s2, 7
    s_and_b32 s68, s2, 127
    s_lshr_b32 s61, s68, 2
    s_and_b32 s62, s68, 3
    s_waitcnt lgkmcnt(0)
    s_mov_b32 s40, s16
    s_mov_b32 s41, s17
    s_and_b32 s41, s41, 0xffff
    s_mov_b32 s42, 2359296
    s_mov_b32 s43, 0x00020000
    s_mov_b32 s44, s18
    s_mov_b32 s45, s19
    s_and_b32 s45, s45, 0xffff
    s_mov_b32 s46, 1990656
    s_mov_b32 s47, 0x00020000
    s_mov_b32 s48, s20
    s_mov_b32 s49, s21
    s_and_b32 s49, s49, 0xffff
    s_mov_b32 s50, 20736
    s_mov_b32 s51, 0x00020000
    s_mov_b32 s52, s38
    s_mov_b32 s53, s39
    s_and_b32 s53, s53, 0xffff
    s_mov_b32 s54, 6291456
    s_mov_b32 s55, 0x00020000
    s_add_u32 s56, s38, 62914560
    s_addc_u32 s57, s39, 0
    s_and_b32 s57, s57, 0xffff
    s_mov_b32 s58, 6291456
    s_mov_b32 s59, 0x00020000
    s_mov_b32 s76, s36
    s_mov_b32 s77, s37
    s_and_b32 s77, s77, 0xffff
    s_mov_b32 s78, 256
    s_mov_b32 s79, 0x00020000
    v_and_b32 v2, 7, v1
    v_lshrrev_b32 v3, 3, v1
    s_lshl_b32 s68, s60, 3
    v_add_u32 v3, s68, v3
    s_lshl_b32 s69, s61, 6
    v_add_u32 v4, s69, v3
    v_mul_u32_u24 v4, 1152, v4
    v_lshlrev_b32 v5, 4, v2
    v_add_u32 v4, v4, v5
    buffer_load_dwordx4 v[32:35], v4, s[40:43], 0 offen offset:0
    buffer_load_dwordx4 v[36:39], v4, s[40:43], 0 offen offset:128
    buffer_load_dwordx4 v[40:43], v4, s[40:43], 0 offen offset:256
    buffer_load_dwordx4 v[44:47], v4, s[40:43], 0 offen offset:384
    buffer_load_dwordx4 v[48:51], v4, s[40:43], 0 offen offset:512
    buffer_load_dwordx4 v[52:55], v4, s[40:43], 0 offen offset:640
    buffer_load_dwordx4 v[56:59], v4, s[40:43], 0 offen offset:768
    buffer_load_dwordx4 v[60:63], v4, s[40:43], 0 offen offset:896
    buffer_load_dwordx4 v[64:67], v4, s[40:43], 0 offen offset:1024
    s_mul_i32 s86, s62, 5184
    v_mul_u32_u24 v6, 36, v0
    v_add_u32 v6, s86, v6
    buffer_load_dwordx4 v[216:219], v6, s[48:51], 0 offen
    buffer_load_dwordx4 v[220:223], v6, s[48:51], 0 offen offset:16
    buffer_load_dword v224, v6, s[48:51], 0 offen offset:32
    s_mul_i32 s74, s62, 144
    s_cmp_eq_u32 s73, 1
    s_cselect_b32 s68, 0, 576
    s_add_u32 s74, s74, s68
    s_cmp_lt_u32 s60, 4
    s_cbranch_scc0 a1_kernel_ldr
    s_lshr_b32 s82, s2, 3
    s_lshl_b32 s82, s82, 16
    v_lshlrev_b32 v5, 4, v0
    s_add_u32 s83, s82, 0
    buffer_load_dwordx4 v[228:231], v5, s[44:47], s83 offen
    s_add_u32 s83, s82, 4096
    buffer_load_dwordx4 v[228:231], v5, s[44:47], s83 offen
    s_add_u32 s83, s82, 8192
    buffer_load_dwordx4 v[228:231], v5, s[44:47], s83 offen
    s_add_u32 s83, s82, 12288
    buffer_load_dwordx4 v[228:231], v5, s[44:47], s83 offen
    s_add_u32 s83, s82, 16384
    buffer_load_dwordx4 v[228:231], v5, s[44:47], s83 offen
    s_add_u32 s83, s82, 20480
    buffer_load_dwordx4 v[228:231], v5, s[44:47], s83 offen
    s_add_u32 s83, s82, 24576
    buffer_load_dwordx4 v[228:231], v5, s[44:47], s83 offen
    s_add_u32 s83, s82, 28672
    buffer_load_dwordx4 v[228:231], v5, s[44:47], s83 offen
    s_add_u32 s83, s82, 32768
    buffer_load_dwordx4 v[228:231], v5, s[44:47], s83 offen
    s_add_u32 s83, s82, 36864
    buffer_load_dwordx4 v[228:231], v5, s[44:47], s83 offen
    s_add_u32 s83, s82, 40960
    buffer_load_dwordx4 v[228:231], v5, s[44:47], s83 offen
    s_add_u32 s83, s82, 45056
    buffer_load_dwordx4 v[228:231], v5, s[44:47], s83 offen
    s_add_u32 s83, s82, 49152
    buffer_load_dwordx4 v[228:231], v5, s[44:47], s83 offen
    s_add_u32 s83, s82, 53248
    buffer_load_dwordx4 v[228:231], v5, s[44:47], s83 offen
    s_add_u32 s83, s82, 57344
    buffer_load_dwordx4 v[228:231], v5, s[44:47], s83 offen
    s_add_u32 s83, s82, 61440
    buffer_load_dwordx4 v[228:231], v5, s[44:47], s83 offen
    s_branch a1_kernel_noldr
a1_kernel_ldr:
    s_add_u32 s82, s75, 0
    s_cmp_ge_u32 s82, 18
    s_cselect_b32 s83, 18, 0
    s_cselect_b32 s84, 576, 0
    s_sub_u32 s82, s82, s83
    s_lshl_b32 s100, s82, 6
    v_add_u32 v5, s100, v1
    s_mov_b32 s100, 58255
    v_mul_lo_u32 v6, v5, s100
    v_lshrrev_b32 v6, 20, v6
    v_mul_u32_u24 v7, 18, v6
    v_sub_u32 v7, v5, v7
    v_and_b32 v8, 0x73, v6
    v_and_b32 v9, 4, v6
    v_lshlrev_b32 v9, 1, v9
    v_or_b32 v8, v8, v9
    v_and_b32 v9, 8, v6
    v_lshrrev_b32 v9, 1, v9
    v_or_b32 v8, v8, v9
    s_mov_b32 s100, 3456
    v_mul_lo_u32 v8, v8, s100
    v_lshlrev_b32 v7, 4, v7
    v_add_u32 v10, v8, v7
    s_add_u32 s84, s84, s74
    s_lshl_b32 s84, s84, 1
    v_add_u32 v10, s84, v10
    s_add_u32 s82, s75, 4
    s_cmp_ge_u32 s82, 18
    s_cselect_b32 s83, 18, 0
    s_cselect_b32 s84, 576, 0
    s_sub_u32 s82, s82, s83
    s_lshl_b32 s100, s82, 6
    v_add_u32 v5, s100, v1
    s_mov_b32 s100, 58255
    v_mul_lo_u32 v6, v5, s100
    v_lshrrev_b32 v6, 20, v6
    v_mul_u32_u24 v7, 18, v6
    v_sub_u32 v7, v5, v7
    v_and_b32 v8, 0x73, v6
    v_and_b32 v9, 4, v6
    v_lshlrev_b32 v9, 1, v9
    v_or_b32 v8, v8, v9
    v_and_b32 v9, 8, v6
    v_lshrrev_b32 v9, 1, v9
    v_or_b32 v8, v8, v9
    s_mov_b32 s100, 3456
    v_mul_lo_u32 v8, v8, s100
    v_lshlrev_b32 v7, 4, v7
    v_add_u32 v11, v8, v7
    s_add_u32 s84, s84, s74
    s_lshl_b32 s84, s84, 1
    v_add_u32 v11, s84, v11
    s_add_u32 s82, s75, 8
    s_cmp_ge_u32 s82, 18
    s_cselect_b32 s83, 18, 0
    s_cselect_b32 s84, 576, 0
    s_sub_u32 s82, s82, s83
    s_lshl_b32 s100, s82, 6
    v_add_u32 v5, s100, v1
    s_mov_b32 s100, 58255
    v_mul_lo_u32 v6, v5, s100
    v_lshrrev_b32 v6, 20, v6
    v_mul_u32_u24 v7, 18, v6
    v_sub_u32 v7, v5, v7
    v_and_b32 v8, 0x73, v6
    v_and_b32 v9, 4, v6
    v_lshlrev_b32 v9, 1, v9
    v_or_b32 v8, v8, v9
    v_and_b32 v9, 8, v6
    v_lshrrev_b32 v9, 1, v9
    v_or_b32 v8, v8, v9
    s_mov_b32 s100, 3456
    v_mul_lo_u32 v8, v8, s100
    v_lshlrev_b32 v7, 4, v7
    v_add_u32 v12, v8, v7
    s_add_u32 s84, s84, s74
    s_lshl_b32 s84, s84, 1
    v_add_u32 v12, s84, v12
    s_add_u32 s82, s75, 12
    s_cmp_ge_u32 s82, 18
    s_cselect_b32 s83, 18, 0
    s_cselect_b32 s84, 576, 0
    s_sub_u32 s82, s82, s83
    s_lshl_b32 s100, s82, 6
    v_add_u32 v5, s100, v1
    s_mov_b32 s100, 58255
    v_mul_lo_u32 v6, v5, s100
    v_lshrrev_b32 v6, 20, v6
    v_mul_u32_u24 v7, 18, v6
    v_sub_u32 v7, v5, v7
    v_and_b32 v8, 0x73, v6
    v_and_b32 v9, 4, v6
    v_lshlrev_b32 v9, 1, v9
    v_or_b32 v8, v8, v9
    v_and_b32 v9, 8, v6
    v_lshrrev_b32 v9, 1, v9
    v_or_b32 v8, v8, v9
    s_mov_b32 s100, 3456
    v_mul_lo_u32 v8, v8, s100
    v_lshlrev_b32 v7, 4, v7
    v_add_u32 v13, v8, v7
    s_add_u32 s84, s84, s74
    s_lshl_b32 s84, s84, 1
    v_add_u32 v13, s84, v13
    s_add_u32 s82, s75, 16
    s_cmp_ge_u32 s82, 18
    s_cselect_b32 s83, 18, 0
    s_cselect_b32 s84, 576, 0
    s_sub_u32 s82, s82, s83
    s_lshl_b32 s100, s82, 6
    v_add_u32 v5, s100, v1
    s_mov_b32 s100, 58255
    v_mul_lo_u32 v6, v5, s100
    v_lshrrev_b32 v6, 20, v6
    v_mul_u32_u24 v7, 18, v6
    v_sub_u32 v7, v5, v7
    v_and_b32 v8, 0x73, v6
    v_and_b32 v9, 4, v6
    v_lshlrev_b32 v9, 1, v9
    v_or_b32 v8, v8, v9
    v_and_b32 v9, 8, v6
    v_lshrrev_b32 v9, 1, v9
    v_or_b32 v8, v8, v9
    s_mov_b32 s100, 3456
    v_mul_lo_u32 v8, v8, s100
    v_lshlrev_b32 v7, 4, v7
    v_add_u32 v14, v8, v7
    s_add_u32 s84, s84, s74
    s_lshl_b32 s84, s84, 1
    v_add_u32 v14, s84, v14
    s_add_u32 s82, s75, 20
    s_cmp_ge_u32 s82, 18
    s_cselect_b32 s83, 18, 0
    s_cselect_b32 s84, 576, 0
    s_sub_u32 s82, s82, s83
    s_lshl_b32 s100, s82, 6
    v_add_u32 v5, s100, v1
    s_mov_b32 s100, 58255
    v_mul_lo_u32 v6, v5, s100
    v_lshrrev_b32 v6, 20, v6
    v_mul_u32_u24 v7, 18, v6
    v_sub_u32 v7, v5, v7
    v_and_b32 v8, 0x73, v6
    v_and_b32 v9, 4, v6
    v_lshlrev_b32 v9, 1, v9
    v_or_b32 v8, v8, v9
    v_and_b32 v9, 8, v6
    v_lshrrev_b32 v9, 1, v9
    v_or_b32 v8, v8, v9
    s_mov_b32 s100, 3456
    v_mul_lo_u32 v8, v8, s100
    v_lshlrev_b32 v7, 4, v7
    v_add_u32 v15, v8, v7
    s_add_u32 s84, s84, s74
    s_lshl_b32 s84, s84, 1
    v_add_u32 v15, s84, v15
    s_add_u32 s82, s75, 24
    s_cmp_ge_u32 s82, 18
    s_cselect_b32 s83, 18, 0
    s_cselect_b32 s84, 576, 0
    s_sub_u32 s82, s82, s83
    s_lshl_b32 s100, s82, 6
    v_add_u32 v5, s100, v1
    s_mov_b32 s100, 58255
    v_mul_lo_u32 v6, v5, s100
    v_lshrrev_b32 v6, 20, v6
    v_mul_u32_u24 v7, 18, v6
    v_sub_u32 v7, v5, v7
    v_and_b32 v8, 0x73, v6
    v_and_b32 v9, 4, v6
    v_lshlrev_b32 v9, 1, v9
    v_or_b32 v8, v8, v9
    v_and_b32 v9, 8, v6
    v_lshrrev_b32 v9, 1, v9
    v_or_b32 v8, v8, v9
    s_mov_b32 s100, 3456
    v_mul_lo_u32 v8, v8, s100
    v_lshlrev_b32 v7, 4, v7
    v_add_u32 v16, v8, v7
    s_add_u32 s84, s84, s74
    s_lshl_b32 s84, s84, 1
    v_add_u32 v16, s84, v16
    s_add_u32 s82, s75, 28
    s_cmp_ge_u32 s82, 18
    s_cselect_b32 s83, 18, 0
    s_cselect_b32 s84, 576, 0
    s_sub_u32 s82, s82, s83
    s_lshl_b32 s100, s82, 6
    v_add_u32 v5, s100, v1
    s_mov_b32 s100, 58255
    v_mul_lo_u32 v6, v5, s100
    v_lshrrev_b32 v6, 20, v6
    v_mul_u32_u24 v7, 18, v6
    v_sub_u32 v7, v5, v7
    v_and_b32 v8, 0x73, v6
    v_and_b32 v9, 4, v6
    v_lshlrev_b32 v9, 1, v9
    v_or_b32 v8, v8, v9
    v_and_b32 v9, 8, v6
    v_lshrrev_b32 v9, 1, v9
    v_or_b32 v8, v8, v9
    s_mov_b32 s100, 3456
    v_mul_lo_u32 v8, v8, s100
    v_lshlrev_b32 v7, 4, v7
    v_add_u32 v17, v8, v7
    s_add_u32 s84, s84, s74
    s_lshl_b32 s84, s84, 1
    v_add_u32 v17, s84, v17
    s_add_u32 s82, s75, 32
    s_cmp_ge_u32 s82, 18
    s_cselect_b32 s83, 18, 0
    s_cselect_b32 s84, 576, 0
    s_sub_u32 s82, s82, s83
    s_lshl_b32 s100, s82, 6
    v_add_u32 v5, s100, v1
    s_mov_b32 s100, 58255
    v_mul_lo_u32 v6, v5, s100
    v_lshrrev_b32 v6, 20, v6
    v_mul_u32_u24 v7, 18, v6
    v_sub_u32 v7, v5, v7
    v_and_b32 v8, 0x73, v6
    v_and_b32 v9, 4, v6
    v_lshlrev_b32 v9, 1, v9
    v_or_b32 v8, v8, v9
    v_and_b32 v9, 8, v6
    v_lshrrev_b32 v9, 1, v9
    v_or_b32 v8, v8, v9
    s_mov_b32 s100, 3456
    v_mul_lo_u32 v8, v8, s100
    v_lshlrev_b32 v7, 4, v7
    v_add_u32 v18, v8, v7
    s_add_u32 s84, s84, s74
    s_lshl_b32 s84, s84, 1
    v_add_u32 v18, s84, v18
    s_mov_b32 s63, 0
    s_lshl_b32 s65, s75, 10
    s_cmp_eq_u32 s73, 1
    s_cbranch_scc1 a1_kernel_lq
    s_add_u32 m0, s65, 73728
    s_nop 0
    buffer_load_dwordx4 v10, s[44:47], s63 offen lds
    s_add_u32 m0, s65, 77824
    s_nop 0
    buffer_load_dwordx4 v11, s[44:47], s63 offen lds
    s_add_u32 m0, s65, 81920
    s_nop 0
    buffer_load_dwordx4 v12, s[44:47], s63 offen lds
    s_add_u32 m0, s65, 86016
    s_nop 0
    buffer_load_dwordx4 v13, s[44:47], s63 offen lds
    s_add_u32 m0, s65, 90112
    s_nop 0
    buffer_load_dwordx4 v14, s[44:47], s63 offen lds
    s_add_u32 m0, s65, 94208
    s_nop 0
    buffer_load_dwordx4 v15, s[44:47], s63 offen lds
    s_add_u32 m0, s65, 98304
    s_nop 0
    buffer_load_dwordx4 v16, s[44:47], s63 offen lds
    s_add_u32 m0, s65, 102400
    s_nop 0
    buffer_load_dwordx4 v17, s[44:47], s63 offen lds
    s_add_u32 m0, s65, 106496
    s_nop 0
    buffer_load_dwordx4 v18, s[44:47], s63 offen lds
    s_add_u32 s63, s63, 221184
    s_add_u32 s65, s65, 36864
    s_cmp_ge_u32 s65, 73728
    s_cselect_b32 s68, 73728, 0
    s_sub_u32 s65, s65, s68
    s_add_u32 m0, s65, 73728
    s_nop 0
    buffer_load_dwordx4 v10, s[44:47], s63 offen lds
    s_add_u32 m0, s65, 77824
    s_nop 0
    buffer_load_dwordx4 v11, s[44:47], s63 offen lds
    s_add_u32 m0, s65, 81920
    s_nop 0
    buffer_load_dwordx4 v12, s[44:47], s63 offen lds
    s_add_u32 m0, s65, 86016
    s_nop 0
    buffer_load_dwordx4 v13, s[44:47], s63 offen lds
    s_add_u32 m0, s65, 90112
    s_nop 0
    buffer_load_dwordx4 v14, s[44:47], s63 offen lds
    s_add_u32 m0, s65, 94208
    s_nop 0
    buffer_load_dwordx4 v15, s[44:47], s63 offen lds
    s_add_u32 m0, s65, 98304
    s_nop 0
    buffer_load_dwordx4 v16, s[44:47], s63 offen lds
    s_add_u32 m0, s65, 102400
    s_nop 0
    buffer_load_dwordx4 v17, s[44:47], s63 offen lds
    s_add_u32 m0, s65, 106496
    s_nop 0
    buffer_load_dwordx4 v18, s[44:47], s63 offen lds
    s_add_u32 s63, s63, 221184
    s_add_u32 s65, s65, 36864
    s_cmp_ge_u32 s65, 73728
    s_cselect_b32 s68, 73728, 0
    s_sub_u32 s65, s65, s68
    s_branch a1_kernel_noldr
a1_kernel_lq:
    s_add_u32 m0, s65, 73728
    s_nop 0
    buffer_load_dwordx4 v10, s[44:47], s63 offen lds
    s_add_u32 m0, s65, 77824
    s_nop 0
    buffer_load_dwordx4 v11, s[44:47], s63 offen lds
    s_add_u32 m0, s65, 81920
    s_nop 0
    buffer_load_dwordx4 v12, s[44:47], s63 offen lds
    s_add_u32 m0, s65, 86016
    s_nop 0
    buffer_load_dwordx4 v13, s[44:47], s63 offen lds
    s_add_u32 m0, s65, 90112
    s_nop 0
    buffer_load_dwordx4 v14, s[44:47], s63 offen lds
    s_add_u32 s63, s63, 221184
    s_add_u32 s65, s65, 20480
    s_cmp_ge_u32 s65, 61440
    s_cselect_b32 s68, 61440, 0
    s_sub_u32 s65, s65, s68
    s_add_u32 m0, s65, 73728
    s_nop 0
    buffer_load_dwordx4 v10, s[44:47], s63 offen lds
    s_add_u32 m0, s65, 77824
    s_nop 0
    buffer_load_dwordx4 v11, s[44:47], s63 offen lds
    s_add_u32 m0, s65, 81920
    s_nop 0
    buffer_load_dwordx4 v12, s[44:47], s63 offen lds
    s_add_u32 m0, s65, 86016
    s_nop 0
    buffer_load_dwordx4 v13, s[44:47], s63 offen lds
    s_add_u32 m0, s65, 90112
    s_nop 0
    buffer_load_dwordx4 v14, s[44:47], s63 offen lds
    s_add_u32 s63, s63, 221184
    s_add_u32 s65, s65, 20480
    s_cmp_ge_u32 s65, 61440
    s_cselect_b32 s68, 61440, 0
    s_sub_u32 s65, s65, s68
    s_add_u32 m0, s65, 73728
    s_nop 0
    buffer_load_dwordx4 v10, s[44:47], s63 offen lds
    s_add_u32 m0, s65, 77824
    s_nop 0
    buffer_load_dwordx4 v11, s[44:47], s63 offen lds
    s_add_u32 m0, s65, 81920
    s_nop 0
    buffer_load_dwordx4 v12, s[44:47], s63 offen lds
    s_add_u32 m0, s65, 86016
    s_nop 0
    buffer_load_dwordx4 v13, s[44:47], s63 offen lds
    s_add_u32 m0, s65, 90112
    s_nop 0
    buffer_load_dwordx4 v14, s[44:47], s63 offen lds
    s_add_u32 s63, s63, 221184
    s_add_u32 s65, s65, 20480
    s_cmp_ge_u32 s65, 61440
    s_cselect_b32 s68, 61440, 0
    s_sub_u32 s65, s65, s68
a1_kernel_noldr:
    s_cmp_lt_u32 s60, 4
    s_cbranch_scc1 a1_kernel_w0
    s_waitcnt vmcnt(18)
    s_branch a1_kernel_w1
a1_kernel_w0:
    s_waitcnt vmcnt(19)
a1_kernel_w1:
    s_mov_b32 s87, 0x3ae38e39
    v_lshlrev_b32 v128, 16, v32
    v_and_b32 v129, 0xffff0000, v32
    v_lshlrev_b32 v130, 16, v33
    v_and_b32 v131, 0xffff0000, v33
    v_lshlrev_b32 v132, 16, v34
    v_and_b32 v133, 0xffff0000, v34
    v_lshlrev_b32 v134, 16, v35
    v_and_b32 v135, 0xffff0000, v35
    v_lshlrev_b32 v136, 16, v36
    v_and_b32 v137, 0xffff0000, v36
    v_lshlrev_b32 v138, 16, v37
    v_and_b32 v139, 0xffff0000, v37
    v_lshlrev_b32 v140, 16, v38
    v_and_b32 v141, 0xffff0000, v38
    v_lshlrev_b32 v142, 16, v39
    v_and_b32 v143, 0xffff0000, v39
    v_lshlrev_b32 v144, 16, v40
    v_and_b32 v145, 0xffff0000, v40
    v_lshlrev_b32 v146, 16, v41
    v_and_b32 v147, 0xffff0000, v41
    v_lshlrev_b32 v148, 16, v42
    v_and_b32 v149, 0xffff0000, v42
    v_lshlrev_b32 v150, 16, v43
    v_and_b32 v151, 0xffff0000, v43
    v_lshlrev_b32 v152, 16, v44
    v_and_b32 v153, 0xffff0000, v44
    v_lshlrev_b32 v154, 16, v45
    v_and_b32 v155, 0xffff0000, v45
    v_lshlrev_b32 v156, 16, v46
    v_and_b32 v157, 0xffff0000, v46
    v_lshlrev_b32 v158, 16, v47
    v_and_b32 v159, 0xffff0000, v47
    v_lshlrev_b32 v160, 16, v48
    v_and_b32 v161, 0xffff0000, v48
    v_lshlrev_b32 v162, 16, v49
    v_and_b32 v163, 0xffff0000, v49
    v_lshlrev_b32 v164, 16, v50
    v_and_b32 v165, 0xffff0000, v50
    v_lshlrev_b32 v166, 16, v51
    v_and_b32 v167, 0xffff0000, v51
    v_lshlrev_b32 v168, 16, v52
    v_and_b32 v169, 0xffff0000, v52
    v_lshlrev_b32 v170, 16, v53
    v_and_b32 v171, 0xffff0000, v53
    v_lshlrev_b32 v172, 16, v54
    v_and_b32 v173, 0xffff0000, v54
    v_lshlrev_b32 v174, 16, v55
    v_and_b32 v175, 0xffff0000, v55
    v_lshlrev_b32 v176, 16, v56
    v_and_b32 v177, 0xffff0000, v56
    v_lshlrev_b32 v178, 16, v57
    v_and_b32 v179, 0xffff0000, v57
    v_lshlrev_b32 v180, 16, v58
    v_and_b32 v181, 0xffff0000, v58
    v_lshlrev_b32 v182, 16, v59
    v_and_b32 v183, 0xffff0000, v59
    v_lshlrev_b32 v184, 16, v60
    v_and_b32 v185, 0xffff0000, v60
    v_lshlrev_b32 v186, 16, v61
    v_and_b32 v187, 0xffff0000, v61
    v_lshlrev_b32 v188, 16, v62
    v_and_b32 v189, 0xffff0000, v62
    v_lshlrev_b32 v190, 16, v63
    v_and_b32 v191, 0xffff0000, v63
    v_lshlrev_b32 v192, 16, v64
    v_and_b32 v193, 0xffff0000, v64
    v_lshlrev_b32 v194, 16, v65
    v_and_b32 v195, 0xffff0000, v65
    v_lshlrev_b32 v196, 16, v66
    v_and_b32 v197, 0xffff0000, v66
    v_lshlrev_b32 v198, 16, v67
    v_and_b32 v199, 0xffff0000, v67
    v_add_f32 v68, v128, v132
    v_add_f32 v69, v129, v133
    v_add_f32 v70, v130, v134
    v_add_f32 v71, v131, v135
    v_add_f32 v68, v68, v136
    v_add_f32 v69, v69, v137
    v_add_f32 v70, v70, v138
    v_add_f32 v71, v71, v139
    v_add_f32 v68, v68, v140
    v_add_f32 v69, v69, v141
    v_add_f32 v70, v70, v142
    v_add_f32 v71, v71, v143
    v_add_f32 v68, v68, v144
    v_add_f32 v69, v69, v145
    v_add_f32 v70, v70, v146
    v_add_f32 v71, v71, v147
    v_add_f32 v68, v68, v148
    v_add_f32 v69, v69, v149
    v_add_f32 v70, v70, v150
    v_add_f32 v71, v71, v151
    v_add_f32 v68, v68, v152
    v_add_f32 v69, v69, v153
    v_add_f32 v70, v70, v154
    v_add_f32 v71, v71, v155
    v_add_f32 v68, v68, v156
    v_add_f32 v69, v69, v157
    v_add_f32 v70, v70, v158
    v_add_f32 v71, v71, v159
    v_add_f32 v68, v68, v160
    v_add_f32 v69, v69, v161
    v_add_f32 v70, v70, v162
    v_add_f32 v71, v71, v163
    v_add_f32 v68, v68, v164
    v_add_f32 v69, v69, v165
    v_add_f32 v70, v70, v166
    v_add_f32 v71, v71, v167
    v_add_f32 v68, v68, v168
    v_add_f32 v69, v69, v169
    v_add_f32 v70, v70, v170
    v_add_f32 v71, v71, v171
    v_add_f32 v68, v68, v172
    v_add_f32 v69, v69, v173
    v_add_f32 v70, v70, v174
    v_add_f32 v71, v71, v175
    v_add_f32 v68, v68, v176
    v_add_f32 v69, v69, v177
    v_add_f32 v70, v70, v178
    v_add_f32 v71, v71, v179
    v_add_f32 v68, v68, v180
    v_add_f32 v69, v69, v181
    v_add_f32 v70, v70, v182
    v_add_f32 v71, v71, v183
    v_add_f32 v68, v68, v184
    v_add_f32 v69, v69, v185
    v_add_f32 v70, v70, v186
    v_add_f32 v71, v71, v187
    v_add_f32 v68, v68, v188
    v_add_f32 v69, v69, v189
    v_add_f32 v70, v70, v190
    v_add_f32 v71, v71, v191
    v_add_f32 v68, v68, v192
    v_add_f32 v69, v69, v193
    v_add_f32 v70, v70, v194
    v_add_f32 v71, v71, v195
    v_add_f32 v68, v68, v196
    v_add_f32 v69, v69, v197
    v_add_f32 v70, v70, v198
    v_add_f32 v71, v71, v199
    v_add_f32 v68, v68, v69
    v_add_f32 v70, v70, v71
    v_add_f32 v68, v68, v70
    s_nop 1
    v_add_f32_dpp v68, v68, v68 quad_perm:[1,0,3,2] row_mask:0xf bank_mask:0xf
    s_nop 1
    v_add_f32_dpp v68, v68, v68 quad_perm:[2,3,0,1] row_mask:0xf bank_mask:0xf
    s_nop 1
    v_add_f32_dpp v68, v68, v68 row_half_mirror row_mask:0xf bank_mask:0xf
    v_mul_f32 v68, s87, v68
    v_sub_f32 v128, v128, v68
    v_sub_f32 v129, v129, v68
    v_sub_f32 v130, v130, v68
    v_sub_f32 v131, v131, v68
    v_sub_f32 v132, v132, v68
    v_sub_f32 v133, v133, v68
    v_sub_f32 v134, v134, v68
    v_sub_f32 v135, v135, v68
    v_sub_f32 v136, v136, v68
    v_sub_f32 v137, v137, v68
    v_sub_f32 v138, v138, v68
    v_sub_f32 v139, v139, v68
    v_sub_f32 v140, v140, v68
    v_sub_f32 v141, v141, v68
    v_sub_f32 v142, v142, v68
    v_sub_f32 v143, v143, v68
    v_sub_f32 v144, v144, v68
    v_sub_f32 v145, v145, v68
    v_sub_f32 v146, v146, v68
    v_sub_f32 v147, v147, v68
    v_sub_f32 v148, v148, v68
    v_sub_f32 v149, v149, v68
    v_sub_f32 v150, v150, v68
    v_sub_f32 v151, v151, v68
    v_sub_f32 v152, v152, v68
    v_sub_f32 v153, v153, v68
    v_sub_f32 v154, v154, v68
    v_sub_f32 v155, v155, v68
    v_sub_f32 v156, v156, v68
    v_sub_f32 v157, v157, v68
    v_sub_f32 v158, v158, v68
    v_sub_f32 v159, v159, v68
    v_sub_f32 v160, v160, v68
    v_sub_f32 v161, v161, v68
    v_sub_f32 v162, v162, v68
    v_sub_f32 v163, v163, v68
    v_sub_f32 v164, v164, v68
    v_sub_f32 v165, v165, v68
    v_sub_f32 v166, v166, v68
    v_sub_f32 v167, v167, v68
    v_sub_f32 v168, v168, v68
    v_sub_f32 v169, v169, v68
    v_sub_f32 v170, v170, v68
    v_sub_f32 v171, v171, v68
    v_sub_f32 v172, v172, v68
    v_sub_f32 v173, v173, v68
    v_sub_f32 v174, v174, v68
    v_sub_f32 v175, v175, v68
    v_sub_f32 v176, v176, v68
    v_sub_f32 v177, v177, v68
    v_sub_f32 v178, v178, v68
    v_sub_f32 v179, v179, v68
    v_sub_f32 v180, v180, v68
    v_sub_f32 v181, v181, v68
    v_sub_f32 v182, v182, v68
    v_sub_f32 v183, v183, v68
    v_sub_f32 v184, v184, v68
    v_sub_f32 v185, v185, v68
    v_sub_f32 v186, v186, v68
    v_sub_f32 v187, v187, v68
    v_sub_f32 v188, v188, v68
    v_sub_f32 v189, v189, v68
    v_sub_f32 v190, v190, v68
    v_sub_f32 v191, v191, v68
    v_sub_f32 v192, v192, v68
    v_sub_f32 v193, v193, v68
    v_sub_f32 v194, v194, v68
    v_sub_f32 v195, v195, v68
    v_sub_f32 v196, v196, v68
    v_sub_f32 v197, v197, v68
    v_sub_f32 v198, v198, v68
    v_sub_f32 v199, v199, v68
    v_mul_f32 v72, v128, v128
    v_mul_f32 v73, v129, v129
    v_mul_f32 v74, v130, v130
    v_mul_f32 v75, v131, v131
    v_fmac_f32 v72, v132, v132
    v_fmac_f32 v73, v133, v133
    v_fmac_f32 v74, v134, v134
    v_fmac_f32 v75, v135, v135
    v_fmac_f32 v72, v136, v136
    v_fmac_f32 v73, v137, v137
    v_fmac_f32 v74, v138, v138
    v_fmac_f32 v75, v139, v139
    v_fmac_f32 v72, v140, v140
    v_fmac_f32 v73, v141, v141
    v_fmac_f32 v74, v142, v142
    v_fmac_f32 v75, v143, v143
    v_fmac_f32 v72, v144, v144
    v_fmac_f32 v73, v145, v145
    v_fmac_f32 v74, v146, v146
    v_fmac_f32 v75, v147, v147
    v_fmac_f32 v72, v148, v148
    v_fmac_f32 v73, v149, v149
    v_fmac_f32 v74, v150, v150
    v_fmac_f32 v75, v151, v151
    v_fmac_f32 v72, v152, v152
    v_fmac_f32 v73, v153, v153
    v_fmac_f32 v74, v154, v154
    v_fmac_f32 v75, v155, v155
    v_fmac_f32 v72, v156, v156
    v_fmac_f32 v73, v157, v157
    v_fmac_f32 v74, v158, v158
    v_fmac_f32 v75, v159, v159
    v_fmac_f32 v72, v160, v160
    v_fmac_f32 v73, v161, v161
    v_fmac_f32 v74, v162, v162
    v_fmac_f32 v75, v163, v163
    v_fmac_f32 v72, v164, v164
    v_fmac_f32 v73, v165, v165
    v_fmac_f32 v74, v166, v166
    v_fmac_f32 v75, v167, v167
    v_fmac_f32 v72, v168, v168
    v_fmac_f32 v73, v169, v169
    v_fmac_f32 v74, v170, v170
    v_fmac_f32 v75, v171, v171
    v_fmac_f32 v72, v172, v172
    v_fmac_f32 v73, v173, v173
    v_fmac_f32 v74, v174, v174
    v_fmac_f32 v75, v175, v175
    v_fmac_f32 v72, v176, v176
    v_fmac_f32 v73, v177, v177
    v_fmac_f32 v74, v178, v178
    v_fmac_f32 v75, v179, v179
    v_fmac_f32 v72, v180, v180
    v_fmac_f32 v73, v181, v181
    v_fmac_f32 v74, v182, v182
    v_fmac_f32 v75, v183, v183
    v_fmac_f32 v72, v184, v184
    v_fmac_f32 v73, v185, v185
    v_fmac_f32 v74, v186, v186
    v_fmac_f32 v75, v187, v187
    v_fmac_f32 v72, v188, v188
    v_fmac_f32 v73, v189, v189
    v_fmac_f32 v74, v190, v190
    v_fmac_f32 v75, v191, v191
    v_fmac_f32 v72, v192, v192
    v_fmac_f32 v73, v193, v193
    v_fmac_f32 v74, v194, v194
    v_fmac_f32 v75, v195, v195
    v_fmac_f32 v72, v196, v196
    v_fmac_f32 v73, v197, v197
    v_fmac_f32 v74, v198, v198
    v_fmac_f32 v75, v199, v199
    v_add_f32 v72, v72, v73
    v_add_f32 v74, v74, v75
    v_add_f32 v72, v72, v74
    s_nop 1
    v_add_f32_dpp v72, v72, v72 quad_perm:[1,0,3,2] row_mask:0xf bank_mask:0xf
    s_nop 1
    v_add_f32_dpp v72, v72, v72 quad_perm:[2,3,0,1] row_mask:0xf bank_mask:0xf
    s_nop 1
    v_add_f32_dpp v72, v72, v72 row_half_mirror row_mask:0xf bank_mask:0xf
    v_mul_f32 v72, s87, v72
    v_add_f32 v72, 0x3727c5ac, v72
    v_rsq_f32 v72, v72
    s_nop 0
    v_mul_f32 v128, v128, v72
    v_mul_f32 v129, v129, v72
    v_cvt_pk_bf16_f32 v32, v128, v129
    v_mul_f32 v130, v130, v72
    v_mul_f32 v131, v131, v72
    v_cvt_pk_bf16_f32 v33, v130, v131
    v_mul_f32 v132, v132, v72
    v_mul_f32 v133, v133, v72
    v_cvt_pk_bf16_f32 v34, v132, v133
    v_mul_f32 v134, v134, v72
    v_mul_f32 v135, v135, v72
    v_cvt_pk_bf16_f32 v35, v134, v135
    v_mul_f32 v136, v136, v72
    v_mul_f32 v137, v137, v72
    v_cvt_pk_bf16_f32 v36, v136, v137
    v_mul_f32 v138, v138, v72
    v_mul_f32 v139, v139, v72
    v_cvt_pk_bf16_f32 v37, v138, v139
    v_mul_f32 v140, v140, v72
    v_mul_f32 v141, v141, v72
    v_cvt_pk_bf16_f32 v38, v140, v141
    v_mul_f32 v142, v142, v72
    v_mul_f32 v143, v143, v72
    v_cvt_pk_bf16_f32 v39, v142, v143
    v_mul_f32 v144, v144, v72
    v_mul_f32 v145, v145, v72
    v_cvt_pk_bf16_f32 v40, v144, v145
    v_mul_f32 v146, v146, v72
    v_mul_f32 v147, v147, v72
    v_cvt_pk_bf16_f32 v41, v146, v147
    v_mul_f32 v148, v148, v72
    v_mul_f32 v149, v149, v72
    v_cvt_pk_bf16_f32 v42, v148, v149
    v_mul_f32 v150, v150, v72
    v_mul_f32 v151, v151, v72
    v_cvt_pk_bf16_f32 v43, v150, v151
    v_mul_f32 v152, v152, v72
    v_mul_f32 v153, v153, v72
    v_cvt_pk_bf16_f32 v44, v152, v153
    v_mul_f32 v154, v154, v72
    v_mul_f32 v155, v155, v72
    v_cvt_pk_bf16_f32 v45, v154, v155
    v_mul_f32 v156, v156, v72
    v_mul_f32 v157, v157, v72
    v_cvt_pk_bf16_f32 v46, v156, v157
    v_mul_f32 v158, v158, v72
    v_mul_f32 v159, v159, v72
    v_cvt_pk_bf16_f32 v47, v158, v159
    v_mul_f32 v160, v160, v72
    v_mul_f32 v161, v161, v72
    v_cvt_pk_bf16_f32 v48, v160, v161
    v_mul_f32 v162, v162, v72
    v_mul_f32 v163, v163, v72
    v_cvt_pk_bf16_f32 v49, v162, v163
    v_mul_f32 v164, v164, v72
    v_mul_f32 v165, v165, v72
    v_cvt_pk_bf16_f32 v50, v164, v165
    v_mul_f32 v166, v166, v72
    v_mul_f32 v167, v167, v72
    v_cvt_pk_bf16_f32 v51, v166, v167
    v_mul_f32 v168, v168, v72
    v_mul_f32 v169, v169, v72
    v_cvt_pk_bf16_f32 v52, v168, v169
    v_mul_f32 v170, v170, v72
    v_mul_f32 v171, v171, v72
    v_cvt_pk_bf16_f32 v53, v170, v171
    v_mul_f32 v172, v172, v72
    v_mul_f32 v173, v173, v72
    v_cvt_pk_bf16_f32 v54, v172, v173
    v_mul_f32 v174, v174, v72
    v_mul_f32 v175, v175, v72
    v_cvt_pk_bf16_f32 v55, v174, v175
    v_mul_f32 v176, v176, v72
    v_mul_f32 v177, v177, v72
    v_cvt_pk_bf16_f32 v56, v176, v177
    v_mul_f32 v178, v178, v72
    v_mul_f32 v179, v179, v72
    v_cvt_pk_bf16_f32 v57, v178, v179
    v_mul_f32 v180, v180, v72
    v_mul_f32 v181, v181, v72
    v_cvt_pk_bf16_f32 v58, v180, v181
    v_mul_f32 v182, v182, v72
    v_mul_f32 v183, v183, v72
    v_cvt_pk_bf16_f32 v59, v182, v183
    v_mul_f32 v184, v184, v72
    v_mul_f32 v185, v185, v72
    v_cvt_pk_bf16_f32 v60, v184, v185
    v_mul_f32 v186, v186, v72
    v_mul_f32 v187, v187, v72
    v_cvt_pk_bf16_f32 v61, v186, v187
    v_mul_f32 v188, v188, v72
    v_mul_f32 v189, v189, v72
    v_cvt_pk_bf16_f32 v62, v188, v189
    v_mul_f32 v190, v190, v72
    v_mul_f32 v191, v191, v72
    v_cvt_pk_bf16_f32 v63, v190, v191
    v_mul_f32 v192, v192, v72
    v_mul_f32 v193, v193, v72
    v_cvt_pk_bf16_f32 v64, v192, v193
    v_mul_f32 v194, v194, v72
    v_mul_f32 v195, v195, v72
    v_cvt_pk_bf16_f32 v65, v194, v195
    v_mul_f32 v196, v196, v72
    v_mul_f32 v197, v197, v72
    v_cvt_pk_bf16_f32 v66, v196, v197
    v_mul_f32 v198, v198, v72
    v_mul_f32 v199, v199, v72
    v_cvt_pk_bf16_f32 v67, v198, v199
    v_lshrrev_b32 v8, 1, v3
    v_and_b32 v8, 7, v8
    v_xor_b32 v8, v8, v2
    v_lshlrev_b32 v8, 4, v8
    v_lshlrev_b32 v9, 7, v3
    v_add_u32 v8, v8, v9
    v_add_u32 v9, 40960, v8
    ds_write_b128 v8, v[32:35] offset:0
    ds_write_b128 v8, v[36:39] offset:8192
    ds_write_b128 v8, v[40:43] offset:16384
    ds_write_b128 v8, v[44:47] offset:24576
    ds_write_b128 v8, v[48:51] offset:32768
    ds_write_b128 v9, v[52:55] offset:0
    ds_write_b128 v9, v[56:59] offset:8192
    ds_write_b128 v9, v[60:63] offset:16384
    ds_write_b128 v9, v[64:67] offset:24576
    s_waitcnt lgkmcnt(0)
    s_cmp_lt_u32 s60, 4
    s_cbranch_scc1 a1_kernel_comp
    s_cmp_eq_u32 s73, 1
    s_cbranch_scc1 a1_kernel_lq2
    s_waitcnt vmcnt(9)
    s_barrier
    s_mov_b32 s67, 0
a1_kernel_k_lloop:
    s_waitcnt vmcnt(0)
    s_barrier
    s_add_u32 m0, s65, 73728
    s_nop 0
    buffer_load_dwordx4 v10, s[44:47], s63 offen lds
    s_add_u32 m0, s65, 77824
    s_nop 0
    buffer_load_dwordx4 v11, s[44:47], s63 offen lds
    s_add_u32 m0, s65, 81920
    s_nop 0
    buffer_load_dwordx4 v12, s[44:47], s63 offen lds
    s_add_u32 m0, s65, 86016
    s_nop 0
    buffer_load_dwordx4 v13, s[44:47], s63 offen lds
    s_add_u32 m0, s65, 90112
    s_nop 0
    buffer_load_dwordx4 v14, s[44:47], s63 offen lds
    s_add_u32 m0, s65, 94208
    s_nop 0
    buffer_load_dwordx4 v15, s[44:47], s63 offen lds
    s_add_u32 m0, s65, 98304
    s_nop 0
    buffer_load_dwordx4 v16, s[44:47], s63 offen lds
    s_add_u32 m0, s65, 102400
    s_nop 0
    buffer_load_dwordx4 v17, s[44:47], s63 offen lds
    s_add_u32 m0, s65, 106496
    s_nop 0
    buffer_load_dwordx4 v18, s[44:47], s63 offen lds
    s_add_u32 s63, s63, 221184
    s_add_u32 s65, s65, 36864
    s_cmp_ge_u32 s65, 73728
    s_cselect_b32 s68, 73728, 0
    s_sub_u32 s65, s65, s68
    s_add_u32 s67, s67, 1
    s_cmp_lt_u32 s67, 9
    s_cbranch_scc1 a1_kernel_k_lloop
    s_waitcnt vmcnt(0)
    s_barrier
    s_branch a1_kernel_epi
a1_kernel_lq2:
    s_waitcnt vmcnt(10)
    s_barrier
    s_mov_b32 s67, 0
a1_kernel_q_lloop:
    s_waitcnt vmcnt(5)
    s_barrier
    s_add_u32 m0, s65, 73728
    s_nop 0
    buffer_load_dwordx4 v10, s[44:47], s63 offen lds
    s_add_u32 m0, s65, 77824
    s_nop 0
    buffer_load_dwordx4 v11, s[44:47], s63 offen lds
    s_add_u32 m0, s65, 81920
    s_nop 0
    buffer_load_dwordx4 v12, s[44:47], s63 offen lds
    s_add_u32 m0, s65, 86016
    s_nop 0
    buffer_load_dwordx4 v13, s[44:47], s63 offen lds
    s_add_u32 m0, s65, 90112
    s_nop 0
    buffer_load_dwordx4 v14, s[44:47], s63 offen lds
    s_add_u32 s63, s63, 221184
    s_add_u32 s65, s65, 20480
    s_cmp_ge_u32 s65, 61440
    s_cselect_b32 s68, 61440, 0
    s_sub_u32 s65, s65, s68
    s_add_u32 s67, s67, 1
    s_cmp_lt_u32 s67, 9
    s_cbranch_scc1 a1_kernel_q_lloop
    s_waitcnt vmcnt(0)
    s_barrier
    s_branch a1_kernel_epi
a1_kernel_comp:
    v_and_b32 v2, 15, v1
    v_lshlrev_b32 v2, 3, v2
    v_lshrrev_b32 v3, 4, v1
    v_lshrrev_b32 v4, 1, v1
    v_and_b32 v4, 7, v4
    v_xor_b32 v3, v3, v4
    v_add_u32 v2, v2, v3
    v_lshlrev_b32 v20, 4, v2
    v_xor_b32 v21, 64, v20
    v_lshrrev_b32 v2, 5, v1
    v_lshlrev_b32 v2, 4, v2
    v_lshrrev_b32 v3, 4, v1
    v_and_b32 v3, 1, v3
    v_lshlrev_b32 v3, 2, v3
    v_add_u32 v2, v2, v3
    v_lshrrev_b32 v3, 2, v1
    v_and_b32 v3, 3, v3
    v_add_u32 v2, v2, v3
    v_mul_u32_u24 v2, 288, v2
    v_and_b32 v3, 3, v1
    v_lshlrev_b32 v3, 3, v3
    v_add_u32 v26, v2, v3
    s_mov_b32 s72, 0
    s_cmp_eq_u32 s73, 1
    s_cbranch_scc1 a1_kernel_cq
    s_lshl_b32 s68, s70, 12
    v_add_u32 v20, s68, v20
    v_add_u32 v21, s68, v21
    s_mul_i32 s68, s71, 18432
    s_add_u32 s68, s68, 73728
    v_add_u32 v26, s68, v26
    v_mov_b32 v128, 0
    v_mov_b32 v129, 0
    v_mov_b32 v130, 0
    v_mov_b32 v131, 0
    v_mov_b32 v132, 0
    v_mov_b32 v133, 0
    v_mov_b32 v134, 0
    v_mov_b32 v135, 0
    v_mov_b32 v136, 0
    v_mov_b32 v137, 0
    v_mov_b32 v138, 0
    v_mov_b32 v139, 0
    v_mov_b32 v140, 0
    v_mov_b32 v141, 0
    v_mov_b32 v142, 0
    v_mov_b32 v143, 0
    v_mov_b32 v144, 0
    v_mov_b32 v145, 0
    v_mov_b32 v146, 0
    v_mov_b32 v147, 0
    v_mov_b32 v148, 0
    v_mov_b32 v149, 0
    v_mov_b32 v150, 0
    v_mov_b32 v151, 0
    v_mov_b32 v152, 0
    v_mov_b32 v153, 0
    v_mov_b32 v154, 0
    v_mov_b32 v155, 0
    v_mov_b32 v156, 0
    v_mov_b32 v157, 0
    v_mov_b32 v158, 0
    v_mov_b32 v159, 0
    v_mov_b32 v160, 0
    v_mov_b32 v161, 0
    v_mov_b32 v162, 0
    v_mov_b32 v163, 0
    v_mov_b32 v164, 0
    v_mov_b32 v165, 0
    v_mov_b32 v166, 0
    v_mov_b32 v167, 0
    v_mov_b32 v168, 0
    v_mov_b32 v169, 0
    v_mov_b32 v170, 0
    v_mov_b32 v171, 0
    v_mov_b32 v172, 0
    v_mov_b32 v173, 0
    v_mov_b32 v174, 0
    v_mov_b32 v175, 0
    v_mov_b32 v176, 0
    v_mov_b32 v177, 0
    v_mov_b32 v178, 0
    v_mov_b32 v179, 0
    v_mov_b32 v180, 0
    v_mov_b32 v181, 0
    v_mov_b32 v182, 0
    v_mov_b32 v183, 0
    v_mov_b32 v184, 0
    v_mov_b32 v185, 0
    v_mov_b32 v186, 0
    v_mov_b32 v187, 0
    v_mov_b32 v188, 0
    v_mov_b32 v189, 0
    v_mov_b32 v190, 0
    v_mov_b32 v191, 0
    v_mov_b32 v192, 0
    v_mov_b32 v193, 0
    v_mov_b32 v194, 0
    v_mov_b32 v195, 0
    v_mov_b32 v196, 0
    v_mov_b32 v197, 0
    v_mov_b32 v198, 0
    v_mov_b32 v199, 0
    s_cmp_eq_u32 s71, 1
    s_cbranch_scc1 a1_kernel_cv
    s_mov_b32 s66, 0
    v_add_u32 v22, s72, v20
    v_add_u32 v23, s72, v21
    v_add_u32 v28, s66, v26
    s_barrier
    ds_read_b128 v[32:35], v22 offset:0
    ds_read_b128 v[36:39], v22 offset:2048
    ds_read_b64_tr_b16 v[40:41], v28 offset:0
    ds_read_b64_tr_b16 v[42:43], v28 offset:2304
    ds_read_b64_tr_b16 v[44:45], v28 offset:32
    ds_read_b64_tr_b16 v[46:47], v28 offset:2336
    ds_read_b64_tr_b16 v[48:49], v28 offset:64
    ds_read_b64_tr_b16 v[50:51], v28 offset:2368
    ds_read_b64_tr_b16 v[52:53], v28 offset:96
    ds_read_b64_tr_b16 v[54:55], v28 offset:2400
    ds_read_b64_tr_b16 v[56:57], v28 offset:128
    ds_read_b64_tr_b16 v[58:59], v28 offset:2432
    ds_read_b64_tr_b16 v[60:61], v28 offset:160
    ds_read_b64_tr_b16 v[62:63], v28 offset:2464
    ds_read_b64_tr_b16 v[64:65], v28 offset:192
    ds_read_b64_tr_b16 v[66:67], v28 offset:2496
    ds_read_b64_tr_b16 v[68:69], v28 offset:224
    ds_read_b64_tr_b16 v[70:71], v28 offset:2528
    ds_read_b64_tr_b16 v[72:73], v28 offset:256
    ds_read_b64_tr_b16 v[74:75], v28 offset:2560
    s_mov_b32 s67, 0
a1_kernel_k_loop:
    s_waitcnt lgkmcnt(0)
    v_mfma_f32_16x16x32_bf16 v[128:131], v[40:43], v[32:35], v[128:131]
    ds_read_b128 v[76:79], v23 offset:0
    ds_read_b128 v[80:83], v23 offset:2048
    v_mfma_f32_16x16x32_bf16 v[132:135], v[40:43], v[36:39], v[132:135]
    ds_read_b64_tr_b16 v[84:85], v28 offset:9216
    ds_read_b64_tr_b16 v[86:87], v28 offset:11520
    v_mfma_f32_16x16x32_bf16 v[136:139], v[44:47], v[32:35], v[136:139]
    ds_read_b64_tr_b16 v[88:89], v28 offset:9248
    ds_read_b64_tr_b16 v[90:91], v28 offset:11552
    v_mfma_f32_16x16x32_bf16 v[140:143], v[44:47], v[36:39], v[140:143]
    ds_read_b64_tr_b16 v[92:93], v28 offset:9280
    ds_read_b64_tr_b16 v[94:95], v28 offset:11584
    v_mfma_f32_16x16x32_bf16 v[144:147], v[48:51], v[32:35], v[144:147]
    ds_read_b64_tr_b16 v[96:97], v28 offset:9312
    v_mfma_f32_16x16x32_bf16 v[148:151], v[48:51], v[36:39], v[148:151]
    ds_read_b64_tr_b16 v[98:99], v28 offset:11616
    v_mfma_f32_16x16x32_bf16 v[152:155], v[52:55], v[32:35], v[152:155]
    ds_read_b64_tr_b16 v[100:101], v28 offset:9344
    v_mfma_f32_16x16x32_bf16 v[156:159], v[52:55], v[36:39], v[156:159]
    ds_read_b64_tr_b16 v[102:103], v28 offset:11648
    v_mfma_f32_16x16x32_bf16 v[160:163], v[56:59], v[32:35], v[160:163]
    ds_read_b64_tr_b16 v[104:105], v28 offset:9376
    v_mfma_f32_16x16x32_bf16 v[164:167], v[56:59], v[36:39], v[164:167]
    ds_read_b64_tr_b16 v[106:107], v28 offset:11680
    v_mfma_f32_16x16x32_bf16 v[168:171], v[60:63], v[32:35], v[168:171]
    ds_read_b64_tr_b16 v[108:109], v28 offset:9408
    v_mfma_f32_16x16x32_bf16 v[172:175], v[60:63], v[36:39], v[172:175]
    ds_read_b64_tr_b16 v[110:111], v28 offset:11712
    v_mfma_f32_16x16x32_bf16 v[176:179], v[64:67], v[32:35], v[176:179]
    ds_read_b64_tr_b16 v[112:113], v28 offset:9440
    v_mfma_f32_16x16x32_bf16 v[180:183], v[64:67], v[36:39], v[180:183]
    ds_read_b64_tr_b16 v[114:115], v28 offset:11744
    v_mfma_f32_16x16x32_bf16 v[184:187], v[68:71], v[32:35], v[184:187]
    ds_read_b64_tr_b16 v[116:117], v28 offset:9472
    v_mfma_f32_16x16x32_bf16 v[188:191], v[68:71], v[36:39], v[188:191]
    ds_read_b64_tr_b16 v[118:119], v28 offset:11776
    v_mfma_f32_16x16x32_bf16 v[192:195], v[72:75], v[32:35], v[192:195]
    v_mfma_f32_16x16x32_bf16 v[196:199], v[72:75], v[36:39], v[196:199]
    s_add_u32 s66, s66, 36864
    s_cmp_ge_u32 s66, 73728
    s_cselect_b32 s68, 73728, 0
    s_sub_u32 s66, s66, s68
    s_add_u32 s72, s72, 8192
    s_waitcnt lgkmcnt(0)
    v_add_u32 v22, s72, v20
    v_add_u32 v23, s72, v21
    v_add_u32 v28, s66, v26
    s_barrier
    ds_read_b128 v[32:35], v22 offset:0
    ds_read_b128 v[36:39], v22 offset:2048
    v_mfma_f32_16x16x32_bf16 v[128:131], v[84:87], v[76:79], v[128:131]
    ds_read_b64_tr_b16 v[40:41], v28 offset:0
    ds_read_b64_tr_b16 v[42:43], v28 offset:2304
    v_mfma_f32_16x16x32_bf16 v[132:135], v[84:87], v[80:83], v[132:135]
    ds_read_b64_tr_b16 v[44:45], v28 offset:32
    ds_read_b64_tr_b16 v[46:47], v28 offset:2336
    v_mfma_f32_16x16x32_bf16 v[136:139], v[88:91], v[76:79], v[136:139]
    ds_read_b64_tr_b16 v[48:49], v28 offset:64
    ds_read_b64_tr_b16 v[50:51], v28 offset:2368
    v_mfma_f32_16x16x32_bf16 v[140:143], v[88:91], v[80:83], v[140:143]
    ds_read_b64_tr_b16 v[52:53], v28 offset:96
    ds_read_b64_tr_b16 v[54:55], v28 offset:2400
    v_mfma_f32_16x16x32_bf16 v[144:147], v[92:95], v[76:79], v[144:147]
    ds_read_b64_tr_b16 v[56:57], v28 offset:128
    ds_read_b64_tr_b16 v[58:59], v28 offset:2432
    v_mfma_f32_16x16x32_bf16 v[148:151], v[92:95], v[80:83], v[148:151]
    ds_read_b64_tr_b16 v[60:61], v28 offset:160
    ds_read_b64_tr_b16 v[62:63], v28 offset:2464
    v_mfma_f32_16x16x32_bf16 v[152:155], v[96:99], v[76:79], v[152:155]
    ds_read_b64_tr_b16 v[64:65], v28 offset:192
    ds_read_b64_tr_b16 v[66:67], v28 offset:2496
    v_mfma_f32_16x16x32_bf16 v[156:159], v[96:99], v[80:83], v[156:159]
    ds_read_b64_tr_b16 v[68:69], v28 offset:224
    ds_read_b64_tr_b16 v[70:71], v28 offset:2528
    v_mfma_f32_16x16x32_bf16 v[160:163], v[100:103], v[76:79], v[160:163]
    ds_read_b64_tr_b16 v[72:73], v28 offset:256
    ds_read_b64_tr_b16 v[74:75], v28 offset:2560
    v_mfma_f32_16x16x32_bf16 v[164:167], v[100:103], v[80:83], v[164:167]
    v_mfma_f32_16x16x32_bf16 v[168:171], v[104:107], v[76:79], v[168:171]
    v_mfma_f32_16x16x32_bf16 v[172:175], v[104:107], v[80:83], v[172:175]
    v_mfma_f32_16x16x32_bf16 v[176:179], v[108:111], v[76:79], v[176:179]
    v_mfma_f32_16x16x32_bf16 v[180:183], v[108:111], v[80:83], v[180:183]
    v_mfma_f32_16x16x32_bf16 v[184:187], v[112:115], v[76:79], v[184:187]
    v_mfma_f32_16x16x32_bf16 v[188:191], v[112:115], v[80:83], v[188:191]
    v_mfma_f32_16x16x32_bf16 v[192:195], v[116:119], v[76:79], v[192:195]
    v_mfma_f32_16x16x32_bf16 v[196:199], v[116:119], v[80:83], v[196:199]
    s_add_u32 s67, s67, 1
    s_cmp_lt_u32 s67, 9
    s_cbranch_scc1 a1_kernel_k_loop
    s_waitcnt lgkmcnt(0)
    s_barrier
    s_branch a1_kernel_epi
a1_kernel_cv:
    s_mov_b32 s66, 0
    v_add_u32 v22, s72, v20
    v_add_u32 v23, s72, v21
    v_add_u32 v28, s66, v26
    s_barrier
    ds_read_b128 v[32:35], v22 offset:0
    ds_read_b128 v[36:39], v22 offset:2048
    ds_read_b64_tr_b16 v[40:41], v28 offset:0
    ds_read_b64_tr_b16 v[42:43], v28 offset:2304
    ds_read_b64_tr_b16 v[44:45], v28 offset:32
    ds_read_b64_tr_b16 v[46:47], v28 offset:2336
    ds_read_b64_tr_b16 v[48:49], v28 offset:64
    ds_read_b64_tr_b16 v[50:51], v28 offset:2368
    ds_read_b64_tr_b16 v[52:53], v28 offset:96
    ds_read_b64_tr_b16 v[54:55], v28 offset:2400
    ds_read_b64_tr_b16 v[56:57], v28 offset:128
    ds_read_b64_tr_b16 v[58:59], v28 offset:2432
    ds_read_b64_tr_b16 v[60:61], v28 offset:160
    ds_read_b64_tr_b16 v[62:63], v28 offset:2464
    ds_read_b64_tr_b16 v[64:65], v28 offset:192
    ds_read_b64_tr_b16 v[66:67], v28 offset:2496
    ds_read_b64_tr_b16 v[68:69], v28 offset:224
    ds_read_b64_tr_b16 v[70:71], v28 offset:2528
    ds_read_b64_tr_b16 v[72:73], v28 offset:256
    ds_read_b64_tr_b16 v[74:75], v28 offset:2560
    s_mov_b32 s67, 0
a1_kernel_v_loop:
    s_waitcnt lgkmcnt(0)
    v_mfma_f32_16x16x32_bf16 v[128:131], v[32:35], v[40:43], v[128:131]
    ds_read_b128 v[76:79], v23 offset:0
    ds_read_b128 v[80:83], v23 offset:2048
    v_mfma_f32_16x16x32_bf16 v[132:135], v[36:39], v[40:43], v[132:135]
    ds_read_b64_tr_b16 v[84:85], v28 offset:9216
    ds_read_b64_tr_b16 v[86:87], v28 offset:11520
    v_mfma_f32_16x16x32_bf16 v[136:139], v[32:35], v[44:47], v[136:139]
    ds_read_b64_tr_b16 v[88:89], v28 offset:9248
    ds_read_b64_tr_b16 v[90:91], v28 offset:11552
    v_mfma_f32_16x16x32_bf16 v[140:143], v[36:39], v[44:47], v[140:143]
    ds_read_b64_tr_b16 v[92:93], v28 offset:9280
    ds_read_b64_tr_b16 v[94:95], v28 offset:11584
    v_mfma_f32_16x16x32_bf16 v[144:147], v[32:35], v[48:51], v[144:147]
    ds_read_b64_tr_b16 v[96:97], v28 offset:9312
    v_mfma_f32_16x16x32_bf16 v[148:151], v[36:39], v[48:51], v[148:151]
    ds_read_b64_tr_b16 v[98:99], v28 offset:11616
    v_mfma_f32_16x16x32_bf16 v[152:155], v[32:35], v[52:55], v[152:155]
    ds_read_b64_tr_b16 v[100:101], v28 offset:9344
    v_mfma_f32_16x16x32_bf16 v[156:159], v[36:39], v[52:55], v[156:159]
    ds_read_b64_tr_b16 v[102:103], v28 offset:11648
    v_mfma_f32_16x16x32_bf16 v[160:163], v[32:35], v[56:59], v[160:163]
    ds_read_b64_tr_b16 v[104:105], v28 offset:9376
    v_mfma_f32_16x16x32_bf16 v[164:167], v[36:39], v[56:59], v[164:167]
    ds_read_b64_tr_b16 v[106:107], v28 offset:11680
    v_mfma_f32_16x16x32_bf16 v[168:171], v[32:35], v[60:63], v[168:171]
    ds_read_b64_tr_b16 v[108:109], v28 offset:9408
    v_mfma_f32_16x16x32_bf16 v[172:175], v[36:39], v[60:63], v[172:175]
    ds_read_b64_tr_b16 v[110:111], v28 offset:11712
    v_mfma_f32_16x16x32_bf16 v[176:179], v[32:35], v[64:67], v[176:179]
    ds_read_b64_tr_b16 v[112:113], v28 offset:9440
    v_mfma_f32_16x16x32_bf16 v[180:183], v[36:39], v[64:67], v[180:183]
    ds_read_b64_tr_b16 v[114:115], v28 offset:11744
    v_mfma_f32_16x16x32_bf16 v[184:187], v[32:35], v[68:71], v[184:187]
    ds_read_b64_tr_b16 v[116:117], v28 offset:9472
    v_mfma_f32_16x16x32_bf16 v[188:191], v[36:39], v[68:71], v[188:191]
    ds_read_b64_tr_b16 v[118:119], v28 offset:11776
    v_mfma_f32_16x16x32_bf16 v[192:195], v[32:35], v[72:75], v[192:195]
    v_mfma_f32_16x16x32_bf16 v[196:199], v[36:39], v[72:75], v[196:199]
    s_add_u32 s66, s66, 36864
    s_cmp_ge_u32 s66, 73728
    s_cselect_b32 s68, 73728, 0
    s_sub_u32 s66, s66, s68
    s_add_u32 s72, s72, 8192
    s_waitcnt lgkmcnt(0)
    v_add_u32 v22, s72, v20
    v_add_u32 v23, s72, v21
    v_add_u32 v28, s66, v26
    s_barrier
    ds_read_b128 v[32:35], v22 offset:0
    ds_read_b128 v[36:39], v22 offset:2048
    v_mfma_f32_16x16x32_bf16 v[128:131], v[76:79], v[84:87], v[128:131]
    ds_read_b64_tr_b16 v[40:41], v28 offset:0
    ds_read_b64_tr_b16 v[42:43], v28 offset:2304
    v_mfma_f32_16x16x32_bf16 v[132:135], v[80:83], v[84:87], v[132:135]
    ds_read_b64_tr_b16 v[44:45], v28 offset:32
    ds_read_b64_tr_b16 v[46:47], v28 offset:2336
    v_mfma_f32_16x16x32_bf16 v[136:139], v[76:79], v[88:91], v[136:139]
    ds_read_b64_tr_b16 v[48:49], v28 offset:64
    ds_read_b64_tr_b16 v[50:51], v28 offset:2368
    v_mfma_f32_16x16x32_bf16 v[140:143], v[80:83], v[88:91], v[140:143]
    ds_read_b64_tr_b16 v[52:53], v28 offset:96
    ds_read_b64_tr_b16 v[54:55], v28 offset:2400
    v_mfma_f32_16x16x32_bf16 v[144:147], v[76:79], v[92:95], v[144:147]
    ds_read_b64_tr_b16 v[56:57], v28 offset:128
    ds_read_b64_tr_b16 v[58:59], v28 offset:2432
    v_mfma_f32_16x16x32_bf16 v[148:151], v[80:83], v[92:95], v[148:151]
    ds_read_b64_tr_b16 v[60:61], v28 offset:160
    ds_read_b64_tr_b16 v[62:63], v28 offset:2464
    v_mfma_f32_16x16x32_bf16 v[152:155], v[76:79], v[96:99], v[152:155]
    ds_read_b64_tr_b16 v[64:65], v28 offset:192
    ds_read_b64_tr_b16 v[66:67], v28 offset:2496
    v_mfma_f32_16x16x32_bf16 v[156:159], v[80:83], v[96:99], v[156:159]
    ds_read_b64_tr_b16 v[68:69], v28 offset:224
    ds_read_b64_tr_b16 v[70:71], v28 offset:2528
    v_mfma_f32_16x16x32_bf16 v[160:163], v[76:79], v[100:103], v[160:163]
    ds_read_b64_tr_b16 v[72:73], v28 offset:256
    ds_read_b64_tr_b16 v[74:75], v28 offset:2560
    v_mfma_f32_16x16x32_bf16 v[164:167], v[80:83], v[100:103], v[164:167]
    v_mfma_f32_16x16x32_bf16 v[168:171], v[76:79], v[104:107], v[168:171]
    v_mfma_f32_16x16x32_bf16 v[172:175], v[80:83], v[104:107], v[172:175]
    v_mfma_f32_16x16x32_bf16 v[176:179], v[76:79], v[108:111], v[176:179]
    v_mfma_f32_16x16x32_bf16 v[180:183], v[80:83], v[108:111], v[180:183]
    v_mfma_f32_16x16x32_bf16 v[184:187], v[76:79], v[112:115], v[184:187]
    v_mfma_f32_16x16x32_bf16 v[188:191], v[80:83], v[112:115], v[188:191]
    v_mfma_f32_16x16x32_bf16 v[192:195], v[76:79], v[116:119], v[192:195]
    v_mfma_f32_16x16x32_bf16 v[196:199], v[80:83], v[116:119], v[196:199]
    s_add_u32 s67, s67, 1
    s_cmp_lt_u32 s67, 9
    s_cbranch_scc1 a1_kernel_v_loop
    s_waitcnt lgkmcnt(0)
    s_barrier
    s_branch a1_kernel_epi
a1_kernel_cq:
    s_lshl_b32 s68, s60, 11
    v_add_u32 v20, s68, v20
    v_add_u32 v21, s68, v21
    v_add_u32 v26, 73728, v26
    v_mov_b32 v128, 0
    v_mov_b32 v129, 0
    v_mov_b32 v130, 0
    v_mov_b32 v131, 0
    v_mov_b32 v132, 0
    v_mov_b32 v133, 0
    v_mov_b32 v134, 0
    v_mov_b32 v135, 0
    v_mov_b32 v136, 0
    v_mov_b32 v137, 0
    v_mov_b32 v138, 0
    v_mov_b32 v139, 0
    v_mov_b32 v140, 0
    v_mov_b32 v141, 0
    v_mov_b32 v142, 0
    v_mov_b32 v143, 0
    v_mov_b32 v144, 0
    v_mov_b32 v145, 0
    v_mov_b32 v146, 0
    v_mov_b32 v147, 0
    v_mov_b32 v148, 0
    v_mov_b32 v149, 0
    v_mov_b32 v150, 0
    v_mov_b32 v151, 0
    v_mov_b32 v152, 0
    v_mov_b32 v153, 0
    v_mov_b32 v154, 0
    v_mov_b32 v155, 0
    v_mov_b32 v156, 0
    v_mov_b32 v157, 0
    v_mov_b32 v158, 0
    v_mov_b32 v159, 0
    v_mov_b32 v160, 0
    v_mov_b32 v161, 0
    v_mov_b32 v162, 0
    v_mov_b32 v163, 0
    s_mov_b32 s66, 0
    v_add_u32 v22, s72, v20
    v_add_u32 v23, s72, v21
    v_add_u32 v28, s66, v26
    s_barrier
    ds_read_b128 v[32:35], v22 offset:0
    ds_read_b64_tr_b16 v[36:37], v28 offset:0
    ds_read_b64_tr_b16 v[38:39], v28 offset:2304
    ds_read_b64_tr_b16 v[40:41], v28 offset:32
    ds_read_b64_tr_b16 v[42:43], v28 offset:2336
    ds_read_b64_tr_b16 v[44:45], v28 offset:64
    ds_read_b64_tr_b16 v[46:47], v28 offset:2368
    ds_read_b64_tr_b16 v[48:49], v28 offset:96
    ds_read_b64_tr_b16 v[50:51], v28 offset:2400
    ds_read_b64_tr_b16 v[52:53], v28 offset:128
    ds_read_b64_tr_b16 v[54:55], v28 offset:2432
    ds_read_b64_tr_b16 v[56:57], v28 offset:160
    ds_read_b64_tr_b16 v[58:59], v28 offset:2464
    ds_read_b64_tr_b16 v[60:61], v28 offset:192
    ds_read_b64_tr_b16 v[62:63], v28 offset:2496
    ds_read_b64_tr_b16 v[64:65], v28 offset:224
    ds_read_b64_tr_b16 v[66:67], v28 offset:2528
    ds_read_b64_tr_b16 v[68:69], v28 offset:256
    ds_read_b64_tr_b16 v[70:71], v28 offset:2560
    s_mov_b32 s67, 0
a1_kernel_q_loop:
    s_waitcnt lgkmcnt(0)
    v_mfma_f32_16x16x32_bf16 v[128:131], v[36:39], v[32:35], v[128:131]
    ds_read_b128 v[76:79], v23 offset:0
    ds_read_b64_tr_b16 v[80:81], v28 offset:9216
    v_mfma_f32_16x16x32_bf16 v[132:135], v[40:43], v[32:35], v[132:135]
    ds_read_b64_tr_b16 v[82:83], v28 offset:11520
    ds_read_b64_tr_b16 v[84:85], v28 offset:9248
    v_mfma_f32_16x16x32_bf16 v[136:139], v[44:47], v[32:35], v[136:139]
    ds_read_b64_tr_b16 v[86:87], v28 offset:11552
    ds_read_b64_tr_b16 v[88:89], v28 offset:9280
    v_mfma_f32_16x16x32_bf16 v[140:143], v[48:51], v[32:35], v[140:143]
    ds_read_b64_tr_b16 v[90:91], v28 offset:11584
    ds_read_b64_tr_b16 v[92:93], v28 offset:9312
    v_mfma_f32_16x16x32_bf16 v[144:147], v[52:55], v[32:35], v[144:147]
    ds_read_b64_tr_b16 v[94:95], v28 offset:11616
    ds_read_b64_tr_b16 v[96:97], v28 offset:9344
    v_mfma_f32_16x16x32_bf16 v[148:151], v[56:59], v[32:35], v[148:151]
    ds_read_b64_tr_b16 v[98:99], v28 offset:11648
    ds_read_b64_tr_b16 v[100:101], v28 offset:9376
    v_mfma_f32_16x16x32_bf16 v[152:155], v[60:63], v[32:35], v[152:155]
    ds_read_b64_tr_b16 v[102:103], v28 offset:11680
    ds_read_b64_tr_b16 v[104:105], v28 offset:9408
    v_mfma_f32_16x16x32_bf16 v[156:159], v[64:67], v[32:35], v[156:159]
    ds_read_b64_tr_b16 v[106:107], v28 offset:11712
    ds_read_b64_tr_b16 v[108:109], v28 offset:9440
    v_mfma_f32_16x16x32_bf16 v[160:163], v[68:71], v[32:35], v[160:163]
    ds_read_b64_tr_b16 v[110:111], v28 offset:11744
    ds_read_b64_tr_b16 v[112:113], v28 offset:9472
    ds_read_b64_tr_b16 v[114:115], v28 offset:11776
    s_add_u32 s66, s66, 20480
    s_cmp_ge_u32 s66, 61440
    s_cselect_b32 s68, 61440, 0
    s_sub_u32 s66, s66, s68
    s_add_u32 s72, s72, 8192
    s_waitcnt lgkmcnt(0)
    v_add_u32 v22, s72, v20
    v_add_u32 v23, s72, v21
    v_add_u32 v28, s66, v26
    s_barrier
    ds_read_b128 v[32:35], v22 offset:0
    ds_read_b64_tr_b16 v[36:37], v28 offset:0
    v_mfma_f32_16x16x32_bf16 v[128:131], v[80:83], v[76:79], v[128:131]
    ds_read_b64_tr_b16 v[38:39], v28 offset:2304
    ds_read_b64_tr_b16 v[40:41], v28 offset:32
    v_mfma_f32_16x16x32_bf16 v[132:135], v[84:87], v[76:79], v[132:135]
    ds_read_b64_tr_b16 v[42:43], v28 offset:2336
    ds_read_b64_tr_b16 v[44:45], v28 offset:64
    v_mfma_f32_16x16x32_bf16 v[136:139], v[88:91], v[76:79], v[136:139]
    ds_read_b64_tr_b16 v[46:47], v28 offset:2368
    ds_read_b64_tr_b16 v[48:49], v28 offset:96
    v_mfma_f32_16x16x32_bf16 v[140:143], v[92:95], v[76:79], v[140:143]
    ds_read_b64_tr_b16 v[50:51], v28 offset:2400
    ds_read_b64_tr_b16 v[52:53], v28 offset:128
    v_mfma_f32_16x16x32_bf16 v[144:147], v[96:99], v[76:79], v[144:147]
    ds_read_b64_tr_b16 v[54:55], v28 offset:2432
    ds_read_b64_tr_b16 v[56:57], v28 offset:160
    v_mfma_f32_16x16x32_bf16 v[148:151], v[100:103], v[76:79], v[148:151]
    ds_read_b64_tr_b16 v[58:59], v28 offset:2464
    ds_read_b64_tr_b16 v[60:61], v28 offset:192
    v_mfma_f32_16x16x32_bf16 v[152:155], v[104:107], v[76:79], v[152:155]
    ds_read_b64_tr_b16 v[62:63], v28 offset:2496
    ds_read_b64_tr_b16 v[64:65], v28 offset:224
    v_mfma_f32_16x16x32_bf16 v[156:159], v[108:111], v[76:79], v[156:159]
    ds_read_b64_tr_b16 v[66:67], v28 offset:2528
    ds_read_b64_tr_b16 v[68:69], v28 offset:256
    v_mfma_f32_16x16x32_bf16 v[160:163], v[112:115], v[76:79], v[160:163]
    ds_read_b64_tr_b16 v[70:71], v28 offset:2560
    s_add_u32 s67, s67, 1
    s_cmp_lt_u32 s67, 9
    s_cbranch_scc1 a1_kernel_q_loop
    s_waitcnt lgkmcnt(0)
    s_barrier
a1_kernel_epi:
    v_cmp_gt_u32 vcc, 144, v0
    s_and_saveexec_b64 s[80:81], vcc
    s_cbranch_execz a1_kernel_nww
    s_waitcnt vmcnt(0)
    v_lshlrev_b32 v32, 16, v216
    v_and_b32 v33, 0xffff0000, v216
    v_lshlrev_b32 v34, 16, v217
    v_and_b32 v35, 0xffff0000, v217
    v_lshlrev_b32 v36, 16, v218
    v_and_b32 v37, 0xffff0000, v218
    v_lshlrev_b32 v38, 16, v219
    v_and_b32 v39, 0xffff0000, v219
    v_lshlrev_b32 v40, 16, v220
    v_and_b32 v41, 0xffff0000, v220
    v_lshlrev_b32 v42, 16, v221
    v_and_b32 v43, 0xffff0000, v221
    v_lshlrev_b32 v44, 16, v222
    v_and_b32 v45, 0xffff0000, v222
    v_lshlrev_b32 v46, 16, v223
    v_and_b32 v47, 0xffff0000, v223
    v_lshlrev_b32 v48, 16, v224
    v_and_b32 v49, 0xffff0000, v224
    v_mul_u32_u24 v2, 80, v0
    ds_write_b128 v2, v[32:35] offset:20480
    ds_write_b128 v2, v[36:39] offset:20496
    ds_write_b128 v2, v[40:43] offset:20512
    ds_write_b128 v2, v[44:47] offset:20528
    ds_write_b64 v2, v[48:49] offset:20544
a1_kernel_nww:
    s_mov_b64 exec, s[80:81]
    s_cmp_ge_u32 s60, 4
    s_cbranch_scc1 a1_kernel_wdone
    v_and_b32 v2, 15, v1
    v_lshrrev_b32 v3, 4, v1
    v_lshlrev_b32 v3, 3, v3
    s_cmp_eq_u32 s73, 1
    s_cbranch_scc1 a1_kernel_qw
    s_cmp_eq_u32 s71, 1
    s_cbranch_scc1 a1_kernel_vw
    s_lshl_b32 s68, s70, 5
    v_add_u32 v2, s68, v2
    v_mul_u32_u24 v2, 304, v2
    v_add_u32 v2, v2, v3
    v_cvt_pk_bf16_f32 v128, v128, v129
    v_cvt_pk_bf16_f32 v129, v130, v131
    ds_write_b64 v2, v[128:129] offset:0
    v_cvt_pk_bf16_f32 v132, v132, v133
    v_cvt_pk_bf16_f32 v133, v134, v135
    ds_write_b64 v2, v[132:133] offset:4864
    v_cvt_pk_bf16_f32 v136, v136, v137
    v_cvt_pk_bf16_f32 v137, v138, v139
    ds_write_b64 v2, v[136:137] offset:32
    v_cvt_pk_bf16_f32 v140, v140, v141
    v_cvt_pk_bf16_f32 v141, v142, v143
    ds_write_b64 v2, v[140:141] offset:4896
    v_cvt_pk_bf16_f32 v144, v144, v145
    v_cvt_pk_bf16_f32 v145, v146, v147
    ds_write_b64 v2, v[144:145] offset:64
    v_cvt_pk_bf16_f32 v148, v148, v149
    v_cvt_pk_bf16_f32 v149, v150, v151
    ds_write_b64 v2, v[148:149] offset:4928
    v_cvt_pk_bf16_f32 v152, v152, v153
    v_cvt_pk_bf16_f32 v153, v154, v155
    ds_write_b64 v2, v[152:153] offset:96
    v_cvt_pk_bf16_f32 v156, v156, v157
    v_cvt_pk_bf16_f32 v157, v158, v159
    ds_write_b64 v2, v[156:157] offset:4960
    v_cvt_pk_bf16_f32 v160, v160, v161
    v_cvt_pk_bf16_f32 v161, v162, v163
    ds_write_b64 v2, v[160:161] offset:128
    v_cvt_pk_bf16_f32 v164, v164, v165
    v_cvt_pk_bf16_f32 v165, v166, v167
    ds_write_b64 v2, v[164:165] offset:4992
    v_cvt_pk_bf16_f32 v168, v168, v169
    v_cvt_pk_bf16_f32 v169, v170, v171
    ds_write_b64 v2, v[168:169] offset:160
    v_cvt_pk_bf16_f32 v172, v172, v173
    v_cvt_pk_bf16_f32 v173, v174, v175
    ds_write_b64 v2, v[172:173] offset:5024
    v_cvt_pk_bf16_f32 v176, v176, v177
    v_cvt_pk_bf16_f32 v177, v178, v179
    ds_write_b64 v2, v[176:177] offset:192
    v_cvt_pk_bf16_f32 v180, v180, v181
    v_cvt_pk_bf16_f32 v181, v182, v183
    ds_write_b64 v2, v[180:181] offset:5056
    v_cvt_pk_bf16_f32 v184, v184, v185
    v_cvt_pk_bf16_f32 v185, v186, v187
    ds_write_b64 v2, v[184:185] offset:224
    v_cvt_pk_bf16_f32 v188, v188, v189
    v_cvt_pk_bf16_f32 v189, v190, v191
    ds_write_b64 v2, v[188:189] offset:5088
    v_cvt_pk_bf16_f32 v192, v192, v193
    v_cvt_pk_bf16_f32 v193, v194, v195
    ds_write_b64 v2, v[192:193] offset:256
    v_cvt_pk_bf16_f32 v196, v196, v197
    v_cvt_pk_bf16_f32 v197, v198, v199
    ds_write_b64 v2, v[196:197] offset:5120
    s_branch a1_kernel_wdone
a1_kernel_qw:
    s_lshl_b32 s68, s60, 4
    v_add_u32 v2, s68, v2
    v_mul_u32_u24 v2, 304, v2
    v_add_u32 v2, v2, v3
    v_cvt_pk_bf16_f32 v128, v128, v129
    v_cvt_pk_bf16_f32 v129, v130, v131
    ds_write_b64 v2, v[128:129] offset:0
    v_cvt_pk_bf16_f32 v132, v132, v133
    v_cvt_pk_bf16_f32 v133, v134, v135
    ds_write_b64 v2, v[132:133] offset:32
    v_cvt_pk_bf16_f32 v136, v136, v137
    v_cvt_pk_bf16_f32 v137, v138, v139
    ds_write_b64 v2, v[136:137] offset:64
    v_cvt_pk_bf16_f32 v140, v140, v141
    v_cvt_pk_bf16_f32 v141, v142, v143
    ds_write_b64 v2, v[140:141] offset:96
    v_cvt_pk_bf16_f32 v144, v144, v145
    v_cvt_pk_bf16_f32 v145, v146, v147
    ds_write_b64 v2, v[144:145] offset:128
    v_cvt_pk_bf16_f32 v148, v148, v149
    v_cvt_pk_bf16_f32 v149, v150, v151
    ds_write_b64 v2, v[148:149] offset:160
    v_cvt_pk_bf16_f32 v152, v152, v153
    v_cvt_pk_bf16_f32 v153, v154, v155
    ds_write_b64 v2, v[152:153] offset:192
    v_cvt_pk_bf16_f32 v156, v156, v157
    v_cvt_pk_bf16_f32 v157, v158, v159
    ds_write_b64 v2, v[156:157] offset:224
    v_cvt_pk_bf16_f32 v160, v160, v161
    v_cvt_pk_bf16_f32 v161, v162, v163
    ds_write_b64 v2, v[160:161] offset:256
    s_branch a1_kernel_wdone
a1_kernel_vw:
    v_mul_u32_u24 v2, 144, v2
    v_add_u32 v2, v2, v3
    s_lshl_b32 s68, s70, 6
    s_add_u32 s68, s68, 32768
    v_add_u32 v2, s68, v2
    v_cvt_pk_bf16_f32 v128, v128, v129
    v_cvt_pk_bf16_f32 v129, v130, v131
    ds_write_b64 v2, v[128:129] offset:0
    v_cvt_pk_bf16_f32 v132, v132, v133
    v_cvt_pk_bf16_f32 v133, v134, v135
    ds_write_b64 v2, v[132:133] offset:32
    v_cvt_pk_bf16_f32 v136, v136, v137
    v_cvt_pk_bf16_f32 v137, v138, v139
    ds_write_b64 v2, v[136:137] offset:2304
    v_cvt_pk_bf16_f32 v140, v140, v141
    v_cvt_pk_bf16_f32 v141, v142, v143
    ds_write_b64 v2, v[140:141] offset:2336
    v_cvt_pk_bf16_f32 v144, v144, v145
    v_cvt_pk_bf16_f32 v145, v146, v147
    ds_write_b64 v2, v[144:145] offset:4608
    v_cvt_pk_bf16_f32 v148, v148, v149
    v_cvt_pk_bf16_f32 v149, v150, v151
    ds_write_b64 v2, v[148:149] offset:4640
    v_cvt_pk_bf16_f32 v152, v152, v153
    v_cvt_pk_bf16_f32 v153, v154, v155
    ds_write_b64 v2, v[152:153] offset:6912
    v_cvt_pk_bf16_f32 v156, v156, v157
    v_cvt_pk_bf16_f32 v157, v158, v159
    ds_write_b64 v2, v[156:157] offset:6944
    v_cvt_pk_bf16_f32 v160, v160, v161
    v_cvt_pk_bf16_f32 v161, v162, v163
    ds_write_b64 v2, v[160:161] offset:9216
    v_cvt_pk_bf16_f32 v164, v164, v165
    v_cvt_pk_bf16_f32 v165, v166, v167
    ds_write_b64 v2, v[164:165] offset:9248
    v_cvt_pk_bf16_f32 v168, v168, v169
    v_cvt_pk_bf16_f32 v169, v170, v171
    ds_write_b64 v2, v[168:169] offset:11520
    v_cvt_pk_bf16_f32 v172, v172, v173
    v_cvt_pk_bf16_f32 v173, v174, v175
    ds_write_b64 v2, v[172:173] offset:11552
    v_cvt_pk_bf16_f32 v176, v176, v177
    v_cvt_pk_bf16_f32 v177, v178, v179
    ds_write_b64 v2, v[176:177] offset:13824
    v_cvt_pk_bf16_f32 v180, v180, v181
    v_cvt_pk_bf16_f32 v181, v182, v183
    ds_write_b64 v2, v[180:181] offset:13856
    v_cvt_pk_bf16_f32 v184, v184, v185
    v_cvt_pk_bf16_f32 v185, v186, v187
    ds_write_b64 v2, v[184:185] offset:16128
    v_cvt_pk_bf16_f32 v188, v188, v189
    v_cvt_pk_bf16_f32 v189, v190, v191
    ds_write_b64 v2, v[188:189] offset:16160
    v_cvt_pk_bf16_f32 v192, v192, v193
    v_cvt_pk_bf16_f32 v193, v194, v195
    ds_write_b64 v2, v[192:193] offset:18432
    v_cvt_pk_bf16_f32 v196, v196, v197
    v_cvt_pk_bf16_f32 v197, v198, v199
    ds_write_b64 v2, v[196:197] offset:18464
    v_mov_b32 v4, 0x3f803f80
    v_lshlrev_b32 v3, 2, v1
    v_add_u32 v3, 53504, v3
    v_cmp_gt_u32 vcc, 32, v1
    s_and_saveexec_b64 s[80:81], vcc
    ds_write_b32 v3, v4
    s_mov_b64 exec, s[80:81]
a1_kernel_wdone:
    s_waitcnt lgkmcnt(0)
    s_barrier
    v_mul_u32_u24 v2, 304, v1
    s_mov_b32 s90, 0x3fb8aa3b
    s_mul_i32 s91, s60, 36
    v_add_u32 v3, s91, v2
    ds_read_b32 v32, v3 offset:0
    ds_read_b32 v33, v3 offset:4
    ds_read_b32 v34, v3 offset:8
    ds_read_b32 v35, v3 offset:12
    ds_read_b32 v36, v3 offset:16
    ds_read_b32 v37, v3 offset:20
    ds_read_b32 v38, v3 offset:24
    ds_read_b32 v39, v3 offset:28
    ds_read_b32 v40, v3 offset:32
    s_mul_i32 s91, s60, 1440
    v_mov_b32 v4, s91
    ds_read_b128 v[96:99], v4 offset:20480
    ds_read_b128 v[100:103], v4 offset:20496
    ds_read_b128 v[104:107], v4 offset:20512
    ds_read_b128 v[108:111], v4 offset:20528
    ds_read_b128 v[112:115], v4 offset:20544
    s_waitcnt lgkmcnt(5)
    v_lshlrev_b32 v48, 16, v32
    v_and_b32 v49, 0xffff0000, v32
    v_lshlrev_b32 v50, 16, v33
    v_and_b32 v51, 0xffff0000, v33
    v_lshlrev_b32 v52, 16, v34
    v_and_b32 v53, 0xffff0000, v34
    v_lshlrev_b32 v54, 16, v35
    v_and_b32 v55, 0xffff0000, v35
    v_lshlrev_b32 v56, 16, v36
    v_and_b32 v57, 0xffff0000, v36
    v_lshlrev_b32 v58, 16, v37
    v_and_b32 v59, 0xffff0000, v37
    v_lshlrev_b32 v60, 16, v38
    v_and_b32 v61, 0xffff0000, v38
    v_lshlrev_b32 v62, 16, v39
    v_and_b32 v63, 0xffff0000, v39
    v_lshlrev_b32 v64, 16, v40
    v_and_b32 v65, 0xffff0000, v40
    ds_read_b128 v[116:119], v4 offset:20560
    ds_read_b128 v[120:123], v4 offset:20576
    ds_read_b128 v[124:127], v4 offset:20592
    ds_read_b128 v[128:131], v4 offset:20608
    ds_read_b128 v[132:135], v4 offset:20624
    s_waitcnt lgkmcnt(5)
    v_mul_f32 v70, v96, v48
    v_mul_f32 v71, v97, v48
    v_mul_f32 v72, v98, v48
    v_mul_f32 v73, v99, v48
    v_mul_f32 v74, v100, v48
    v_mul_f32 v75, v101, v48
    v_mul_f32 v76, v102, v48
    v_mul_f32 v77, v103, v48
    v_mul_f32 v78, v104, v48
    v_mul_f32 v79, v105, v48
    v_mul_f32 v80, v106, v48
    v_mul_f32 v81, v107, v48
    v_mul_f32 v82, v108, v48
    v_mul_f32 v83, v109, v48
    v_mul_f32 v84, v110, v48
    v_mul_f32 v85, v111, v48
    v_mul_f32 v86, v112, v48
    v_mul_f32 v87, v113, v48
    ds_read_b128 v[96:99], v4 offset:20640
    ds_read_b128 v[100:103], v4 offset:20656
    ds_read_b128 v[104:107], v4 offset:20672
    ds_read_b128 v[108:111], v4 offset:20688
    ds_read_b128 v[112:115], v4 offset:20704
    s_waitcnt lgkmcnt(5)
    v_fmac_f32 v70, v116, v49
    v_fmac_f32 v71, v117, v49
    v_fmac_f32 v72, v118, v49
    v_fmac_f32 v73, v119, v49
    v_fmac_f32 v74, v120, v49
    v_fmac_f32 v75, v121, v49
    v_fmac_f32 v76, v122, v49
    v_fmac_f32 v77, v123, v49
    v_fmac_f32 v78, v124, v49
    v_fmac_f32 v79, v125, v49
    v_fmac_f32 v80, v126, v49
    v_fmac_f32 v81, v127, v49
    v_fmac_f32 v82, v128, v49
    v_fmac_f32 v83, v129, v49
    v_fmac_f32 v84, v130, v49
    v_fmac_f32 v85, v131, v49
    v_fmac_f32 v86, v132, v49
    v_fmac_f32 v87, v133, v49
    ds_read_b128 v[116:119], v4 offset:20720
    ds_read_b128 v[120:123], v4 offset:20736
    ds_read_b128 v[124:127], v4 offset:20752
    ds_read_b128 v[128:131], v4 offset:20768
    ds_read_b128 v[132:135], v4 offset:20784
    s_waitcnt lgkmcnt(5)
    v_fmac_f32 v70, v96, v50
    v_fmac_f32 v71, v97, v50
    v_fmac_f32 v72, v98, v50
    v_fmac_f32 v73, v99, v50
    v_fmac_f32 v74, v100, v50
    v_fmac_f32 v75, v101, v50
    v_fmac_f32 v76, v102, v50
    v_fmac_f32 v77, v103, v50
    v_fmac_f32 v78, v104, v50
    v_fmac_f32 v79, v105, v50
    v_fmac_f32 v80, v106, v50
    v_fmac_f32 v81, v107, v50
    v_fmac_f32 v82, v108, v50
    v_fmac_f32 v83, v109, v50
    v_fmac_f32 v84, v110, v50
    v_fmac_f32 v85, v111, v50
    v_fmac_f32 v86, v112, v50
    v_fmac_f32 v87, v113, v50
    ds_read_b128 v[96:99], v4 offset:20800
    ds_read_b128 v[100:103], v4 offset:20816
    ds_read_b128 v[104:107], v4 offset:20832
    ds_read_b128 v[108:111], v4 offset:20848
    ds_read_b128 v[112:115], v4 offset:20864
    s_waitcnt lgkmcnt(5)
    v_fmac_f32 v70, v116, v51
    v_fmac_f32 v71, v117, v51
    v_fmac_f32 v72, v118, v51
    v_fmac_f32 v73, v119, v51
    v_fmac_f32 v74, v120, v51
    v_fmac_f32 v75, v121, v51
    v_fmac_f32 v76, v122, v51
    v_fmac_f32 v77, v123, v51
    v_fmac_f32 v78, v124, v51
    v_fmac_f32 v79, v125, v51
    v_fmac_f32 v80, v126, v51
    v_fmac_f32 v81, v127, v51
    v_fmac_f32 v82, v128, v51
    v_fmac_f32 v83, v129, v51
    v_fmac_f32 v84, v130, v51
    v_fmac_f32 v85, v131, v51
    v_fmac_f32 v86, v132, v51
    v_fmac_f32 v87, v133, v51
    ds_read_b128 v[116:119], v4 offset:20880
    ds_read_b128 v[120:123], v4 offset:20896
    ds_read_b128 v[124:127], v4 offset:20912
    ds_read_b128 v[128:131], v4 offset:20928
    ds_read_b128 v[132:135], v4 offset:20944
    s_waitcnt lgkmcnt(5)
    v_fmac_f32 v70, v96, v52
    v_fmac_f32 v71, v97, v52
    v_fmac_f32 v72, v98, v52
    v_fmac_f32 v73, v99, v52
    v_fmac_f32 v74, v100, v52
    v_fmac_f32 v75, v101, v52
    v_fmac_f32 v76, v102, v52
    v_fmac_f32 v77, v103, v52
    v_fmac_f32 v78, v104, v52
    v_fmac_f32 v79, v105, v52
    v_fmac_f32 v80, v106, v52
    v_fmac_f32 v81, v107, v52
    v_fmac_f32 v82, v108, v52
    v_fmac_f32 v83, v109, v52
    v_fmac_f32 v84, v110, v52
    v_fmac_f32 v85, v111, v52
    v_fmac_f32 v86, v112, v52
    v_fmac_f32 v87, v113, v52
    ds_read_b128 v[96:99], v4 offset:20960
    ds_read_b128 v[100:103], v4 offset:20976
    ds_read_b128 v[104:107], v4 offset:20992
    ds_read_b128 v[108:111], v4 offset:21008
    ds_read_b128 v[112:115], v4 offset:21024
    s_waitcnt lgkmcnt(5)
    v_fmac_f32 v70, v116, v53
    v_fmac_f32 v71, v117, v53
    v_fmac_f32 v72, v118, v53
    v_fmac_f32 v73, v119, v53
    v_fmac_f32 v74, v120, v53
    v_fmac_f32 v75, v121, v53
    v_fmac_f32 v76, v122, v53
    v_fmac_f32 v77, v123, v53
    v_fmac_f32 v78, v124, v53
    v_fmac_f32 v79, v125, v53
    v_fmac_f32 v80, v126, v53
    v_fmac_f32 v81, v127, v53
    v_fmac_f32 v82, v128, v53
    v_fmac_f32 v83, v129, v53
    v_fmac_f32 v84, v130, v53
    v_fmac_f32 v85, v131, v53
    v_fmac_f32 v86, v132, v53
    v_fmac_f32 v87, v133, v53
    ds_read_b128 v[116:119], v4 offset:21040
    ds_read_b128 v[120:123], v4 offset:21056
    ds_read_b128 v[124:127], v4 offset:21072
    ds_read_b128 v[128:131], v4 offset:21088
    ds_read_b128 v[132:135], v4 offset:21104
    s_waitcnt lgkmcnt(5)
    v_fmac_f32 v70, v96, v54
    v_fmac_f32 v71, v97, v54
    v_fmac_f32 v72, v98, v54
    v_fmac_f32 v73, v99, v54
    v_fmac_f32 v74, v100, v54
    v_fmac_f32 v75, v101, v54
    v_fmac_f32 v76, v102, v54
    v_fmac_f32 v77, v103, v54
    v_fmac_f32 v78, v104, v54
    v_fmac_f32 v79, v105, v54
    v_fmac_f32 v80, v106, v54
    v_fmac_f32 v81, v107, v54
    v_fmac_f32 v82, v108, v54
    v_fmac_f32 v83, v109, v54
    v_fmac_f32 v84, v110, v54
    v_fmac_f32 v85, v111, v54
    v_fmac_f32 v86, v112, v54
    v_fmac_f32 v87, v113, v54
    ds_read_b128 v[96:99], v4 offset:21120
    ds_read_b128 v[100:103], v4 offset:21136
    ds_read_b128 v[104:107], v4 offset:21152
    ds_read_b128 v[108:111], v4 offset:21168
    ds_read_b128 v[112:115], v4 offset:21184
    s_waitcnt lgkmcnt(5)
    v_fmac_f32 v70, v116, v55
    v_fmac_f32 v71, v117, v55
    v_fmac_f32 v72, v118, v55
    v_fmac_f32 v73, v119, v55
    v_fmac_f32 v74, v120, v55
    v_fmac_f32 v75, v121, v55
    v_fmac_f32 v76, v122, v55
    v_fmac_f32 v77, v123, v55
    v_fmac_f32 v78, v124, v55
    v_fmac_f32 v79, v125, v55
    v_fmac_f32 v80, v126, v55
    v_fmac_f32 v81, v127, v55
    v_fmac_f32 v82, v128, v55
    v_fmac_f32 v83, v129, v55
    v_fmac_f32 v84, v130, v55
    v_fmac_f32 v85, v131, v55
    v_fmac_f32 v86, v132, v55
    v_fmac_f32 v87, v133, v55
    ds_read_b128 v[116:119], v4 offset:21200
    ds_read_b128 v[120:123], v4 offset:21216
    ds_read_b128 v[124:127], v4 offset:21232
    ds_read_b128 v[128:131], v4 offset:21248
    ds_read_b128 v[132:135], v4 offset:21264
    s_waitcnt lgkmcnt(5)
    v_fmac_f32 v70, v96, v56
    v_fmac_f32 v71, v97, v56
    v_fmac_f32 v72, v98, v56
    v_fmac_f32 v73, v99, v56
    v_fmac_f32 v74, v100, v56
    v_fmac_f32 v75, v101, v56
    v_fmac_f32 v76, v102, v56
    v_fmac_f32 v77, v103, v56
    v_fmac_f32 v78, v104, v56
    v_fmac_f32 v79, v105, v56
    v_fmac_f32 v80, v106, v56
    v_fmac_f32 v81, v107, v56
    v_fmac_f32 v82, v108, v56
    v_fmac_f32 v83, v109, v56
    v_fmac_f32 v84, v110, v56
    v_fmac_f32 v85, v111, v56
    v_fmac_f32 v86, v112, v56
    v_fmac_f32 v87, v113, v56
    ds_read_b128 v[96:99], v4 offset:21280
    ds_read_b128 v[100:103], v4 offset:21296
    ds_read_b128 v[104:107], v4 offset:21312
    ds_read_b128 v[108:111], v4 offset:21328
    ds_read_b128 v[112:115], v4 offset:21344
    s_waitcnt lgkmcnt(5)
    v_fmac_f32 v70, v116, v57
    v_fmac_f32 v71, v117, v57
    v_fmac_f32 v72, v118, v57
    v_fmac_f32 v73, v119, v57
    v_fmac_f32 v74, v120, v57
    v_fmac_f32 v75, v121, v57
    v_fmac_f32 v76, v122, v57
    v_fmac_f32 v77, v123, v57
    v_fmac_f32 v78, v124, v57
    v_fmac_f32 v79, v125, v57
    v_fmac_f32 v80, v126, v57
    v_fmac_f32 v81, v127, v57
    v_fmac_f32 v82, v128, v57
    v_fmac_f32 v83, v129, v57
    v_fmac_f32 v84, v130, v57
    v_fmac_f32 v85, v131, v57
    v_fmac_f32 v86, v132, v57
    v_fmac_f32 v87, v133, v57
    ds_read_b128 v[116:119], v4 offset:21360
    ds_read_b128 v[120:123], v4 offset:21376
    ds_read_b128 v[124:127], v4 offset:21392
    ds_read_b128 v[128:131], v4 offset:21408
    ds_read_b128 v[132:135], v4 offset:21424
    s_waitcnt lgkmcnt(5)
    v_fmac_f32 v70, v96, v58
    v_fmac_f32 v71, v97, v58
    v_fmac_f32 v72, v98, v58
    v_fmac_f32 v73, v99, v58
    v_fmac_f32 v74, v100, v58
    v_fmac_f32 v75, v101, v58
    v_fmac_f32 v76, v102, v58
    v_fmac_f32 v77, v103, v58
    v_fmac_f32 v78, v104, v58
    v_fmac_f32 v79, v105, v58
    v_fmac_f32 v80, v106, v58
    v_fmac_f32 v81, v107, v58
    v_fmac_f32 v82, v108, v58
    v_fmac_f32 v83, v109, v58
    v_fmac_f32 v84, v110, v58
    v_fmac_f32 v85, v111, v58
    v_fmac_f32 v86, v112, v58
    v_fmac_f32 v87, v113, v58
    ds_read_b128 v[96:99], v4 offset:21440
    ds_read_b128 v[100:103], v4 offset:21456
    ds_read_b128 v[104:107], v4 offset:21472
    ds_read_b128 v[108:111], v4 offset:21488
    ds_read_b128 v[112:115], v4 offset:21504
    s_waitcnt lgkmcnt(5)
    v_fmac_f32 v70, v116, v59
    v_fmac_f32 v71, v117, v59
    v_fmac_f32 v72, v118, v59
    v_fmac_f32 v73, v119, v59
    v_fmac_f32 v74, v120, v59
    v_fmac_f32 v75, v121, v59
    v_fmac_f32 v76, v122, v59
    v_fmac_f32 v77, v123, v59
    v_fmac_f32 v78, v124, v59
    v_fmac_f32 v79, v125, v59
    v_fmac_f32 v80, v126, v59
    v_fmac_f32 v81, v127, v59
    v_fmac_f32 v82, v128, v59
    v_fmac_f32 v83, v129, v59
    v_fmac_f32 v84, v130, v59
    v_fmac_f32 v85, v131, v59
    v_fmac_f32 v86, v132, v59
    v_fmac_f32 v87, v133, v59
    ds_read_b128 v[116:119], v4 offset:21520
    ds_read_b128 v[120:123], v4 offset:21536
    ds_read_b128 v[124:127], v4 offset:21552
    ds_read_b128 v[128:131], v4 offset:21568
    ds_read_b128 v[132:135], v4 offset:21584
    s_waitcnt lgkmcnt(5)
    v_fmac_f32 v70, v96, v60
    v_fmac_f32 v71, v97, v60
    v_fmac_f32 v72, v98, v60
    v_fmac_f32 v73, v99, v60
    v_fmac_f32 v74, v100, v60
    v_fmac_f32 v75, v101, v60
    v_fmac_f32 v76, v102, v60
    v_fmac_f32 v77, v103, v60
    v_fmac_f32 v78, v104, v60
    v_fmac_f32 v79, v105, v60
    v_fmac_f32 v80, v106, v60
    v_fmac_f32 v81, v107, v60
    v_fmac_f32 v82, v108, v60
    v_fmac_f32 v83, v109, v60
    v_fmac_f32 v84, v110, v60
    v_fmac_f32 v85, v111, v60
    v_fmac_f32 v86, v112, v60
    v_fmac_f32 v87, v113, v60
    ds_read_b128 v[96:99], v4 offset:21600
    ds_read_b128 v[100:103], v4 offset:21616
    ds_read_b128 v[104:107], v4 offset:21632
    ds_read_b128 v[108:111], v4 offset:21648
    ds_read_b128 v[112:115], v4 offset:21664
    s_waitcnt lgkmcnt(5)
    v_fmac_f32 v70, v116, v61
    v_fmac_f32 v71, v117, v61
    v_fmac_f32 v72, v118, v61
    v_fmac_f32 v73, v119, v61
    v_fmac_f32 v74, v120, v61
    v_fmac_f32 v75, v121, v61
    v_fmac_f32 v76, v122, v61
    v_fmac_f32 v77, v123, v61
    v_fmac_f32 v78, v124, v61
    v_fmac_f32 v79, v125, v61
    v_fmac_f32 v80, v126, v61
    v_fmac_f32 v81, v127, v61
    v_fmac_f32 v82, v128, v61
    v_fmac_f32 v83, v129, v61
    v_fmac_f32 v84, v130, v61
    v_fmac_f32 v85, v131, v61
    v_fmac_f32 v86, v132, v61
    v_fmac_f32 v87, v133, v61
    ds_read_b128 v[116:119], v4 offset:21680
    ds_read_b128 v[120:123], v4 offset:21696
    ds_read_b128 v[124:127], v4 offset:21712
    ds_read_b128 v[128:131], v4 offset:21728
    ds_read_b128 v[132:135], v4 offset:21744
    s_waitcnt lgkmcnt(5)
    v_fmac_f32 v70, v96, v62
    v_fmac_f32 v71, v97, v62
    v_fmac_f32 v72, v98, v62
    v_fmac_f32 v73, v99, v62
    v_fmac_f32 v74, v100, v62
    v_fmac_f32 v75, v101, v62
    v_fmac_f32 v76, v102, v62
    v_fmac_f32 v77, v103, v62
    v_fmac_f32 v78, v104, v62
    v_fmac_f32 v79, v105, v62
    v_fmac_f32 v80, v106, v62
    v_fmac_f32 v81, v107, v62
    v_fmac_f32 v82, v108, v62
    v_fmac_f32 v83, v109, v62
    v_fmac_f32 v84, v110, v62
    v_fmac_f32 v85, v111, v62
    v_fmac_f32 v86, v112, v62
    v_fmac_f32 v87, v113, v62
    ds_read_b128 v[96:99], v4 offset:21760
    ds_read_b128 v[100:103], v4 offset:21776
    ds_read_b128 v[104:107], v4 offset:21792
    ds_read_b128 v[108:111], v4 offset:21808
    ds_read_b128 v[112:115], v4 offset:21824
    s_waitcnt lgkmcnt(5)
    v_fmac_f32 v70, v116, v63
    v_fmac_f32 v71, v117, v63
    v_fmac_f32 v72, v118, v63
    v_fmac_f32 v73, v119, v63
    v_fmac_f32 v74, v120, v63
    v_fmac_f32 v75, v121, v63
    v_fmac_f32 v76, v122, v63
    v_fmac_f32 v77, v123, v63
    v_fmac_f32 v78, v124, v63
    v_fmac_f32 v79, v125, v63
    v_fmac_f32 v80, v126, v63
    v_fmac_f32 v81, v127, v63
    v_fmac_f32 v82, v128, v63
    v_fmac_f32 v83, v129, v63
    v_fmac_f32 v84, v130, v63
    v_fmac_f32 v85, v131, v63
    v_fmac_f32 v86, v132, v63
    v_fmac_f32 v87, v133, v63
    ds_read_b128 v[116:119], v4 offset:21840
    ds_read_b128 v[120:123], v4 offset:21856
    ds_read_b128 v[124:127], v4 offset:21872
    ds_read_b128 v[128:131], v4 offset:21888
    ds_read_b128 v[132:135], v4 offset:21904
    s_waitcnt lgkmcnt(5)
    v_fmac_f32 v70, v96, v64
    v_fmac_f32 v71, v97, v64
    v_fmac_f32 v72, v98, v64
    v_fmac_f32 v73, v99, v64
    v_fmac_f32 v74, v100, v64
    v_fmac_f32 v75, v101, v64
    v_fmac_f32 v76, v102, v64
    v_fmac_f32 v77, v103, v64
    v_fmac_f32 v78, v104, v64
    v_fmac_f32 v79, v105, v64
    v_fmac_f32 v80, v106, v64
    v_fmac_f32 v81, v107, v64
    v_fmac_f32 v82, v108, v64
    v_fmac_f32 v83, v109, v64
    v_fmac_f32 v84, v110, v64
    v_fmac_f32 v85, v111, v64
    v_fmac_f32 v86, v112, v64
    v_fmac_f32 v87, v113, v64
    s_waitcnt lgkmcnt(0)
    v_fmac_f32 v70, v116, v65
    v_fmac_f32 v71, v117, v65
    v_fmac_f32 v72, v118, v65
    v_fmac_f32 v73, v119, v65
    v_fmac_f32 v74, v120, v65
    v_fmac_f32 v75, v121, v65
    v_fmac_f32 v76, v122, v65
    v_fmac_f32 v77, v123, v65
    v_fmac_f32 v78, v124, v65
    v_fmac_f32 v79, v125, v65
    v_fmac_f32 v80, v126, v65
    v_fmac_f32 v81, v127, v65
    v_fmac_f32 v82, v128, v65
    v_fmac_f32 v83, v129, v65
    v_fmac_f32 v84, v130, v65
    v_fmac_f32 v85, v131, v65
    v_fmac_f32 v86, v132, v65
    v_fmac_f32 v87, v133, v65
    v_max3_f32 v5, v70, v71, v72
    v_min3_f32 v6, v70, v71, v72
    v_max3_f32 v5, v5, v73, v74
    v_min3_f32 v6, v6, v73, v74
    v_max3_f32 v5, v5, v75, v76
    v_min3_f32 v6, v6, v75, v76
    v_max3_f32 v5, v5, v77, v78
    v_min3_f32 v6, v6, v77, v78
    v_max3_f32 v5, v5, v79, v80
    v_min3_f32 v6, v6, v79, v80
    v_max3_f32 v5, v5, v81, v82
    v_min3_f32 v6, v6, v81, v82
    v_max3_f32 v5, v5, v83, v84
    v_min3_f32 v6, v6, v83, v84
    v_max3_f32 v5, v5, v85, v86
    v_min3_f32 v6, v6, v85, v86
    v_max_f32 v5, v5, v87
    v_min_f32 v6, v6, v87
    v_mul_f32 v7, s90, v5
    v_mul_f32 v8, s90, v6
    v_fma_f32 v140, v70, s90, -v7
    v_fma_f32 v158, -v70, s90, v8
    v_fma_f32 v141, v71, s90, -v7
    v_fma_f32 v159, -v71, s90, v8
    v_fma_f32 v142, v72, s90, -v7
    v_fma_f32 v160, -v72, s90, v8
    v_fma_f32 v143, v73, s90, -v7
    v_fma_f32 v161, -v73, s90, v8
    v_fma_f32 v144, v74, s90, -v7
    v_fma_f32 v162, -v74, s90, v8
    v_fma_f32 v145, v75, s90, -v7
    v_fma_f32 v163, -v75, s90, v8
    v_fma_f32 v146, v76, s90, -v7
    v_fma_f32 v164, -v76, s90, v8
    v_fma_f32 v147, v77, s90, -v7
    v_fma_f32 v165, -v77, s90, v8
    v_fma_f32 v148, v78, s90, -v7
    v_fma_f32 v166, -v78, s90, v8
    v_fma_f32 v149, v79, s90, -v7
    v_fma_f32 v167, -v79, s90, v8
    v_fma_f32 v150, v80, s90, -v7
    v_fma_f32 v168, -v80, s90, v8
    v_fma_f32 v151, v81, s90, -v7
    v_fma_f32 v169, -v81, s90, v8
    v_fma_f32 v152, v82, s90, -v7
    v_fma_f32 v170, -v82, s90, v8
    v_fma_f32 v153, v83, s90, -v7
    v_fma_f32 v171, -v83, s90, v8
    v_fma_f32 v154, v84, s90, -v7
    v_fma_f32 v172, -v84, s90, v8
    v_fma_f32 v155, v85, s90, -v7
    v_fma_f32 v173, -v85, s90, v8
    v_fma_f32 v156, v86, s90, -v7
    v_fma_f32 v174, -v86, s90, v8
    v_fma_f32 v157, v87, s90, -v7
    v_fma_f32 v175, -v87, s90, v8
    v_exp_f32 v140, v140
    v_exp_f32 v141, v141
    v_exp_f32 v142, v142
    v_exp_f32 v143, v143
    v_exp_f32 v144, v144
    v_exp_f32 v145, v145
    v_exp_f32 v146, v146
    v_exp_f32 v147, v147
    v_exp_f32 v148, v148
    v_exp_f32 v149, v149
    v_exp_f32 v150, v150
    v_exp_f32 v151, v151
    v_exp_f32 v152, v152
    v_exp_f32 v153, v153
    v_exp_f32 v154, v154
    v_exp_f32 v155, v155
    v_exp_f32 v156, v156
    v_exp_f32 v157, v157
    v_exp_f32 v158, v158
    v_exp_f32 v159, v159
    v_exp_f32 v160, v160
    v_exp_f32 v161, v161
    v_exp_f32 v162, v162
    v_exp_f32 v163, v163
    v_exp_f32 v164, v164
    v_exp_f32 v165, v165
    v_exp_f32 v166, v166
    v_exp_f32 v167, v167
    v_exp_f32 v168, v168
    v_exp_f32 v169, v169
    v_exp_f32 v170, v170
    v_exp_f32 v171, v171
    v_exp_f32 v172, v172
    v_exp_f32 v173, v173
    v_exp_f32 v174, v174
    v_exp_f32 v175, v175
    s_nop 0
    v_add_f32 v5, v140, v141
    v_add_f32 v6, v158, v159
    v_add_f32 v5, v5, v142
    v_add_f32 v6, v6, v160
    v_add_f32 v5, v5, v143
    v_add_f32 v6, v6, v161
    v_add_f32 v5, v5, v144
    v_add_f32 v6, v6, v162
    v_add_f32 v5, v5, v145
    v_add_f32 v6, v6, v163
    v_add_f32 v5, v5, v146
    v_add_f32 v6, v6, v164
    v_add_f32 v5, v5, v147
    v_add_f32 v6, v6, v165
    v_add_f32 v5, v5, v148
    v_add_f32 v6, v6, v166
    v_add_f32 v5, v5, v149
    v_add_f32 v6, v6, v167
    v_add_f32 v5, v5, v150
    v_add_f32 v6, v6, v168
    v_add_f32 v5, v5, v151
    v_add_f32 v6, v6, v169
    v_add_f32 v5, v5, v152
    v_add_f32 v6, v6, v170
    v_add_f32 v5, v5, v153
    v_add_f32 v6, v6, v171
    v_add_f32 v5, v5, v154
    v_add_f32 v6, v6, v172
    v_add_f32 v5, v5, v155
    v_add_f32 v6, v6, v173
    v_add_f32 v5, v5, v156
    v_add_f32 v6, v6, v174
    v_add_f32 v5, v5, v157
    v_add_f32 v6, v6, v175
    v_rcp_f32 v5, v5
    v_rcp_f32 v6, v6
    s_nop 0
    v_mul_f32 v140, v140, v5
    v_mul_f32 v158, v158, v6
    v_mul_f32 v141, v141, v5
    v_mul_f32 v159, v159, v6
    v_mul_f32 v142, v142, v5
    v_mul_f32 v160, v160, v6
    v_mul_f32 v143, v143, v5
    v_mul_f32 v161, v161, v6
    v_mul_f32 v144, v144, v5
    v_mul_f32 v162, v162, v6
    v_mul_f32 v145, v145, v5
    v_mul_f32 v163, v163, v6
    v_mul_f32 v146, v146, v5
    v_mul_f32 v164, v164, v6
    v_mul_f32 v147, v147, v5
    v_mul_f32 v165, v165, v6
    v_mul_f32 v148, v148, v5
    v_mul_f32 v166, v166, v6
    v_mul_f32 v149, v149, v5
    v_mul_f32 v167, v167, v6
    v_mul_f32 v150, v150, v5
    v_mul_f32 v168, v168, v6
    v_mul_f32 v151, v151, v5
    v_mul_f32 v169, v169, v6
    v_mul_f32 v152, v152, v5
    v_mul_f32 v170, v170, v6
    v_mul_f32 v153, v153, v5
    v_mul_f32 v171, v171, v6
    v_mul_f32 v154, v154, v5
    v_mul_f32 v172, v172, v6
    v_mul_f32 v155, v155, v5
    v_mul_f32 v173, v173, v6
    v_mul_f32 v156, v156, v5
    v_mul_f32 v174, v174, v6
    v_mul_f32 v157, v157, v5
    v_mul_f32 v175, v175, v6
    v_cvt_pk_bf16_f32 v180, v140, v141
    v_cvt_pk_bf16_f32 v181, v142, v143
    v_cvt_pk_bf16_f32 v182, v144, v145
    v_cvt_pk_bf16_f32 v183, v146, v147
    v_cvt_pk_bf16_f32 v184, v148, v149
    v_cvt_pk_bf16_f32 v185, v150, v151
    v_cvt_pk_bf16_f32 v186, v152, v153
    v_cvt_pk_bf16_f32 v187, v154, v155
    v_cvt_pk_bf16_f32 v188, v156, v157
    v_cvt_pk_bf16_f32 v189, v158, v159
    v_cvt_pk_bf16_f32 v190, v160, v161
    v_cvt_pk_bf16_f32 v191, v162, v163
    v_cvt_pk_bf16_f32 v192, v164, v165
    v_cvt_pk_bf16_f32 v193, v166, v167
    v_cvt_pk_bf16_f32 v194, v168, v169
    v_cvt_pk_bf16_f32 v195, v170, v171
    v_cvt_pk_bf16_f32 v196, v172, v173
    v_cvt_pk_bf16_f32 v197, v174, v175
    s_cmp_eq_u32 s73, 1
    s_cbranch_scc0 a1_kernel_kst
    v_lshrrev_b32 v3, 4, v1
    s_lshl_b32 s91, s61, 2
    v_add_u32 v3, s91, v3
    v_mul_u32_u24 v3, 49152, v3
    s_lshl_b32 s91, s62, 3
    s_add_u32 s91, s91, s60
    s_mul_i32 s91, s91, 1536
    v_add_u32 v3, s91, v3
    v_and_b32 v4, 15, v1
    v_lshlrev_b32 v5, 4, v4
    v_add_u32 v5, v3, v5
    v_lshlrev_b32 v6, 3, v4
    v_add_u32 v6, v3, v6
    v_mov_b32 v198, 0
    v_mov_b32 v199, 0
    buffer_store_dwordx4 v[180:183], v5, s[52:55], 0 offen offset:0
    buffer_store_dwordx4 v[184:187], v5, s[52:55], 0 offen offset:256
    buffer_store_dwordx4 v[188:191], v5, s[52:55], 0 offen offset:512
    buffer_store_dwordx4 v[192:195], v5, s[52:55], 0 offen offset:768
    buffer_store_dwordx2 v[196:197], v6, s[52:55], 0 offen offset:1024
    buffer_store_dwordx2 v[198:199], v6, s[52:55], 0 offen offset:1152
    buffer_store_dwordx2 v[198:199], v6, s[52:55], 0 offen offset:1280
    buffer_store_dwordx2 v[198:199], v6, s[52:55], 0 offen offset:1408
    s_endpgm
a1_kernel_kst:
    s_mul_i32 s91, s60, 6912
    v_lshlrev_b32 v3, 1, v1
    v_add_u32 v3, s91, v3
    v_add_u32 v3, 55296, v3
    ds_write_b16 v3, v180 offset:0
    ds_write_b16_d16_hi v3, v180 offset:144
    ds_write_b16 v3, v181 offset:288
    ds_write_b16_d16_hi v3, v181 offset:432
    ds_write_b16 v3, v182 offset:576
    ds_write_b16_d16_hi v3, v182 offset:720
    ds_write_b16 v3, v183 offset:864
    ds_write_b16_d16_hi v3, v183 offset:1008
    ds_write_b16 v3, v184 offset:1152
    ds_write_b16_d16_hi v3, v184 offset:1296
    ds_write_b16 v3, v185 offset:1440
    ds_write_b16_d16_hi v3, v185 offset:1584
    ds_write_b16 v3, v186 offset:1728
    ds_write_b16_d16_hi v3, v186 offset:1872
    ds_write_b16 v3, v187 offset:2016
    ds_write_b16_d16_hi v3, v187 offset:2160
    ds_write_b16 v3, v188 offset:2304
    ds_write_b16_d16_hi v3, v188 offset:2448
    ds_write_b16 v3, v189 offset:2592
    ds_write_b16_d16_hi v3, v189 offset:2736
    ds_write_b16 v3, v190 offset:2880
    ds_write_b16_d16_hi v3, v190 offset:3024
    ds_write_b16 v3, v191 offset:3168
    ds_write_b16_d16_hi v3, v191 offset:3312
    ds_write_b16 v3, v192 offset:3456
    ds_write_b16_d16_hi v3, v192 offset:3600
    ds_write_b16 v3, v193 offset:3744
    ds_write_b16_d16_hi v3, v193 offset:3888
    ds_write_b16 v3, v194 offset:4032
    ds_write_b16_d16_hi v3, v194 offset:4176
    ds_write_b16 v3, v195 offset:4320
    ds_write_b16_d16_hi v3, v195 offset:4464
    ds_write_b16 v3, v196 offset:4608
    ds_write_b16_d16_hi v3, v196 offset:4752
    ds_write_b16 v3, v197 offset:4896
    ds_write_b16_d16_hi v3, v197 offset:5040
    s_add_u32 s91, s91, 60480
    v_lshlrev_b32 v3, 4, v1
    v_add_u32 v3, s91, v3
    v_mov_b32 v4, 0
    v_mov_b32 v5, 0
    v_mov_b32 v6, 0
    v_mov_b32 v7, 0
    v_cmp_gt_u32 vcc, 54, v1
    s_and_saveexec_b64 s[80:81], vcc
    ds_write_b128 v3, v[4:7]
    ds_write_b128 v3, v[4:7] offset:864
    s_mov_b64 exec, s[80:81]
    s_waitcnt lgkmcnt(0)
    v_and_b32 v2, 15, v1
    v_lshrrev_b32 v3, 4, v1
    v_lshlrev_b32 v5, 4, v3
    s_mul_i32 s91, s60, 18
    v_add_u32 v6, s91, v2
    v_mul_u32_u24 v6, 144, v6
    v_add_u32 v6, v6, v5
    v_add_u32 v6, 32768, v6
    v_add_u32 v7, 2304, v6
    v_add_u32 v8, 53504, v5
    v_cmp_gt_u32 vcc, 2, v2
    s_nop 1
    v_cndmask_b32 v7, v8, v7, vcc
    s_mul_i32 s91, s60, 6912
    v_mul_u32_u24 v9, 144, v2
    v_add_u32 v9, v9, v5
    v_add_u32 v9, s91, v9
    v_add_u32 v9, 55296, v9
    ds_read_b128 v[32:35], v6 offset:0
    ds_read_b128 v[36:39], v7 offset:0
    ds_read_b128 v[48:51], v9 offset:0
    ds_read_b128 v[52:55], v9 offset:2304
    ds_read_b128 v[56:59], v9 offset:4608
    ds_read_b128 v[40:43], v6 offset:64
    ds_read_b128 v[44:47], v7 offset:64
    ds_read_b128 v[60:63], v9 offset:64
    ds_read_b128 v[64:67], v9 offset:2368
    ds_read_b128 v[68:71], v9 offset:4672
    v_mov_b32 v80, 0
    v_mov_b32 v81, 0
    v_mov_b32 v82, 0
    v_mov_b32 v83, 0
    v_mov_b32 v84, 0
    v_mov_b32 v85, 0
    v_mov_b32 v86, 0
    v_mov_b32 v87, 0
    v_mov_b32 v88, 0
    v_mov_b32 v89, 0
    v_mov_b32 v90, 0
    v_mov_b32 v91, 0
    v_mov_b32 v92, 0
    v_mov_b32 v93, 0
    v_mov_b32 v94, 0
    v_mov_b32 v95, 0
    v_mov_b32 v96, 0
    v_mov_b32 v97, 0
    v_mov_b32 v98, 0
    v_mov_b32 v99, 0
    v_mov_b32 v100, 0
    v_mov_b32 v101, 0
    v_mov_b32 v102, 0
    v_mov_b32 v103, 0
    s_waitcnt lgkmcnt(0)
    v_mfma_f32_16x16x32_bf16 v[80:83], v[32:35], v[48:51], v[80:83]
    v_mfma_f32_16x16x32_bf16 v[84:87], v[32:35], v[52:55], v[84:87]
    v_mfma_f32_16x16x32_bf16 v[88:91], v[32:35], v[56:59], v[88:91]
    v_mfma_f32_16x16x32_bf16 v[92:95], v[36:39], v[48:51], v[92:95]
    v_mfma_f32_16x16x32_bf16 v[96:99], v[36:39], v[52:55], v[96:99]
    v_mfma_f32_16x16x32_bf16 v[100:103], v[36:39], v[56:59], v[100:103]
    v_mfma_f32_16x16x32_bf16 v[80:83], v[40:43], v[60:63], v[80:83]
    v_mfma_f32_16x16x32_bf16 v[84:87], v[40:43], v[64:67], v[84:87]
    v_mfma_f32_16x16x32_bf16 v[88:91], v[40:43], v[68:71], v[88:91]
    v_mfma_f32_16x16x32_bf16 v[92:95], v[44:47], v[60:63], v[92:95]
    v_mfma_f32_16x16x32_bf16 v[96:99], v[44:47], v[64:67], v[96:99]
    v_mfma_f32_16x16x32_bf16 v[100:103], v[44:47], v[68:71], v[100:103]
    s_lshl_b32 s91, s62, 3
    s_add_u32 s91, s91, s60
    s_mul_i32 s91, s91, 6144
    s_mul_i32 s93, s61, 196608
    s_add_u32 s91, s91, s93
    v_lshrrev_b32 v6, 3, v2
    v_lshlrev_b32 v6, 9, v6
    v_and_b32 v7, 7, v2
    v_lshlrev_b32 v7, 2, v7
    v_add_u32 v6, v6, v7
    v_lshlrev_b32 v7, 7, v3
    v_add_u32 v6, v6, v7
    v_add_u32 v6, s91, v6
    v_lshlrev_b32 v7, 2, v2
    v_lshlrev_b32 v8, 6, v3
    v_add_u32 v7, v7, v8
    v_add_u32 v7, s91, v7
    s_movk_i32 s92, 4096
    s_nop 7
    s_nop 7
    s_mov_b64 s[80:81], exec
    buffer_store_dword v80, v6, s[56:59], 0 offen offset:0
    buffer_store_dword v81, v6, s[56:59], 0 offen offset:32
    buffer_store_dword v82, v6, s[56:59], 0 offen offset:64
    buffer_store_dword v83, v6, s[56:59], 0 offen offset:96
    s_mov_b64 exec, s[80:81]
    s_mov_b64 s[80:81], exec
    buffer_store_dword v84, v6, s[56:59], 0 offen offset:1024
    buffer_store_dword v85, v6, s[56:59], 0 offen offset:1056
    buffer_store_dword v86, v6, s[56:59], 0 offen offset:1088
    buffer_store_dword v87, v6, s[56:59], 0 offen offset:1120
    s_mov_b64 exec, s[80:81]
    s_mov_b64 s[80:81], exec
    v_cmp_gt_u32 vcc, 4, v2
    s_and_b64 exec, exec, vcc
    buffer_store_dword v88, v7, s[56:59], 0 offen offset:2048
    buffer_store_dword v89, v7, s[56:59], 0 offen offset:2064
    buffer_store_dword v90, v7, s[56:59], 0 offen offset:2080
    buffer_store_dword v91, v7, s[56:59], 0 offen offset:2096
    s_mov_b64 exec, s[80:81]
    s_mov_b64 s[80:81], exec
    v_cmp_gt_u32 vcc, 16, v1
    s_and_b64 exec, exec, vcc
    buffer_store_dword v92, v6, s[56:59], 0 offen offset:3072
    buffer_store_dword v93, v6, s[56:59], 0 offen offset:3104
    buffer_store_dword v94, v6, s[56:59], 0 offen offset:3136
    s_mov_b64 exec, s[80:81]
    s_mov_b64 s[80:81], exec
    v_cmp_gt_u32 vcc, 16, v1
    s_and_b64 exec, exec, vcc
    buffer_store_dword v96, v6, s[56:59], s92 offen offset:0
    buffer_store_dword v97, v6, s[56:59], s92 offen offset:32
    buffer_store_dword v98, v6, s[56:59], s92 offen offset:64
    s_mov_b64 exec, s[80:81]
    s_mov_b64 s[80:81], exec
    v_cmp_gt_u32 vcc, 16, v1
    s_and_b64 exec, exec, vcc
    v_cmp_gt_u32 vcc, 4, v2
    s_and_b64 exec, exec, vcc
    buffer_store_dword v100, v7, s[56:59], s92 offen offset:1024
    buffer_store_dword v101, v7, s[56:59], s92 offen offset:1040
    buffer_store_dword v102, v7, s[56:59], s92 offen offset:1056
    s_mov_b64 exec, s[80:81]
a1_kernel_end:
    s_endpgm
.section .rodata,"a"
.p2align 6
.amdhsa_kernel a1_kernel
  .amdhsa_next_free_vgpr 240
  .amdhsa_next_free_sgpr 102
  .amdhsa_accum_offset 240
  .amdhsa_group_segment_fixed_size 0
  .amdhsa_kernarg_size 96
  .amdhsa_user_sgpr_count 2
  .amdhsa_user_sgpr_kernarg_segment_ptr 1
  .amdhsa_system_sgpr_workgroup_id_x 1
  .amdhsa_float_denorm_mode_32 3
.end_amdhsa_kernel
.text

.globl kvr_kernel
.p2align 8
.type kvr_kernel,@function
kvr_kernel:
    s_cmp_ge_u32 s2, 724
    s_cbranch_scc1 kvr_kernel_end
    s_load_dwordx16 s[16:31], s[0:1], 0
    s_load_dwordx8 s[32:39], s[0:1], 64
    s_cmp_ge_u32 s2, 596
    s_cbranch_scc1 kvr_kernel_pf
    s_cmp_ge_u32 s2, 128
    s_cbranch_scc1 kvr_kernel_tr
    s_lshl_b32 s3, s2, 8
    v_add_u32 v1, s3, v0
    v_and_b32 v2, 3, v1
    v_lshrrev_b32 v3, 2, v1
    v_and_b32 v4, 15, v3
    v_bfe_u32 v5, v3, 4, 2
    v_bfe_u32 v6, v3, 6, 1
    v_bfe_u32 v7, v3, 7, 1
    v_lshrrev_b32 v8, 8, v3
    s_waitcnt lgkmcnt(0)
    s_add_u32 s40, s38, 62914560
    s_addc_u32 s41, s39, 0
    s_and_b32 s41, s41, 0xffff
    s_mov_b32 s42, 6291456
    s_mov_b32 s43, 0x00020000
    s_add_u32 s44, s38, 8388608
    s_addc_u32 s45, s39, 0
    s_and_b32 s45, s45, 0xffff
    s_mov_b32 s46, 196608
    s_mov_b32 s47, 0x00020000
    v_min_u32 v9, 2, v4
    v_cmp_eq_u32 vcc, 1, v7
    s_nop 1
    v_cndmask_b32 v9, v4, v9, vcc
    v_lshlrev_b32 v10, 9, v5
    v_lshlrev_b32 v11, 5, v9
    v_add_u32 v10, v10, v11
    v_lshrrev_b32 v11, 1, v10
    v_add_u32 v11, 2048, v11
    v_cmp_eq_u32 vcc, 1, v6
    s_nop 1
    v_cndmask_b32 v10, v10, v11, vcc
    v_mul_u32_u24 v11, 6144, v8
    v_add_u32 v10, v10, v11
    v_mul_u32_u24 v11, 3072, v7
    v_add_u32 v10, v10, v11
    s_mov_b32 s60, 1572864
    v_mul_lo_u32 v11, v2, s60
    v_add_u32 v10, v10, v11
    s_mov_b32 s61, 0
    buffer_load_dwordx4 v[16:19], v10, s[40:43], s61 offen
    buffer_load_dwordx4 v[20:23], v10, s[40:43], s61 offen offset:16
    s_mov_b32 s61, 196608
    buffer_load_dwordx4 v[24:27], v10, s[40:43], s61 offen
    buffer_load_dwordx4 v[28:31], v10, s[40:43], s61 offen offset:16
    s_mov_b32 s61, 393216
    buffer_load_dwordx4 v[32:35], v10, s[40:43], s61 offen
    buffer_load_dwordx4 v[36:39], v10, s[40:43], s61 offen offset:16
    s_mov_b32 s61, 589824
    buffer_load_dwordx4 v[40:43], v10, s[40:43], s61 offen
    buffer_load_dwordx4 v[44:47], v10, s[40:43], s61 offen offset:16
    s_mov_b32 s61, 786432
    buffer_load_dwordx4 v[48:51], v10, s[40:43], s61 offen
    buffer_load_dwordx4 v[52:55], v10, s[40:43], s61 offen offset:16
    s_mov_b32 s61, 983040
    buffer_load_dwordx4 v[56:59], v10, s[40:43], s61 offen
    buffer_load_dwordx4 v[60:63], v10, s[40:43], s61 offen offset:16
    s_mov_b32 s61, 1179648
    buffer_load_dwordx4 v[64:67], v10, s[40:43], s61 offen
    buffer_load_dwordx4 v[68:71], v10, s[40:43], s61 offen offset:16
    s_mov_b32 s61, 1376256
    buffer_load_dwordx4 v[72:75], v10, s[40:43], s61 offen
    buffer_load_dwordx4 v[76:79], v10, s[40:43], s61 offen offset:16
    s_waitcnt vmcnt(0)
    v_add_f32 v16, v16, v24
    v_add_f32 v17, v17, v25
    v_add_f32 v18, v18, v26
    v_add_f32 v19, v19, v27
    v_add_f32 v20, v20, v28
    v_add_f32 v21, v21, v29
    v_add_f32 v22, v22, v30
    v_add_f32 v23, v23, v31
    v_add_f32 v16, v16, v32
    v_add_f32 v17, v17, v33
    v_add_f32 v18, v18, v34
    v_add_f32 v19, v19, v35
    v_add_f32 v20, v20, v36
    v_add_f32 v21, v21, v37
    v_add_f32 v22, v22, v38
    v_add_f32 v23, v23, v39
    v_add_f32 v16, v16, v40
    v_add_f32 v17, v17, v41
    v_add_f32 v18, v18, v42
    v_add_f32 v19, v19, v43
    v_add_f32 v20, v20, v44
    v_add_f32 v21, v21, v45
    v_add_f32 v22, v22, v46
    v_add_f32 v23, v23, v47
    v_add_f32 v16, v16, v48
    v_add_f32 v17, v17, v49
    v_add_f32 v18, v18, v50
    v_add_f32 v19, v19, v51
    v_add_f32 v20, v20, v52
    v_add_f32 v21, v21, v53
    v_add_f32 v22, v22, v54
    v_add_f32 v23, v23, v55
    v_add_f32 v16, v16, v56
    v_add_f32 v17, v17, v57
    v_add_f32 v18, v18, v58
    v_add_f32 v19, v19, v59
    v_add_f32 v20, v20, v60
    v_add_f32 v21, v21, v61
    v_add_f32 v22, v22, v62
    v_add_f32 v23, v23, v63
    v_add_f32 v16, v16, v64
    v_add_f32 v17, v17, v65
    v_add_f32 v18, v18, v66
    v_add_f32 v19, v19, v67
    v_add_f32 v20, v20, v68
    v_add_f32 v21, v21, v69
    v_add_f32 v22, v22, v70
    v_add_f32 v23, v23, v71
    v_add_f32 v16, v16, v72
    v_add_f32 v17, v17, v73
    v_add_f32 v18, v18, v74
    v_add_f32 v19, v19, v75
    v_add_f32 v20, v20, v76
    v_add_f32 v21, v21, v77
    v_add_f32 v22, v22, v78
    v_add_f32 v23, v23, v79
    s_nop 1
    v_add_f32_dpp v16, v16, v16 quad_perm:[1,0,3,2] row_mask:0xf bank_mask:0xf
    v_add_f32_dpp v17, v17, v17 quad_perm:[1,0,3,2] row_mask:0xf bank_mask:0xf
    v_add_f32_dpp v18, v18, v18 quad_perm:[1,0,3,2] row_mask:0xf bank_mask:0xf
    v_add_f32_dpp v19, v19, v19 quad_perm:[1,0,3,2] row_mask:0xf bank_mask:0xf
    v_add_f32_dpp v20, v20, v20 quad_perm:[1,0,3,2] row_mask:0xf bank_mask:0xf
    v_add_f32_dpp v21, v21, v21 quad_perm:[1,0,3,2] row_mask:0xf bank_mask:0xf
    v_add_f32_dpp v22, v22, v22 quad_perm:[1,0,3,2] row_mask:0xf bank_mask:0xf
    v_add_f32_dpp v23, v23, v23 quad_perm:[1,0,3,2] row_mask:0xf bank_mask:0xf
    s_nop 1
    v_add_f32_dpp v16, v16, v16 quad_perm:[2,3,0,1] row_mask:0xf bank_mask:0xf
    v_add_f32_dpp v17, v17, v17 quad_perm:[2,3,0,1] row_mask:0xf bank_mask:0xf
    v_add_f32_dpp v18, v18, v18 quad_perm:[2,3,0,1] row_mask:0xf bank_mask:0xf
    v_add_f32_dpp v19, v19, v19 quad_perm:[2,3,0,1] row_mask:0xf bank_mask:0xf
    v_add_f32_dpp v20, v20, v20 quad_perm:[2,3,0,1] row_mask:0xf bank_mask:0xf
    v_add_f32_dpp v21, v21, v21 quad_perm:[2,3,0,1] row_mask:0xf bank_mask:0xf
    v_add_f32_dpp v22, v22, v22 quad_perm:[2,3,0,1] row_mask:0xf bank_mask:0xf
    v_add_f32_dpp v23, v23, v23 quad_perm:[2,3,0,1] row_mask:0xf bank_mask:0xf
    v_and_b32 v12, v6, v6
    v_cmp_ne_u32 vcc, 0, v5
    v_cndmask_b32 v13, 0, 1, vcc
    v_and_b32 v13, v13, v6
    v_cmp_eq_u32 vcc, 1, v13
    s_nop 1
    v_cndmask_b32 v16, v16, 0, vcc
    v_cndmask_b32 v17, v17, 0, vcc
    v_cndmask_b32 v18, v18, 0, vcc
    v_cndmask_b32 v19, v19, 0, vcc
    v_cvt_pk_bf16_f32 v32, v16, v17
    v_cvt_pk_bf16_f32 v33, v18, v19
    v_cvt_pk_bf16_f32 v34, v20, v21
    v_cvt_pk_bf16_f32 v35, v22, v23
    v_lshlrev_b32 v10, 8, v5
    v_lshlrev_b32 v11, 4, v4
    v_add_u32 v10, v10, v11
    v_lshrrev_b32 v11, 1, v10
    v_add_u32 v11, 1024, v11
    v_cmp_eq_u32 vcc, 1, v6
    s_nop 1
    v_cndmask_b32 v10, v10, v11, vcc
    v_lshlrev_b32 v11, 1, v8
    v_add_u32 v11, v11, v7
    v_mul_u32_u24 v11, 1536, v11
    v_add_u32 v10, v10, v11
    v_cmp_eq_u32 vcc, 0, v2
    s_and_saveexec_b64 s[62:63], vcc
    v_cmp_eq_u32 vcc, 0, v6
    s_and_saveexec_b64 s[64:65], vcc
    buffer_store_dwordx4 v[32:35], v10, s[44:47], 0 offen
    s_andn2_b64 exec, s[64:65], exec
    buffer_store_dwordx2 v[32:33], v10, s[44:47], 0 offen
    s_endpgm
kvr_kernel_pf:
    s_waitcnt lgkmcnt(0)
    s_mov_b32 s40, s28
    s_mov_b32 s41, s29
    s_and_b32 s41, s41, 0xffff
    s_mov_b32 s42, 8388608
    s_mov_b32 s43, 0x00020000
    s_sub_u32 s61, s2, 596
    s_lshl_b32 s61, s61, 16
    v_lshlrev_b32 v1, 4, v0
    s_add_u32 s62, s61, 0
    buffer_load_dwordx4 v[4:7], v1, s[40:43], s62 offen
    s_add_u32 s62, s61, 4096
    buffer_load_dwordx4 v[8:11], v1, s[40:43], s62 offen
    s_add_u32 s62, s61, 8192
    buffer_load_dwordx4 v[12:15], v1, s[40:43], s62 offen
    s_add_u32 s62, s61, 12288
    buffer_load_dwordx4 v[16:19], v1, s[40:43], s62 offen
    s_add_u32 s62, s61, 16384
    buffer_load_dwordx4 v[20:23], v1, s[40:43], s62 offen
    s_add_u32 s62, s61, 20480
    buffer_load_dwordx4 v[24:27], v1, s[40:43], s62 offen
    s_add_u32 s62, s61, 24576
    buffer_load_dwordx4 v[28:31], v1, s[40:43], s62 offen
    s_add_u32 s62, s61, 28672
    buffer_load_dwordx4 v[32:35], v1, s[40:43], s62 offen
    s_add_u32 s62, s61, 32768
    buffer_load_dwordx4 v[36:39], v1, s[40:43], s62 offen
    s_add_u32 s62, s61, 36864
    buffer_load_dwordx4 v[40:43], v1, s[40:43], s62 offen
    s_add_u32 s62, s61, 40960
    buffer_load_dwordx4 v[44:47], v1, s[40:43], s62 offen
    s_add_u32 s62, s61, 45056
    buffer_load_dwordx4 v[48:51], v1, s[40:43], s62 offen
    s_add_u32 s62, s61, 49152
    buffer_load_dwordx4 v[52:55], v1, s[40:43], s62 offen
    s_add_u32 s62, s61, 53248
    buffer_load_dwordx4 v[56:59], v1, s[40:43], s62 offen
    s_add_u32 s62, s61, 57344
    buffer_load_dwordx4 v[60:63], v1, s[40:43], s62 offen
    s_add_u32 s62, s61, 61440
    buffer_load_dwordx4 v[64:67], v1, s[40:43], s62 offen
    s_waitcnt vmcnt(0)
    s_endpgm
kvr_kernel_tr:
    v_and_b32 v1, 63, v0
    v_lshrrev_b32 v2, 6, v0
    s_nop 0
    v_readfirstlane_b32 s60, v2
    s_sub_u32 s61, s2, 128
    s_waitcnt lgkmcnt(0)
    s_cmp_lt_u32 s61, 288
    s_cbranch_scc1 kvr_kernel_m0
    s_cmp_lt_u32 s61, 432
    s_cbranch_scc1 kvr_kernel_m1
    s_sub_u32 s61, s61, 432
    s_mov_b32 s40, s22
    s_mov_b32 s41, s23
    s_and_b32 s41, s41, 0xffff
    s_mov_b32 s42, 663552
    s_mov_b32 s43, 0x00020000
    s_add_u32 s44, s38, 81788928
    s_addc_u32 s45, s39, 0
    s_and_b32 s45, s45, 0xffff
    s_mov_b32 s46, 663552
    s_mov_b32 s47, 0x00020000
    s_mul_hi_u32 s63, s61, 477218589
    s_mul_i32 s62, s63, 9
    s_sub_u32 s62, s61, s62
    s_movk_i32 s64, 1152
    s_movk_i32 s65, 1152
    s_branch kvr_kernel_go
kvr_kernel_m0:
    s_mov_b32 s40, s26
    s_mov_b32 s41, s27
    s_and_b32 s41, s41, 0xffff
    s_mov_b32 s42, 5308416
    s_mov_b32 s43, 0x00020000
    s_add_u32 s44, s38, 71303168
    s_addc_u32 s45, s39, 0
    s_and_b32 s45, s45, 0xffff
    s_mov_b32 s46, 5308416
    s_mov_b32 s47, 0x00020000
    s_mul_hi_u32 s63, s61, 477218589
    s_mul_i32 s62, s63, 9
    s_sub_u32 s62, s61, s62
    s_movk_i32 s64, 9216
    s_movk_i32 s65, 1152
    s_branch kvr_kernel_go
kvr_kernel_m1:
    s_sub_u32 s61, s61, 288
    s_mov_b32 s40, s32
    s_mov_b32 s41, s33
    s_and_b32 s41, s41, 0xffff
    s_mov_b32 s42, 2654208
    s_mov_b32 s43, 0x00020000
    s_add_u32 s44, s38, 77594624
    s_addc_u32 s45, s39, 0
    s_and_b32 s45, s45, 0xffff
    s_mov_b32 s46, 2654208
    s_mov_b32 s47, 0x00020000
    s_mul_hi_u32 s63, s61, 119304648
    s_mul_i32 s62, s63, 36
    s_sub_u32 s62, s61, s62
    s_movk_i32 s64, 1152
    s_movk_i32 s65, 4608
kvr_kernel_go:
    s_lshl_b32 s66, s62, 6
    s_mul_i32 s66, s66, s64
    s_mul_i32 s67, s63, 288
    s_add_u32 s66, s66, s67
    s_add_u32 s72, s60, 0
    s_lshl_b32 s100, s72, 6
    v_add_u32 v2, s100, v1
    s_mov_b32 s100, 58255
    v_mul_lo_u32 v3, v2, s100
    v_lshrrev_b32 v3, 20, v3
    v_mul_u32_u24 v4, 18, v3
    v_sub_u32 v4, v2, v4
    v_and_b32 v5, 0x73, v3
    v_and_b32 v6, 4, v3
    v_lshlrev_b32 v6, 1, v6
    v_or_b32 v5, v5, v6
    v_and_b32 v6, 8, v3
    v_lshrrev_b32 v6, 1, v6
    v_or_b32 v5, v5, v6
    v_mul_lo_u32 v5, v5, s64
    v_lshlrev_b32 v4, 4, v4
    v_add_u32 v10, v5, v4
    s_lshl_b32 s73, s72, 10
    s_mov_b32 m0, s73
    s_nop 0
    buffer_load_dwordx4 v10, s[40:43], s66 offen lds
    s_add_u32 s72, s60, 4
    s_lshl_b32 s100, s72, 6
    v_add_u32 v2, s100, v1
    s_mov_b32 s100, 58255
    v_mul_lo_u32 v3, v2, s100
    v_lshrrev_b32 v3, 20, v3
    v_mul_u32_u24 v4, 18, v3
    v_sub_u32 v4, v2, v4
    v_and_b32 v5, 0x73, v3
    v_and_b32 v6, 4, v3
    v_lshlrev_b32 v6, 1, v6
    v_or_b32 v5, v5, v6
    v_and_b32 v6, 8, v3
    v_lshrrev_b32 v6, 1, v6
    v_or_b32 v5, v5, v6
    v_mul_lo_u32 v5, v5, s64
    v_lshlrev_b32 v4, 4, v4
    v_add_u32 v11, v5, v4
    s_lshl_b32 s73, s72, 10
    s_mov_b32 m0, s73
    s_nop 0
    buffer_load_dwordx4 v11, s[40:43], s66 offen lds
    s_add_u32 s72, s60, 8
    s_lshl_b32 s100, s72, 6
    v_add_u32 v2, s100, v1
    s_mov_b32 s100, 58255
    v_mul_lo_u32 v3, v2, s100
    v_lshrrev_b32 v3, 20, v3
    v_mul_u32_u24 v4, 18, v3
    v_sub_u32 v4, v2, v4
    v_and_b32 v5, 0x73, v3
    v_and_b32 v6, 4, v3
    v_lshlrev_b32 v6, 1, v6
    v_or_b32 v5, v5, v6
    v_and_b32 v6, 8, v3
    v_lshrrev_b32 v6, 1, v6
    v_or_b32 v5, v5, v6
    v_mul_lo_u32 v5, v5, s64
    v_lshlrev_b32 v4, 4, v4
    v_add_u32 v12, v5, v4
    s_lshl_b32 s73, s72, 10
    s_mov_b32 m0, s73
    s_nop 0
    buffer_load_dwordx4 v12, s[40:43], s66 offen lds
    s_add_u32 s72, s60, 12
    s_lshl_b32 s100, s72, 6
    v_add_u32 v2, s100, v1
    s_mov_b32 s100, 58255
    v_mul_lo_u32 v3, v2, s100
    v_lshrrev_b32 v3, 20, v3
    v_mul_u32_u24 v4, 18, v3
    v_sub_u32 v4, v2, v4
    v_and_b32 v5, 0x73, v3
    v_and_b32 v6, 4, v3
    v_lshlrev_b32 v6, 1, v6
    v_or_b32 v5, v5, v6
    v_and_b32 v6, 8, v3
    v_lshrrev_b32 v6, 1, v6
    v_or_b32 v5, v5, v6
    v_mul_lo_u32 v5, v5, s64
    v_lshlrev_b32 v4, 4, v4
    v_add_u32 v13, v5, v4
    s_lshl_b32 s73, s72, 10
    s_mov_b32 m0, s73
    s_nop 0
    buffer_load_dwordx4 v13, s[40:43], s66 offen lds
    s_add_u32 s72, s60, 16
    s_lshl_b32 s100, s72, 6
    v_add_u32 v2, s100, v1
    s_mov_b32 s100, 58255
    v_mul_lo_u32 v3, v2, s100
    v_lshrrev_b32 v3, 20, v3
    v_mul_u32_u24 v4, 18, v3
    v_sub_u32 v4, v2, v4
    v_and_b32 v5, 0x73, v3
    v_and_b32 v6, 4, v3
    v_lshlrev_b32 v6, 1, v6
    v_or_b32 v5, v5, v6
    v_and_b32 v6, 8, v3
    v_lshrrev_b32 v6, 1, v6
    v_or_b32 v5, v5, v6
    v_mul_lo_u32 v5, v5, s64
    v_lshlrev_b32 v4, 4, v4
    v_add_u32 v14, v5, v4
    s_lshl_b32 s73, s72, 10
    s_mov_b32 m0, s73
    s_nop 0
    buffer_load_dwordx4 v14, s[40:43], s66 offen lds
    v_lshrrev_b32 v2, 5, v1
    v_lshlrev_b32 v2, 4, v2
    v_lshrrev_b32 v3, 4, v1
    v_and_b32 v3, 1, v3
    v_lshlrev_b32 v3, 2, v3
    v_add_u32 v2, v2, v3
    v_lshrrev_b32 v3, 2, v1
    v_and_b32 v3, 3, v3
    v_add_u32 v2, v2, v3
    v_mul_u32_u24 v2, 288, v2
    v_and_b32 v3, 3, v1
    v_lshlrev_b32 v3, 3, v3
    v_add_u32 v20, v2, v3
    v_and_b32 v2, 15, v1
    s_mul_i32 s67, s63, 144
    v_add_u32 v2, s67, v2
    v_mul_lo_u32 v2, v2, s65
    v_lshrrev_b32 v3, 4, v1
    v_lshlrev_b32 v3, 4, v3
    v_add_u32 v2, v2, v3
    s_lshl_b32 s67, s62, 7
    v_add_u32 v2, s67, v2
    s_and_b32 s68, s60, 1
    s_lshr_b32 s69, s60, 1
    s_mul_i32 s70, s68, 9216
    s_lshl_b32 s71, s69, 5
    s_add_u32 s70, s70, s71
    v_add_u32 v20, s70, v20
    s_lshl_b32 s70, s68, 6
    s_lshl_b32 s71, s69, 4
    s_mul_i32 s71, s71, s65
    s_add_u32 s70, s70, s71
    v_add_u32 v2, s70, v2
    s_lshl_b32 s71, s65, 5
    s_waitcnt vmcnt(0)
    s_barrier
    ds_read_b64_tr_b16 v[24:25], v20 offset:0
    ds_read_b64_tr_b16 v[26:27], v20 offset:2304
    ds_read_b64_tr_b16 v[28:29], v20 offset:64
    ds_read_b64_tr_b16 v[30:31], v20 offset:2368
    ds_read_b64_tr_b16 v[32:33], v20 offset:128
    ds_read_b64_tr_b16 v[34:35], v20 offset:2432
    ds_read_b64_tr_b16 v[36:37], v20 offset:192
    ds_read_b64_tr_b16 v[38:39], v20 offset:2496
    ds_read_b64_tr_b16 v[40:41], v20 offset:256
    ds_read_b64_tr_b16 v[42:43], v20 offset:2560
    s_waitcnt lgkmcnt(8)
    buffer_store_dwordx4 v[24:27], v2, s[44:47], 0 offen
    v_add_u32 v2, s71, v2
    s_waitcnt lgkmcnt(6)
    buffer_store_dwordx4 v[28:31], v2, s[44:47], 0 offen
    v_add_u32 v2, s71, v2
    s_waitcnt lgkmcnt(4)
    buffer_store_dwordx4 v[32:35], v2, s[44:47], 0 offen
    v_add_u32 v2, s71, v2
    s_waitcnt lgkmcnt(2)
    buffer_store_dwordx4 v[36:39], v2, s[44:47], 0 offen
    v_add_u32 v2, s71, v2
    s_cmp_ge_u32 s60, 2
    s_cbranch_scc1 kvr_kernel_end
    s_waitcnt lgkmcnt(0)
    buffer_store_dwordx4 v[40:43], v2, s[44:47], 0 offen
    v_add_u32 v2, s71, v2
kvr_kernel_end:
    s_endpgm
.section .rodata,"a"
.p2align 6
.amdhsa_kernel kvr_kernel
  .amdhsa_next_free_vgpr 88
  .amdhsa_next_free_sgpr 102
  .amdhsa_accum_offset 88
  .amdhsa_group_segment_fixed_size 0
  .amdhsa_kernarg_size 96
  .amdhsa_user_sgpr_count 2
  .amdhsa_user_sgpr_kernarg_segment_ptr 1
  .amdhsa_system_sgpr_workgroup_id_x 1
  .amdhsa_float_denorm_mode_32 3
.end_amdhsa_kernel
.text

.globl a2_kernel
.p2align 8
.type a2_kernel,@function
a2_kernel:
    s_cmp_ge_u32 s2, 256
    s_cbranch_scc1 a2_kernel_end
    s_load_dwordx16 s[16:31], s[0:1], 0
    s_load_dwordx8 s[32:39], s[0:1], 64
    v_and_b32 v1, 63, v0
    v_lshrrev_b32 v2, 6, v0
    s_nop 0
    v_readfirstlane_b32 s60, v2
    s_lshr_b32 s61, s2, 2
    s_and_b32 s62, s2, 3
    s_waitcnt lgkmcnt(0)
    s_mov_b32 s40, s16
    s_mov_b32 s41, s17
    s_and_b32 s41, s41, 0xffff
    s_mov_b32 s42, 2359296
    s_mov_b32 s43, 0x00020000
    s_mov_b32 s44, s22
    s_mov_b32 s45, s23
    s_and_b32 s45, s45, 0xffff
    s_mov_b32 s46, 663552
    s_mov_b32 s47, 0x00020000
    s_mov_b32 s48, s38
    s_mov_b32 s49, s39
    s_and_b32 s49, s49, 0xffff
    s_mov_b32 s50, 6291456
    s_mov_b32 s51, 0x00020000
    s_add_u32 s52, s38, 8388608
    s_addc_u32 s53, s39, 0
    s_and_b32 s53, s53, 0xffff
    s_mov_b32 s54, 196608
    s_mov_b32 s55, 0x00020000
    s_add_u32 s56, s38, 9437184
    s_addc_u32 s57, s39, 0
    s_and_b32 s57, s57, 0xffff
    s_mov_b32 s58, 2359296
    s_mov_b32 s59, 0x00020000
    s_add_u32 s76, s38, 49283072
    s_addc_u32 s77, s39, 0
    s_and_b32 s77, s77, 0xffff
    s_mov_b32 s78, 131072
    s_mov_b32 s79, 0x00020000
    s_mov_b32 s82, 0
    s_lshl_b32 s100, s82, 6
    v_add_u32 v2, s100, v1
    s_mov_b32 s100, 58255
    v_mul_lo_u32 v3, v2, s100
    v_lshrrev_b32 v3, 20, v3
    v_mul_u32_u24 v4, 18, v3
    v_sub_u32 v4, v2, v4
    v_and_b32 v5, 0x73, v3
    v_and_b32 v6, 4, v3
    v_lshlrev_b32 v6, 1, v6
    v_or_b32 v5, v5, v6
    v_and_b32 v6, 8, v3
    v_lshrrev_b32 v6, 1, v6
    v_or_b32 v5, v5, v6
    s_mov_b32 s100, 1152
    v_mul_lo_u32 v5, v5, s100
    v_lshlrev_b32 v4, 4, v4
    v_add_u32 v10, v5, v4
    s_mul_i32 s84, s62, 288
    v_add_u32 v10, s84, v10
    s_mov_b32 s82, 1
    s_lshl_b32 s100, s82, 6
    v_add_u32 v2, s100, v1
    s_mov_b32 s100, 58255
    v_mul_lo_u32 v3, v2, s100
    v_lshrrev_b32 v3, 20, v3
    v_mul_u32_u24 v4, 18, v3
    v_sub_u32 v4, v2, v4
    v_and_b32 v5, 0x73, v3
    v_and_b32 v6, 4, v3
    v_lshlrev_b32 v6, 1, v6
    v_or_b32 v5, v5, v6
    v_and_b32 v6, 8, v3
    v_lshrrev_b32 v6, 1, v6
    v_or_b32 v5, v5, v6
    s_mov_b32 s100, 1152
    v_mul_lo_u32 v5, v5, s100
    v_lshlrev_b32 v4, 4, v4
    v_add_u32 v11, v5, v4
    s_mul_i32 s84, s62, 288
    v_add_u32 v11, s84, v11
    s_mov_b32 s82, 2
    s_lshl_b32 s100, s82, 6
    v_add_u32 v2, s100, v1
    s_mov_b32 s100, 58255
    v_mul_lo_u32 v3, v2, s100
    v_lshrrev_b32 v3, 20, v3
    v_mul_u32_u24 v4, 18, v3
    v_sub_u32 v4, v2, v4
    v_and_b32 v5, 0x73, v3
    v_and_b32 v6, 4, v3
    v_lshlrev_b32 v6, 1, v6
    v_or_b32 v5, v5, v6
    v_and_b32 v6, 8, v3
    v_lshrrev_b32 v6, 1, v6
    v_or_b32 v5, v5, v6
    s_mov_b32 s100, 1152
    v_mul_lo_u32 v5, v5, s100
    v_lshlrev_b32 v4, 4, v4
    v_add_u32 v12, v5, v4
    s_mul_i32 s84, s62, 288
    v_add_u32 v12, s84, v12
    s_mov_b32 s82, 3
    s_lshl_b32 s100, s82, 6
    v_add_u32 v2, s100, v1
    s_mov_b32 s100, 58255
    v_mul_lo_u32 v3, v2, s100
    v_lshrrev_b32 v3, 20, v3
    v_mul_u32_u24 v4, 18, v3
    v_sub_u32 v4, v2, v4
    v_and_b32 v5, 0x73, v3
    v_and_b32 v6, 4, v3
    v_lshlrev_b32 v6, 1, v6
    v_or_b32 v5, v5, v6
    v_and_b32 v6, 8, v3
    v_lshrrev_b32 v6, 1, v6
    v_or_b32 v5, v5, v6
    s_mov_b32 s100, 1152
    v_mul_lo_u32 v5, v5, s100
    v_lshlrev_b32 v4, 4, v4
    v_add_u32 v13, v5, v4
    s_mul_i32 s84, s62, 288
    v_add_u32 v13, s84, v13
    s_mov_b32 s82, 4
    s_lshl_b32 s100, s82, 6
    v_add_u32 v2, s100, v1
    s_mov_b32 s100, 58255
    v_mul_lo_u32 v3, v2, s100
    v_lshrrev_b32 v3, 20, v3
    v_mul_u32_u24 v4, 18, v3
    v_sub_u32 v4, v2, v4
    v_and_b32 v5, 0x73, v3
    v_and_b32 v6, 4, v3
    v_lshlrev_b32 v6, 1, v6
    v_or_b32 v5, v5, v6
    v_and_b32 v6, 8, v3
    v_lshrrev_b32 v6, 1, v6
    v_or_b32 v5, v5, v6
    s_mov_b32 s100, 1152
    v_mul_lo_u32 v5, v5, s100
    v_lshlrev_b32 v4, 4, v4
    v_add_u32 v14, v5, v4
    s_mul_i32 s84, s62, 288
    v_add_u32 v14, s84, v14
    s_mov_b32 s82, 5
    s_lshl_b32 s100, s82, 6
    v_add_u32 v2, s100, v1
    s_mov_b32 s100, 58255
    v_mul_lo_u32 v3, v2, s100
    v_lshrrev_b32 v3, 20, v3
    v_mul_u32_u24 v4, 18, v3
    v_sub_u32 v4, v2, v4
    v_and_b32 v5, 0x73, v3
    v_and_b32 v6, 4, v3
    v_lshlrev_b32 v6, 1, v6
    v_or_b32 v5, v5, v6
    v_and_b32 v6, 8, v3
    v_lshrrev_b32 v6, 1, v6
    v_or_b32 v5, v5, v6
    s_mov_b32 s100, 1152
    v_mul_lo_u32 v5, v5, s100
    v_lshlrev_b32 v4, 4, v4
    v_add_u32 v15, v5, v4
    s_mul_i32 s84, s62, 288
    v_add_u32 v15, s84, v15
    s_mov_b32 s82, 6
    s_lshl_b32 s100, s82, 6
    v_add_u32 v2, s100, v1
    s_mov_b32 s100, 58255
    v_mul_lo_u32 v3, v2, s100
    v_lshrrev_b32 v3, 20, v3
    v_mul_u32_u24 v4, 18, v3
    v_sub_u32 v4, v2, v4
    v_and_b32 v5, 0x73, v3
    v_and_b32 v6, 4, v3
    v_lshlrev_b32 v6, 1, v6
    v_or_b32 v5, v5, v6
    v_and_b32 v6, 8, v3
    v_lshrrev_b32 v6, 1, v6
    v_or_b32 v5, v5, v6
    s_mov_b32 s100, 1152
    v_mul_lo_u32 v5, v5, s100
    v_lshlrev_b32 v4, 4, v4
    v_add_u32 v16, v5, v4
    s_mul_i32 s84, s62, 288
    v_add_u32 v16, s84, v16
    s_mov_b32 s82, 7
    s_lshl_b32 s100, s82, 6
    v_add_u32 v2, s100, v1
    s_mov_b32 s100, 58255
    v_mul_lo_u32 v3, v2, s100
    v_lshrrev_b32 v3, 20, v3
    v_mul_u32_u24 v4, 18, v3
    v_sub_u32 v4, v2, v4
    v_and_b32 v5, 0x73, v3
    v_and_b32 v6, 4, v3
    v_lshlrev_b32 v6, 1, v6
    v_or_b32 v5, v5, v6
    v_and_b32 v6, 8, v3
    v_lshrrev_b32 v6, 1, v6
    v_or_b32 v5, v5, v6
    s_mov_b32 s100, 1152
    v_mul_lo_u32 v5, v5, s100
    v_lshlrev_b32 v4, 4, v4
    v_add_u32 v17, v5, v4
    s_mul_i32 s84, s62, 288
    v_add_u32 v17, s84, v17
    s_mov_b32 s82, 8
    s_lshl_b32 s100, s82, 6
    v_add_u32 v2, s100, v1
    s_mov_b32 s100, 58255
    v_mul_lo_u32 v3, v2, s100
    v_lshrrev_b32 v3, 20, v3
    v_mul_u32_u24 v4, 18, v3
    v_sub_u32 v4, v2, v4
    v_and_b32 v5, 0x73, v3
    v_and_b32 v6, 4, v3
    v_lshlrev_b32 v6, 1, v6
    v_or_b32 v5, v5, v6
    v_and_b32 v6, 8, v3
    v_lshrrev_b32 v6, 1, v6
    v_or_b32 v5, v5, v6
    s_mov_b32 s100, 1152
    v_mul_lo_u32 v5, v5, s100
    v_lshlrev_b32 v4, 4, v4
    v_add_u32 v18, v5, v4
    s_mul_i32 s84, s62, 288
    v_add_u32 v18, s84, v18
    s_mul_i32 s63, s60, 36864
    s_mul_i32 s65, s60, 27648
    s_add_u32 s65, s65, 37376
    s_mov_b32 s73, s65
    v_and_b32 v2, 15, v1
    v_lshrrev_b32 v3, 4, v1
    s_lshl_b32 s68, s61, 5
    v_add_u32 v4, s68, v2
    s_lshl_b32 s68, s61, 1
    s_mul_i32 s68, s68, 49152
    s_mul_i32 s69, s60, 12288
    s_add_u32 s68, s68, s69
    v_lshlrev_b32 v6, 4, v1
    v_add_u32 v24, s68, v6
    v_add_u32 v25, 49152, v24
    v_lshlrev_b32 v6, 3, v1
    v_add_u32 v30, s68, v6
    v_add_u32 v30, 1024, v30
    v_add_u32 v31, 49152, v30
    s_mul_i32 s68, s60, 24576
    v_lshlrev_b32 v6, 4, v1
    v_add_u32 v26, s68, v6
    v_lshlrev_b32 v6, 3, v1
    v_add_u32 v28, s68, v6
    v_mul_u32_u24 v22, 1168, v2
    v_lshlrev_b32 v6, 3, v3
    v_add_u32 v22, v22, v6
    s_mul_i32 s68, s60, 288
    v_add_u32 v22, s68, v22
    s_mov_b32 s90, 0x358637bd
    s_mov_b32 s91, 0
    s_mov_b32 s92, 0
    buffer_load_dwordx4 v[32:35], v26, s[52:55], s91 offen offset:0
    buffer_load_dwordx2 v[36:37], v28, s[52:55], s91 offen offset:1024
    buffer_load_dwordx4 v[38:41], v26, s[52:55], s91 offen offset:1536
    buffer_load_dwordx2 v[42:43], v28, s[52:55], s91 offen offset:2560
    buffer_load_dwordx4 v[44:47], v24, s[48:51], s92 offen
    buffer_load_dwordx2 v[48:49], v30, s[48:51], s92 offen
    buffer_load_dwordx4 v[50:53], v25, s[48:51], s92 offen
    buffer_load_dwordx2 v[54:55], v31, s[48:51], s92 offen
    s_mov_b32 s91, 3072
    s_mov_b32 s92, 1536
    buffer_load_dwordx4 v[56:59], v26, s[52:55], s91 offen offset:0
    buffer_load_dwordx2 v[60:61], v28, s[52:55], s91 offen offset:1024
    buffer_load_dwordx4 v[62:65], v26, s[52:55], s91 offen offset:1536
    buffer_load_dwordx2 v[66:67], v28, s[52:55], s91 offen offset:2560
    buffer_load_dwordx4 v[68:71], v24, s[48:51], s92 offen
    buffer_load_dwordx2 v[72:73], v30, s[48:51], s92 offen
    buffer_load_dwordx4 v[74:77], v25, s[48:51], s92 offen
    buffer_load_dwordx2 v[78:79], v31, s[48:51], s92 offen
    s_mov_b32 s91, 6144
    s_mov_b32 s92, 3072
    buffer_load_dwordx4 v[80:83], v26, s[52:55], s91 offen offset:0
    buffer_load_dwordx2 v[84:85], v28, s[52:55], s91 offen offset:1024
    buffer_load_dwordx4 v[86:89], v26, s[52:55], s91 offen offset:1536
    buffer_load_dwordx2 v[90:91], v28, s[52:55], s91 offen offset:2560
    buffer_load_dwordx4 v[92:95], v24, s[48:51], s92 offen
    buffer_load_dwordx2 v[96:97], v30, s[48:51], s92 offen
    buffer_load_dwordx4 v[98:101], v25, s[48:51], s92 offen
    buffer_load_dwordx2 v[102:103], v31, s[48:51], s92 offen
    s_mov_b32 s91, 9216
    s_mov_b32 s92, 4608
    buffer_load_dwordx4 v[104:107], v26, s[52:55], s91 offen offset:0
    buffer_load_dwordx2 v[108:109], v28, s[52:55], s91 offen offset:1024
    buffer_load_dwordx4 v[110:113], v26, s[52:55], s91 offen offset:1536
    buffer_load_dwordx2 v[114:115], v28, s[52:55], s91 offen offset:2560
    buffer_load_dwordx4 v[116:119], v24, s[48:51], s92 offen
    buffer_load_dwordx2 v[120:121], v30, s[48:51], s92 offen
    buffer_load_dwordx4 v[122:125], v25, s[48:51], s92 offen
    buffer_load_dwordx2 v[126:127], v31, s[48:51], s92 offen
    s_add_u32 m0, s65, 0
    s_nop 0
    buffer_load_dwordx4 v10, s[44:47], s63 offen lds
    s_add_u32 m0, s65, 1024
    s_nop 0
    buffer_load_dwordx4 v11, s[44:47], s63 offen lds
    s_add_u32 m0, s65, 2048
    s_nop 0
    buffer_load_dwordx4 v12, s[44:47], s63 offen lds
    s_add_u32 m0, s65, 3072
    s_nop 0
    buffer_load_dwordx4 v13, s[44:47], s63 offen lds
    s_add_u32 m0, s65, 4096
    s_nop 0
    buffer_load_dwordx4 v14, s[44:47], s63 offen lds
    s_add_u32 m0, s65, 5120
    s_nop 0
    buffer_load_dwordx4 v15, s[44:47], s63 offen lds
    s_add_u32 m0, s65, 6144
    s_nop 0
    buffer_load_dwordx4 v16, s[44:47], s63 offen lds
    s_add_u32 m0, s65, 7168
    s_nop 0
    buffer_load_dwordx4 v17, s[44:47], s63 offen lds
    s_add_u32 m0, s65, 8192
    s_nop 0
    buffer_load_dwordx4 v18, s[44:47], s63 offen lds
    s_add_u32 s63, s63, 147456
    s_add_u32 s65, s65, 9216
    s_add_u32 s68, s73, 27648
    s_cmp_ge_u32 s65, s68
    s_cselect_b32 s65, s73, s65
    s_add_u32 m0, s65, 0
    s_nop 0
    buffer_load_dwordx4 v10, s[44:47], s63 offen lds
    s_add_u32 m0, s65, 1024
    s_nop 0
    buffer_load_dwordx4 v11, s[44:47], s63 offen lds
    s_add_u32 m0, s65, 2048
    s_nop 0
    buffer_load_dwordx4 v12, s[44:47], s63 offen lds
    s_add_u32 m0, s65, 3072
    s_nop 0
    buffer_load_dwordx4 v13, s[44:47], s63 offen lds
    s_add_u32 m0, s65, 4096
    s_nop 0
    buffer_load_dwordx4 v14, s[44:47], s63 offen lds
    s_add_u32 m0, s65, 5120
    s_nop 0
    buffer_load_dwordx4 v15, s[44:47], s63 offen lds
    s_add_u32 m0, s65, 6144
    s_nop 0
    buffer_load_dwordx4 v16, s[44:47], s63 offen lds
    s_add_u32 m0, s65, 7168
    s_nop 0
    buffer_load_dwordx4 v17, s[44:47], s63 offen lds
    s_add_u32 m0, s65, 8192
    s_nop 0
    buffer_load_dwordx4 v18, s[44:47], s63 offen lds
    s_add_u32 s63, s63, 147456
    s_add_u32 s65, s65, 9216
    s_add_u32 s68, s73, 27648
    s_cmp_ge_u32 s65, s68
    s_cselect_b32 s65, s73, s65
    s_add_u32 m0, s65, 0
    s_nop 0
    buffer_load_dwordx4 v10, s[44:47], s63 offen lds
    s_add_u32 m0, s65, 1024
    s_nop 0
    buffer_load_dwordx4 v11, s[44:47], s63 offen lds
    s_add_u32 m0, s65, 2048
    s_nop 0
    buffer_load_dwordx4 v12, s[44:47], s63 offen lds
    s_add_u32 m0, s65, 3072
    s_nop 0
    buffer_load_dwordx4 v13, s[44:47], s63 offen lds
    s_add_u32 m0, s65, 4096
    s_nop 0
    buffer_load_dwordx4 v14, s[44:47], s63 offen lds
    s_add_u32 m0, s65, 5120
    s_nop 0
    buffer_load_dwordx4 v15, s[44:47], s63 offen lds
    s_add_u32 m0, s65, 6144
    s_nop 0
    buffer_load_dwordx4 v16, s[44:47], s63 offen lds
    s_add_u32 m0, s65, 7168
    s_nop 0
    buffer_load_dwordx4 v17, s[44:47], s63 offen lds
    s_add_u32 m0, s65, 8192
    s_nop 0
    buffer_load_dwordx4 v18, s[44:47], s63 offen lds
    s_add_u32 s63, s63, 147456
    s_add_u32 s65, s65, 9216
    s_add_u32 s68, s73, 27648
    s_cmp_ge_u32 s65, s68
    s_cselect_b32 s65, s73, s65
    v_mul_u32_u24 v5, 1152, v4
    v_lshlrev_b32 v6, 3, v3
    v_add_u32 v5, v5, v6
    s_mul_i32 s68, s62, 288
    s_and_b32 s82, s60, 1
    s_mul_i32 s82, s82, 18432
    s_add_u32 s68, s68, s82
    s_lshr_b32 s82, s60, 1
    s_lshl_b32 s82, s82, 5
    s_add_u32 s68, s68, s82
    v_add_u32 v8, s68, v5
    buffer_load_dwordx2 v[200:201], v8, s[40:43], 0 offen offset:0
    buffer_load_dwordx2 v[202:203], v8, s[40:43], 0 offen offset:64
    buffer_load_dwordx2 v[204:205], v8, s[40:43], 0 offen offset:128
    buffer_load_dwordx2 v[206:207], v8, s[40:43], 0 offen offset:192
    buffer_load_dwordx2 v[208:209], v8, s[40:43], 0 offen offset:256
    s_waitcnt vmcnt(56)
    v_mov_b32 v212, 0
    v_mov_b32 v213, 0
    v_mov_b32 v214, 0
    v_mov_b32 v215, 0
    v_mov_b32 v216, 0
    v_mov_b32 v217, 0
    v_mov_b32 v218, 0
    v_mov_b32 v219, 0
    v_mov_b32 v220, 0
    v_mov_b32 v221, 0
    v_mov_b32 v222, 0
    v_mov_b32 v223, 0
    v_mov_b32 v224, 0
    v_mov_b32 v225, 0
    v_mov_b32 v226, 0
    v_mov_b32 v227, 0
    s_nop 1
    v_mfma_f32_16x16x32_bf16 v[212:215], v[32:35], v[44:47], v[212:215]
    v_mfma_f32_16x16x32_bf16 v[216:219], v[32:35], v[50:53], v[216:219]
    v_mfma_f32_16x16x32_bf16 v[220:223], v[38:41], v[44:47], v[220:223]
    v_mfma_f32_16x16x32_bf16 v[224:227], v[38:41], v[50:53], v[224:227]
    v_mfma_f32_16x16x16_bf16 v[212:215], v[36:37], v[48:49], v[212:215]
    v_mfma_f32_16x16x16_bf16 v[216:219], v[36:37], v[54:55], v[216:219]
    v_mfma_f32_16x16x16_bf16 v[220:223], v[42:43], v[48:49], v[220:223]
    v_mfma_f32_16x16x16_bf16 v[224:227], v[42:43], v[54:55], v[224:227]
    s_mov_b32 s91, 12288
    s_mov_b32 s92, 6144
    buffer_load_dwordx4 v[32:35], v26, s[52:55], s91 offen offset:0
    buffer_load_dwordx2 v[36:37], v28, s[52:55], s91 offen offset:1024
    buffer_load_dwordx4 v[38:41], v26, s[52:55], s91 offen offset:1536
    buffer_load_dwordx2 v[42:43], v28, s[52:55], s91 offen offset:2560
    buffer_load_dwordx4 v[44:47], v24, s[48:51], s92 offen
    buffer_load_dwordx2 v[48:49], v30, s[48:51], s92 offen
    buffer_load_dwordx4 v[50:53], v25, s[48:51], s92 offen
    buffer_load_dwordx2 v[54:55], v31, s[48:51], s92 offen
    s_nop 3
    v_add_f32 v228, s90, v222
    v_rcp_f32 v228, v228
    s_nop 0
    v_mul_f32 v212, v212, v228
    v_mul_f32 v213, v213, v228
    v_mul_f32 v214, v214, v228
    v_mul_f32 v215, v215, v228
    v_mul_f32 v220, v220, v228
    v_mul_f32 v221, v221, v228
    v_cvt_pk_bf16_f32 v229, v212, v213
    v_cvt_pk_bf16_f32 v230, v214, v215
    v_cvt_pk_bf16_f32 v231, v220, v221
    ds_write_b32 v22, v229 offset:0
    ds_write_b32 v22, v230 offset:4
    s_mov_b64 s[80:81], exec
    v_cmp_gt_u32 vcc, 16, v1
    s_and_b64 exec, exec, vcc
    ds_write_b32 v22, v231 offset:32
    s_mov_b64 exec, s[80:81]
    v_add_f32 v228, s90, v226
    v_rcp_f32 v228, v228
    s_nop 0
    v_mul_f32 v216, v216, v228
    v_mul_f32 v217, v217, v228
    v_mul_f32 v218, v218, v228
    v_mul_f32 v219, v219, v228
    v_mul_f32 v224, v224, v228
    v_mul_f32 v225, v225, v228
    v_cvt_pk_bf16_f32 v229, v216, v217
    v_cvt_pk_bf16_f32 v230, v218, v219
    v_cvt_pk_bf16_f32 v231, v224, v225
    ds_write_b32 v22, v229 offset:18688
    ds_write_b32 v22, v230 offset:18692
    s_mov_b64 s[80:81], exec
    v_cmp_gt_u32 vcc, 16, v1
    s_and_b64 exec, exec, vcc
    ds_write_b32 v22, v231 offset:18720
    s_mov_b64 exec, s[80:81]
    s_waitcnt vmcnt(56)
    v_mov_b32 v212, 0
    v_mov_b32 v213, 0
    v_mov_b32 v214, 0
    v_mov_b32 v215, 0
    v_mov_b32 v216, 0
    v_mov_b32 v217, 0
    v_mov_b32 v218, 0
    v_mov_b32 v219, 0
    v_mov_b32 v220, 0
    v_mov_b32 v221, 0
    v_mov_b32 v222, 0
    v_mov_b32 v223, 0
    v_mov_b32 v224, 0
    v_mov_b32 v225, 0
    v_mov_b32 v226, 0
    v_mov_b32 v227, 0
    s_nop 1
    v_mfma_f32_16x16x32_bf16 v[212:215], v[56:59], v[68:71], v[212:215]
    v_mfma_f32_16x16x32_bf16 v[216:219], v[56:59], v[74:77], v[216:219]
    v_mfma_f32_16x16x32_bf16 v[220:223], v[62:65], v[68:71], v[220:223]
    v_mfma_f32_16x16x32_bf16 v[224:227], v[62:65], v[74:77], v[224:227]
    v_mfma_f32_16x16x16_bf16 v[212:215], v[60:61], v[72:73], v[212:215]
    v_mfma_f32_16x16x16_bf16 v[216:219], v[60:61], v[78:79], v[216:219]
    v_mfma_f32_16x16x16_bf16 v[220:223], v[66:67], v[72:73], v[220:223]
    v_mfma_f32_16x16x16_bf16 v[224:227], v[66:67], v[78:79], v[224:227]
    s_mov_b32 s91, 15360
    s_mov_b32 s92, 7680
    buffer_load_dwordx4 v[56:59], v26, s[52:55], s91 offen offset:0
    buffer_load_dwordx2 v[60:61], v28, s[52:55], s91 offen offset:1024
    buffer_load_dwordx4 v[62:65], v26, s[52:55], s91 offen offset:1536
    buffer_load_dwordx2 v[66:67], v28, s[52:55], s91 offen offset:2560
    buffer_load_dwordx4 v[68:71], v24, s[48:51], s92 offen
    buffer_load_dwordx2 v[72:73], v30, s[48:51], s92 offen
    buffer_load_dwordx4 v[74:77], v25, s[48:51], s92 offen
    buffer_load_dwordx2 v[78:79], v31, s[48:51], s92 offen
    s_nop 3
    v_add_f32 v228, s90, v222
    v_rcp_f32 v228, v228
    s_nop 0
    v_mul_f32 v212, v212, v228
    v_mul_f32 v213, v213, v228
    v_mul_f32 v214, v214, v228
    v_mul_f32 v215, v215, v228
    v_mul_f32 v220, v220, v228
    v_mul_f32 v221, v221, v228
    v_cvt_pk_bf16_f32 v229, v212, v213
    v_cvt_pk_bf16_f32 v230, v214, v215
    v_cvt_pk_bf16_f32 v231, v220, v221
    ds_write_b32 v22, v229 offset:36
    ds_write_b32 v22, v230 offset:40
    s_mov_b64 s[80:81], exec
    v_cmp_gt_u32 vcc, 16, v1
    s_and_b64 exec, exec, vcc
    ds_write_b32 v22, v231 offset:68
    s_mov_b64 exec, s[80:81]
    v_add_f32 v228, s90, v226
    v_rcp_f32 v228, v228
    s_nop 0
    v_mul_f32 v216, v216, v228
    v_mul_f32 v217, v217, v228
    v_mul_f32 v218, v218, v228
    v_mul_f32 v219, v219, v228
    v_mul_f32 v224, v224, v228
    v_mul_f32 v225, v225, v228
    v_cvt_pk_bf16_f32 v229, v216, v217
    v_cvt_pk_bf16_f32 v230, v218, v219
    v_cvt_pk_bf16_f32 v231, v224, v225
    ds_write_b32 v22, v229 offset:18724
    ds_write_b32 v22, v230 offset:18728
    s_mov_b64 s[80:81], exec
    v_cmp_gt_u32 vcc, 16, v1
    s_and_b64 exec, exec, vcc
    ds_write_b32 v22, v231 offset:18756
    s_mov_b64 exec, s[80:81]
    s_waitcnt vmcnt(56)
    v_mov_b32 v212, 0
    v_mov_b32 v213, 0
    v_mov_b32 v214, 0
    v_mov_b32 v215, 0
    v_mov_b32 v216, 0
    v_mov_b32 v217, 0
    v_mov_b32 v218, 0
    v_mov_b32 v219, 0
    v_mov_b32 v220, 0
    v_mov_b32 v221, 0
    v_mov_b32 v222, 0
    v_mov_b32 v223, 0
    v_mov_b32 v224, 0
    v_mov_b32 v225, 0
    v_mov_b32 v226, 0
    v_mov_b32 v227, 0
    s_nop 1
    v_mfma_f32_16x16x32_bf16 v[212:215], v[80:83], v[92:95], v[212:215]
    v_mfma_f32_16x16x32_bf16 v[216:219], v[80:83], v[98:101], v[216:219]
    v_mfma_f32_16x16x32_bf16 v[220:223], v[86:89], v[92:95], v[220:223]
    v_mfma_f32_16x16x32_bf16 v[224:227], v[86:89], v[98:101], v[224:227]
    v_mfma_f32_16x16x16_bf16 v[212:215], v[84:85], v[96:97], v[212:215]
    v_mfma_f32_16x16x16_bf16 v[216:219], v[84:85], v[102:103], v[216:219]
    v_mfma_f32_16x16x16_bf16 v[220:223], v[90:91], v[96:97], v[220:223]
    v_mfma_f32_16x16x16_bf16 v[224:227], v[90:91], v[102:103], v[224:227]
    s_mov_b32 s91, 18432
    s_mov_b32 s92, 9216
    buffer_load_dwordx4 v[80:83], v26, s[52:55], s91 offen offset:0
    buffer_load_dwordx2 v[84:85], v28, s[52:55], s91 offen offset:1024
    buffer_load_dwordx4 v[86:89], v26, s[52:55], s91 offen offset:1536
    buffer_load_dwordx2 v[90:91], v28, s[52:55], s91 offen offset:2560
    buffer_load_dwordx4 v[92:95], v24, s[48:51], s92 offen
    buffer_load_dwordx2 v[96:97], v30, s[48:51], s92 offen
    buffer_load_dwordx4 v[98:101], v25, s[48:51], s92 offen
    buffer_load_dwordx2 v[102:103], v31, s[48:51], s92 offen
    s_nop 3
    v_add_f32 v228, s90, v222
    v_rcp_f32 v228, v228
    s_nop 0
    v_mul_f32 v212, v212, v228
    v_mul_f32 v213, v213, v228
    v_mul_f32 v214, v214, v228
    v_mul_f32 v215, v215, v228
    v_mul_f32 v220, v220, v228
    v_mul_f32 v221, v221, v228
    v_cvt_pk_bf16_f32 v229, v212, v213
    v_cvt_pk_bf16_f32 v230, v214, v215
    v_cvt_pk_bf16_f32 v231, v220, v221
    ds_write_b32 v22, v229 offset:72
    ds_write_b32 v22, v230 offset:76
    s_mov_b64 s[80:81], exec
    v_cmp_gt_u32 vcc, 16, v1
    s_and_b64 exec, exec, vcc
    ds_write_b32 v22, v231 offset:104
    s_mov_b64 exec, s[80:81]
    v_add_f32 v228, s90, v226
    v_rcp_f32 v228, v228
    s_nop 0
    v_mul_f32 v216, v216, v228
    v_mul_f32 v217, v217, v228
    v_mul_f32 v218, v218, v228
    v_mul_f32 v219, v219, v228
    v_mul_f32 v224, v224, v228
    v_mul_f32 v225, v225, v228
    v_cvt_pk_bf16_f32 v229, v216, v217
    v_cvt_pk_bf16_f32 v230, v218, v219
    v_cvt_pk_bf16_f32 v231, v224, v225
    ds_write_b32 v22, v229 offset:18760
    ds_write_b32 v22, v230 offset:18764
    s_mov_b64 s[80:81], exec
    v_cmp_gt_u32 vcc, 16, v1
    s_and_b64 exec, exec, vcc
    ds_write_b32 v22, v231 offset:18792
    s_mov_b64 exec, s[80:81]
    s_waitcnt vmcnt(56)
    v_mov_b32 v212, 0
    v_mov_b32 v213, 0
    v_mov_b32 v214, 0
    v_mov_b32 v215, 0
    v_mov_b32 v216, 0
    v_mov_b32 v217, 0
    v_mov_b32 v218, 0
    v_mov_b32 v219, 0
    v_mov_b32 v220, 0
    v_mov_b32 v221, 0
    v_mov_b32 v222, 0
    v_mov_b32 v223, 0
    v_mov_b32 v224, 0
    v_mov_b32 v225, 0
    v_mov_b32 v226, 0
    v_mov_b32 v227, 0
    s_nop 1
    v_mfma_f32_16x16x32_bf16 v[212:215], v[104:107], v[116:119], v[212:215]
    v_mfma_f32_16x16x32_bf16 v[216:219], v[104:107], v[122:125], v[216:219]
    v_mfma_f32_16x16x32_bf16 v[220:223], v[110:113], v[116:119], v[220:223]
    v_mfma_f32_16x16x32_bf16 v[224:227], v[110:113], v[122:125], v[224:227]
    v_mfma_f32_16x16x16_bf16 v[212:215], v[108:109], v[120:121], v[212:215]
    v_mfma_f32_16x16x16_bf16 v[216:219], v[108:109], v[126:127], v[216:219]
    v_mfma_f32_16x16x16_bf16 v[220:223], v[114:115], v[120:121], v[220:223]
    v_mfma_f32_16x16x16_bf16 v[224:227], v[114:115], v[126:127], v[224:227]
    s_mov_b32 s91, 21504
    s_mov_b32 s92, 10752
    buffer_load_dwordx4 v[104:107], v26, s[52:55], s91 offen offset:0
    buffer_load_dwordx2 v[108:109], v28, s[52:55], s91 offen offset:1024
    buffer_load_dwordx4 v[110:113], v26, s[52:55], s91 offen offset:1536
    buffer_load_dwordx2 v[114:115], v28, s[52:55], s91 offen offset:2560
    buffer_load_dwordx4 v[116:119], v24, s[48:51], s92 offen
    buffer_load_dwordx2 v[120:121], v30, s[48:51], s92 offen
    buffer_load_dwordx4 v[122:125], v25, s[48:51], s92 offen
    buffer_load_dwordx2 v[126:127], v31, s[48:51], s92 offen
    s_nop 3
    v_add_f32 v228, s90, v222
    v_rcp_f32 v228, v228
    s_nop 0
    v_mul_f32 v212, v212, v228
    v_mul_f32 v213, v213, v228
    v_mul_f32 v214, v214, v228
    v_mul_f32 v215, v215, v228
    v_mul_f32 v220, v220, v228
    v_mul_f32 v221, v221, v228
    v_cvt_pk_bf16_f32 v229, v212, v213
    v_cvt_pk_bf16_f32 v230, v214, v215
    v_cvt_pk_bf16_f32 v231, v220, v221
    ds_write_b32 v22, v229 offset:108
    ds_write_b32 v22, v230 offset:112
    s_mov_b64 s[80:81], exec
    v_cmp_gt_u32 vcc, 16, v1
    s_and_b64 exec, exec, vcc
    ds_write_b32 v22, v231 offset:140
    s_mov_b64 exec, s[80:81]
    v_add_f32 v228, s90, v226
    v_rcp_f32 v228, v228
    s_nop 0
    v_mul_f32 v216, v216, v228
    v_mul_f32 v217, v217, v228
    v_mul_f32 v218, v218, v228
    v_mul_f32 v219, v219, v228
    v_mul_f32 v224, v224, v228
    v_mul_f32 v225, v225, v228
    v_cvt_pk_bf16_f32 v229, v216, v217
    v_cvt_pk_bf16_f32 v230, v218, v219
    v_cvt_pk_bf16_f32 v231, v224, v225
    ds_write_b32 v22, v229 offset:18796
    ds_write_b32 v22, v230 offset:18800
    s_mov_b64 s[80:81], exec
    v_cmp_gt_u32 vcc, 16, v1
    s_and_b64 exec, exec, vcc
    ds_write_b32 v22, v231 offset:18828
    s_mov_b64 exec, s[80:81]
    s_waitcnt vmcnt(24)
    v_mov_b32 v212, 0
    v_mov_b32 v213, 0
    v_mov_b32 v214, 0
    v_mov_b32 v215, 0
    v_mov_b32 v216, 0
    v_mov_b32 v217, 0
    v_mov_b32 v218, 0
    v_mov_b32 v219, 0
    v_mov_b32 v220, 0
    v_mov_b32 v221, 0
    v_mov_b32 v222, 0
    v_mov_b32 v223, 0
    v_mov_b32 v224, 0
    v_mov_b32 v225, 0
    v_mov_b32 v226, 0
    v_mov_b32 v227, 0
    s_nop 1
    v_mfma_f32_16x16x32_bf16 v[212:215], v[32:35], v[44:47], v[212:215]
    v_mfma_f32_16x16x32_bf16 v[216:219], v[32:35], v[50:53], v[216:219]
    v_mfma_f32_16x16x32_bf16 v[220:223], v[38:41], v[44:47], v[220:223]
    v_mfma_f32_16x16x32_bf16 v[224:227], v[38:41], v[50:53], v[224:227]
    v_mfma_f32_16x16x16_bf16 v[212:215], v[36:37], v[48:49], v[212:215]
    v_mfma_f32_16x16x16_bf16 v[216:219], v[36:37], v[54:55], v[216:219]
    v_mfma_f32_16x16x16_bf16 v[220:223], v[42:43], v[48:49], v[220:223]
    v_mfma_f32_16x16x16_bf16 v[224:227], v[42:43], v[54:55], v[224:227]
    s_nop 7
    s_nop 3
    v_add_f32 v228, s90, v222
    v_rcp_f32 v228, v228
    s_nop 0
    v_mul_f32 v212, v212, v228
    v_mul_f32 v213, v213, v228
    v_mul_f32 v214, v214, v228
    v_mul_f32 v215, v215, v228
    v_mul_f32 v220, v220, v228
    v_mul_f32 v221, v221, v228
    v_cvt_pk_bf16_f32 v229, v212, v213
    v_cvt_pk_bf16_f32 v230, v214, v215
    v_cvt_pk_bf16_f32 v231, v220, v221
    ds_write_b32 v22, v229 offset:144
    ds_write_b32 v22, v230 offset:148
    s_mov_b64 s[80:81], exec
    v_cmp_gt_u32 vcc, 16, v1
    s_and_b64 exec, exec, vcc
    ds_write_b32 v22, v231 offset:176
    s_mov_b64 exec, s[80:81]
    v_add_f32 v228, s90, v226
    v_rcp_f32 v228, v228
    s_nop 0
    v_mul_f32 v216, v216, v228
    v_mul_f32 v217, v217, v228
    v_mul_f32 v218, v218, v228
    v_mul_f32 v219, v219, v228
    v_mul_f32 v224, v224, v228
    v_mul_f32 v225, v225, v228
    v_cvt_pk_bf16_f32 v229, v216, v217
    v_cvt_pk_bf16_f32 v230, v218, v219
    v_cvt_pk_bf16_f32 v231, v224, v225
    ds_write_b32 v22, v229 offset:18832
    ds_write_b32 v22, v230 offset:18836
    s_mov_b64 s[80:81], exec
    v_cmp_gt_u32 vcc, 16, v1
    s_and_b64 exec, exec, vcc
    ds_write_b32 v22, v231 offset:18864
    s_mov_b64 exec, s[80:81]
    s_waitcnt vmcnt(16)
    v_mov_b32 v212, 0
    v_mov_b32 v213, 0
    v_mov_b32 v214, 0
    v_mov_b32 v215, 0
    v_mov_b32 v216, 0
    v_mov_b32 v217, 0
    v_mov_b32 v218, 0
    v_mov_b32 v219, 0
    v_mov_b32 v220, 0
    v_mov_b32 v221, 0
    v_mov_b32 v222, 0
    v_mov_b32 v223, 0
    v_mov_b32 v224, 0
    v_mov_b32 v225, 0
    v_mov_b32 v226, 0
    v_mov_b32 v227, 0
    s_nop 1
    v_mfma_f32_16x16x32_bf16 v[212:215], v[56:59], v[68:71], v[212:215]
    v_mfma_f32_16x16x32_bf16 v[216:219], v[56:59], v[74:77], v[216:219]
    v_mfma_f32_16x16x32_bf16 v[220:223], v[62:65], v[68:71], v[220:223]
    v_mfma_f32_16x16x32_bf16 v[224:227], v[62:65], v[74:77], v[224:227]
    v_mfma_f32_16x16x16_bf16 v[212:215], v[60:61], v[72:73], v[212:215]
    v_mfma_f32_16x16x16_bf16 v[216:219], v[60:61], v[78:79], v[216:219]
    v_mfma_f32_16x16x16_bf16 v[220:223], v[66:67], v[72:73], v[220:223]
    v_mfma_f32_16x16x16_bf16 v[224:227], v[66:67], v[78:79], v[224:227]
    s_nop 7
    s_nop 3
    v_add_f32 v228, s90, v222
    v_rcp_f32 v228, v228
    s_nop 0
    v_mul_f32 v212, v212, v228
    v_mul_f32 v213, v213, v228
    v_mul_f32 v214, v214, v228
    v_mul_f32 v215, v215, v228
    v_mul_f32 v220, v220, v228
    v_mul_f32 v221, v221, v228
    v_cvt_pk_bf16_f32 v229, v212, v213
    v_cvt_pk_bf16_f32 v230, v214, v215
    v_cvt_pk_bf16_f32 v231, v220, v221
    ds_write_b32 v22, v229 offset:180
    ds_write_b32 v22, v230 offset:184
    s_mov_b64 s[80:81], exec
    v_cmp_gt_u32 vcc, 16, v1
    s_and_b64 exec, exec, vcc
    ds_write_b32 v22, v231 offset:212
    s_mov_b64 exec, s[80:81]
    v_add_f32 v228, s90, v226
    v_rcp_f32 v228, v228
    s_nop 0
    v_mul_f32 v216, v216, v228
    v_mul_f32 v217, v217, v228
    v_mul_f32 v218, v218, v228
    v_mul_f32 v219, v219, v228
    v_mul_f32 v224, v224, v228
    v_mul_f32 v225, v225, v228
    v_cvt_pk_bf16_f32 v229, v216, v217
    v_cvt_pk_bf16_f32 v230, v218, v219
    v_cvt_pk_bf16_f32 v231, v224, v225
    ds_write_b32 v22, v229 offset:18868
    ds_write_b32 v22, v230 offset:18872
    s_mov_b64 s[80:81], exec
    v_cmp_gt_u32 vcc, 16, v1
    s_and_b64 exec, exec, vcc
    ds_write_b32 v22, v231 offset:18900
    s_mov_b64 exec, s[80:81]
    s_waitcnt vmcnt(8)
    v_mov_b32 v212, 0
    v_mov_b32 v213, 0
    v_mov_b32 v214, 0
    v_mov_b32 v215, 0
    v_mov_b32 v216, 0
    v_mov_b32 v217, 0
    v_mov_b32 v218, 0
    v_mov_b32 v219, 0
    v_mov_b32 v220, 0
    v_mov_b32 v221, 0
    v_mov_b32 v222, 0
    v_mov_b32 v223, 0
    v_mov_b32 v224, 0
    v_mov_b32 v225, 0
    v_mov_b32 v226, 0
    v_mov_b32 v227, 0
    s_nop 1
    v_mfma_f32_16x16x32_bf16 v[212:215], v[80:83], v[92:95], v[212:215]
    v_mfma_f32_16x16x32_bf16 v[216:219], v[80:83], v[98:101], v[216:219]
    v_mfma_f32_16x16x32_bf16 v[220:223], v[86:89], v[92:95], v[220:223]
    v_mfma_f32_16x16x32_bf16 v[224:227], v[86:89], v[98:101], v[224:227]
    v_mfma_f32_16x16x16_bf16 v[212:215], v[84:85], v[96:97], v[212:215]
    v_mfma_f32_16x16x16_bf16 v[216:219], v[84:85], v[102:103], v[216:219]
    v_mfma_f32_16x16x16_bf16 v[220:223], v[90:91], v[96:97], v[220:223]
    v_mfma_f32_16x16x16_bf16 v[224:227], v[90:91], v[102:103], v[224:227]
    s_nop 7
    s_nop 3
    v_add_f32 v228, s90, v222
    v_rcp_f32 v228, v228
    s_nop 0
    v_mul_f32 v212, v212, v228
    v_mul_f32 v213, v213, v228
    v_mul_f32 v214, v214, v228
    v_mul_f32 v215, v215, v228
    v_mul_f32 v220, v220, v228
    v_mul_f32 v221, v221, v228
    v_cvt_pk_bf16_f32 v229, v212, v213
    v_cvt_pk_bf16_f32 v230, v214, v215
    v_cvt_pk_bf16_f32 v231, v220, v221
    ds_write_b32 v22, v229 offset:216
    ds_write_b32 v22, v230 offset:220
    s_mov_b64 s[80:81], exec
    v_cmp_gt_u32 vcc, 16, v1
    s_and_b64 exec, exec, vcc
    ds_write_b32 v22, v231 offset:248
    s_mov_b64 exec, s[80:81]
    v_add_f32 v228, s90, v226
    v_rcp_f32 v228, v228
    s_nop 0
    v_mul_f32 v216, v216, v228
    v_mul_f32 v217, v217, v228
    v_mul_f32 v218, v218, v228
    v_mul_f32 v219, v219, v228
    v_mul_f32 v224, v224, v228
    v_mul_f32 v225, v225, v228
    v_cvt_pk_bf16_f32 v229, v216, v217
    v_cvt_pk_bf16_f32 v230, v218, v219
    v_cvt_pk_bf16_f32 v231, v224, v225
    ds_write_b32 v22, v229 offset:18904
    ds_write_b32 v22, v230 offset:18908
    s_mov_b64 s[80:81], exec
    v_cmp_gt_u32 vcc, 16, v1
    s_and_b64 exec, exec, vcc
    ds_write_b32 v22, v231 offset:18936
    s_mov_b64 exec, s[80:81]
    s_waitcnt vmcnt(0)
    v_mov_b32 v212, 0
    v_mov_b32 v213, 0
    v_mov_b32 v214, 0
    v_mov_b32 v215, 0
    v_mov_b32 v216, 0
    v_mov_b32 v217, 0
    v_mov_b32 v218, 0
    v_mov_b32 v219, 0
    v_mov_b32 v220, 0
    v_mov_b32 v221, 0
    v_mov_b32 v222, 0
    v_mov_b32 v223, 0
    v_mov_b32 v224, 0
    v_mov_b32 v225, 0
    v_mov_b32 v226, 0
    v_mov_b32 v227, 0
    s_nop 1
    v_mfma_f32_16x16x32_bf16 v[212:215], v[104:107], v[116:119], v[212:215]
    v_mfma_f32_16x16x32_bf16 v[216:219], v[104:107], v[122:125], v[216:219]
    v_mfma_f32_16x16x32_bf16 v[220:223], v[110:113], v[116:119], v[220:223]
    v_mfma_f32_16x16x32_bf16 v[224:227], v[110:113], v[122:125], v[224:227]
    v_mfma_f32_16x16x16_bf16 v[212:215], v[108:109], v[120:121], v[212:215]
    v_mfma_f32_16x16x16_bf16 v[216:219], v[108:109], v[126:127], v[216:219]
    v_mfma_f32_16x16x16_bf16 v[220:223], v[114:115], v[120:121], v[220:223]
    v_mfma_f32_16x16x16_bf16 v[224:227], v[114:115], v[126:127], v[224:227]
    s_nop 7
    s_nop 3
    v_add_f32 v228, s90, v222
    v_rcp_f32 v228, v228
    s_nop 0
    v_mul_f32 v212, v212, v228
    v_mul_f32 v213, v213, v228
    v_mul_f32 v214, v214, v228
    v_mul_f32 v215, v215, v228
    v_mul_f32 v220, v220, v228
    v_mul_f32 v221, v221, v228
    v_cvt_pk_bf16_f32 v229, v212, v213
    v_cvt_pk_bf16_f32 v230, v214, v215
    v_cvt_pk_bf16_f32 v231, v220, v221
    ds_write_b32 v22, v229 offset:252
    ds_write_b32 v22, v230 offset:256
    s_mov_b64 s[80:81], exec
    v_cmp_gt_u32 vcc, 16, v1
    s_and_b64 exec, exec, vcc
    ds_write_b32 v22, v231 offset:284
    s_mov_b64 exec, s[80:81]
    v_add_f32 v228, s90, v226
    v_rcp_f32 v228, v228
    s_nop 0
    v_mul_f32 v216, v216, v228
    v_mul_f32 v217, v217, v228
    v_mul_f32 v218, v218, v228
    v_mul_f32 v219, v219, v228
    v_mul_f32 v224, v224, v228
    v_mul_f32 v225, v225, v228
    v_cvt_pk_bf16_f32 v229, v216, v217
    v_cvt_pk_bf16_f32 v230, v218, v219
    v_cvt_pk_bf16_f32 v231, v224, v225
    ds_write_b32 v22, v229 offset:18940
    ds_write_b32 v22, v230 offset:18944
    s_mov_b64 s[80:81], exec
    v_cmp_gt_u32 vcc, 16, v1
    s_and_b64 exec, exec, vcc
    ds_write_b32 v22, v231 offset:18972
    s_mov_b64 exec, s[80:81]
    s_waitcnt vmcnt(0) lgkmcnt(0)
    s_barrier
    v_mul_u32_u24 v20, 1168, v2
    v_lshlrev_b32 v6, 4, v3
    v_add_u32 v20, v20, v6
    s_lshl_b32 s68, s60, 6
    v_add_u32 v20, s68, v20
    v_lshrrev_b32 v2, 5, v1
    v_lshlrev_b32 v2, 4, v2
    v_lshrrev_b32 v3, 4, v1
    v_and_b32 v3, 1, v3
    v_lshlrev_b32 v3, 2, v3
    v_add_u32 v2, v2, v3
    v_lshrrev_b32 v3, 2, v1
    v_and_b32 v3, 3, v3
    v_add_u32 v2, v2, v3
    v_mul_u32_u24 v2, 288, v2
    v_and_b32 v3, 3, v1
    v_lshlrev_b32 v3, 3, v3
    v_add_u32 v26, v2, v3
    v_add_u32 v26, s73, v26
    v_mov_b32 v128, 0
    v_mov_b32 v129, 0
    v_mov_b32 v130, 0
    v_mov_b32 v131, 0
    v_mov_b32 v132, 0
    v_mov_b32 v133, 0
    v_mov_b32 v134, 0
    v_mov_b32 v135, 0
    v_mov_b32 v136, 0
    v_mov_b32 v137, 0
    v_mov_b32 v138, 0
    v_mov_b32 v139, 0
    v_mov_b32 v140, 0
    v_mov_b32 v141, 0
    v_mov_b32 v142, 0
    v_mov_b32 v143, 0
    v_mov_b32 v144, 0
    v_mov_b32 v145, 0
    v_mov_b32 v146, 0
    v_mov_b32 v147, 0
    v_mov_b32 v148, 0
    v_mov_b32 v149, 0
    v_mov_b32 v150, 0
    v_mov_b32 v151, 0
    v_mov_b32 v152, 0
    v_mov_b32 v153, 0
    v_mov_b32 v154, 0
    v_mov_b32 v155, 0
    v_mov_b32 v156, 0
    v_mov_b32 v157, 0
    v_mov_b32 v158, 0
    v_mov_b32 v159, 0
    v_mov_b32 v160, 0
    v_mov_b32 v161, 0
    v_mov_b32 v162, 0
    v_mov_b32 v163, 0
    v_mov_b32 v164, 0
    v_mov_b32 v165, 0
    v_mov_b32 v166, 0
    v_mov_b32 v167, 0
    v_mov_b32 v168, 0
    v_mov_b32 v169, 0
    v_mov_b32 v170, 0
    v_mov_b32 v171, 0
    v_mov_b32 v172, 0
    v_mov_b32 v173, 0
    v_mov_b32 v174, 0
    v_mov_b32 v175, 0
    v_mov_b32 v176, 0
    v_mov_b32 v177, 0
    v_mov_b32 v178, 0
    v_mov_b32 v179, 0
    v_mov_b32 v180, 0
    v_mov_b32 v181, 0
    v_mov_b32 v182, 0
    v_mov_b32 v183, 0
    v_mov_b32 v184, 0
    v_mov_b32 v185, 0
    v_mov_b32 v186, 0
    v_mov_b32 v187, 0
    v_mov_b32 v188, 0
    v_mov_b32 v189, 0
    v_mov_b32 v190, 0
    v_mov_b32 v191, 0
    v_mov_b32 v192, 0
    v_mov_b32 v193, 0
    v_mov_b32 v194, 0
    v_mov_b32 v195, 0
    v_mov_b32 v196, 0
    v_mov_b32 v197, 0
    v_mov_b32 v198, 0
    v_mov_b32 v199, 0
    ds_read_b128 v[32:35], v20 offset:0
    ds_read_b128 v[36:39], v20 offset:18688
    ds_read_b64_tr_b16 v[40:41], v26 offset:0
    ds_read_b64_tr_b16 v[42:43], v26 offset:2304
    ds_read_b64_tr_b16 v[44:45], v26 offset:32
    ds_read_b64_tr_b16 v[46:47], v26 offset:2336
    ds_read_b64_tr_b16 v[48:49], v26 offset:64
    ds_read_b64_tr_b16 v[50:51], v26 offset:2368
    ds_read_b64_tr_b16 v[52:53], v26 offset:96
    ds_read_b64_tr_b16 v[54:55], v26 offset:2400
    ds_read_b64_tr_b16 v[56:57], v26 offset:128
    ds_read_b64_tr_b16 v[58:59], v26 offset:2432
    ds_read_b64_tr_b16 v[60:61], v26 offset:160
    ds_read_b64_tr_b16 v[62:63], v26 offset:2464
    ds_read_b64_tr_b16 v[64:65], v26 offset:192
    ds_read_b64_tr_b16 v[66:67], v26 offset:2496
    ds_read_b64_tr_b16 v[68:69], v26 offset:224
    ds_read_b64_tr_b16 v[70:71], v26 offset:2528
    ds_read_b64_tr_b16 v[72:73], v26 offset:256
    ds_read_b64_tr_b16 v[74:75], v26 offset:2560
    s_waitcnt lgkmcnt(0)
    s_add_u32 m0, s65, 0
    s_nop 0
    buffer_load_dwordx4 v10, s[44:47], s63 offen lds
    s_add_u32 m0, s65, 1024
    s_nop 0
    buffer_load_dwordx4 v11, s[44:47], s63 offen lds
    s_add_u32 m0, s65, 2048
    s_nop 0
    buffer_load_dwordx4 v12, s[44:47], s63 offen lds
    s_add_u32 m0, s65, 3072
    s_nop 0
    buffer_load_dwordx4 v13, s[44:47], s63 offen lds
    s_add_u32 m0, s65, 4096
    s_nop 0
    buffer_load_dwordx4 v14, s[44:47], s63 offen lds
    s_add_u32 m0, s65, 5120
    s_nop 0
    buffer_load_dwordx4 v15, s[44:47], s63 offen lds
    s_add_u32 m0, s65, 6144
    s_nop 0
    buffer_load_dwordx4 v16, s[44:47], s63 offen lds
    s_add_u32 m0, s65, 7168
    s_nop 0
    buffer_load_dwordx4 v17, s[44:47], s63 offen lds
    s_add_u32 m0, s65, 8192
    s_nop 0
    buffer_load_dwordx4 v18, s[44:47], s63 offen lds
    s_add_u32 s63, s63, 147456
    s_add_u32 s65, s65, 9216
    s_add_u32 s68, s73, 27648
    s_cmp_ge_u32 s65, s68
    s_cselect_b32 s65, s73, s65
    ds_read_b128 v[76:79], v20 offset:256
    ds_read_b128 v[80:83], v20 offset:18944
    v_mfma_f32_16x16x32_bf16 v[128:131], v[40:43], v[32:35], v[128:131]
    ds_read_b64_tr_b16 v[84:85], v26 offset:9216
    ds_read_b64_tr_b16 v[86:87], v26 offset:11520
    v_mfma_f32_16x16x32_bf16 v[132:135], v[40:43], v[36:39], v[132:135]
    ds_read_b64_tr_b16 v[88:89], v26 offset:9248
    ds_read_b64_tr_b16 v[90:91], v26 offset:11552
    v_mfma_f32_16x16x32_bf16 v[136:139], v[44:47], v[32:35], v[136:139]
    ds_read_b64_tr_b16 v[92:93], v26 offset:9280
    ds_read_b64_tr_b16 v[94:95], v26 offset:11584
    v_mfma_f32_16x16x32_bf16 v[140:143], v[44:47], v[36:39], v[140:143]
    ds_read_b64_tr_b16 v[96:97], v26 offset:9312
    ds_read_b64_tr_b16 v[98:99], v26 offset:11616
    v_mfma_f32_16x16x32_bf16 v[144:147], v[48:51], v[32:35], v[144:147]
    ds_read_b64_tr_b16 v[100:101], v26 offset:9344
    ds_read_b64_tr_b16 v[102:103], v26 offset:11648
    v_mfma_f32_16x16x32_bf16 v[148:151], v[48:51], v[36:39], v[148:151]
    ds_read_b64_tr_b16 v[104:105], v26 offset:9376
    ds_read_b64_tr_b16 v[106:107], v26 offset:11680
    v_mfma_f32_16x16x32_bf16 v[152:155], v[52:55], v[32:35], v[152:155]
    ds_read_b64_tr_b16 v[108:109], v26 offset:9408
    ds_read_b64_tr_b16 v[110:111], v26 offset:11712
    v_mfma_f32_16x16x32_bf16 v[156:159], v[52:55], v[36:39], v[156:159]
    ds_read_b64_tr_b16 v[112:113], v26 offset:9440
    ds_read_b64_tr_b16 v[114:115], v26 offset:11744
    v_mfma_f32_16x16x32_bf16 v[160:163], v[56:59], v[32:35], v[160:163]
    ds_read_b64_tr_b16 v[116:117], v26 offset:9472
    ds_read_b64_tr_b16 v[118:119], v26 offset:11776
    v_mfma_f32_16x16x32_bf16 v[164:167], v[56:59], v[36:39], v[164:167]
    v_mfma_f32_16x16x32_bf16 v[168:171], v[60:63], v[32:35], v[168:171]
    v_mfma_f32_16x16x32_bf16 v[172:175], v[60:63], v[36:39], v[172:175]
    v_mfma_f32_16x16x32_bf16 v[176:179], v[64:67], v[32:35], v[176:179]
    v_mfma_f32_16x16x32_bf16 v[180:183], v[64:67], v[36:39], v[180:183]
    v_mfma_f32_16x16x32_bf16 v[184:187], v[68:71], v[32:35], v[184:187]
    v_mfma_f32_16x16x32_bf16 v[188:191], v[68:71], v[36:39], v[188:191]
    v_mfma_f32_16x16x32_bf16 v[192:195], v[72:75], v[32:35], v[192:195]
    v_mfma_f32_16x16x32_bf16 v[196:199], v[72:75], v[36:39], v[196:199]
    s_waitcnt lgkmcnt(0)
    s_add_u32 m0, s65, 0
    s_nop 0
    buffer_load_dwordx4 v10, s[44:47], s63 offen lds
    s_add_u32 m0, s65, 1024
    s_nop 0
    buffer_load_dwordx4 v11, s[44:47], s63 offen lds
    s_add_u32 m0, s65, 2048
    s_nop 0
    buffer_load_dwordx4 v12, s[44:47], s63 offen lds
    s_add_u32 m0, s65, 3072
    s_nop 0
    buffer_load_dwordx4 v13, s[44:47], s63 offen lds
    s_add_u32 m0, s65, 4096
    s_nop 0
    buffer_load_dwordx4 v14, s[44:47], s63 offen lds
    s_add_u32 m0, s65, 5120
    s_nop 0
    buffer_load_dwordx4 v15, s[44:47], s63 offen lds
    s_add_u32 m0, s65, 6144
    s_nop 0
    buffer_load_dwordx4 v16, s[44:47], s63 offen lds
    s_add_u32 m0, s65, 7168
    s_nop 0
    buffer_load_dwordx4 v17, s[44:47], s63 offen lds
    s_add_u32 m0, s65, 8192
    s_nop 0
    buffer_load_dwordx4 v18, s[44:47], s63 offen lds
    s_add_u32 s63, s63, 147456
    s_add_u32 s65, s65, 9216
    s_add_u32 s68, s73, 27648
    s_cmp_ge_u32 s65, s68
    s_cselect_b32 s65, s73, s65
    ds_read_b128 v[32:35], v20 offset:512
    ds_read_b128 v[36:39], v20 offset:19200
    v_mfma_f32_16x16x32_bf16 v[128:131], v[84:87], v[76:79], v[128:131]
    ds_read_b64_tr_b16 v[40:41], v26 offset:18432
    ds_read_b64_tr_b16 v[42:43], v26 offset:20736
    v_mfma_f32_16x16x32_bf16 v[132:135], v[84:87], v[80:83], v[132:135]
    ds_read_b64_tr_b16 v[44:45], v26 offset:18464
    ds_read_b64_tr_b16 v[46:47], v26 offset:20768
    v_mfma_f32_16x16x32_bf16 v[136:139], v[88:91], v[76:79], v[136:139]
    ds_read_b64_tr_b16 v[48:49], v26 offset:18496
    ds_read_b64_tr_b16 v[50:51], v26 offset:20800
    v_mfma_f32_16x16x32_bf16 v[140:143], v[88:91], v[80:83], v[140:143]
    ds_read_b64_tr_b16 v[52:53], v26 offset:18528
    ds_read_b64_tr_b16 v[54:55], v26 offset:20832
    v_mfma_f32_16x16x32_bf16 v[144:147], v[92:95], v[76:79], v[144:147]
    ds_read_b64_tr_b16 v[56:57], v26 offset:18560
    ds_read_b64_tr_b16 v[58:59], v26 offset:20864
    v_mfma_f32_16x16x32_bf16 v[148:151], v[92:95], v[80:83], v[148:151]
    ds_read_b64_tr_b16 v[60:61], v26 offset:18592
    ds_read_b64_tr_b16 v[62:63], v26 offset:20896
    v_mfma_f32_16x16x32_bf16 v[152:155], v[96:99], v[76:79], v[152:155]
    ds_read_b64_tr_b16 v[64:65], v26 offset:18624
    ds_read_b64_tr_b16 v[66:67], v26 offset:20928
    v_mfma_f32_16x16x32_bf16 v[156:159], v[96:99], v[80:83], v[156:159]
    ds_read_b64_tr_b16 v[68:69], v26 offset:18656
    ds_read_b64_tr_b16 v[70:71], v26 offset:20960
    v_mfma_f32_16x16x32_bf16 v[160:163], v[100:103], v[76:79], v[160:163]
    ds_read_b64_tr_b16 v[72:73], v26 offset:18688
    ds_read_b64_tr_b16 v[74:75], v26 offset:20992
    v_mfma_f32_16x16x32_bf16 v[164:167], v[100:103], v[80:83], v[164:167]
    v_mfma_f32_16x16x32_bf16 v[168:171], v[104:107], v[76:79], v[168:171]
    v_mfma_f32_16x16x32_bf16 v[172:175], v[104:107], v[80:83], v[172:175]
    v_mfma_f32_16x16x32_bf16 v[176:179], v[108:111], v[76:79], v[176:179]
    v_mfma_f32_16x16x32_bf16 v[180:183], v[108:111], v[80:83], v[180:183]
    v_mfma_f32_16x16x32_bf16 v[184:187], v[112:115], v[76:79], v[184:187]
    v_mfma_f32_16x16x32_bf16 v[188:191], v[112:115], v[80:83], v[188:191]
    v_mfma_f32_16x16x32_bf16 v[192:195], v[116:119], v[76:79], v[192:195]
    v_mfma_f32_16x16x32_bf16 v[196:199], v[116:119], v[80:83], v[196:199]
    s_waitcnt lgkmcnt(0)
    s_waitcnt vmcnt(9)
    ds_read_b128 v[76:79], v20 offset:768
    ds_read_b128 v[80:83], v20 offset:19456
    v_mfma_f32_16x16x32_bf16 v[128:131], v[40:43], v[32:35], v[128:131]
    ds_read_b64_tr_b16 v[84:85], v26 offset:0
    ds_read_b64_tr_b16 v[86:87], v26 offset:2304
    v_mfma_f32_16x16x32_bf16 v[132:135], v[40:43], v[36:39], v[132:135]
    ds_read_b64_tr_b16 v[88:89], v26 offset:32
    ds_read_b64_tr_b16 v[90:91], v26 offset:2336
    v_mfma_f32_16x16x32_bf16 v[136:139], v[44:47], v[32:35], v[136:139]
    ds_read_b64_tr_b16 v[92:93], v26 offset:64
    ds_read_b64_tr_b16 v[94:95], v26 offset:2368
    v_mfma_f32_16x16x32_bf16 v[140:143], v[44:47], v[36:39], v[140:143]
    ds_read_b64_tr_b16 v[96:97], v26 offset:96
    ds_read_b64_tr_b16 v[98:99], v26 offset:2400
    v_mfma_f32_16x16x32_bf16 v[144:147], v[48:51], v[32:35], v[144:147]
    ds_read_b64_tr_b16 v[100:101], v26 offset:128
    ds_read_b64_tr_b16 v[102:103], v26 offset:2432
    v_mfma_f32_16x16x32_bf16 v[148:151], v[48:51], v[36:39], v[148:151]
    ds_read_b64_tr_b16 v[104:105], v26 offset:160
    ds_read_b64_tr_b16 v[106:107], v26 offset:2464
    v_mfma_f32_16x16x32_bf16 v[152:155], v[52:55], v[32:35], v[152:155]
    ds_read_b64_tr_b16 v[108:109], v26 offset:192
    ds_read_b64_tr_b16 v[110:111], v26 offset:2496
    v_mfma_f32_16x16x32_bf16 v[156:159], v[52:55], v[36:39], v[156:159]
    ds_read_b64_tr_b16 v[112:113], v26 offset:224
    ds_read_b64_tr_b16 v[114:115], v26 offset:2528
    v_mfma_f32_16x16x32_bf16 v[160:163], v[56:59], v[32:35], v[160:163]
    ds_read_b64_tr_b16 v[116:117], v26 offset:256
    ds_read_b64_tr_b16 v[118:119], v26 offset:2560
    v_mfma_f32_16x16x32_bf16 v[164:167], v[56:59], v[36:39], v[164:167]
    v_mfma_f32_16x16x32_bf16 v[168:171], v[60:63], v[32:35], v[168:171]
    v_mfma_f32_16x16x32_bf16 v[172:175], v[60:63], v[36:39], v[172:175]
    v_mfma_f32_16x16x32_bf16 v[176:179], v[64:67], v[32:35], v[176:179]
    v_mfma_f32_16x16x32_bf16 v[180:183], v[64:67], v[36:39], v[180:183]
    v_mfma_f32_16x16x32_bf16 v[184:187], v[68:71], v[32:35], v[184:187]
    v_mfma_f32_16x16x32_bf16 v[188:191], v[68:71], v[36:39], v[188:191]
    v_mfma_f32_16x16x32_bf16 v[192:195], v[72:75], v[32:35], v[192:195]
    v_mfma_f32_16x16x32_bf16 v[196:199], v[72:75], v[36:39], v[196:199]
    s_waitcnt lgkmcnt(0)
    s_waitcnt vmcnt(0)
    ds_read_b128 v[32:35], v20 offset:1024
    ds_read_b128 v[36:39], v20 offset:19712
    v_mfma_f32_16x16x32_bf16 v[128:131], v[84:87], v[76:79], v[128:131]
    ds_read_b64_tr_b16 v[40:41], v26 offset:9216
    ds_read_b64_tr_b16 v[42:43], v26 offset:11520
    v_mfma_f32_16x16x32_bf16 v[132:135], v[84:87], v[80:83], v[132:135]
    ds_read_b64_tr_b16 v[44:45], v26 offset:9248
    ds_read_b64_tr_b16 v[46:47], v26 offset:11552
    v_mfma_f32_16x16x32_bf16 v[136:139], v[88:91], v[76:79], v[136:139]
    ds_read_b64_tr_b16 v[48:49], v26 offset:9280
    ds_read_b64_tr_b16 v[50:51], v26 offset:11584
    v_mfma_f32_16x16x32_bf16 v[140:143], v[88:91], v[80:83], v[140:143]
    ds_read_b64_tr_b16 v[52:53], v26 offset:9312
    ds_read_b64_tr_b16 v[54:55], v26 offset:11616
    v_mfma_f32_16x16x32_bf16 v[144:147], v[92:95], v[76:79], v[144:147]
    ds_read_b64_tr_b16 v[56:57], v26 offset:9344
    ds_read_b64_tr_b16 v[58:59], v26 offset:11648
    v_mfma_f32_16x16x32_bf16 v[148:151], v[92:95], v[80:83], v[148:151]
    ds_read_b64_tr_b16 v[60:61], v26 offset:9376
    ds_read_b64_tr_b16 v[62:63], v26 offset:11680
    v_mfma_f32_16x16x32_bf16 v[152:155], v[96:99], v[76:79], v[152:155]
    ds_read_b64_tr_b16 v[64:65], v26 offset:9408
    ds_read_b64_tr_b16 v[66:67], v26 offset:11712
    v_mfma_f32_16x16x32_bf16 v[156:159], v[96:99], v[80:83], v[156:159]
    ds_read_b64_tr_b16 v[68:69], v26 offset:9440
    ds_read_b64_tr_b16 v[70:71], v26 offset:11744
    v_mfma_f32_16x16x32_bf16 v[160:163], v[100:103], v[76:79], v[160:163]
    ds_read_b64_tr_b16 v[72:73], v26 offset:9472
    ds_read_b64_tr_b16 v[74:75], v26 offset:11776
    v_mfma_f32_16x16x32_bf16 v[164:167], v[100:103], v[80:83], v[164:167]
    v_mfma_f32_16x16x32_bf16 v[168:171], v[104:107], v[76:79], v[168:171]
    v_mfma_f32_16x16x32_bf16 v[172:175], v[104:107], v[80:83], v[172:175]
    v_mfma_f32_16x16x32_bf16 v[176:179], v[108:111], v[76:79], v[176:179]
    v_mfma_f32_16x16x32_bf16 v[180:183], v[108:111], v[80:83], v[180:183]
    v_mfma_f32_16x16x32_bf16 v[184:187], v[112:115], v[76:79], v[184:187]
    v_mfma_f32_16x16x32_bf16 v[188:191], v[112:115], v[80:83], v[188:191]
    v_mfma_f32_16x16x32_bf16 v[192:195], v[116:119], v[76:79], v[192:195]
    v_mfma_f32_16x16x32_bf16 v[196:199], v[116:119], v[80:83], v[196:199]
    s_cmp_ge_u32 s60, 2
    s_cbranch_scc1 a2_kernel_kdone
    s_waitcnt lgkmcnt(0)
    v_mfma_f32_16x16x32_bf16 v[128:131], v[40:43], v[32:35], v[128:131]
    v_mfma_f32_16x16x32_bf16 v[132:135], v[40:43], v[36:39], v[132:135]
    v_mfma_f32_16x16x32_bf16 v[136:139], v[44:47], v[32:35], v[136:139]
    v_mfma_f32_16x16x32_bf16 v[140:143], v[44:47], v[36:39], v[140:143]
    v_mfma_f32_16x16x32_bf16 v[144:147], v[48:51], v[32:35], v[144:147]
    v_mfma_f32_16x16x32_bf16 v[148:151], v[48:51], v[36:39], v[148:151]
    v_mfma_f32_16x16x32_bf16 v[152:155], v[52:55], v[32:35], v[152:155]
    v_mfma_f32_16x16x32_bf16 v[156:159], v[52:55], v[36:39], v[156:159]
    v_mfma_f32_16x16x32_bf16 v[160:163], v[56:59], v[32:35], v[160:163]
    v_mfma_f32_16x16x32_bf16 v[164:167], v[56:59], v[36:39], v[164:167]
    v_mfma_f32_16x16x32_bf16 v[168:171], v[60:63], v[32:35], v[168:171]
    v_mfma_f32_16x16x32_bf16 v[172:175], v[60:63], v[36:39], v[172:175]
    v_mfma_f32_16x16x32_bf16 v[176:179], v[64:67], v[32:35], v[176:179]
    v_mfma_f32_16x16x32_bf16 v[180:183], v[64:67], v[36:39], v[180:183]
    v_mfma_f32_16x16x32_bf16 v[184:187], v[68:71], v[32:35], v[184:187]
    v_mfma_f32_16x16x32_bf16 v[188:191], v[68:71], v[36:39], v[188:191]
    v_mfma_f32_16x16x32_bf16 v[192:195], v[72:75], v[32:35], v[192:195]
    v_mfma_f32_16x16x32_bf16 v[196:199], v[72:75], v[36:39], v[196:199]
a2_kernel_kdone:
    s_waitcnt vmcnt(0) lgkmcnt(0)
    s_barrier
    v_lshlrev_b32 v3, 4, v1
    s_mul_i32 s82, s60, 18432
    v_add_u32 v4, s82, v3
    s_nop 4
    ds_write_b128 v4, v[128:131] offset:0
    ds_write_b128 v4, v[132:135] offset:1024
    ds_write_b128 v4, v[136:139] offset:2048
    ds_write_b128 v4, v[140:143] offset:3072
    ds_write_b128 v4, v[144:147] offset:4096
    ds_write_b128 v4, v[148:151] offset:5120
    ds_write_b128 v4, v[152:155] offset:6144
    ds_write_b128 v4, v[156:159] offset:7168
    ds_write_b128 v4, v[160:163] offset:8192
    ds_write_b128 v4, v[164:167] offset:9216
    ds_write_b128 v4, v[168:171] offset:10240
    ds_write_b128 v4, v[172:175] offset:11264
    ds_write_b128 v4, v[176:179] offset:12288
    ds_write_b128 v4, v[180:183] offset:13312
    ds_write_b128 v4, v[184:187] offset:14336
    ds_write_b128 v4, v[188:191] offset:15360
    ds_write_b128 v4, v[192:195] offset:16384
    ds_write_b128 v4, v[196:199] offset:17408
    s_waitcnt lgkmcnt(0)
    s_barrier
    s_lshl_b32 s82, s60, 10
    v_add_u32 v4, s82, v3
    v_add_u32 v7, 36864, v4
    ds_read_b128 v[32:35], v4 offset:0
    ds_read_b128 v[36:39], v4 offset:18432
    ds_read_b128 v[40:43], v7 offset:0
    ds_read_b128 v[44:47], v7 offset:18432
    ds_read_b128 v[48:51], v4 offset:4096
    ds_read_b128 v[52:55], v4 offset:22528
    ds_read_b128 v[56:59], v7 offset:4096
    ds_read_b128 v[60:63], v7 offset:22528
    ds_read_b128 v[64:67], v4 offset:8192
    ds_read_b128 v[68:71], v4 offset:26624
    ds_read_b128 v[72:75], v7 offset:8192
    ds_read_b128 v[76:79], v7 offset:26624
    ds_read_b128 v[80:83], v4 offset:12288
    ds_read_b128 v[84:87], v4 offset:30720
    ds_read_b128 v[88:91], v7 offset:12288
    ds_read_b128 v[92:95], v7 offset:30720
    ds_read_b128 v[96:99], v4 offset:16384
    ds_read_b128 v[100:103], v4 offset:34816
    ds_read_b128 v[104:107], v7 offset:16384
    ds_read_b128 v[108:111], v7 offset:34816
    v_mov_b32 v10, 0
    v_mov_b32 v11, 0
    s_waitcnt lgkmcnt(15)
    v_add_f32 v32, v32, v36
    v_add_f32 v40, v40, v44
    v_add_f32 v32, v32, v40
    v_add_f32 v33, v33, v37
    v_add_f32 v41, v41, v45
    v_add_f32 v33, v33, v41
    v_add_f32 v34, v34, v38
    v_add_f32 v42, v42, v46
    v_add_f32 v34, v34, v42
    v_add_f32 v35, v35, v39
    v_add_f32 v43, v43, v47
    v_add_f32 v35, v35, v43
    v_lshlrev_b32 v5, 16, v200
    v_and_b32 v6, 0xffff0000, v200
    v_add_f32 v32, v32, v5
    v_add_f32 v33, v33, v6
    v_lshlrev_b32 v5, 16, v201
    v_and_b32 v6, 0xffff0000, v201
    v_add_f32 v34, v34, v5
    v_add_f32 v35, v35, v6
    v_cvt_pk_bf16_f32 v36, v32, v33
    v_cvt_pk_bf16_f32 v37, v34, v35
    buffer_store_dwordx2 v[36:37], v8, s[56:59], 0 offen offset:0
    v_lshlrev_b32 v32, 16, v36
    v_and_b32 v33, 0xffff0000, v36
    v_lshlrev_b32 v34, 16, v37
    v_and_b32 v35, 0xffff0000, v37
    v_add_f32 v10, v10, v32
    v_fmac_f32 v11, v32, v32
    v_add_f32 v10, v10, v33
    v_fmac_f32 v11, v33, v33
    v_add_f32 v10, v10, v34
    v_fmac_f32 v11, v34, v34
    v_add_f32 v10, v10, v35
    v_fmac_f32 v11, v35, v35
    s_waitcnt lgkmcnt(12)
    v_add_f32 v48, v48, v52
    v_add_f32 v56, v56, v60
    v_add_f32 v48, v48, v56
    v_add_f32 v49, v49, v53
    v_add_f32 v57, v57, v61
    v_add_f32 v49, v49, v57
    v_add_f32 v50, v50, v54
    v_add_f32 v58, v58, v62
    v_add_f32 v50, v50, v58
    v_add_f32 v51, v51, v55
    v_add_f32 v59, v59, v63
    v_add_f32 v51, v51, v59
    v_lshlrev_b32 v5, 16, v202
    v_and_b32 v6, 0xffff0000, v202
    v_add_f32 v48, v48, v5
    v_add_f32 v49, v49, v6
    v_lshlrev_b32 v5, 16, v203
    v_and_b32 v6, 0xffff0000, v203
    v_add_f32 v50, v50, v5
    v_add_f32 v51, v51, v6
    v_cvt_pk_bf16_f32 v52, v48, v49
    v_cvt_pk_bf16_f32 v53, v50, v51
    buffer_store_dwordx2 v[52:53], v8, s[56:59], 0 offen offset:64
    v_lshlrev_b32 v48, 16, v52
    v_and_b32 v49, 0xffff0000, v52
    v_lshlrev_b32 v50, 16, v53
    v_and_b32 v51, 0xffff0000, v53
    v_add_f32 v10, v10, v48
    v_fmac_f32 v11, v48, v48
    v_add_f32 v10, v10, v49
    v_fmac_f32 v11, v49, v49
    v_add_f32 v10, v10, v50
    v_fmac_f32 v11, v50, v50
    v_add_f32 v10, v10, v51
    v_fmac_f32 v11, v51, v51
    s_waitcnt lgkmcnt(8)
    v_add_f32 v64, v64, v68
    v_add_f32 v72, v72, v76
    v_add_f32 v64, v64, v72
    v_add_f32 v65, v65, v69
    v_add_f32 v73, v73, v77
    v_add_f32 v65, v65, v73
    v_add_f32 v66, v66, v70
    v_add_f32 v74, v74, v78
    v_add_f32 v66, v66, v74
    v_add_f32 v67, v67, v71
    v_add_f32 v75, v75, v79
    v_add_f32 v67, v67, v75
    v_lshlrev_b32 v5, 16, v204
    v_and_b32 v6, 0xffff0000, v204
    v_add_f32 v64, v64, v5
    v_add_f32 v65, v65, v6
    v_lshlrev_b32 v5, 16, v205
    v_and_b32 v6, 0xffff0000, v205
    v_add_f32 v66, v66, v5
    v_add_f32 v67, v67, v6
    v_cvt_pk_bf16_f32 v68, v64, v65
    v_cvt_pk_bf16_f32 v69, v66, v67
    buffer_store_dwordx2 v[68:69], v8, s[56:59], 0 offen offset:128
    v_lshlrev_b32 v64, 16, v68
    v_and_b32 v65, 0xffff0000, v68
    v_lshlrev_b32 v66, 16, v69
    v_and_b32 v67, 0xffff0000, v69
    v_add_f32 v10, v10, v64
    v_fmac_f32 v11, v64, v64
    v_add_f32 v10, v10, v65
    v_fmac_f32 v11, v65, v65
    v_add_f32 v10, v10, v66
    v_fmac_f32 v11, v66, v66
    v_add_f32 v10, v10, v67
    v_fmac_f32 v11, v67, v67
    s_waitcnt lgkmcnt(4)
    v_add_f32 v80, v80, v84
    v_add_f32 v88, v88, v92
    v_add_f32 v80, v80, v88
    v_add_f32 v81, v81, v85
    v_add_f32 v89, v89, v93
    v_add_f32 v81, v81, v89
    v_add_f32 v82, v82, v86
    v_add_f32 v90, v90, v94
    v_add_f32 v82, v82, v90
    v_add_f32 v83, v83, v87
    v_add_f32 v91, v91, v95
    v_add_f32 v83, v83, v91
    v_lshlrev_b32 v5, 16, v206
    v_and_b32 v6, 0xffff0000, v206
    v_add_f32 v80, v80, v5
    v_add_f32 v81, v81, v6
    v_lshlrev_b32 v5, 16, v207
    v_and_b32 v6, 0xffff0000, v207
    v_add_f32 v82, v82, v5
    v_add_f32 v83, v83, v6
    v_cvt_pk_bf16_f32 v84, v80, v81
    v_cvt_pk_bf16_f32 v85, v82, v83
    buffer_store_dwordx2 v[84:85], v8, s[56:59], 0 offen offset:192
    v_lshlrev_b32 v80, 16, v84
    v_and_b32 v81, 0xffff0000, v84
    v_lshlrev_b32 v82, 16, v85
    v_and_b32 v83, 0xffff0000, v85
    v_add_f32 v10, v10, v80
    v_fmac_f32 v11, v80, v80
    v_add_f32 v10, v10, v81
    v_fmac_f32 v11, v81, v81
    v_add_f32 v10, v10, v82
    v_fmac_f32 v11, v82, v82
    v_add_f32 v10, v10, v83
    v_fmac_f32 v11, v83, v83
    s_cmp_ge_u32 s60, 2
    s_cbranch_scc1 a2_kernel_st
    s_waitcnt lgkmcnt(0)
    v_add_f32 v96, v96, v100
    v_add_f32 v104, v104, v108
    v_add_f32 v96, v96, v104
    v_add_f32 v97, v97, v101
    v_add_f32 v105, v105, v109
    v_add_f32 v97, v97, v105
    v_add_f32 v98, v98, v102
    v_add_f32 v106, v106, v110
    v_add_f32 v98, v98, v106
    v_add_f32 v99, v99, v103
    v_add_f32 v107, v107, v111
    v_add_f32 v99, v99, v107
    v_lshlrev_b32 v5, 16, v208
    v_and_b32 v6, 0xffff0000, v208
    v_add_f32 v96, v96, v5
    v_add_f32 v97, v97, v6
    v_lshlrev_b32 v5, 16, v209
    v_and_b32 v6, 0xffff0000, v209
    v_add_f32 v98, v98, v5
    v_add_f32 v99, v99, v6
    v_cvt_pk_bf16_f32 v100, v96, v97
    v_cvt_pk_bf16_f32 v101, v98, v99
    buffer_store_dwordx2 v[100:101], v8, s[56:59], 0 offen offset:256
    v_lshlrev_b32 v96, 16, v100
    v_and_b32 v97, 0xffff0000, v100
    v_lshlrev_b32 v98, 16, v101
    v_and_b32 v99, 0xffff0000, v101
    v_add_f32 v10, v10, v96
    v_fmac_f32 v11, v96, v96
    v_add_f32 v10, v10, v97
    v_fmac_f32 v11, v97, v97
    v_add_f32 v10, v10, v98
    v_fmac_f32 v11, v98, v98
    v_add_f32 v10, v10, v99
    v_fmac_f32 v11, v99, v99
a2_kernel_st:
    s_nop 1
    v_mov_b32 v12, v10
    v_mov_b32 v13, v11
    s_nop 1
    v_permlane32_swap_b32 v10, v12
    v_permlane32_swap_b32 v11, v13
    s_nop 1
    v_add_f32 v10, v10, v12
    v_add_f32 v11, v11, v13
    v_mov_b32 v12, v10
    v_mov_b32 v13, v11
    s_nop 1
    v_permlane16_swap_b32 v10, v12
    v_permlane16_swap_b32 v11, v13
    s_nop 1
    v_add_f32 v10, v10, v12
    v_add_f32 v11, v11, v13
    v_and_b32 v2, 15, v1
    s_lshl_b32 s82, s61, 5
    s_and_b32 s83, s60, 1
    s_lshl_b32 s83, s83, 4
    s_add_u32 s82, s82, s83
    v_add_u32 v2, s82, v2
    v_lshlrev_b32 v2, 6, v2
    s_lshl_b32 s82, s62, 1
    s_lshr_b32 s83, s60, 1
    s_add_u32 s82, s82, s83
    s_lshl_b32 s82, s82, 3
    v_add_u32 v2, s82, v2
    v_cmp_gt_u32 vcc, 16, v1
    s_and_saveexec_b64 s[80:81], vcc
    buffer_store_dwordx2 v[10:11], v2, s[76:79], 0 offen
a2_kernel_end:
    s_endpgm
.section .rodata,"a"
.p2align 6
.amdhsa_kernel a2_kernel
  .amdhsa_next_free_vgpr 240
  .amdhsa_next_free_sgpr 102
  .amdhsa_accum_offset 240
  .amdhsa_group_segment_fixed_size 0
  .amdhsa_kernarg_size 96
  .amdhsa_user_sgpr_count 2
  .amdhsa_user_sgpr_kernarg_segment_ptr 1
  .amdhsa_system_sgpr_workgroup_id_x 1
  .amdhsa_float_denorm_mode_32 3
.end_amdhsa_kernel
.text

.globl b1_kernel
.p2align 8
.type b1_kernel,@function
b1_kernel:
    s_cmp_ge_u32 s2, 256
    s_cbranch_scc1 b1_kernel_end
    s_load_dwordx16 s[16:31], s[0:1], 0
    s_load_dwordx8 s[32:39], s[0:1], 64
    v_and_b32 v1, 63, v0
    v_lshrrev_b32 v2, 6, v0
    s_nop 0
    v_readfirstlane_b32 s60, v2
    s_and_b32 s68, s2, 7
    s_lshr_b32 s69, s2, 3
    s_and_b32 s61, s68, 3
    s_lshl_b32 s61, s61, 2
    s_and_b32 s72, s69, 3
    s_add_u32 s61, s61, s72
    s_lshr_b32 s62, s69, 2
    s_lshl_b32 s62, s62, 1
    s_lshr_b32 s72, s68, 2
    s_add_u32 s62, s62, s72
    s_and_b32 s70, s60, 3
    s_lshr_b32 s71, s60, 2
    s_waitcnt lgkmcnt(0)
    s_add_u32 s40, s38, 9437184
    s_addc_u32 s41, s39, 0
    s_and_b32 s41, s41, 0xffff
    s_mov_b32 s42, 2359296
    s_mov_b32 s43, 0x00020000
    s_add_u32 s44, s38, 71303168
    s_addc_u32 s45, s39, 0
    s_and_b32 s45, s45, 0xffff
    s_mov_b32 s46, 5308416
    s_mov_b32 s47, 0x00020000
    s_add_u32 s48, s38, 16777216
    s_addc_u32 s49, s39, 0
    s_and_b32 s49, s49, 0xffff
    s_mov_b32 s50, 9437184
    s_mov_b32 s51, 0x00020000
    s_add_u32 s52, s38, 37748736
    s_addc_u32 s53, s39, 0
    s_and_b32 s53, s53, 0xffff
    s_mov_b32 s54, 9437184
    s_mov_b32 s55, 0x00020000
    s_add_u32 s56, s38, 48234496
    s_addc_u32 s57, s39, 0
    s_and_b32 s57, s57, 0xffff
    s_mov_b32 s58, 262144
    s_mov_b32 s59, 0x00020000
    s_add_u32 s76, s38, 49283072
    s_addc_u32 s77, s39, 0
    s_and_b32 s77, s77, 0xffff
    s_mov_b32 s78, 131072
    s_mov_b32 s79, 0x00020000
    s_mov_b32 s80, s36
    s_mov_b32 s81, s37
    s_and_b32 s81, s81, 0xffff
    s_mov_b32 s82, 256
    s_mov_b32 s83, 0x00020000
    v_lshrrev_b32 v5, 3, v1
    s_lshl_b32 s100, s60, 3
    v_add_u32 v5, s100, v5
    v_lshrrev_b32 v6, 1, v5
    v_and_b32 v6, 7, v6
    v_and_b32 v7, 7, v1
    v_xor_b32 v6, v6, v7
    v_lshlrev_b32 v6, 4, v6
    s_mov_b32 s100, 1152
    v_mul_lo_u32 v5, v5, s100
    v_add_u32 v193, v5, v6
    s_mul_i32 s73, s62, 331776
    v_add_u32 v193, s73, v193
    s_lshl_b32 s65, s60, 10
    v_lshrrev_b32 v2, 3, v1
    s_lshl_b32 s72, s60, 3
    v_add_u32 v2, s72, v2
    v_and_b32 v3, 7, v1
    s_lshl_b32 s72, s61, 7
    v_add_u32 v4, s72, v2
    v_mul_u32_u24 v192, 1152, v4
    v_lshlrev_b32 v6, 4, v3
    v_add_u32 v192, v192, v6
    v_lshlrev_b32 v5, 6, v4
    buffer_load_dwordx4 v[8:11], v5, s[76:79], 0 offen offset:0
    buffer_load_dwordx4 v[12:15], v5, s[76:79], 0 offen offset:16
    buffer_load_dwordx4 v[16:19], v5, s[76:79], 0 offen offset:32
    buffer_load_dwordx4 v[20:23], v5, s[76:79], 0 offen offset:48
    v_add_u32 v5, 4096, v5
    buffer_load_dwordx4 v[24:27], v5, s[76:79], 0 offen offset:0
    buffer_load_dwordx4 v[28:31], v5, s[76:79], 0 offen offset:16
    buffer_load_dwordx4 v[32:35], v5, s[76:79], 0 offen offset:32
    buffer_load_dwordx4 v[36:39], v5, s[76:79], 0 offen offset:48
    s_mov_b32 s72, 0
    buffer_load_dwordx4 v[48:51], v192, s[40:43], s72 offen
    s_mov_b32 s72, 73728
    buffer_load_dwordx4 v[52:55], v192, s[40:43], s72 offen
    s_mov_b32 s72, 128
    buffer_load_dwordx4 v[56:59], v192, s[40:43], s72 offen
    s_mov_b32 s72, 73856
    buffer_load_dwordx4 v[60:63], v192, s[40:43], s72 offen
    s_mov_b32 s72, 256
    buffer_load_dwordx4 v[64:67], v192, s[40:43], s72 offen
    s_mov_b32 s72, 73984
    buffer_load_dwordx4 v[68:71], v192, s[40:43], s72 offen
    v_lshrrev_b32 v6, 1, v2
    v_and_b32 v6, 7, v6
    v_xor_b32 v6, v6, v3
    v_lshlrev_b32 v6, 4, v6
    v_lshlrev_b32 v194, 7, v2
    v_add_u32 v194, v194, v6
    v_add_u32 v197, 106496, v194
    s_cmp_ge_u32 s62, 8
    s_cbranch_scc1 b1_kernel_z2
    s_cmp_ge_u32 s60, 4
    s_cbranch_scc1 b1_kernel_z1q4
    s_add_u32 m0, s65, 16384
    s_mov_b32 s72, 0
    buffer_load_dwordx4 v193, s[44:47], s72 offen lds
    s_add_u32 m0, s65, 24576
    s_mov_b32 s72, 73728
    buffer_load_dwordx4 v193, s[44:47], s72 offen lds
    s_add_u32 m0, s65, 32768
    s_mov_b32 s72, 147456
    buffer_load_dwordx4 v193, s[44:47], s72 offen lds
    s_add_u32 m0, s65, 40960
    s_mov_b32 s72, 221184
    buffer_load_dwordx4 v193, s[44:47], s72 offen lds
    s_add_u32 m0, s65, 49152
    s_mov_b32 s72, 294912
    buffer_load_dwordx4 v193, s[44:47], s72 offen lds
    s_add_u32 m0, s65, 69632
    s_mov_b32 s72, 128
    buffer_load_dwordx4 v193, s[44:47], s72 offen lds
    s_add_u32 m0, s65, 77824
    s_mov_b32 s72, 73856
    buffer_load_dwordx4 v193, s[44:47], s72 offen lds
    s_add_u32 m0, s65, 86016
    s_mov_b32 s72, 147584
    buffer_load_dwordx4 v193, s[44:47], s72 offen lds
    s_add_u32 m0, s65, 94208
    s_mov_b32 s72, 221312
    buffer_load_dwordx4 v193, s[44:47], s72 offen lds
    s_add_u32 m0, s65, 102400
    s_mov_b32 s72, 295040
    buffer_load_dwordx4 v193, s[44:47], s72 offen lds
    s_add_u32 m0, s65, 122880
    s_mov_b32 s72, 256
    buffer_load_dwordx4 v193, s[44:47], s72 offen lds
    s_add_u32 m0, s65, 131072
    s_mov_b32 s72, 73984
    buffer_load_dwordx4 v193, s[44:47], s72 offen lds
    s_add_u32 m0, s65, 139264
    s_mov_b32 s72, 147712
    buffer_load_dwordx4 v193, s[44:47], s72 offen lds
    s_add_u32 m0, s65, 147456
    s_mov_b32 s72, 221440
    buffer_load_dwordx4 v193, s[44:47], s72 offen lds
    s_add_u32 m0, s65, 155648
    s_mov_b32 s72, 295168
    buffer_load_dwordx4 v193, s[44:47], s72 offen lds
    s_mov_b32 s72, 384
    buffer_load_dwordx4 v[168:171], v192, s[40:43], s72 offen
    s_mov_b32 s72, 74112
    buffer_load_dwordx4 v[172:175], v192, s[40:43], s72 offen
    s_mov_b32 s72, 512
    buffer_load_dwordx4 v[176:179], v192, s[40:43], s72 offen
    s_mov_b32 s72, 74240
    buffer_load_dwordx4 v[180:183], v192, s[40:43], s72 offen
    s_mov_b32 s87, 0x3ae38e39
    s_waitcnt vmcnt(25)
    v_add_f32 v8, v8, v10
    v_add_f32 v9, v9, v11
    v_add_f32 v8, v8, v12
    v_add_f32 v9, v9, v13
    v_add_f32 v8, v8, v14
    v_add_f32 v9, v9, v15
    v_add_f32 v8, v8, v16
    v_add_f32 v9, v9, v17
    v_add_f32 v8, v8, v18
    v_add_f32 v9, v9, v19
    v_add_f32 v8, v8, v20
    v_add_f32 v9, v9, v21
    v_add_f32 v8, v8, v22
    v_add_f32 v9, v9, v23
    v_mul_f32 v8, s87, v8
    v_mul_f32 v9, s87, v9
    v_fma_f32 v9, -v8, v8, v9
    v_max_f32 v9, 0, v9
    v_add_f32 v9, 0x3727c5ac, v9
    v_rsq_f32 v184, v9
    s_nop 0
    v_mul_f32 v185, v8, v184
    v_sub_f32 v185, 0, v185
    v_add_f32 v24, v24, v26
    v_add_f32 v25, v25, v27
    v_add_f32 v24, v24, v28
    v_add_f32 v25, v25, v29
    v_add_f32 v24, v24, v30
    v_add_f32 v25, v25, v31
    v_add_f32 v24, v24, v32
    v_add_f32 v25, v25, v33
    v_add_f32 v24, v24, v34
    v_add_f32 v25, v25, v35
    v_add_f32 v24, v24, v36
    v_add_f32 v25, v25, v37
    v_add_f32 v24, v24, v38
    v_add_f32 v25, v25, v39
    v_mul_f32 v24, s87, v24
    v_mul_f32 v25, s87, v25
    v_fma_f32 v25, -v24, v24, v25
    v_max_f32 v25, 0, v25
    v_add_f32 v25, 0x3727c5ac, v25
    v_rsq_f32 v186, v25
    s_nop 0
    v_mul_f32 v187, v24, v186
    v_sub_f32 v187, 0, v187
    s_waitcnt vmcnt(19)
    v_lshlrev_b32 v195, 16, v48
    v_and_b32 v196, 0xffff0000, v48
    v_fma_f32 v195, v195, v184, v185
    v_fma_f32 v196, v196, v184, v185
    v_cvt_pk_bf16_f32 v48, v195, v196
    v_lshlrev_b32 v195, 16, v49
    v_and_b32 v196, 0xffff0000, v49
    v_fma_f32 v195, v195, v184, v185
    v_fma_f32 v196, v196, v184, v185
    v_cvt_pk_bf16_f32 v49, v195, v196
    v_lshlrev_b32 v195, 16, v50
    v_and_b32 v196, 0xffff0000, v50
    v_fma_f32 v195, v195, v184, v185
    v_fma_f32 v196, v196, v184, v185
    v_cvt_pk_bf16_f32 v50, v195, v196
    v_lshlrev_b32 v195, 16, v51
    v_and_b32 v196, 0xffff0000, v51
    v_fma_f32 v195, v195, v184, v185
    v_fma_f32 v196, v196, v184, v185
    v_cvt_pk_bf16_f32 v51, v195, v196
    ds_write_b128 v194, v[48:51] offset:0
    v_lshlrev_b32 v195, 16, v52
    v_and_b32 v196, 0xffff0000, v52
    v_fma_f32 v195, v195, v186, v187
    v_fma_f32 v196, v196, v186, v187
    v_cvt_pk_bf16_f32 v52, v195, v196
    v_lshlrev_b32 v195, 16, v53
    v_and_b32 v196, 0xffff0000, v53
    v_fma_f32 v195, v195, v186, v187
    v_fma_f32 v196, v196, v186, v187
    v_cvt_pk_bf16_f32 v53, v195, v196
    v_lshlrev_b32 v195, 16, v54
    v_and_b32 v196, 0xffff0000, v54
    v_fma_f32 v195, v195, v186, v187
    v_fma_f32 v196, v196, v186, v187
    v_cvt_pk_bf16_f32 v54, v195, v196
    v_lshlrev_b32 v195, 16, v55
    v_and_b32 v196, 0xffff0000, v55
    v_fma_f32 v195, v195, v186, v187
    v_fma_f32 v196, v196, v186, v187
    v_cvt_pk_bf16_f32 v55, v195, v196
    ds_write_b128 v194, v[52:55] offset:8192
    v_lshlrev_b32 v195, 16, v56
    v_and_b32 v196, 0xffff0000, v56
    v_fma_f32 v195, v195, v184, v185
    v_fma_f32 v196, v196, v184, v185
    v_cvt_pk_bf16_f32 v56, v195, v196
    v_lshlrev_b32 v195, 16, v57
    v_and_b32 v196, 0xffff0000, v57
    v_fma_f32 v195, v195, v184, v185
    v_fma_f32 v196, v196, v184, v185
    v_cvt_pk_bf16_f32 v57, v195, v196
    v_lshlrev_b32 v195, 16, v58
    v_and_b32 v196, 0xffff0000, v58
    v_fma_f32 v195, v195, v184, v185
    v_fma_f32 v196, v196, v184, v185
    v_cvt_pk_bf16_f32 v58, v195, v196
    v_lshlrev_b32 v195, 16, v59
    v_and_b32 v196, 0xffff0000, v59
    v_fma_f32 v195, v195, v184, v185
    v_fma_f32 v196, v196, v184, v185
    v_cvt_pk_bf16_f32 v59, v195, v196
    ds_write_b128 v194, v[56:59] offset:53248
    v_lshlrev_b32 v195, 16, v60
    v_and_b32 v196, 0xffff0000, v60
    v_fma_f32 v195, v195, v186, v187
    v_fma_f32 v196, v196, v186, v187
    v_cvt_pk_bf16_f32 v60, v195, v196
    v_lshlrev_b32 v195, 16, v61
    v_and_b32 v196, 0xffff0000, v61
    v_fma_f32 v195, v195, v186, v187
    v_fma_f32 v196, v196, v186, v187
    v_cvt_pk_bf16_f32 v61, v195, v196
    v_lshlrev_b32 v195, 16, v62
    v_and_b32 v196, 0xffff0000, v62
    v_fma_f32 v195, v195, v186, v187
    v_fma_f32 v196, v196, v186, v187
    v_cvt_pk_bf16_f32 v62, v195, v196
    v_lshlrev_b32 v195, 16, v63
    v_and_b32 v196, 0xffff0000, v63
    v_fma_f32 v195, v195, v186, v187
    v_fma_f32 v196, v196, v186, v187
    v_cvt_pk_bf16_f32 v63, v195, v196
    ds_write_b128 v194, v[60:63] offset:61440
    v_lshlrev_b32 v195, 16, v64
    v_and_b32 v196, 0xffff0000, v64
    v_fma_f32 v195, v195, v184, v185
    v_fma_f32 v196, v196, v184, v185
    v_cvt_pk_bf16_f32 v64, v195, v196
    v_lshlrev_b32 v195, 16, v65
    v_and_b32 v196, 0xffff0000, v65
    v_fma_f32 v195, v195, v184, v185
    v_fma_f32 v196, v196, v184, v185
    v_cvt_pk_bf16_f32 v65, v195, v196
    v_lshlrev_b32 v195, 16, v66
    v_and_b32 v196, 0xffff0000, v66
    v_fma_f32 v195, v195, v184, v185
    v_fma_f32 v196, v196, v184, v185
    v_cvt_pk_bf16_f32 v66, v195, v196
    v_lshlrev_b32 v195, 16, v67
    v_and_b32 v196, 0xffff0000, v67
    v_fma_f32 v195, v195, v184, v185
    v_fma_f32 v196, v196, v184, v185
    v_cvt_pk_bf16_f32 v67, v195, v196
    ds_write_b128 v197, v[64:67] offset:0
    v_lshlrev_b32 v195, 16, v68
    v_and_b32 v196, 0xffff0000, v68
    v_fma_f32 v195, v195, v186, v187
    v_fma_f32 v196, v196, v186, v187
    v_cvt_pk_bf16_f32 v68, v195, v196
    v_lshlrev_b32 v195, 16, v69
    v_and_b32 v196, 0xffff0000, v69
    v_fma_f32 v195, v195, v186, v187
    v_fma_f32 v196, v196, v186, v187
    v_cvt_pk_bf16_f32 v69, v195, v196
    v_lshlrev_b32 v195, 16, v70
    v_and_b32 v196, 0xffff0000, v70
    v_fma_f32 v195, v195, v186, v187
    v_fma_f32 v196, v196, v186, v187
    v_cvt_pk_bf16_f32 v70, v195, v196
    v_lshlrev_b32 v195, 16, v71
    v_and_b32 v196, 0xffff0000, v71
    v_fma_f32 v195, v195, v186, v187
    v_fma_f32 v196, v196, v186, v187
    v_cvt_pk_bf16_f32 v71, v195, v196
    ds_write_b128 v197, v[68:71] offset:8192
    v_and_b32 v8, 15, v1
    v_lshlrev_b32 v8, 3, v8
    v_lshrrev_b32 v9, 4, v1
    v_lshrrev_b32 v10, 1, v1
    v_and_b32 v10, 7, v10
    v_xor_b32 v9, v9, v10
    v_add_u32 v8, v8, v9
    v_lshlrev_b32 v2, 4, v8
    v_xor_b32 v3, 64, v2
    s_lshl_b32 s68, s70, 12
    v_add_u32 v4, s68, v2
    v_add_u32 v5, s68, v3
    s_mul_i32 s68, s71, 18432
    s_add_u32 s68, s68, 16384
    v_add_u32 v2, s68, v2
    v_add_u32 v3, s68, v3
    v_add_u32 v198, 53248, v4
    v_add_u32 v199, 53248, v5
    v_add_u32 v200, 53248, v2
    v_add_u32 v201, 53248, v3
    v_add_u32 v202, 106496, v4
    v_add_u32 v203, 106496, v5
    v_add_u32 v204, 106496, v2
    v_add_u32 v205, 106496, v3
    v_mov_b32 v96, 0
    v_mov_b32 v97, 0
    v_mov_b32 v98, 0
    v_mov_b32 v99, 0
    v_mov_b32 v100, 0
    v_mov_b32 v101, 0
    v_mov_b32 v102, 0
    v_mov_b32 v103, 0
    v_mov_b32 v104, 0
    v_mov_b32 v105, 0
    v_mov_b32 v106, 0
    v_mov_b32 v107, 0
    v_mov_b32 v108, 0
    v_mov_b32 v109, 0
    v_mov_b32 v110, 0
    v_mov_b32 v111, 0
    v_mov_b32 v112, 0
    v_mov_b32 v113, 0
    v_mov_b32 v114, 0
    v_mov_b32 v115, 0
    v_mov_b32 v116, 0
    v_mov_b32 v117, 0
    v_mov_b32 v118, 0
    v_mov_b32 v119, 0
    v_mov_b32 v120, 0
    v_mov_b32 v121, 0
    v_mov_b32 v122, 0
    v_mov_b32 v123, 0
    v_mov_b32 v124, 0
    v_mov_b32 v125, 0
    v_mov_b32 v126, 0
    v_mov_b32 v127, 0
    v_mov_b32 v128, 0
    v_mov_b32 v129, 0
    v_mov_b32 v130, 0
    v_mov_b32 v131, 0
    v_mov_b32 v132, 0
    v_mov_b32 v133, 0
    v_mov_b32 v134, 0
    v_mov_b32 v135, 0
    v_mov_b32 v136, 0
    v_mov_b32 v137, 0
    v_mov_b32 v138, 0
    v_mov_b32 v139, 0
    v_mov_b32 v140, 0
    v_mov_b32 v141, 0
    v_mov_b32 v142, 0
    v_mov_b32 v143, 0
    v_mov_b32 v144, 0
    v_mov_b32 v145, 0
    v_mov_b32 v146, 0
    v_mov_b32 v147, 0
    v_mov_b32 v148, 0
    v_mov_b32 v149, 0
    v_mov_b32 v150, 0
    v_mov_b32 v151, 0
    v_mov_b32 v152, 0
    v_mov_b32 v153, 0
    v_mov_b32 v154, 0
    v_mov_b32 v155, 0
    v_mov_b32 v156, 0
    v_mov_b32 v157, 0
    v_mov_b32 v158, 0
    v_mov_b32 v159, 0
    v_mov_b32 v160, 0
    v_mov_b32 v161, 0
    v_mov_b32 v162, 0
    v_mov_b32 v163, 0
    v_mov_b32 v164, 0
    v_mov_b32 v165, 0
    v_mov_b32 v166, 0
    v_mov_b32 v167, 0
    s_waitcnt vmcnt(14) lgkmcnt(0)
    s_barrier
    ds_read_b128 v[8:11], v4 offset:0
    ds_read_b128 v[12:15], v4 offset:2048
    ds_read_b128 v[16:19], v2 offset:0
    ds_read_b128 v[20:23], v2 offset:2048
    ds_read_b128 v[24:27], v2 offset:4096
    ds_read_b128 v[28:31], v2 offset:6144
    ds_read_b128 v[32:35], v2 offset:8192
    ds_read_b128 v[36:39], v2 offset:10240
    ds_read_b128 v[40:43], v2 offset:12288
    ds_read_b128 v[44:47], v2 offset:14336
    ds_read_b128 v[48:51], v2 offset:16384
    s_waitcnt lgkmcnt(0)
    v_mfma_f32_16x16x32_bf16 v[96:99], v[16:19], v[8:11], v[96:99]
    ds_read_b128 v[52:55], v5 offset:0
    v_mfma_f32_16x16x32_bf16 v[100:103], v[16:19], v[12:15], v[100:103]
    ds_read_b128 v[56:59], v5 offset:2048
    v_mfma_f32_16x16x32_bf16 v[104:107], v[20:23], v[8:11], v[104:107]
    ds_read_b128 v[60:63], v3 offset:0
    v_mfma_f32_16x16x32_bf16 v[108:111], v[20:23], v[12:15], v[108:111]
    ds_read_b128 v[64:67], v3 offset:2048
    v_mfma_f32_16x16x32_bf16 v[112:115], v[24:27], v[8:11], v[112:115]
    ds_read_b128 v[68:71], v3 offset:4096
    v_mfma_f32_16x16x32_bf16 v[116:119], v[24:27], v[12:15], v[116:119]
    ds_read_b128 v[72:75], v3 offset:6144
    v_mfma_f32_16x16x32_bf16 v[120:123], v[28:31], v[8:11], v[120:123]
    ds_read_b128 v[76:79], v3 offset:8192
    v_mfma_f32_16x16x32_bf16 v[124:127], v[28:31], v[12:15], v[124:127]
    ds_read_b128 v[80:83], v3 offset:10240
    v_mfma_f32_16x16x32_bf16 v[128:131], v[32:35], v[8:11], v[128:131]
    ds_read_b128 v[84:87], v3 offset:12288
    v_mfma_f32_16x16x32_bf16 v[132:135], v[32:35], v[12:15], v[132:135]
    ds_read_b128 v[88:91], v3 offset:14336
    v_mfma_f32_16x16x32_bf16 v[136:139], v[36:39], v[8:11], v[136:139]
    ds_read_b128 v[92:95], v3 offset:16384
    v_mfma_f32_16x16x32_bf16 v[140:143], v[36:39], v[12:15], v[140:143]
    v_mfma_f32_16x16x32_bf16 v[144:147], v[40:43], v[8:11], v[144:147]
    v_mfma_f32_16x16x32_bf16 v[148:151], v[40:43], v[12:15], v[148:151]
    v_mfma_f32_16x16x32_bf16 v[152:155], v[44:47], v[8:11], v[152:155]
    v_mfma_f32_16x16x32_bf16 v[156:159], v[44:47], v[12:15], v[156:159]
    v_mfma_f32_16x16x32_bf16 v[160:163], v[48:51], v[8:11], v[160:163]
    v_mfma_f32_16x16x32_bf16 v[164:167], v[48:51], v[12:15], v[164:167]
    s_waitcnt vmcnt(9) lgkmcnt(0)
    s_barrier
    ds_read_b128 v[8:11], v198 offset:0
    ds_read_b128 v[12:15], v198 offset:2048
    ds_read_b128 v[16:19], v200 offset:0
    ds_read_b128 v[20:23], v200 offset:2048
    ds_read_b128 v[24:27], v200 offset:4096
    v_mfma_f32_16x16x32_bf16 v[96:99], v[60:63], v[52:55], v[96:99]
    ds_read_b128 v[28:31], v200 offset:6144
    ds_read_b128 v[32:35], v200 offset:8192
    ds_read_b128 v[36:39], v200 offset:10240
    ds_read_b128 v[40:43], v200 offset:12288
    ds_read_b128 v[44:47], v200 offset:14336
    v_mfma_f32_16x16x32_bf16 v[100:103], v[60:63], v[56:59], v[100:103]
    ds_read_b128 v[48:51], v200 offset:16384
    s_add_u32 m0, s65, 16384
    s_mov_b32 s72, 384
    buffer_load_dwordx4 v193, s[44:47], s72 offen lds
    s_add_u32 m0, s65, 24576
    v_mfma_f32_16x16x32_bf16 v[104:107], v[64:67], v[52:55], v[104:107]
    s_mov_b32 s72, 74112
    buffer_load_dwordx4 v193, s[44:47], s72 offen lds
    s_add_u32 m0, s65, 32768
    s_mov_b32 s72, 147840
    buffer_load_dwordx4 v193, s[44:47], s72 offen lds
    v_mfma_f32_16x16x32_bf16 v[108:111], v[64:67], v[56:59], v[108:111]
    s_add_u32 m0, s65, 40960
    s_mov_b32 s72, 221568
    buffer_load_dwordx4 v193, s[44:47], s72 offen lds
    s_add_u32 m0, s65, 49152
    s_mov_b32 s72, 295296
    v_mfma_f32_16x16x32_bf16 v[112:115], v[68:71], v[52:55], v[112:115]
    buffer_load_dwordx4 v193, s[44:47], s72 offen lds
    s_waitcnt vmcnt(7)
    v_lshlrev_b32 v195, 16, v168
    v_and_b32 v196, 0xffff0000, v168
    v_fma_f32 v195, v195, v184, v185
    v_mfma_f32_16x16x32_bf16 v[116:119], v[68:71], v[56:59], v[116:119]
    v_fma_f32 v196, v196, v184, v185
    v_cvt_pk_bf16_f32 v168, v195, v196
    v_lshlrev_b32 v195, 16, v169
    v_and_b32 v196, 0xffff0000, v169
    v_fma_f32 v195, v195, v184, v185
    v_mfma_f32_16x16x32_bf16 v[120:123], v[72:75], v[52:55], v[120:123]
    v_fma_f32 v196, v196, v184, v185
    v_cvt_pk_bf16_f32 v169, v195, v196
    v_lshlrev_b32 v195, 16, v170
    v_and_b32 v196, 0xffff0000, v170
    v_fma_f32 v195, v195, v184, v185
    v_mfma_f32_16x16x32_bf16 v[124:127], v[72:75], v[56:59], v[124:127]
    v_fma_f32 v196, v196, v184, v185
    v_cvt_pk_bf16_f32 v170, v195, v196
    v_lshlrev_b32 v195, 16, v171
    v_and_b32 v196, 0xffff0000, v171
    v_fma_f32 v195, v195, v184, v185
    v_mfma_f32_16x16x32_bf16 v[128:131], v[76:79], v[52:55], v[128:131]
    v_fma_f32 v196, v196, v184, v185
    v_cvt_pk_bf16_f32 v171, v195, v196
    ds_write_b128 v194, v[168:171] offset:0
    v_lshlrev_b32 v195, 16, v172
    v_and_b32 v196, 0xffff0000, v172
    v_mfma_f32_16x16x32_bf16 v[132:135], v[76:79], v[56:59], v[132:135]
    v_fma_f32 v195, v195, v186, v187
    v_fma_f32 v196, v196, v186, v187
    v_cvt_pk_bf16_f32 v172, v195, v196
    v_lshlrev_b32 v195, 16, v173
    v_and_b32 v196, 0xffff0000, v173
    v_mfma_f32_16x16x32_bf16 v[136:139], v[80:83], v[52:55], v[136:139]
    v_fma_f32 v195, v195, v186, v187
    v_fma_f32 v196, v196, v186, v187
    v_cvt_pk_bf16_f32 v173, v195, v196
    v_lshlrev_b32 v195, 16, v174
    v_and_b32 v196, 0xffff0000, v174
    v_mfma_f32_16x16x32_bf16 v[140:143], v[80:83], v[56:59], v[140:143]
    v_fma_f32 v195, v195, v186, v187
    v_fma_f32 v196, v196, v186, v187
    v_cvt_pk_bf16_f32 v174, v195, v196
    v_lshlrev_b32 v195, 16, v175
    v_and_b32 v196, 0xffff0000, v175
    v_mfma_f32_16x16x32_bf16 v[144:147], v[84:87], v[52:55], v[144:147]
    v_fma_f32 v195, v195, v186, v187
    v_fma_f32 v196, v196, v186, v187
    v_cvt_pk_bf16_f32 v175, v195, v196
    ds_write_b128 v194, v[172:175] offset:8192
    s_mov_b32 s72, 640
    v_mfma_f32_16x16x32_bf16 v[148:151], v[84:87], v[56:59], v[148:151]
    buffer_load_dwordx4 v[168:171], v192, s[40:43], s72 offen
    s_mov_b32 s72, 74368
    buffer_load_dwordx4 v[172:175], v192, s[40:43], s72 offen
    v_mfma_f32_16x16x32_bf16 v[152:155], v[88:91], v[52:55], v[152:155]
    v_mfma_f32_16x16x32_bf16 v[156:159], v[88:91], v[56:59], v[156:159]
    v_mfma_f32_16x16x32_bf16 v[160:163], v[92:95], v[52:55], v[160:163]
    v_mfma_f32_16x16x32_bf16 v[164:167], v[92:95], v[56:59], v[164:167]
    s_waitcnt lgkmcnt(0)
    v_mfma_f32_16x16x32_bf16 v[96:99], v[16:19], v[8:11], v[96:99]
    ds_read_b128 v[52:55], v199 offset:0
    v_mfma_f32_16x16x32_bf16 v[100:103], v[16:19], v[12:15], v[100:103]
    ds_read_b128 v[56:59], v199 offset:2048
    v_mfma_f32_16x16x32_bf16 v[104:107], v[20:23], v[8:11], v[104:107]
    ds_read_b128 v[60:63], v201 offset:0
    v_mfma_f32_16x16x32_bf16 v[108:111], v[20:23], v[12:15], v[108:111]
    ds_read_b128 v[64:67], v201 offset:2048
    v_mfma_f32_16x16x32_bf16 v[112:115], v[24:27], v[8:11], v[112:115]
    ds_read_b128 v[68:71], v201 offset:4096
    v_mfma_f32_16x16x32_bf16 v[116:119], v[24:27], v[12:15], v[116:119]
    ds_read_b128 v[72:75], v201 offset:6144
    v_mfma_f32_16x16x32_bf16 v[120:123], v[28:31], v[8:11], v[120:123]
    ds_read_b128 v[76:79], v201 offset:8192
    v_mfma_f32_16x16x32_bf16 v[124:127], v[28:31], v[12:15], v[124:127]
    ds_read_b128 v[80:83], v201 offset:10240
    v_mfma_f32_16x16x32_bf16 v[128:131], v[32:35], v[8:11], v[128:131]
    ds_read_b128 v[84:87], v201 offset:12288
    v_mfma_f32_16x16x32_bf16 v[132:135], v[32:35], v[12:15], v[132:135]
    ds_read_b128 v[88:91], v201 offset:14336
    v_mfma_f32_16x16x32_bf16 v[136:139], v[36:39], v[8:11], v[136:139]
    ds_read_b128 v[92:95], v201 offset:16384
    v_mfma_f32_16x16x32_bf16 v[140:143], v[36:39], v[12:15], v[140:143]
    v_mfma_f32_16x16x32_bf16 v[144:147], v[40:43], v[8:11], v[144:147]
    v_mfma_f32_16x16x32_bf16 v[148:151], v[40:43], v[12:15], v[148:151]
    v_mfma_f32_16x16x32_bf16 v[152:155], v[44:47], v[8:11], v[152:155]
    v_mfma_f32_16x16x32_bf16 v[156:159], v[44:47], v[12:15], v[156:159]
    v_mfma_f32_16x16x32_bf16 v[160:163], v[48:51], v[8:11], v[160:163]
    v_mfma_f32_16x16x32_bf16 v[164:167], v[48:51], v[12:15], v[164:167]
    s_waitcnt vmcnt(11) lgkmcnt(0)
    s_barrier
    ds_read_b128 v[8:11], v202 offset:0
    ds_read_b128 v[12:15], v202 offset:2048
    ds_read_b128 v[16:19], v204 offset:0
    ds_read_b128 v[20:23], v204 offset:2048
    ds_read_b128 v[24:27], v204 offset:4096
    v_mfma_f32_16x16x32_bf16 v[96:99], v[60:63], v[52:55], v[96:99]
    ds_read_b128 v[28:31], v204 offset:6144
    ds_read_b128 v[32:35], v204 offset:8192
    ds_read_b128 v[36:39], v204 offset:10240
    ds_read_b128 v[40:43], v204 offset:12288
    ds_read_b128 v[44:47], v204 offset:14336
    v_mfma_f32_16x16x32_bf16 v[100:103], v[60:63], v[56:59], v[100:103]
    ds_read_b128 v[48:51], v204 offset:16384
    s_add_u32 m0, s65, 69632
    s_mov_b32 s72, 512
    buffer_load_dwordx4 v193, s[44:47], s72 offen lds
    s_add_u32 m0, s65, 77824
    v_mfma_f32_16x16x32_bf16 v[104:107], v[64:67], v[52:55], v[104:107]
    s_mov_b32 s72, 74240
    buffer_load_dwordx4 v193, s[44:47], s72 offen lds
    s_add_u32 m0, s65, 86016
    s_mov_b32 s72, 147968
    buffer_load_dwordx4 v193, s[44:47], s72 offen lds
    v_mfma_f32_16x16x32_bf16 v[108:111], v[64:67], v[56:59], v[108:111]
    s_add_u32 m0, s65, 94208
    s_mov_b32 s72, 221696
    buffer_load_dwordx4 v193, s[44:47], s72 offen lds
    s_add_u32 m0, s65, 102400
    s_mov_b32 s72, 295424
    v_mfma_f32_16x16x32_bf16 v[112:115], v[68:71], v[52:55], v[112:115]
    buffer_load_dwordx4 v193, s[44:47], s72 offen lds
    s_waitcnt vmcnt(12)
    v_lshlrev_b32 v195, 16, v176
    v_and_b32 v196, 0xffff0000, v176
    v_fma_f32 v195, v195, v184, v185
    v_mfma_f32_16x16x32_bf16 v[116:119], v[68:71], v[56:59], v[116:119]
    v_fma_f32 v196, v196, v184, v185
    v_cvt_pk_bf16_f32 v176, v195, v196
    v_lshlrev_b32 v195, 16, v177
    v_and_b32 v196, 0xffff0000, v177
    v_fma_f32 v195, v195, v184, v185
    v_mfma_f32_16x16x32_bf16 v[120:123], v[72:75], v[52:55], v[120:123]
    v_fma_f32 v196, v196, v184, v185
    v_cvt_pk_bf16_f32 v177, v195, v196
    v_lshlrev_b32 v195, 16, v178
    v_and_b32 v196, 0xffff0000, v178
    v_fma_f32 v195, v195, v184, v185
    v_mfma_f32_16x16x32_bf16 v[124:127], v[72:75], v[56:59], v[124:127]
    v_fma_f32 v196, v196, v184, v185
    v_cvt_pk_bf16_f32 v178, v195, v196
    v_lshlrev_b32 v195, 16, v179
    v_and_b32 v196, 0xffff0000, v179
    v_fma_f32 v195, v195, v184, v185
    v_mfma_f32_16x16x32_bf16 v[128:131], v[76:79], v[52:55], v[128:131]
    v_fma_f32 v196, v196, v184, v185
    v_cvt_pk_bf16_f32 v179, v195, v196
    ds_write_b128 v194, v[176:179] offset:53248
    v_lshlrev_b32 v195, 16, v180
    v_and_b32 v196, 0xffff0000, v180
    v_mfma_f32_16x16x32_bf16 v[132:135], v[76:79], v[56:59], v[132:135]
    v_fma_f32 v195, v195, v186, v187
    v_fma_f32 v196, v196, v186, v187
    v_cvt_pk_bf16_f32 v180, v195, v196
    v_lshlrev_b32 v195, 16, v181
    v_and_b32 v196, 0xffff0000, v181
    v_mfma_f32_16x16x32_bf16 v[136:139], v[80:83], v[52:55], v[136:139]
    v_fma_f32 v195, v195, v186, v187
    v_fma_f32 v196, v196, v186, v187
    v_cvt_pk_bf16_f32 v181, v195, v196
    v_lshlrev_b32 v195, 16, v182
    v_and_b32 v196, 0xffff0000, v182
    v_mfma_f32_16x16x32_bf16 v[140:143], v[80:83], v[56:59], v[140:143]
    v_fma_f32 v195, v195, v186, v187
    v_fma_f32 v196, v196, v186, v187
    v_cvt_pk_bf16_f32 v182, v195, v196
    v_lshlrev_b32 v195, 16, v183
    v_and_b32 v196, 0xffff0000, v183
    v_mfma_f32_16x16x32_bf16 v[144:147], v[84:87], v[52:55], v[144:147]
    v_fma_f32 v195, v195, v186, v187
    v_fma_f32 v196, v196, v186, v187
    v_cvt_pk_bf16_f32 v183, v195, v196
    ds_write_b128 v194, v[180:183] offset:61440
    s_mov_b32 s72, 768
    v_mfma_f32_16x16x32_bf16 v[148:151], v[84:87], v[56:59], v[148:151]
    buffer_load_dwordx4 v[176:179], v192, s[40:43], s72 offen
    s_mov_b32 s72, 74496
    buffer_load_dwordx4 v[180:183], v192, s[40:43], s72 offen
    v_mfma_f32_16x16x32_bf16 v[152:155], v[88:91], v[52:55], v[152:155]
    v_mfma_f32_16x16x32_bf16 v[156:159], v[88:91], v[56:59], v[156:159]
    v_mfma_f32_16x16x32_bf16 v[160:163], v[92:95], v[52:55], v[160:163]
    v_mfma_f32_16x16x32_bf16 v[164:167], v[92:95], v[56:59], v[164:167]
    s_waitcnt lgkmcnt(0)
    v_mfma_f32_16x16x32_bf16 v[96:99], v[16:19], v[8:11], v[96:99]
    ds_read_b128 v[52:55], v203 offset:0
    v_mfma_f32_16x16x32_bf16 v[100:103], v[16:19], v[12:15], v[100:103]
    ds_read_b128 v[56:59], v203 offset:2048
    v_mfma_f32_16x16x32_bf16 v[104:107], v[20:23], v[8:11], v[104:107]
    ds_read_b128 v[60:63], v205 offset:0
    v_mfma_f32_16x16x32_bf16 v[108:111], v[20:23], v[12:15], v[108:111]
    ds_read_b128 v[64:67], v205 offset:2048
    v_mfma_f32_16x16x32_bf16 v[112:115], v[24:27], v[8:11], v[112:115]
    ds_read_b128 v[68:71], v205 offset:4096
    v_mfma_f32_16x16x32_bf16 v[116:119], v[24:27], v[12:15], v[116:119]
    ds_read_b128 v[72:75], v205 offset:6144
    v_mfma_f32_16x16x32_bf16 v[120:123], v[28:31], v[8:11], v[120:123]
    ds_read_b128 v[76:79], v205 offset:8192
    v_mfma_f32_16x16x32_bf16 v[124:127], v[28:31], v[12:15], v[124:127]
    ds_read_b128 v[80:83], v205 offset:10240
    v_mfma_f32_16x16x32_bf16 v[128:131], v[32:35], v[8:11], v[128:131]
    ds_read_b128 v[84:87], v205 offset:12288
    v_mfma_f32_16x16x32_bf16 v[132:135], v[32:35], v[12:15], v[132:135]
    ds_read_b128 v[88:91], v205 offset:14336
    v_mfma_f32_16x16x32_bf16 v[136:139], v[36:39], v[8:11], v[136:139]
    ds_read_b128 v[92:95], v205 offset:16384
    v_mfma_f32_16x16x32_bf16 v[140:143], v[36:39], v[12:15], v[140:143]
    v_mfma_f32_16x16x32_bf16 v[144:147], v[40:43], v[8:11], v[144:147]
    v_mfma_f32_16x16x32_bf16 v[148:151], v[40:43], v[12:15], v[148:151]
    v_mfma_f32_16x16x32_bf16 v[152:155], v[44:47], v[8:11], v[152:155]
    v_mfma_f32_16x16x32_bf16 v[156:159], v[44:47], v[12:15], v[156:159]
    v_mfma_f32_16x16x32_bf16 v[160:163], v[48:51], v[8:11], v[160:163]
    v_mfma_f32_16x16x32_bf16 v[164:167], v[48:51], v[12:15], v[164:167]
    s_waitcnt vmcnt(9) lgkmcnt(0)
    s_barrier
    ds_read_b128 v[8:11], v4 offset:0
    ds_read_b128 v[12:15], v4 offset:2048
    ds_read_b128 v[16:19], v2 offset:0
    ds_read_b128 v[20:23], v2 offset:2048
    ds_read_b128 v[24:27], v2 offset:4096
    v_mfma_f32_16x16x32_bf16 v[96:99], v[60:63], v[52:55], v[96:99]
    ds_read_b128 v[28:31], v2 offset:6144
    ds_read_b128 v[32:35], v2 offset:8192
    ds_read_b128 v[36:39], v2 offset:10240
    ds_read_b128 v[40:43], v2 offset:12288
    ds_read_b128 v[44:47], v2 offset:14336
    v_mfma_f32_16x16x32_bf16 v[100:103], v[60:63], v[56:59], v[100:103]
    ds_read_b128 v[48:51], v2 offset:16384
    s_add_u32 m0, s65, 122880
    s_mov_b32 s72, 640
    buffer_load_dwordx4 v193, s[44:47], s72 offen lds
    s_add_u32 m0, s65, 131072
    v_mfma_f32_16x16x32_bf16 v[104:107], v[64:67], v[52:55], v[104:107]
    s_mov_b32 s72, 74368
    buffer_load_dwordx4 v193, s[44:47], s72 offen lds
    s_add_u32 m0, s65, 139264
    s_mov_b32 s72, 148096
    buffer_load_dwordx4 v193, s[44:47], s72 offen lds
    v_mfma_f32_16x16x32_bf16 v[108:111], v[64:67], v[56:59], v[108:111]
    s_add_u32 m0, s65, 147456
    s_mov_b32 s72, 221824
    buffer_load_dwordx4 v193, s[44:47], s72 offen lds
    s_add_u32 m0, s65, 155648
    s_mov_b32 s72, 295552
    v_mfma_f32_16x16x32_bf16 v[112:115], v[68:71], v[52:55], v[112:115]
    buffer_load_dwordx4 v193, s[44:47], s72 offen lds
    s_waitcnt vmcnt(12)
    v_lshlrev_b32 v195, 16, v168
    v_and_b32 v196, 0xffff0000, v168
    v_fma_f32 v195, v195, v184, v185
    v_mfma_f32_16x16x32_bf16 v[116:119], v[68:71], v[56:59], v[116:119]
    v_fma_f32 v196, v196, v184, v185
    v_cvt_pk_bf16_f32 v168, v195, v196
    v_lshlrev_b32 v195, 16, v169
    v_and_b32 v196, 0xffff0000, v169
    v_fma_f32 v195, v195, v184, v185
    v_mfma_f32_16x16x32_bf16 v[120:123], v[72:75], v[52:55], v[120:123]
    v_fma_f32 v196, v196, v184, v185
    v_cvt_pk_bf16_f32 v169, v195, v196
    v_lshlrev_b32 v195, 16, v170
    v_and_b32 v196, 0xffff0000, v170
    v_fma_f32 v195, v195, v184, v185
    v_mfma_f32_16x16x32_bf16 v[124:127], v[72:75], v[56:59], v[124:127]
    v_fma_f32 v196, v196, v184, v185
    v_cvt_pk_bf16_f32 v170, v195, v196
    v_lshlrev_b32 v195, 16, v171
    v_and_b32 v196, 0xffff0000, v171
    v_fma_f32 v195, v195, v184, v185
    v_mfma_f32_16x16x32_bf16 v[128:131], v[76:79], v[52:55], v[128:131]
    v_fma_f32 v196, v196, v184, v185
    v_cvt_pk_bf16_f32 v171, v195, v196
    ds_write_b128 v197, v[168:171] offset:0
    v_lshlrev_b32 v195, 16, v172
    v_and_b32 v196, 0xffff0000, v172
    v_mfma_f32_16x16x32_bf16 v[132:135], v[76:79], v[56:59], v[132:135]
    v_fma_f32 v195, v195, v186, v187
    v_fma_f32 v196, v196, v186, v187
    v_cvt_pk_bf16_f32 v172, v195, v196
    v_lshlrev_b32 v195, 16, v173
    v_and_b32 v196, 0xffff0000, v173
    v_mfma_f32_16x16x32_bf16 v[136:139], v[80:83], v[52:55], v[136:139]
    v_fma_f32 v195, v195, v186, v187
    v_fma_f32 v196, v196, v186, v187
    v_cvt_pk_bf16_f32 v173, v195, v196
    v_lshlrev_b32 v195, 16, v174
    v_and_b32 v196, 0xffff0000, v174
    v_mfma_f32_16x16x32_bf16 v[140:143], v[80:83], v[56:59], v[140:143]
    v_fma_f32 v195, v195, v186, v187
    v_fma_f32 v196, v196, v186, v187
    v_cvt_pk_bf16_f32 v174, v195, v196
    v_lshlrev_b32 v195, 16, v175
    v_and_b32 v196, 0xffff0000, v175
    v_mfma_f32_16x16x32_bf16 v[144:147], v[84:87], v[52:55], v[144:147]
    v_fma_f32 v195, v195, v186, v187
    v_fma_f32 v196, v196, v186, v187
    v_cvt_pk_bf16_f32 v175, v195, v196
    ds_write_b128 v197, v[172:175] offset:8192
    s_mov_b32 s72, 896
    v_mfma_f32_16x16x32_bf16 v[148:151], v[84:87], v[56:59], v[148:151]
    buffer_load_dwordx4 v[168:171], v192, s[40:43], s72 offen
    s_mov_b32 s72, 74624
    buffer_load_dwordx4 v[172:175], v192, s[40:43], s72 offen
    v_mfma_f32_16x16x32_bf16 v[152:155], v[88:91], v[52:55], v[152:155]
    v_mfma_f32_16x16x32_bf16 v[156:159], v[88:91], v[56:59], v[156:159]
    v_mfma_f32_16x16x32_bf16 v[160:163], v[92:95], v[52:55], v[160:163]
    v_mfma_f32_16x16x32_bf16 v[164:167], v[92:95], v[56:59], v[164:167]
    s_waitcnt lgkmcnt(0)
    v_mfma_f32_16x16x32_bf16 v[96:99], v[16:19], v[8:11], v[96:99]
    ds_read_b128 v[52:55], v5 offset:0
    v_mfma_f32_16x16x32_bf16 v[100:103], v[16:19], v[12:15], v[100:103]
    ds_read_b128 v[56:59], v5 offset:2048
    v_mfma_f32_16x16x32_bf16 v[104:107], v[20:23], v[8:11], v[104:107]
    ds_read_b128 v[60:63], v3 offset:0
    v_mfma_f32_16x16x32_bf16 v[108:111], v[20:23], v[12:15], v[108:111]
    ds_read_b128 v[64:67], v3 offset:2048
    v_mfma_f32_16x16x32_bf16 v[112:115], v[24:27], v[8:11], v[112:115]
    ds_read_b128 v[68:71], v3 offset:4096
    v_mfma_f32_16x16x32_bf16 v[116:119], v[24:27], v[12:15], v[116:119]
    ds_read_b128 v[72:75], v3 offset:6144
    v_mfma_f32_16x16x32_bf16 v[120:123], v[28:31], v[8:11], v[120:123]
    ds_read_b128 v[76:79], v3 offset:8192
    v_mfma_f32_16x16x32_bf16 v[124:127], v[28:31], v[12:15], v[124:127]
    ds_read_b128 v[80:83], v3 offset:10240
    v_mfma_f32_16x16x32_bf16 v[128:131], v[32:35], v[8:11], v[128:131]
    ds_read_b128 v[84:87], v3 offset:12288
    v_mfma_f32_16x16x32_bf16 v[132:135], v[32:35], v[12:15], v[132:135]
    ds_read_b128 v[88:91], v3 offset:14336
    v_mfma_f32_16x16x32_bf16 v[136:139], v[36:39], v[8:11], v[136:139]
    ds_read_b128 v[92:95], v3 offset:16384
    v_mfma_f32_16x16x32_bf16 v[140:143], v[36:39], v[12:15], v[140:143]
    v_mfma_f32_16x16x32_bf16 v[144:147], v[40:43], v[8:11], v[144:147]
    v_mfma_f32_16x16x32_bf16 v[148:151], v[40:43], v[12:15], v[148:151]
    v_mfma_f32_16x16x32_bf16 v[152:155], v[44:47], v[8:11], v[152:155]
    v_mfma_f32_16x16x32_bf16 v[156:159], v[44:47], v[12:15], v[156:159]
    v_mfma_f32_16x16x32_bf16 v[160:163], v[48:51], v[8:11], v[160:163]
    v_mfma_f32_16x16x32_bf16 v[164:167], v[48:51], v[12:15], v[164:167]
    s_waitcnt vmcnt(9) lgkmcnt(0)
    s_barrier
    ds_read_b128 v[8:11], v198 offset:0
    ds_read_b128 v[12:15], v198 offset:2048
    ds_read_b128 v[16:19], v200 offset:0
    ds_read_b128 v[20:23], v200 offset:2048
    ds_read_b128 v[24:27], v200 offset:4096
    v_mfma_f32_16x16x32_bf16 v[96:99], v[60:63], v[52:55], v[96:99]
    ds_read_b128 v[28:31], v200 offset:6144
    ds_read_b128 v[32:35], v200 offset:8192
    ds_read_b128 v[36:39], v200 offset:10240
    ds_read_b128 v[40:43], v200 offset:12288
    ds_read_b128 v[44:47], v200 offset:14336
    v_mfma_f32_16x16x32_bf16 v[100:103], v[60:63], v[56:59], v[100:103]
    ds_read_b128 v[48:51], v200 offset:16384
    s_add_u32 m0, s65, 16384
    s_mov_b32 s72, 768
    buffer_load_dwordx4 v193, s[44:47], s72 offen lds
    s_add_u32 m0, s65, 24576
    v_mfma_f32_16x16x32_bf16 v[104:107], v[64:67], v[52:55], v[104:107]
    s_mov_b32 s72, 74496
    buffer_load_dwordx4 v193, s[44:47], s72 offen lds
    s_add_u32 m0, s65, 32768
    s_mov_b32 s72, 148224
    buffer_load_dwordx4 v193, s[44:47], s72 offen lds
    v_mfma_f32_16x16x32_bf16 v[108:111], v[64:67], v[56:59], v[108:111]
    s_add_u32 m0, s65, 40960
    s_mov_b32 s72, 221952
    buffer_load_dwordx4 v193, s[44:47], s72 offen lds
    s_add_u32 m0, s65, 49152
    s_mov_b32 s72, 295680
    v_mfma_f32_16x16x32_bf16 v[112:115], v[68:71], v[52:55], v[112:115]
    buffer_load_dwordx4 v193, s[44:47], s72 offen lds
    s_waitcnt vmcnt(12)
    v_lshlrev_b32 v195, 16, v176
    v_and_b32 v196, 0xffff0000, v176
    v_fma_f32 v195, v195, v184, v185
    v_mfma_f32_16x16x32_bf16 v[116:119], v[68:71], v[56:59], v[116:119]
    v_fma_f32 v196, v196, v184, v185
    v_cvt_pk_bf16_f32 v176, v195, v196
    v_lshlrev_b32 v195, 16, v177
    v_and_b32 v196, 0xffff0000, v177
    v_fma_f32 v195, v195, v184, v185
    v_mfma_f32_16x16x32_bf16 v[120:123], v[72:75], v[52:55], v[120:123]
    v_fma_f32 v196, v196, v184, v185
    v_cvt_pk_bf16_f32 v177, v195, v196
    v_lshlrev_b32 v195, 16, v178
    v_and_b32 v196, 0xffff0000, v178
    v_fma_f32 v195, v195, v184, v185
    v_mfma_f32_16x16x32_bf16 v[124:127], v[72:75], v[56:59], v[124:127]
    v_fma_f32 v196, v196, v184, v185
    v_cvt_pk_bf16_f32 v178, v195, v196
    v_lshlrev_b32 v195, 16, v179
    v_and_b32 v196, 0xffff0000, v179
    v_fma_f32 v195, v195, v184, v185
    v_mfma_f32_16x16x32_bf16 v[128:131], v[76:79], v[52:55], v[128:131]
    v_fma_f32 v196, v196, v184, v185
    v_cvt_pk_bf16_f32 v179, v195, v196
    ds_write_b128 v194, v[176:179] offset:0
    v_lshlrev_b32 v195, 16, v180
    v_and_b32 v196, 0xffff0000, v180
    v_mfma_f32_16x16x32_bf16 v[132:135], v[76:79], v[56:59], v[132:135]
    v_fma_f32 v195, v195, v186, v187
    v_fma_f32 v196, v196, v186, v187
    v_cvt_pk_bf16_f32 v180, v195, v196
    v_lshlrev_b32 v195, 16, v181
    v_and_b32 v196, 0xffff0000, v181
    v_mfma_f32_16x16x32_bf16 v[136:139], v[80:83], v[52:55], v[136:139]
    v_fma_f32 v195, v195, v186, v187
    v_fma_f32 v196, v196, v186, v187
    v_cvt_pk_bf16_f32 v181, v195, v196
    v_lshlrev_b32 v195, 16, v182
    v_and_b32 v196, 0xffff0000, v182
    v_mfma_f32_16x16x32_bf16 v[140:143], v[80:83], v[56:59], v[140:143]
    v_fma_f32 v195, v195, v186, v187
    v_fma_f32 v196, v196, v186, v187
    v_cvt_pk_bf16_f32 v182, v195, v196
    v_lshlrev_b32 v195, 16, v183
    v_and_b32 v196, 0xffff0000, v183
    v_mfma_f32_16x16x32_bf16 v[144:147], v[84:87], v[52:55], v[144:147]
    v_fma_f32 v195, v195, v186, v187
    v_fma_f32 v196, v196, v186, v187
    v_cvt_pk_bf16_f32 v183, v195, v196
    ds_write_b128 v194, v[180:183] offset:8192
    s_mov_b32 s72, 1024
    v_mfma_f32_16x16x32_bf16 v[148:151], v[84:87], v[56:59], v[148:151]
    buffer_load_dwordx4 v[176:179], v192, s[40:43], s72 offen
    s_mov_b32 s72, 74752
    buffer_load_dwordx4 v[180:183], v192, s[40:43], s72 offen
    v_mfma_f32_16x16x32_bf16 v[152:155], v[88:91], v[52:55], v[152:155]
    v_mfma_f32_16x16x32_bf16 v[156:159], v[88:91], v[56:59], v[156:159]
    v_mfma_f32_16x16x32_bf16 v[160:163], v[92:95], v[52:55], v[160:163]
    v_mfma_f32_16x16x32_bf16 v[164:167], v[92:95], v[56:59], v[164:167]
    s_waitcnt lgkmcnt(0)
    v_mfma_f32_16x16x32_bf16 v[96:99], v[16:19], v[8:11], v[96:99]
    ds_read_b128 v[52:55], v199 offset:0
    v_mfma_f32_16x16x32_bf16 v[100:103], v[16:19], v[12:15], v[100:103]
    ds_read_b128 v[56:59], v199 offset:2048
    v_mfma_f32_16x16x32_bf16 v[104:107], v[20:23], v[8:11], v[104:107]
    ds_read_b128 v[60:63], v201 offset:0
    v_mfma_f32_16x16x32_bf16 v[108:111], v[20:23], v[12:15], v[108:111]
    ds_read_b128 v[64:67], v201 offset:2048
    v_mfma_f32_16x16x32_bf16 v[112:115], v[24:27], v[8:11], v[112:115]
    ds_read_b128 v[68:71], v201 offset:4096
    v_mfma_f32_16x16x32_bf16 v[116:119], v[24:27], v[12:15], v[116:119]
    ds_read_b128 v[72:75], v201 offset:6144
    v_mfma_f32_16x16x32_bf16 v[120:123], v[28:31], v[8:11], v[120:123]
    ds_read_b128 v[76:79], v201 offset:8192
    v_mfma_f32_16x16x32_bf16 v[124:127], v[28:31], v[12:15], v[124:127]
    ds_read_b128 v[80:83], v201 offset:10240
    v_mfma_f32_16x16x32_bf16 v[128:131], v[32:35], v[8:11], v[128:131]
    ds_read_b128 v[84:87], v201 offset:12288
    v_mfma_f32_16x16x32_bf16 v[132:135], v[32:35], v[12:15], v[132:135]
    ds_read_b128 v[88:91], v201 offset:14336
    v_mfma_f32_16x16x32_bf16 v[136:139], v[36:39], v[8:11], v[136:139]
    ds_read_b128 v[92:95], v201 offset:16384
    v_mfma_f32_16x16x32_bf16 v[140:143], v[36:39], v[12:15], v[140:143]
    v_mfma_f32_16x16x32_bf16 v[144:147], v[40:43], v[8:11], v[144:147]
    v_mfma_f32_16x16x32_bf16 v[148:151], v[40:43], v[12:15], v[148:151]
    v_mfma_f32_16x16x32_bf16 v[152:155], v[44:47], v[8:11], v[152:155]
    v_mfma_f32_16x16x32_bf16 v[156:159], v[44:47], v[12:15], v[156:159]
    v_mfma_f32_16x16x32_bf16 v[160:163], v[48:51], v[8:11], v[160:163]
    v_mfma_f32_16x16x32_bf16 v[164:167], v[48:51], v[12:15], v[164:167]
    s_waitcnt vmcnt(9) lgkmcnt(0)
    s_barrier
    ds_read_b128 v[8:11], v202 offset:0
    ds_read_b128 v[12:15], v202 offset:2048
    ds_read_b128 v[16:19], v204 offset:0
    ds_read_b128 v[20:23], v204 offset:2048
    v_mfma_f32_16x16x32_bf16 v[96:99], v[60:63], v[52:55], v[96:99]
    ds_read_b128 v[24:27], v204 offset:4096
    ds_read_b128 v[28:31], v204 offset:6144
    ds_read_b128 v[32:35], v204 offset:8192
    ds_read_b128 v[36:39], v204 offset:10240
    v_mfma_f32_16x16x32_bf16 v[100:103], v[60:63], v[56:59], v[100:103]
    ds_read_b128 v[40:43], v204 offset:12288
    ds_read_b128 v[44:47], v204 offset:14336
    ds_read_b128 v[48:51], v204 offset:16384
    s_add_u32 m0, s65, 69632
    v_mfma_f32_16x16x32_bf16 v[104:107], v[64:67], v[52:55], v[104:107]
    s_mov_b32 s72, 896
    buffer_load_dwordx4 v193, s[44:47], s72 offen lds
    s_add_u32 m0, s65, 77824
    s_mov_b32 s72, 74624
    v_mfma_f32_16x16x32_bf16 v[108:111], v[64:67], v[56:59], v[108:111]
    buffer_load_dwordx4 v193, s[44:47], s72 offen lds
    s_add_u32 m0, s65, 86016
    s_mov_b32 s72, 148352
    buffer_load_dwordx4 v193, s[44:47], s72 offen lds
    v_mfma_f32_16x16x32_bf16 v[112:115], v[68:71], v[52:55], v[112:115]
    s_add_u32 m0, s65, 94208
    s_mov_b32 s72, 222080
    buffer_load_dwordx4 v193, s[44:47], s72 offen lds
    s_add_u32 m0, s65, 102400
    v_mfma_f32_16x16x32_bf16 v[116:119], v[68:71], v[56:59], v[116:119]
    s_mov_b32 s72, 295808
    buffer_load_dwordx4 v193, s[44:47], s72 offen lds
    s_waitcnt vmcnt(12)
    v_lshlrev_b32 v195, 16, v168
    v_mfma_f32_16x16x32_bf16 v[120:123], v[72:75], v[52:55], v[120:123]
    v_and_b32 v196, 0xffff0000, v168
    v_fma_f32 v195, v195, v184, v185
    v_fma_f32 v196, v196, v184, v185
    v_cvt_pk_bf16_f32 v168, v195, v196
    v_mfma_f32_16x16x32_bf16 v[124:127], v[72:75], v[56:59], v[124:127]
    v_lshlrev_b32 v195, 16, v169
    v_and_b32 v196, 0xffff0000, v169
    v_fma_f32 v195, v195, v184, v185
    v_fma_f32 v196, v196, v184, v185
    v_mfma_f32_16x16x32_bf16 v[128:131], v[76:79], v[52:55], v[128:131]
    v_cvt_pk_bf16_f32 v169, v195, v196
    v_lshlrev_b32 v195, 16, v170
    v_and_b32 v196, 0xffff0000, v170
    v_fma_f32 v195, v195, v184, v185
    v_mfma_f32_16x16x32_bf16 v[132:135], v[76:79], v[56:59], v[132:135]
    v_fma_f32 v196, v196, v184, v185
    v_cvt_pk_bf16_f32 v170, v195, v196
    v_lshlrev_b32 v195, 16, v171
    v_and_b32 v196, 0xffff0000, v171
    v_mfma_f32_16x16x32_bf16 v[136:139], v[80:83], v[52:55], v[136:139]
    v_fma_f32 v195, v195, v184, v185
    v_fma_f32 v196, v196, v184, v185
    v_cvt_pk_bf16_f32 v171, v195, v196
    ds_write_b128 v194, v[168:171] offset:53248
    v_mfma_f32_16x16x32_bf16 v[140:143], v[80:83], v[56:59], v[140:143]
    v_lshlrev_b32 v195, 16, v172
    v_and_b32 v196, 0xffff0000, v172
    v_fma_f32 v195, v195, v186, v187
    v_fma_f32 v196, v196, v186, v187
    v_mfma_f32_16x16x32_bf16 v[144:147], v[84:87], v[52:55], v[144:147]
    v_cvt_pk_bf16_f32 v172, v195, v196
    v_lshlrev_b32 v195, 16, v173
    v_and_b32 v196, 0xffff0000, v173
    v_fma_f32 v195, v195, v186, v187
    v_mfma_f32_16x16x32_bf16 v[148:151], v[84:87], v[56:59], v[148:151]
    v_fma_f32 v196, v196, v186, v187
    v_cvt_pk_bf16_f32 v173, v195, v196
    v_lshlrev_b32 v195, 16, v174
    v_and_b32 v196, 0xffff0000, v174
    v_mfma_f32_16x16x32_bf16 v[152:155], v[88:91], v[52:55], v[152:155]
    v_fma_f32 v195, v195, v186, v187
    v_fma_f32 v196, v196, v186, v187
    v_cvt_pk_bf16_f32 v174, v195, v196
    v_lshlrev_b32 v195, 16, v175
    v_mfma_f32_16x16x32_bf16 v[156:159], v[88:91], v[56:59], v[156:159]
    v_and_b32 v196, 0xffff0000, v175
    v_fma_f32 v195, v195, v186, v187
    v_fma_f32 v196, v196, v186, v187
    v_cvt_pk_bf16_f32 v175, v195, v196
    v_mfma_f32_16x16x32_bf16 v[160:163], v[92:95], v[52:55], v[160:163]
    ds_write_b128 v194, v[172:175] offset:61440
    v_mfma_f32_16x16x32_bf16 v[164:167], v[92:95], v[56:59], v[164:167]
    s_waitcnt lgkmcnt(0)
    v_mfma_f32_16x16x32_bf16 v[96:99], v[16:19], v[8:11], v[96:99]
    ds_read_b128 v[52:55], v203 offset:0
    v_mfma_f32_16x16x32_bf16 v[100:103], v[16:19], v[12:15], v[100:103]
    ds_read_b128 v[56:59], v203 offset:2048
    v_mfma_f32_16x16x32_bf16 v[104:107], v[20:23], v[8:11], v[104:107]
    ds_read_b128 v[60:63], v205 offset:0
    v_mfma_f32_16x16x32_bf16 v[108:111], v[20:23], v[12:15], v[108:111]
    ds_read_b128 v[64:67], v205 offset:2048
    v_mfma_f32_16x16x32_bf16 v[112:115], v[24:27], v[8:11], v[112:115]
    ds_read_b128 v[68:71], v205 offset:4096
    v_mfma_f32_16x16x32_bf16 v[116:119], v[24:27], v[12:15], v[116:119]
    ds_read_b128 v[72:75], v205 offset:6144
    v_mfma_f32_16x16x32_bf16 v[120:123], v[28:31], v[8:11], v[120:123]
    ds_read_b128 v[76:79], v205 offset:8192
    v_mfma_f32_16x16x32_bf16 v[124:127], v[28:31], v[12:15], v[124:127]
    ds_read_b128 v[80:83], v205 offset:10240
    v_mfma_f32_16x16x32_bf16 v[128:131], v[32:35], v[8:11], v[128:131]
    ds_read_b128 v[84:87], v205 offset:12288
    v_mfma_f32_16x16x32_bf16 v[132:135], v[32:35], v[12:15], v[132:135]
    ds_read_b128 v[88:91], v205 offset:14336
    v_mfma_f32_16x16x32_bf16 v[136:139], v[36:39], v[8:11], v[136:139]
    ds_read_b128 v[92:95], v205 offset:16384
    v_mfma_f32_16x16x32_bf16 v[140:143], v[36:39], v[12:15], v[140:143]
    v_mfma_f32_16x16x32_bf16 v[144:147], v[40:43], v[8:11], v[144:147]
    v_mfma_f32_16x16x32_bf16 v[148:151], v[40:43], v[12:15], v[148:151]
    v_mfma_f32_16x16x32_bf16 v[152:155], v[44:47], v[8:11], v[152:155]
    v_mfma_f32_16x16x32_bf16 v[156:159], v[44:47], v[12:15], v[156:159]
    v_mfma_f32_16x16x32_bf16 v[160:163], v[48:51], v[8:11], v[160:163]
    v_mfma_f32_16x16x32_bf16 v[164:167], v[48:51], v[12:15], v[164:167]
    s_waitcnt vmcnt(7) lgkmcnt(0)
    s_barrier
    ds_read_b128 v[8:11], v4 offset:0
    ds_read_b128 v[12:15], v4 offset:2048
    ds_read_b128 v[16:19], v2 offset:0
    ds_read_b128 v[20:23], v2 offset:2048
    v_mfma_f32_16x16x32_bf16 v[96:99], v[60:63], v[52:55], v[96:99]
    ds_read_b128 v[24:27], v2 offset:4096
    ds_read_b128 v[28:31], v2 offset:6144
    ds_read_b128 v[32:35], v2 offset:8192
    ds_read_b128 v[36:39], v2 offset:10240
    v_mfma_f32_16x16x32_bf16 v[100:103], v[60:63], v[56:59], v[100:103]
    ds_read_b128 v[40:43], v2 offset:12288
    ds_read_b128 v[44:47], v2 offset:14336
    ds_read_b128 v[48:51], v2 offset:16384
    s_add_u32 m0, s65, 122880
    v_mfma_f32_16x16x32_bf16 v[104:107], v[64:67], v[52:55], v[104:107]
    s_mov_b32 s72, 1024
    buffer_load_dwordx4 v193, s[44:47], s72 offen lds
    s_add_u32 m0, s65, 131072
    s_mov_b32 s72, 74752
    v_mfma_f32_16x16x32_bf16 v[108:111], v[64:67], v[56:59], v[108:111]
    buffer_load_dwordx4 v193, s[44:47], s72 offen lds
    s_add_u32 m0, s65, 139264
    s_mov_b32 s72, 148480
    buffer_load_dwordx4 v193, s[44:47], s72 offen lds
    v_mfma_f32_16x16x32_bf16 v[112:115], v[68:71], v[52:55], v[112:115]
    s_add_u32 m0, s65, 147456
    s_mov_b32 s72, 222208
    buffer_load_dwordx4 v193, s[44:47], s72 offen lds
    s_add_u32 m0, s65, 155648
    v_mfma_f32_16x16x32_bf16 v[116:119], v[68:71], v[56:59], v[116:119]
    s_mov_b32 s72, 295936
    buffer_load_dwordx4 v193, s[44:47], s72 offen lds
    s_waitcnt vmcnt(10)
    v_lshlrev_b32 v195, 16, v176
    v_mfma_f32_16x16x32_bf16 v[120:123], v[72:75], v[52:55], v[120:123]
    v_and_b32 v196, 0xffff0000, v176
    v_fma_f32 v195, v195, v184, v185
    v_fma_f32 v196, v196, v184, v185
    v_cvt_pk_bf16_f32 v176, v195, v196
    v_mfma_f32_16x16x32_bf16 v[124:127], v[72:75], v[56:59], v[124:127]
    v_lshlrev_b32 v195, 16, v177
    v_and_b32 v196, 0xffff0000, v177
    v_fma_f32 v195, v195, v184, v185
    v_fma_f32 v196, v196, v184, v185
    v_mfma_f32_16x16x32_bf16 v[128:131], v[76:79], v[52:55], v[128:131]
    v_cvt_pk_bf16_f32 v177, v195, v196
    v_lshlrev_b32 v195, 16, v178
    v_and_b32 v196, 0xffff0000, v178
    v_fma_f32 v195, v195, v184, v185
    v_mfma_f32_16x16x32_bf16 v[132:135], v[76:79], v[56:59], v[132:135]
    v_fma_f32 v196, v196, v184, v185
    v_cvt_pk_bf16_f32 v178, v195, v196
    v_lshlrev_b32 v195, 16, v179
    v_and_b32 v196, 0xffff0000, v179
    v_mfma_f32_16x16x32_bf16 v[136:139], v[80:83], v[52:55], v[136:139]
    v_fma_f32 v195, v195, v184, v185
    v_fma_f32 v196, v196, v184, v185
    v_cvt_pk_bf16_f32 v179, v195, v196
    ds_write_b128 v197, v[176:179] offset:0
    v_mfma_f32_16x16x32_bf16 v[140:143], v[80:83], v[56:59], v[140:143]
    v_lshlrev_b32 v195, 16, v180
    v_and_b32 v196, 0xffff0000, v180
    v_fma_f32 v195, v195, v186, v187
    v_fma_f32 v196, v196, v186, v187
    v_mfma_f32_16x16x32_bf16 v[144:147], v[84:87], v[52:55], v[144:147]
    v_cvt_pk_bf16_f32 v180, v195, v196
    v_lshlrev_b32 v195, 16, v181
    v_and_b32 v196, 0xffff0000, v181
    v_fma_f32 v195, v195, v186, v187
    v_mfma_f32_16x16x32_bf16 v[148:151], v[84:87], v[56:59], v[148:151]
    v_fma_f32 v196, v196, v186, v187
    v_cvt_pk_bf16_f32 v181, v195, v196
    v_lshlrev_b32 v195, 16, v182
    v_and_b32 v196, 0xffff0000, v182
    v_mfma_f32_16x16x32_bf16 v[152:155], v[88:91], v[52:55], v[152:155]
    v_fma_f32 v195, v195, v186, v187
    v_fma_f32 v196, v196, v186, v187
    v_cvt_pk_bf16_f32 v182, v195, v196
    v_lshlrev_b32 v195, 16, v183
    v_mfma_f32_16x16x32_bf16 v[156:159], v[88:91], v[56:59], v[156:159]
    v_and_b32 v196, 0xffff0000, v183
    v_fma_f32 v195, v195, v186, v187
    v_fma_f32 v196, v196, v186, v187
    v_cvt_pk_bf16_f32 v183, v195, v196
    v_mfma_f32_16x16x32_bf16 v[160:163], v[92:95], v[52:55], v[160:163]
    ds_write_b128 v197, v[180:183] offset:8192
    v_mfma_f32_16x16x32_bf16 v[164:167], v[92:95], v[56:59], v[164:167]
    s_waitcnt lgkmcnt(0)
    v_mfma_f32_16x16x32_bf16 v[96:99], v[16:19], v[8:11], v[96:99]
    ds_read_b128 v[52:55], v5 offset:0
    v_mfma_f32_16x16x32_bf16 v[100:103], v[16:19], v[12:15], v[100:103]
    ds_read_b128 v[56:59], v5 offset:2048
    v_mfma_f32_16x16x32_bf16 v[104:107], v[20:23], v[8:11], v[104:107]
    ds_read_b128 v[60:63], v3 offset:0
    v_mfma_f32_16x16x32_bf16 v[108:111], v[20:23], v[12:15], v[108:111]
    ds_read_b128 v[64:67], v3 offset:2048
    v_mfma_f32_16x16x32_bf16 v[112:115], v[24:27], v[8:11], v[112:115]
    ds_read_b128 v[68:71], v3 offset:4096
    v_mfma_f32_16x16x32_bf16 v[116:119], v[24:27], v[12:15], v[116:119]
    ds_read_b128 v[72:75], v3 offset:6144
    v_mfma_f32_16x16x32_bf16 v[120:123], v[28:31], v[8:11], v[120:123]
    ds_read_b128 v[76:79], v3 offset:8192
    v_mfma_f32_16x16x32_bf16 v[124:127], v[28:31], v[12:15], v[124:127]
    ds_read_b128 v[80:83], v3 offset:10240
    v_mfma_f32_16x16x32_bf16 v[128:131], v[32:35], v[8:11], v[128:131]
    ds_read_b128 v[84:87], v3 offset:12288
    v_mfma_f32_16x16x32_bf16 v[132:135], v[32:35], v[12:15], v[132:135]
    ds_read_b128 v[88:91], v3 offset:14336
    v_mfma_f32_16x16x32_bf16 v[136:139], v[36:39], v[8:11], v[136:139]
    ds_read_b128 v[92:95], v3 offset:16384
    v_mfma_f32_16x16x32_bf16 v[140:143], v[36:39], v[12:15], v[140:143]
    v_mfma_f32_16x16x32_bf16 v[144:147], v[40:43], v[8:11], v[144:147]
    v_mfma_f32_16x16x32_bf16 v[148:151], v[40:43], v[12:15], v[148:151]
    v_mfma_f32_16x16x32_bf16 v[152:155], v[44:47], v[8:11], v[152:155]
    v_mfma_f32_16x16x32_bf16 v[156:159], v[44:47], v[12:15], v[156:159]
    v_mfma_f32_16x16x32_bf16 v[160:163], v[48:51], v[8:11], v[160:163]
    v_mfma_f32_16x16x32_bf16 v[164:167], v[48:51], v[12:15], v[164:167]
    s_waitcnt vmcnt(5) lgkmcnt(0)
    s_barrier
    ds_read_b128 v[8:11], v198 offset:0
    v_mfma_f32_16x16x32_bf16 v[96:99], v[60:63], v[52:55], v[96:99]
    ds_read_b128 v[12:15], v198 offset:2048
    v_mfma_f32_16x16x32_bf16 v[100:103], v[60:63], v[56:59], v[100:103]
    ds_read_b128 v[16:19], v200 offset:0
    v_mfma_f32_16x16x32_bf16 v[104:107], v[64:67], v[52:55], v[104:107]
    ds_read_b128 v[20:23], v200 offset:2048
    v_mfma_f32_16x16x32_bf16 v[108:111], v[64:67], v[56:59], v[108:111]
    ds_read_b128 v[24:27], v200 offset:4096
    v_mfma_f32_16x16x32_bf16 v[112:115], v[68:71], v[52:55], v[112:115]
    ds_read_b128 v[28:31], v200 offset:6144
    v_mfma_f32_16x16x32_bf16 v[116:119], v[68:71], v[56:59], v[116:119]
    ds_read_b128 v[32:35], v200 offset:8192
    v_mfma_f32_16x16x32_bf16 v[120:123], v[72:75], v[52:55], v[120:123]
    ds_read_b128 v[36:39], v200 offset:10240
    v_mfma_f32_16x16x32_bf16 v[124:127], v[72:75], v[56:59], v[124:127]
    ds_read_b128 v[40:43], v200 offset:12288
    v_mfma_f32_16x16x32_bf16 v[128:131], v[76:79], v[52:55], v[128:131]
    ds_read_b128 v[44:47], v200 offset:14336
    v_mfma_f32_16x16x32_bf16 v[132:135], v[76:79], v[56:59], v[132:135]
    ds_read_b128 v[48:51], v200 offset:16384
    v_mfma_f32_16x16x32_bf16 v[136:139], v[80:83], v[52:55], v[136:139]
    v_mfma_f32_16x16x32_bf16 v[140:143], v[80:83], v[56:59], v[140:143]
    v_mfma_f32_16x16x32_bf16 v[144:147], v[84:87], v[52:55], v[144:147]
    v_mfma_f32_16x16x32_bf16 v[148:151], v[84:87], v[56:59], v[148:151]
    v_mfma_f32_16x16x32_bf16 v[152:155], v[88:91], v[52:55], v[152:155]
    v_mfma_f32_16x16x32_bf16 v[156:159], v[88:91], v[56:59], v[156:159]
    v_mfma_f32_16x16x32_bf16 v[160:163], v[92:95], v[52:55], v[160:163]
    v_mfma_f32_16x16x32_bf16 v[164:167], v[92:95], v[56:59], v[164:167]
    s_waitcnt lgkmcnt(0)
    v_mfma_f32_16x16x32_bf16 v[96:99], v[16:19], v[8:11], v[96:99]
    ds_read_b128 v[52:55], v199 offset:0
    v_mfma_f32_16x16x32_bf16 v[100:103], v[16:19], v[12:15], v[100:103]
    ds_read_b128 v[56:59], v199 offset:2048
    v_mfma_f32_16x16x32_bf16 v[104:107], v[20:23], v[8:11], v[104:107]
    ds_read_b128 v[60:63], v201 offset:0
    v_mfma_f32_16x16x32_bf16 v[108:111], v[20:23], v[12:15], v[108:111]
    ds_read_b128 v[64:67], v201 offset:2048
    v_mfma_f32_16x16x32_bf16 v[112:115], v[24:27], v[8:11], v[112:115]
    ds_read_b128 v[68:71], v201 offset:4096
    v_mfma_f32_16x16x32_bf16 v[116:119], v[24:27], v[12:15], v[116:119]
    ds_read_b128 v[72:75], v201 offset:6144
    v_mfma_f32_16x16x32_bf16 v[120:123], v[28:31], v[8:11], v[120:123]
    ds_read_b128 v[76:79], v201 offset:8192
    v_mfma_f32_16x16x32_bf16 v[124:127], v[28:31], v[12:15], v[124:127]
    ds_read_b128 v[80:83], v201 offset:10240
    v_mfma_f32_16x16x32_bf16 v[128:131], v[32:35], v[8:11], v[128:131]
    ds_read_b128 v[84:87], v201 offset:12288
    v_mfma_f32_16x16x32_bf16 v[132:135], v[32:35], v[12:15], v[132:135]
    ds_read_b128 v[88:91], v201 offset:14336
    v_mfma_f32_16x16x32_bf16 v[136:139], v[36:39], v[8:11], v[136:139]
    ds_read_b128 v[92:95], v201 offset:16384
    v_mfma_f32_16x16x32_bf16 v[140:143], v[36:39], v[12:15], v[140:143]
    v_mfma_f32_16x16x32_bf16 v[144:147], v[40:43], v[8:11], v[144:147]
    v_mfma_f32_16x16x32_bf16 v[148:151], v[40:43], v[12:15], v[148:151]
    v_mfma_f32_16x16x32_bf16 v[152:155], v[44:47], v[8:11], v[152:155]
    v_mfma_f32_16x16x32_bf16 v[156:159], v[44:47], v[12:15], v[156:159]
    v_mfma_f32_16x16x32_bf16 v[160:163], v[48:51], v[8:11], v[160:163]
    v_mfma_f32_16x16x32_bf16 v[164:167], v[48:51], v[12:15], v[164:167]
    s_waitcnt vmcnt(0) lgkmcnt(0)
    s_barrier
    ds_read_b128 v[8:11], v202 offset:0
    v_mfma_f32_16x16x32_bf16 v[96:99], v[60:63], v[52:55], v[96:99]
    ds_read_b128 v[12:15], v202 offset:2048
    v_mfma_f32_16x16x32_bf16 v[100:103], v[60:63], v[56:59], v[100:103]
    ds_read_b128 v[16:19], v204 offset:0
    v_mfma_f32_16x16x32_bf16 v[104:107], v[64:67], v[52:55], v[104:107]
    ds_read_b128 v[20:23], v204 offset:2048
    v_mfma_f32_16x16x32_bf16 v[108:111], v[64:67], v[56:59], v[108:111]
    ds_read_b128 v[24:27], v204 offset:4096
    v_mfma_f32_16x16x32_bf16 v[112:115], v[68:71], v[52:55], v[112:115]
    ds_read_b128 v[28:31], v204 offset:6144
    v_mfma_f32_16x16x32_bf16 v[116:119], v[68:71], v[56:59], v[116:119]
    ds_read_b128 v[32:35], v204 offset:8192
    v_mfma_f32_16x16x32_bf16 v[120:123], v[72:75], v[52:55], v[120:123]
    ds_read_b128 v[36:39], v204 offset:10240
    v_mfma_f32_16x16x32_bf16 v[124:127], v[72:75], v[56:59], v[124:127]
    ds_read_b128 v[40:43], v204 offset:12288
    v_mfma_f32_16x16x32_bf16 v[128:131], v[76:79], v[52:55], v[128:131]
    ds_read_b128 v[44:47], v204 offset:14336
    v_mfma_f32_16x16x32_bf16 v[132:135], v[76:79], v[56:59], v[132:135]
    ds_read_b128 v[48:51], v204 offset:16384
    v_mfma_f32_16x16x32_bf16 v[136:139], v[80:83], v[52:55], v[136:139]
    v_mfma_f32_16x16x32_bf16 v[140:143], v[80:83], v[56:59], v[140:143]
    v_mfma_f32_16x16x32_bf16 v[144:147], v[84:87], v[52:55], v[144:147]
    v_mfma_f32_16x16x32_bf16 v[148:151], v[84:87], v[56:59], v[148:151]
    v_mfma_f32_16x16x32_bf16 v[152:155], v[88:91], v[52:55], v[152:155]
    v_mfma_f32_16x16x32_bf16 v[156:159], v[88:91], v[56:59], v[156:159]
    v_mfma_f32_16x16x32_bf16 v[160:163], v[92:95], v[52:55], v[160:163]
    v_mfma_f32_16x16x32_bf16 v[164:167], v[92:95], v[56:59], v[164:167]
    s_waitcnt lgkmcnt(0)
    v_mfma_f32_16x16x32_bf16 v[96:99], v[16:19], v[8:11], v[96:99]
    ds_read_b128 v[52:55], v203 offset:0
    v_mfma_f32_16x16x32_bf16 v[100:103], v[16:19], v[12:15], v[100:103]
    ds_read_b128 v[56:59], v203 offset:2048
    v_mfma_f32_16x16x32_bf16 v[104:107], v[20:23], v[8:11], v[104:107]
    ds_read_b128 v[60:63], v205 offset:0
    v_mfma_f32_16x16x32_bf16 v[108:111], v[20:23], v[12:15], v[108:111]
    ds_read_b128 v[64:67], v205 offset:2048
    v_mfma_f32_16x16x32_bf16 v[112:115], v[24:27], v[8:11], v[112:115]
    ds_read_b128 v[68:71], v205 offset:4096
    v_mfma_f32_16x16x32_bf16 v[116:119], v[24:27], v[12:15], v[116:119]
    ds_read_b128 v[72:75], v205 offset:6144
    v_mfma_f32_16x16x32_bf16 v[120:123], v[28:31], v[8:11], v[120:123]
    ds_read_b128 v[76:79], v205 offset:8192
    v_mfma_f32_16x16x32_bf16 v[124:127], v[28:31], v[12:15], v[124:127]
    ds_read_b128 v[80:83], v205 offset:10240
    v_mfma_f32_16x16x32_bf16 v[128:131], v[32:35], v[8:11], v[128:131]
    ds_read_b128 v[84:87], v205 offset:12288
    v_mfma_f32_16x16x32_bf16 v[132:135], v[32:35], v[12:15], v[132:135]
    ds_read_b128 v[88:91], v205 offset:14336
    v_mfma_f32_16x16x32_bf16 v[136:139], v[36:39], v[8:11], v[136:139]
    ds_read_b128 v[92:95], v205 offset:16384
    v_mfma_f32_16x16x32_bf16 v[140:143], v[36:39], v[12:15], v[140:143]
    v_mfma_f32_16x16x32_bf16 v[144:147], v[40:43], v[8:11], v[144:147]
    v_mfma_f32_16x16x32_bf16 v[148:151], v[40:43], v[12:15], v[148:151]
    v_mfma_f32_16x16x32_bf16 v[152:155], v[44:47], v[8:11], v[152:155]
    v_mfma_f32_16x16x32_bf16 v[156:159], v[44:47], v[12:15], v[156:159]
    v_mfma_f32_16x16x32_bf16 v[160:163], v[48:51], v[8:11], v[160:163]
    v_mfma_f32_16x16x32_bf16 v[164:167], v[48:51], v[12:15], v[164:167]
    s_waitcnt vmcnt(0) lgkmcnt(0)
    s_barrier
    v_mfma_f32_16x16x32_bf16 v[96:99], v[60:63], v[52:55], v[96:99]
    v_mfma_f32_16x16x32_bf16 v[100:103], v[60:63], v[56:59], v[100:103]
    v_mfma_f32_16x16x32_bf16 v[104:107], v[64:67], v[52:55], v[104:107]
    v_mfma_f32_16x16x32_bf16 v[108:111], v[64:67], v[56:59], v[108:111]
    v_mfma_f32_16x16x32_bf16 v[112:115], v[68:71], v[52:55], v[112:115]
    v_mfma_f32_16x16x32_bf16 v[116:119], v[68:71], v[56:59], v[116:119]
    v_mfma_f32_16x16x32_bf16 v[120:123], v[72:75], v[52:55], v[120:123]
    v_mfma_f32_16x16x32_bf16 v[124:127], v[72:75], v[56:59], v[124:127]
    v_mfma_f32_16x16x32_bf16 v[128:131], v[76:79], v[52:55], v[128:131]
    v_mfma_f32_16x16x32_bf16 v[132:135], v[76:79], v[56:59], v[132:135]
    v_mfma_f32_16x16x32_bf16 v[136:139], v[80:83], v[52:55], v[136:139]
    v_mfma_f32_16x16x32_bf16 v[140:143], v[80:83], v[56:59], v[140:143]
    v_mfma_f32_16x16x32_bf16 v[144:147], v[84:87], v[52:55], v[144:147]
    v_mfma_f32_16x16x32_bf16 v[148:151], v[84:87], v[56:59], v[148:151]
    v_mfma_f32_16x16x32_bf16 v[152:155], v[88:91], v[52:55], v[152:155]
    v_mfma_f32_16x16x32_bf16 v[156:159], v[88:91], v[56:59], v[156:159]
    v_mfma_f32_16x16x32_bf16 v[160:163], v[92:95], v[52:55], v[160:163]
    v_mfma_f32_16x16x32_bf16 v[164:167], v[92:95], v[56:59], v[164:167]
    s_waitcnt vmcnt(0) lgkmcnt(0)
    s_barrier
    s_branch b1_kernel_z1epi
b1_kernel_z1q4:
    s_add_u32 m0, s65, 16384
    s_mov_b32 s72, 0
    buffer_load_dwordx4 v193, s[44:47], s72 offen lds
    s_add_u32 m0, s65, 24576
    s_mov_b32 s72, 73728
    buffer_load_dwordx4 v193, s[44:47], s72 offen lds
    s_add_u32 m0, s65, 32768
    s_mov_b32 s72, 147456
    buffer_load_dwordx4 v193, s[44:47], s72 offen lds
    s_add_u32 m0, s65, 40960
    s_mov_b32 s72, 221184
    buffer_load_dwordx4 v193, s[44:47], s72 offen lds
    s_add_u32 m0, s65, 69632
    s_mov_b32 s72, 128
    buffer_load_dwordx4 v193, s[44:47], s72 offen lds
    s_add_u32 m0, s65, 77824
    s_mov_b32 s72, 73856
    buffer_load_dwordx4 v193, s[44:47], s72 offen lds
    s_add_u32 m0, s65, 86016
    s_mov_b32 s72, 147584
    buffer_load_dwordx4 v193, s[44:47], s72 offen lds
    s_add_u32 m0, s65, 94208
    s_mov_b32 s72, 221312
    buffer_load_dwordx4 v193, s[44:47], s72 offen lds
    s_add_u32 m0, s65, 122880
    s_mov_b32 s72, 256
    buffer_load_dwordx4 v193, s[44:47], s72 offen lds
    s_add_u32 m0, s65, 131072
    s_mov_b32 s72, 73984
    buffer_load_dwordx4 v193, s[44:47], s72 offen lds
    s_add_u32 m0, s65, 139264
    s_mov_b32 s72, 147712
    buffer_load_dwordx4 v193, s[44:47], s72 offen lds
    s_add_u32 m0, s65, 147456
    s_mov_b32 s72, 221440
    buffer_load_dwordx4 v193, s[44:47], s72 offen lds
    s_mov_b32 s72, 384
    buffer_load_dwordx4 v[168:171], v192, s[40:43], s72 offen
    s_mov_b32 s72, 74112
    buffer_load_dwordx4 v[172:175], v192, s[40:43], s72 offen
    s_mov_b32 s72, 512
    buffer_load_dwordx4 v[176:179], v192, s[40:43], s72 offen
    s_mov_b32 s72, 74240
    buffer_load_dwordx4 v[180:183], v192, s[40:43], s72 offen
    s_mov_b32 s87, 0x3ae38e39
    s_waitcnt vmcnt(22)
    v_add_f32 v8, v8, v10
    v_add_f32 v9, v9, v11
    v_add_f32 v8, v8, v12
    v_add_f32 v9, v9, v13
    v_add_f32 v8, v8, v14
    v_add_f32 v9, v9, v15
    v_add_f32 v8, v8, v16
    v_add_f32 v9, v9, v17
    v_add_f32 v8, v8, v18
    v_add_f32 v9, v9, v19
    v_add_f32 v8, v8, v20
    v_add_f32 v9, v9, v21
    v_add_f32 v8, v8, v22
    v_add_f32 v9, v9, v23
    v_mul_f32 v8, s87, v8
    v_mul_f32 v9, s87, v9
    v_fma_f32 v9, -v8, v8, v9
    v_max_f32 v9, 0, v9
    v_add_f32 v9, 0x3727c5ac, v9
    v_rsq_f32 v184, v9
    s_nop 0
    v_mul_f32 v185, v8, v184
    v_sub_f32 v185, 0, v185
    v_add_f32 v24, v24, v26
    v_add_f32 v25, v25, v27
    v_add_f32 v24, v24, v28
    v_add_f32 v25, v25, v29
    v_add_f32 v24, v24, v30
    v_add_f32 v25, v25, v31
    v_add_f32 v24, v24, v32
    v_add_f32 v25, v25, v33
    v_add_f32 v24, v24, v34
    v_add_f32 v25, v25, v35
    v_add_f32 v24, v24, v36
    v_add_f32 v25, v25, v37
    v_add_f32 v24, v24, v38
    v_add_f32 v25, v25, v39
    v_mul_f32 v24, s87, v24
    v_mul_f32 v25, s87, v25
    v_fma_f32 v25, -v24, v24, v25
    v_max_f32 v25, 0, v25
    v_add_f32 v25, 0x3727c5ac, v25
    v_rsq_f32 v186, v25
    s_nop 0
    v_mul_f32 v187, v24, v186
    v_sub_f32 v187, 0, v187
    s_waitcnt vmcnt(16)
    v_lshlrev_b32 v195, 16, v48
    v_and_b32 v196, 0xffff0000, v48
    v_fma_f32 v195, v195, v184, v185
    v_fma_f32 v196, v196, v184, v185
    v_cvt_pk_bf16_f32 v48, v195, v196
    v_lshlrev_b32 v195, 16, v49
    v_and_b32 v196, 0xffff0000, v49
    v_fma_f32 v195, v195, v184, v185
    v_fma_f32 v196, v196, v184, v185
    v_cvt_pk_bf16_f32 v49, v195, v196
    v_lshlrev_b32 v195, 16, v50
    v_and_b32 v196, 0xffff0000, v50
    v_fma_f32 v195, v195, v184, v185
    v_fma_f32 v196, v196, v184, v185
    v_cvt_pk_bf16_f32 v50, v195, v196
    v_lshlrev_b32 v195, 16, v51
    v_and_b32 v196, 0xffff0000, v51
    v_fma_f32 v195, v195, v184, v185
    v_fma_f32 v196, v196, v184, v185
    v_cvt_pk_bf16_f32 v51, v195, v196
    ds_write_b128 v194, v[48:51] offset:0
    v_lshlrev_b32 v195, 16, v52
    v_and_b32 v196, 0xffff0000, v52
    v_fma_f32 v195, v195, v186, v187
    v_fma_f32 v196, v196, v186, v187
    v_cvt_pk_bf16_f32 v52, v195, v196
    v_lshlrev_b32 v195, 16, v53
    v_and_b32 v196, 0xffff0000, v53
    v_fma_f32 v195, v195, v186, v187
    v_fma_f32 v196, v196, v186, v187
    v_cvt_pk_bf16_f32 v53, v195, v196
    v_lshlrev_b32 v195, 16, v54
    v_and_b32 v196, 0xffff0000, v54
    v_fma_f32 v195, v195, v186, v187
    v_fma_f32 v196, v196, v186, v187
    v_cvt_pk_bf16_f32 v54, v195, v196
    v_lshlrev_b32 v195, 16, v55
    v_and_b32 v196, 0xffff0000, v55
    v_fma_f32 v195, v195, v186, v187
    v_fma_f32 v196, v196, v186, v187
    v_cvt_pk_bf16_f32 v55, v195, v196
    ds_write_b128 v194, v[52:55] offset:8192
    v_lshlrev_b32 v195, 16, v56
    v_and_b32 v196, 0xffff0000, v56
    v_fma_f32 v195, v195, v184, v185
    v_fma_f32 v196, v196, v184, v185
    v_cvt_pk_bf16_f32 v56, v195, v196
    v_lshlrev_b32 v195, 16, v57
    v_and_b32 v196, 0xffff0000, v57
    v_fma_f32 v195, v195, v184, v185
    v_fma_f32 v196, v196, v184, v185
    v_cvt_pk_bf16_f32 v57, v195, v196
    v_lshlrev_b32 v195, 16, v58
    v_and_b32 v196, 0xffff0000, v58
    v_fma_f32 v195, v195, v184, v185
    v_fma_f32 v196, v196, v184, v185
    v_cvt_pk_bf16_f32 v58, v195, v196
    v_lshlrev_b32 v195, 16, v59
    v_and_b32 v196, 0xffff0000, v59
    v_fma_f32 v195, v195, v184, v185
    v_fma_f32 v196, v196, v184, v185
    v_cvt_pk_bf16_f32 v59, v195, v196
    ds_write_b128 v194, v[56:59] offset:53248
    v_lshlrev_b32 v195, 16, v60
    v_and_b32 v196, 0xffff0000, v60
    v_fma_f32 v195, v195, v186, v187
    v_fma_f32 v196, v196, v186, v187
    v_cvt_pk_bf16_f32 v60, v195, v196
    v_lshlrev_b32 v195, 16, v61
    v_and_b32 v196, 0xffff0000, v61
    v_fma_f32 v195, v195, v186, v187
    v_fma_f32 v196, v196, v186, v187
    v_cvt_pk_bf16_f32 v61, v195, v196
    v_lshlrev_b32 v195, 16, v62
    v_and_b32 v196, 0xffff0000, v62
    v_fma_f32 v195, v195, v186, v187
    v_fma_f32 v196, v196, v186, v187
    v_cvt_pk_bf16_f32 v62, v195, v196
    v_lshlrev_b32 v195, 16, v63
    v_and_b32 v196, 0xffff0000, v63
    v_fma_f32 v195, v195, v186, v187
    v_fma_f32 v196, v196, v186, v187
    v_cvt_pk_bf16_f32 v63, v195, v196
    ds_write_b128 v194, v[60:63] offset:61440
    v_lshlrev_b32 v195, 16, v64
    v_and_b32 v196, 0xffff0000, v64
    v_fma_f32 v195, v195, v184, v185
    v_fma_f32 v196, v196, v184, v185
    v_cvt_pk_bf16_f32 v64, v195, v196
    v_lshlrev_b32 v195, 16, v65
    v_and_b32 v196, 0xffff0000, v65
    v_fma_f32 v195, v195, v184, v185
    v_fma_f32 v196, v196, v184, v185
    v_cvt_pk_bf16_f32 v65, v195, v196
    v_lshlrev_b32 v195, 16, v66
    v_and_b32 v196, 0xffff0000, v66
    v_fma_f32 v195, v195, v184, v185
    v_fma_f32 v196, v196, v184, v185
    v_cvt_pk_bf16_f32 v66, v195, v196
    v_lshlrev_b32 v195, 16, v67
    v_and_b32 v196, 0xffff0000, v67
    v_fma_f32 v195, v195, v184, v185
    v_fma_f32 v196, v196, v184, v185
    v_cvt_pk_bf16_f32 v67, v195, v196
    ds_write_b128 v197, v[64:67] offset:0
    v_lshlrev_b32 v195, 16, v68
    v_and_b32 v196, 0xffff0000, v68
    v_fma_f32 v195, v195, v186, v187
    v_fma_f32 v196, v196, v186, v187
    v_cvt_pk_bf16_f32 v68, v195, v196
    v_lshlrev_b32 v195, 16, v69
    v_and_b32 v196, 0xffff0000, v69
    v_fma_f32 v195, v195, v186, v187
    v_fma_f32 v196, v196, v186, v187
    v_cvt_pk_bf16_f32 v69, v195, v196
    v_lshlrev_b32 v195, 16, v70
    v_and_b32 v196, 0xffff0000, v70
    v_fma_f32 v195, v195, v186, v187
    v_fma_f32 v196, v196, v186, v187
    v_cvt_pk_bf16_f32 v70, v195, v196
    v_lshlrev_b32 v195, 16, v71
    v_and_b32 v196, 0xffff0000, v71
    v_fma_f32 v195, v195, v186, v187
    v_fma_f32 v196, v196, v186, v187
    v_cvt_pk_bf16_f32 v71, v195, v196
    ds_write_b128 v197, v[68:71] offset:8192
    v_and_b32 v8, 15, v1
    v_lshlrev_b32 v8, 3, v8
    v_lshrrev_b32 v9, 4, v1
    v_lshrrev_b32 v10, 1, v1
    v_and_b32 v10, 7, v10
    v_xor_b32 v9, v9, v10
    v_add_u32 v8, v8, v9
    v_lshlrev_b32 v2, 4, v8
    v_xor_b32 v3, 64, v2
    s_lshl_b32 s68, s70, 12
    v_add_u32 v4, s68, v2
    v_add_u32 v5, s68, v3
    s_mul_i32 s68, s71, 18432
    s_add_u32 s68, s68, 16384
    v_add_u32 v2, s68, v2
    v_add_u32 v3, s68, v3
    v_add_u32 v198, 53248, v4
    v_add_u32 v199, 53248, v5
    v_add_u32 v200, 53248, v2
    v_add_u32 v201, 53248, v3
    v_add_u32 v202, 106496, v4
    v_add_u32 v203, 106496, v5
    v_add_u32 v204, 106496, v2
    v_add_u32 v205, 106496, v3
    v_mov_b32 v96, 0
    v_mov_b32 v97, 0
    v_mov_b32 v98, 0
    v_mov_b32 v99, 0
    v_mov_b32 v100, 0
    v_mov_b32 v101, 0
    v_mov_b32 v102, 0
    v_mov_b32 v103, 0
    v_mov_b32 v104, 0
    v_mov_b32 v105, 0
    v_mov_b32 v106, 0
    v_mov_b32 v107, 0
    v_mov_b32 v108, 0
    v_mov_b32 v109, 0
    v_mov_b32 v110, 0
    v_mov_b32 v111, 0
    v_mov_b32 v112, 0
    v_mov_b32 v113, 0
    v_mov_b32 v114, 0
    v_mov_b32 v115, 0
    v_mov_b32 v116, 0
    v_mov_b32 v117, 0
    v_mov_b32 v118, 0
    v_mov_b32 v119, 0
    v_mov_b32 v120, 0
    v_mov_b32 v121, 0
    v_mov_b32 v122, 0
    v_mov_b32 v123, 0
    v_mov_b32 v124, 0
    v_mov_b32 v125, 0
    v_mov_b32 v126, 0
    v_mov_b32 v127, 0
    v_mov_b32 v128, 0
    v_mov_b32 v129, 0
    v_mov_b32 v130, 0
    v_mov_b32 v131, 0
    v_mov_b32 v132, 0
    v_mov_b32 v133, 0
    v_mov_b32 v134, 0
    v_mov_b32 v135, 0
    v_mov_b32 v136, 0
    v_mov_b32 v137, 0
    v_mov_b32 v138, 0
    v_mov_b32 v139, 0
    v_mov_b32 v140, 0
    v_mov_b32 v141, 0
    v_mov_b32 v142, 0
    v_mov_b32 v143, 0
    v_mov_b32 v144, 0
    v_mov_b32 v145, 0
    v_mov_b32 v146, 0
    v_mov_b32 v147, 0
    v_mov_b32 v148, 0
    v_mov_b32 v149, 0
    v_mov_b32 v150, 0
    v_mov_b32 v151, 0
    v_mov_b32 v152, 0
    v_mov_b32 v153, 0
    v_mov_b32 v154, 0
    v_mov_b32 v155, 0
    v_mov_b32 v156, 0
    v_mov_b32 v157, 0
    v_mov_b32 v158, 0
    v_mov_b32 v159, 0
    v_mov_b32 v160, 0
    v_mov_b32 v161, 0
    v_mov_b32 v162, 0
    v_mov_b32 v163, 0
    v_mov_b32 v164, 0
    v_mov_b32 v165, 0
    v_mov_b32 v166, 0
    v_mov_b32 v167, 0
    s_waitcnt vmcnt(12) lgkmcnt(0)
    s_barrier
    ds_read_b128 v[8:11], v4 offset:0
    ds_read_b128 v[12:15], v4 offset:2048
    ds_read_b128 v[16:19], v2 offset:0
    ds_read_b128 v[20:23], v2 offset:2048
    ds_read_b128 v[24:27], v2 offset:4096
    ds_read_b128 v[28:31], v2 offset:6144
    ds_read_b128 v[32:35], v2 offset:8192
    ds_read_b128 v[36:39], v2 offset:10240
    ds_read_b128 v[40:43], v2 offset:12288
    ds_read_b128 v[44:47], v2 offset:14336
    ds_read_b128 v[48:51], v2 offset:16384
    s_waitcnt lgkmcnt(0)
    v_mfma_f32_16x16x32_bf16 v[96:99], v[16:19], v[8:11], v[96:99]
    ds_read_b128 v[52:55], v5 offset:0
    v_mfma_f32_16x16x32_bf16 v[100:103], v[16:19], v[12:15], v[100:103]
    ds_read_b128 v[56:59], v5 offset:2048
    v_mfma_f32_16x16x32_bf16 v[104:107], v[20:23], v[8:11], v[104:107]
    ds_read_b128 v[60:63], v3 offset:0
    v_mfma_f32_16x16x32_bf16 v[108:111], v[20:23], v[12:15], v[108:111]
    ds_read_b128 v[64:67], v3 offset:2048
    v_mfma_f32_16x16x32_bf16 v[112:115], v[24:27], v[8:11], v[112:115]
    ds_read_b128 v[68:71], v3 offset:4096
    v_mfma_f32_16x16x32_bf16 v[116:119], v[24:27], v[12:15], v[116:119]
    ds_read_b128 v[72:75], v3 offset:6144
    v_mfma_f32_16x16x32_bf16 v[120:123], v[28:31], v[8:11], v[120:123]
    ds_read_b128 v[76:79], v3 offset:8192
    v_mfma_f32_16x16x32_bf16 v[124:127], v[28:31], v[12:15], v[124:127]
    ds_read_b128 v[80:83], v3 offset:10240
    v_mfma_f32_16x16x32_bf16 v[128:131], v[32:35], v[8:11], v[128:131]
    ds_read_b128 v[84:87], v3 offset:12288
    v_mfma_f32_16x16x32_bf16 v[132:135], v[32:35], v[12:15], v[132:135]
    ds_read_b128 v[88:91], v3 offset:14336
    v_mfma_f32_16x16x32_bf16 v[136:139], v[36:39], v[8:11], v[136:139]
    ds_read_b128 v[92:95], v3 offset:16384
    v_mfma_f32_16x16x32_bf16 v[140:143], v[36:39], v[12:15], v[140:143]
    v_mfma_f32_16x16x32_bf16 v[144:147], v[40:43], v[8:11], v[144:147]
    v_mfma_f32_16x16x32_bf16 v[148:151], v[40:43], v[12:15], v[148:151]
    v_mfma_f32_16x16x32_bf16 v[152:155], v[44:47], v[8:11], v[152:155]
    v_mfma_f32_16x16x32_bf16 v[156:159], v[44:47], v[12:15], v[156:159]
    v_mfma_f32_16x16x32_bf16 v[160:163], v[48:51], v[8:11], v[160:163]
    v_mfma_f32_16x16x32_bf16 v[164:167], v[48:51], v[12:15], v[164:167]
    s_waitcnt vmcnt(8) lgkmcnt(0)
    s_barrier
    ds_read_b128 v[8:11], v198 offset:0
    ds_read_b128 v[12:15], v198 offset:2048
    ds_read_b128 v[16:19], v200 offset:0
    ds_read_b128 v[20:23], v200 offset:2048
    v_mfma_f32_16x16x32_bf16 v[96:99], v[60:63], v[52:55], v[96:99]
    ds_read_b128 v[24:27], v200 offset:4096
    ds_read_b128 v[28:31], v200 offset:6144
    ds_read_b128 v[32:35], v200 offset:8192
    ds_read_b128 v[36:39], v200 offset:10240
    v_mfma_f32_16x16x32_bf16 v[100:103], v[60:63], v[56:59], v[100:103]
    ds_read_b128 v[40:43], v200 offset:12288
    ds_read_b128 v[44:47], v200 offset:14336
    ds_read_b128 v[48:51], v200 offset:16384
    s_add_u32 m0, s65, 16384
    v_mfma_f32_16x16x32_bf16 v[104:107], v[64:67], v[52:55], v[104:107]
    s_mov_b32 s72, 384
    buffer_load_dwordx4 v193, s[44:47], s72 offen lds
    s_add_u32 m0, s65, 24576
    s_mov_b32 s72, 74112
    v_mfma_f32_16x16x32_bf16 v[108:111], v[64:67], v[56:59], v[108:111]
    buffer_load_dwordx4 v193, s[44:47], s72 offen lds
    s_add_u32 m0, s65, 32768
    s_mov_b32 s72, 147840
    buffer_load_dwordx4 v193, s[44:47], s72 offen lds
    v_mfma_f32_16x16x32_bf16 v[112:115], v[68:71], v[52:55], v[112:115]
    s_add_u32 m0, s65, 40960
    s_mov_b32 s72, 221568
    buffer_load_dwordx4 v193, s[44:47], s72 offen lds
    s_waitcnt vmcnt(6)
    v_mfma_f32_16x16x32_bf16 v[116:119], v[68:71], v[56:59], v[116:119]
    v_lshlrev_b32 v195, 16, v168
    v_and_b32 v196, 0xffff0000, v168
    v_fma_f32 v195, v195, v184, v185
    v_fma_f32 v196, v196, v184, v185
    v_mfma_f32_16x16x32_bf16 v[120:123], v[72:75], v[52:55], v[120:123]
    v_cvt_pk_bf16_f32 v168, v195, v196
    v_lshlrev_b32 v195, 16, v169
    v_and_b32 v196, 0xffff0000, v169
    v_fma_f32 v195, v195, v184, v185
    v_mfma_f32_16x16x32_bf16 v[124:127], v[72:75], v[56:59], v[124:127]
    v_fma_f32 v196, v196, v184, v185
    v_cvt_pk_bf16_f32 v169, v195, v196
    v_lshlrev_b32 v195, 16, v170
    v_and_b32 v196, 0xffff0000, v170
    v_mfma_f32_16x16x32_bf16 v[128:131], v[76:79], v[52:55], v[128:131]
    v_fma_f32 v195, v195, v184, v185
    v_fma_f32 v196, v196, v184, v185
    v_cvt_pk_bf16_f32 v170, v195, v196
    v_lshlrev_b32 v195, 16, v171
    v_mfma_f32_16x16x32_bf16 v[132:135], v[76:79], v[56:59], v[132:135]
    v_and_b32 v196, 0xffff0000, v171
    v_fma_f32 v195, v195, v184, v185
    v_fma_f32 v196, v196, v184, v185
    v_cvt_pk_bf16_f32 v171, v195, v196
    v_mfma_f32_16x16x32_bf16 v[136:139], v[80:83], v[52:55], v[136:139]
    ds_write_b128 v194, v[168:171] offset:0
    v_lshlrev_b32 v195, 16, v172
    v_and_b32 v196, 0xffff0000, v172
    v_fma_f32 v195, v195, v186, v187
    v_mfma_f32_16x16x32_bf16 v[140:143], v[80:83], v[56:59], v[140:143]
    v_fma_f32 v196, v196, v186, v187
    v_cvt_pk_bf16_f32 v172, v195, v196
    v_lshlrev_b32 v195, 16, v173
    v_and_b32 v196, 0xffff0000, v173
    v_mfma_f32_16x16x32_bf16 v[144:147], v[84:87], v[52:55], v[144:147]
    v_fma_f32 v195, v195, v186, v187
    v_fma_f32 v196, v196, v186, v187
    v_cvt_pk_bf16_f32 v173, v195, v196
    v_lshlrev_b32 v195, 16, v174
    v_mfma_f32_16x16x32_bf16 v[148:151], v[84:87], v[56:59], v[148:151]
    v_and_b32 v196, 0xffff0000, v174
    v_fma_f32 v195, v195, v186, v187
    v_fma_f32 v196, v196, v186, v187
    v_cvt_pk_bf16_f32 v174, v195, v196
    v_mfma_f32_16x16x32_bf16 v[152:155], v[88:91], v[52:55], v[152:155]
    v_lshlrev_b32 v195, 16, v175
    v_and_b32 v196, 0xffff0000, v175
    v_fma_f32 v195, v195, v186, v187
    v_fma_f32 v196, v196, v186, v187
    v_mfma_f32_16x16x32_bf16 v[156:159], v[88:91], v[56:59], v[156:159]
    v_cvt_pk_bf16_f32 v175, v195, v196
    ds_write_b128 v194, v[172:175] offset:8192
    s_mov_b32 s72, 640
    buffer_load_dwordx4 v[168:171], v192, s[40:43], s72 offen
    v_mfma_f32_16x16x32_bf16 v[160:163], v[92:95], v[52:55], v[160:163]
    s_mov_b32 s72, 74368
    buffer_load_dwordx4 v[172:175], v192, s[40:43], s72 offen
    v_mfma_f32_16x16x32_bf16 v[164:167], v[92:95], v[56:59], v[164:167]
    s_waitcnt lgkmcnt(0)
    v_mfma_f32_16x16x32_bf16 v[96:99], v[16:19], v[8:11], v[96:99]
    ds_read_b128 v[52:55], v199 offset:0
    v_mfma_f32_16x16x32_bf16 v[100:103], v[16:19], v[12:15], v[100:103]
    ds_read_b128 v[56:59], v199 offset:2048
    v_mfma_f32_16x16x32_bf16 v[104:107], v[20:23], v[8:11], v[104:107]
    ds_read_b128 v[60:63], v201 offset:0
    v_mfma_f32_16x16x32_bf16 v[108:111], v[20:23], v[12:15], v[108:111]
    ds_read_b128 v[64:67], v201 offset:2048
    v_mfma_f32_16x16x32_bf16 v[112:115], v[24:27], v[8:11], v[112:115]
    ds_read_b128 v[68:71], v201 offset:4096
    v_mfma_f32_16x16x32_bf16 v[116:119], v[24:27], v[12:15], v[116:119]
    ds_read_b128 v[72:75], v201 offset:6144
    v_mfma_f32_16x16x32_bf16 v[120:123], v[28:31], v[8:11], v[120:123]
    ds_read_b128 v[76:79], v201 offset:8192
    v_mfma_f32_16x16x32_bf16 v[124:127], v[28:31], v[12:15], v[124:127]
    ds_read_b128 v[80:83], v201 offset:10240
    v_mfma_f32_16x16x32_bf16 v[128:131], v[32:35], v[8:11], v[128:131]
    ds_read_b128 v[84:87], v201 offset:12288
    v_mfma_f32_16x16x32_bf16 v[132:135], v[32:35], v[12:15], v[132:135]
    ds_read_b128 v[88:91], v201 offset:14336
    v_mfma_f32_16x16x32_bf16 v[136:139], v[36:39], v[8:11], v[136:139]
    ds_read_b128 v[92:95], v201 offset:16384
    v_mfma_f32_16x16x32_bf16 v[140:143], v[36:39], v[12:15], v[140:143]
    v_mfma_f32_16x16x32_bf16 v[144:147], v[40:43], v[8:11], v[144:147]
    v_mfma_f32_16x16x32_bf16 v[148:151], v[40:43], v[12:15], v[148:151]
    v_mfma_f32_16x16x32_bf16 v[152:155], v[44:47], v[8:11], v[152:155]
    v_mfma_f32_16x16x32_bf16 v[156:159], v[44:47], v[12:15], v[156:159]
    v_mfma_f32_16x16x32_bf16 v[160:163], v[48:51], v[8:11], v[160:163]
    v_mfma_f32_16x16x32_bf16 v[164:167], v[48:51], v[12:15], v[164:167]
    s_waitcnt vmcnt(10) lgkmcnt(0)
    s_barrier
    ds_read_b128 v[8:11], v202 offset:0
    ds_read_b128 v[12:15], v202 offset:2048
    ds_read_b128 v[16:19], v204 offset:0
    ds_read_b128 v[20:23], v204 offset:2048
    v_mfma_f32_16x16x32_bf16 v[96:99], v[60:63], v[52:55], v[96:99]
    ds_read_b128 v[24:27], v204 offset:4096
    ds_read_b128 v[28:31], v204 offset:6144
    ds_read_b128 v[32:35], v204 offset:8192
    ds_read_b128 v[36:39], v204 offset:10240
    v_mfma_f32_16x16x32_bf16 v[100:103], v[60:63], v[56:59], v[100:103]
    ds_read_b128 v[40:43], v204 offset:12288
    ds_read_b128 v[44:47], v204 offset:14336
    ds_read_b128 v[48:51], v204 offset:16384
    s_add_u32 m0, s65, 69632
    v_mfma_f32_16x16x32_bf16 v[104:107], v[64:67], v[52:55], v[104:107]
    s_mov_b32 s72, 512
    buffer_load_dwordx4 v193, s[44:47], s72 offen lds
    s_add_u32 m0, s65, 77824
    s_mov_b32 s72, 74240
    v_mfma_f32_16x16x32_bf16 v[108:111], v[64:67], v[56:59], v[108:111]
    buffer_load_dwordx4 v193, s[44:47], s72 offen lds
    s_add_u32 m0, s65, 86016
    s_mov_b32 s72, 147968
    buffer_load_dwordx4 v193, s[44:47], s72 offen lds
    v_mfma_f32_16x16x32_bf16 v[112:115], v[68:71], v[52:55], v[112:115]
    s_add_u32 m0, s65, 94208
    s_mov_b32 s72, 221696
    buffer_load_dwordx4 v193, s[44:47], s72 offen lds
    s_waitcnt vmcnt(10)
    v_mfma_f32_16x16x32_bf16 v[116:119], v[68:71], v[56:59], v[116:119]
    v_lshlrev_b32 v195, 16, v176
    v_and_b32 v196, 0xffff0000, v176
    v_fma_f32 v195, v195, v184, v185
    v_fma_f32 v196, v196, v184, v185
    v_mfma_f32_16x16x32_bf16 v[120:123], v[72:75], v[52:55], v[120:123]
    v_cvt_pk_bf16_f32 v176, v195, v196
    v_lshlrev_b32 v195, 16, v177
    v_and_b32 v196, 0xffff0000, v177
    v_fma_f32 v195, v195, v184, v185
    v_mfma_f32_16x16x32_bf16 v[124:127], v[72:75], v[56:59], v[124:127]
    v_fma_f32 v196, v196, v184, v185
    v_cvt_pk_bf16_f32 v177, v195, v196
    v_lshlrev_b32 v195, 16, v178
    v_and_b32 v196, 0xffff0000, v178
    v_mfma_f32_16x16x32_bf16 v[128:131], v[76:79], v[52:55], v[128:131]
    v_fma_f32 v195, v195, v184, v185
    v_fma_f32 v196, v196, v184, v185
    v_cvt_pk_bf16_f32 v178, v195, v196
    v_lshlrev_b32 v195, 16, v179
    v_mfma_f32_16x16x32_bf16 v[132:135], v[76:79], v[56:59], v[132:135]
    v_and_b32 v196, 0xffff0000, v179
    v_fma_f32 v195, v195, v184, v185
    v_fma_f32 v196, v196, v184, v185
    v_cvt_pk_bf16_f32 v179, v195, v196
    v_mfma_f32_16x16x32_bf16 v[136:139], v[80:83], v[52:55], v[136:139]
    ds_write_b128 v194, v[176:179] offset:53248
    v_lshlrev_b32 v195, 16, v180
    v_and_b32 v196, 0xffff0000, v180
    v_fma_f32 v195, v195, v186, v187
    v_mfma_f32_16x16x32_bf16 v[140:143], v[80:83], v[56:59], v[140:143]
    v_fma_f32 v196, v196, v186, v187
    v_cvt_pk_bf16_f32 v180, v195, v196
    v_lshlrev_b32 v195, 16, v181
    v_and_b32 v196, 0xffff0000, v181
    v_mfma_f32_16x16x32_bf16 v[144:147], v[84:87], v[52:55], v[144:147]
    v_fma_f32 v195, v195, v186, v187
    v_fma_f32 v196, v196, v186, v187
    v_cvt_pk_bf16_f32 v181, v195, v196
    v_lshlrev_b32 v195, 16, v182
    v_mfma_f32_16x16x32_bf16 v[148:151], v[84:87], v[56:59], v[148:151]
    v_and_b32 v196, 0xffff0000, v182
    v_fma_f32 v195, v195, v186, v187
    v_fma_f32 v196, v196, v186, v187
    v_cvt_pk_bf16_f32 v182, v195, v196
    v_mfma_f32_16x16x32_bf16 v[152:155], v[88:91], v[52:55], v[152:155]
    v_lshlrev_b32 v195, 16, v183
    v_and_b32 v196, 0xffff0000, v183
    v_fma_f32 v195, v195, v186, v187
    v_fma_f32 v196, v196, v186, v187
    v_mfma_f32_16x16x32_bf16 v[156:159], v[88:91], v[56:59], v[156:159]
    v_cvt_pk_bf16_f32 v183, v195, v196
    ds_write_b128 v194, v[180:183] offset:61440
    s_mov_b32 s72, 768
    buffer_load_dwordx4 v[176:179], v192, s[40:43], s72 offen
    v_mfma_f32_16x16x32_bf16 v[160:163], v[92:95], v[52:55], v[160:163]
    s_mov_b32 s72, 74496
    buffer_load_dwordx4 v[180:183], v192, s[40:43], s72 offen
    v_mfma_f32_16x16x32_bf16 v[164:167], v[92:95], v[56:59], v[164:167]
    s_waitcnt lgkmcnt(0)
    v_mfma_f32_16x16x32_bf16 v[96:99], v[16:19], v[8:11], v[96:99]
    ds_read_b128 v[52:55], v203 offset:0
    v_mfma_f32_16x16x32_bf16 v[100:103], v[16:19], v[12:15], v[100:103]
    ds_read_b128 v[56:59], v203 offset:2048
    v_mfma_f32_16x16x32_bf16 v[104:107], v[20:23], v[8:11], v[104:107]
    ds_read_b128 v[60:63], v205 offset:0
    v_mfma_f32_16x16x32_bf16 v[108:111], v[20:23], v[12:15], v[108:111]
    ds_read_b128 v[64:67], v205 offset:2048
    v_mfma_f32_16x16x32_bf16 v[112:115], v[24:27], v[8:11], v[112:115]
    ds_read_b128 v[68:71], v205 offset:4096
    v_mfma_f32_16x16x32_bf16 v[116:119], v[24:27], v[12:15], v[116:119]
    ds_read_b128 v[72:75], v205 offset:6144
    v_mfma_f32_16x16x32_bf16 v[120:123], v[28:31], v[8:11], v[120:123]
    ds_read_b128 v[76:79], v205 offset:8192
    v_mfma_f32_16x16x32_bf16 v[124:127], v[28:31], v[12:15], v[124:127]
    ds_read_b128 v[80:83], v205 offset:10240
    v_mfma_f32_16x16x32_bf16 v[128:131], v[32:35], v[8:11], v[128:131]
    ds_read_b128 v[84:87], v205 offset:12288
    v_mfma_f32_16x16x32_bf16 v[132:135], v[32:35], v[12:15], v[132:135]
    ds_read_b128 v[88:91], v205 offset:14336
    v_mfma_f32_16x16x32_bf16 v[136:139], v[36:39], v[8:11], v[136:139]
    ds_read_b128 v[92:95], v205 offset:16384
    v_mfma_f32_16x16x32_bf16 v[140:143], v[36:39], v[12:15], v[140:143]
    v_mfma_f32_16x16x32_bf16 v[144:147], v[40:43], v[8:11], v[144:147]
    v_mfma_f32_16x16x32_bf16 v[148:151], v[40:43], v[12:15], v[148:151]
    v_mfma_f32_16x16x32_bf16 v[152:155], v[44:47], v[8:11], v[152:155]
    v_mfma_f32_16x16x32_bf16 v[156:159], v[44:47], v[12:15], v[156:159]
    v_mfma_f32_16x16x32_bf16 v[160:163], v[48:51], v[8:11], v[160:163]
    v_mfma_f32_16x16x32_bf16 v[164:167], v[48:51], v[12:15], v[164:167]
    s_waitcnt vmcnt(8) lgkmcnt(0)
    s_barrier
    ds_read_b128 v[8:11], v4 offset:0
    ds_read_b128 v[12:15], v4 offset:2048
    ds_read_b128 v[16:19], v2 offset:0
    ds_read_b128 v[20:23], v2 offset:2048
    v_mfma_f32_16x16x32_bf16 v[96:99], v[60:63], v[52:55], v[96:99]
    ds_read_b128 v[24:27], v2 offset:4096
    ds_read_b128 v[28:31], v2 offset:6144
    ds_read_b128 v[32:35], v2 offset:8192
    ds_read_b128 v[36:39], v2 offset:10240
    v_mfma_f32_16x16x32_bf16 v[100:103], v[60:63], v[56:59], v[100:103]
    ds_read_b128 v[40:43], v2 offset:12288
    ds_read_b128 v[44:47], v2 offset:14336
    ds_read_b128 v[48:51], v2 offset:16384
    s_add_u32 m0, s65, 122880
    v_mfma_f32_16x16x32_bf16 v[104:107], v[64:67], v[52:55], v[104:107]
    s_mov_b32 s72, 640
    buffer_load_dwordx4 v193, s[44:47], s72 offen lds
    s_add_u32 m0, s65, 131072
    s_mov_b32 s72, 74368
    v_mfma_f32_16x16x32_bf16 v[108:111], v[64:67], v[56:59], v[108:111]
    buffer_load_dwordx4 v193, s[44:47], s72 offen lds
    s_add_u32 m0, s65, 139264
    s_mov_b32 s72, 148096
    buffer_load_dwordx4 v193, s[44:47], s72 offen lds
    v_mfma_f32_16x16x32_bf16 v[112:115], v[68:71], v[52:55], v[112:115]
    s_add_u32 m0, s65, 147456
    s_mov_b32 s72, 221824
    buffer_load_dwordx4 v193, s[44:47], s72 offen lds
    s_waitcnt vmcnt(10)
    v_mfma_f32_16x16x32_bf16 v[116:119], v[68:71], v[56:59], v[116:119]
    v_lshlrev_b32 v195, 16, v168
    v_and_b32 v196, 0xffff0000, v168
    v_fma_f32 v195, v195, v184, v185
    v_fma_f32 v196, v196, v184, v185
    v_mfma_f32_16x16x32_bf16 v[120:123], v[72:75], v[52:55], v[120:123]
    v_cvt_pk_bf16_f32 v168, v195, v196
    v_lshlrev_b32 v195, 16, v169
    v_and_b32 v196, 0xffff0000, v169
    v_fma_f32 v195, v195, v184, v185
    v_mfma_f32_16x16x32_bf16 v[124:127], v[72:75], v[56:59], v[124:127]
    v_fma_f32 v196, v196, v184, v185
    v_cvt_pk_bf16_f32 v169, v195, v196
    v_lshlrev_b32 v195, 16, v170
    v_and_b32 v196, 0xffff0000, v170
    v_mfma_f32_16x16x32_bf16 v[128:131], v[76:79], v[52:55], v[128:131]
    v_fma_f32 v195, v195, v184, v185
    v_fma_f32 v196, v196, v184, v185
    v_cvt_pk_bf16_f32 v170, v195, v196
    v_lshlrev_b32 v195, 16, v171
    v_mfma_f32_16x16x32_bf16 v[132:135], v[76:79], v[56:59], v[132:135]
    v_and_b32 v196, 0xffff0000, v171
    v_fma_f32 v195, v195, v184, v185
    v_fma_f32 v196, v196, v184, v185
    v_cvt_pk_bf16_f32 v171, v195, v196
    v_mfma_f32_16x16x32_bf16 v[136:139], v[80:83], v[52:55], v[136:139]
    ds_write_b128 v197, v[168:171] offset:0
    v_lshlrev_b32 v195, 16, v172
    v_and_b32 v196, 0xffff0000, v172
    v_fma_f32 v195, v195, v186, v187
    v_mfma_f32_16x16x32_bf16 v[140:143], v[80:83], v[56:59], v[140:143]
    v_fma_f32 v196, v196, v186, v187
    v_cvt_pk_bf16_f32 v172, v195, v196
    v_lshlrev_b32 v195, 16, v173
    v_and_b32 v196, 0xffff0000, v173
    v_mfma_f32_16x16x32_bf16 v[144:147], v[84:87], v[52:55], v[144:147]
    v_fma_f32 v195, v195, v186, v187
    v_fma_f32 v196, v196, v186, v187
    v_cvt_pk_bf16_f32 v173, v195, v196
    v_lshlrev_b32 v195, 16, v174
    v_mfma_f32_16x16x32_bf16 v[148:151], v[84:87], v[56:59], v[148:151]
    v_and_b32 v196, 0xffff0000, v174
    v_fma_f32 v195, v195, v186, v187
    v_fma_f32 v196, v196, v186, v187
    v_cvt_pk_bf16_f32 v174, v195, v196
    v_mfma_f32_16x16x32_bf16 v[152:155], v[88:91], v[52:55], v[152:155]
    v_lshlrev_b32 v195, 16, v175
    v_and_b32 v196, 0xffff0000, v175
    v_fma_f32 v195, v195, v186, v187
    v_fma_f32 v196, v196, v186, v187
    v_mfma_f32_16x16x32_bf16 v[156:159], v[88:91], v[56:59], v[156:159]
    v_cvt_pk_bf16_f32 v175, v195, v196
    ds_write_b128 v197, v[172:175] offset:8192
    s_mov_b32 s72, 896
    buffer_load_dwordx4 v[168:171], v192, s[40:43], s72 offen
    v_mfma_f32_16x16x32_bf16 v[160:163], v[92:95], v[52:55], v[160:163]
    s_mov_b32 s72, 74624
    buffer_load_dwordx4 v[172:175], v192, s[40:43], s72 offen
    v_mfma_f32_16x16x32_bf16 v[164:167], v[92:95], v[56:59], v[164:167]
    s_waitcnt lgkmcnt(0)
    v_mfma_f32_16x16x32_bf16 v[96:99], v[16:19], v[8:11], v[96:99]
    ds_read_b128 v[52:55], v5 offset:0
    v_mfma_f32_16x16x32_bf16 v[100:103], v[16:19], v[12:15], v[100:103]
    ds_read_b128 v[56:59], v5 offset:2048
    v_mfma_f32_16x16x32_bf16 v[104:107], v[20:23], v[8:11], v[104:107]
    ds_read_b128 v[60:63], v3 offset:0
    v_mfma_f32_16x16x32_bf16 v[108:111], v[20:23], v[12:15], v[108:111]
    ds_read_b128 v[64:67], v3 offset:2048
    v_mfma_f32_16x16x32_bf16 v[112:115], v[24:27], v[8:11], v[112:115]
    ds_read_b128 v[68:71], v3 offset:4096
    v_mfma_f32_16x16x32_bf16 v[116:119], v[24:27], v[12:15], v[116:119]
    ds_read_b128 v[72:75], v3 offset:6144
    v_mfma_f32_16x16x32_bf16 v[120:123], v[28:31], v[8:11], v[120:123]
    ds_read_b128 v[76:79], v3 offset:8192
    v_mfma_f32_16x16x32_bf16 v[124:127], v[28:31], v[12:15], v[124:127]
    ds_read_b128 v[80:83], v3 offset:10240
    v_mfma_f32_16x16x32_bf16 v[128:131], v[32:35], v[8:11], v[128:131]
    ds_read_b128 v[84:87], v3 offset:12288
    v_mfma_f32_16x16x32_bf16 v[132:135], v[32:35], v[12:15], v[132:135]
    ds_read_b128 v[88:91], v3 offset:14336
    v_mfma_f32_16x16x32_bf16 v[136:139], v[36:39], v[8:11], v[136:139]
    ds_read_b128 v[92:95], v3 offset:16384
    v_mfma_f32_16x16x32_bf16 v[140:143], v[36:39], v[12:15], v[140:143]
    v_mfma_f32_16x16x32_bf16 v[144:147], v[40:43], v[8:11], v[144:147]
    v_mfma_f32_16x16x32_bf16 v[148:151], v[40:43], v[12:15], v[148:151]
    v_mfma_f32_16x16x32_bf16 v[152:155], v[44:47], v[8:11], v[152:155]
    v_mfma_f32_16x16x32_bf16 v[156:159], v[44:47], v[12:15], v[156:159]
    v_mfma_f32_16x16x32_bf16 v[160:163], v[48:51], v[8:11], v[160:163]
    v_mfma_f32_16x16x32_bf16 v[164:167], v[48:51], v[12:15], v[164:167]
    s_waitcnt vmcnt(8) lgkmcnt(0)
    s_barrier
    ds_read_b128 v[8:11], v198 offset:0
    ds_read_b128 v[12:15], v198 offset:2048
    ds_read_b128 v[16:19], v200 offset:0
    ds_read_b128 v[20:23], v200 offset:2048
    v_mfma_f32_16x16x32_bf16 v[96:99], v[60:63], v[52:55], v[96:99]
    ds_read_b128 v[24:27], v200 offset:4096
    ds_read_b128 v[28:31], v200 offset:6144
    ds_read_b128 v[32:35], v200 offset:8192
    ds_read_b128 v[36:39], v200 offset:10240
    v_mfma_f32_16x16x32_bf16 v[100:103], v[60:63], v[56:59], v[100:103]
    ds_read_b128 v[40:43], v200 offset:12288
    ds_read_b128 v[44:47], v200 offset:14336
    ds_read_b128 v[48:51], v200 offset:16384
    s_add_u32 m0, s65, 16384
    v_mfma_f32_16x16x32_bf16 v[104:107], v[64:67], v[52:55], v[104:107]
    s_mov_b32 s72, 768
    buffer_load_dwordx4 v193, s[44:47], s72 offen lds
    s_add_u32 m0, s65, 24576
    s_mov_b32 s72, 74496
    v_mfma_f32_16x16x32_bf16 v[108:111], v[64:67], v[56:59], v[108:111]
    buffer_load_dwordx4 v193, s[44:47], s72 offen lds
    s_add_u32 m0, s65, 32768
    s_mov_b32 s72, 148224
    buffer_load_dwordx4 v193, s[44:47], s72 offen lds
    v_mfma_f32_16x16x32_bf16 v[112:115], v[68:71], v[52:55], v[112:115]
    s_add_u32 m0, s65, 40960
    s_mov_b32 s72, 221952
    buffer_load_dwordx4 v193, s[44:47], s72 offen lds
    s_waitcnt vmcnt(10)
    v_mfma_f32_16x16x32_bf16 v[116:119], v[68:71], v[56:59], v[116:119]
    v_lshlrev_b32 v195, 16, v176
    v_and_b32 v196, 0xffff0000, v176
    v_fma_f32 v195, v195, v184, v185
    v_fma_f32 v196, v196, v184, v185
    v_mfma_f32_16x16x32_bf16 v[120:123], v[72:75], v[52:55], v[120:123]
    v_cvt_pk_bf16_f32 v176, v195, v196
    v_lshlrev_b32 v195, 16, v177
    v_and_b32 v196, 0xffff0000, v177
    v_fma_f32 v195, v195, v184, v185
    v_mfma_f32_16x16x32_bf16 v[124:127], v[72:75], v[56:59], v[124:127]
    v_fma_f32 v196, v196, v184, v185
    v_cvt_pk_bf16_f32 v177, v195, v196
    v_lshlrev_b32 v195, 16, v178
    v_and_b32 v196, 0xffff0000, v178
    v_mfma_f32_16x16x32_bf16 v[128:131], v[76:79], v[52:55], v[128:131]
    v_fma_f32 v195, v195, v184, v185
    v_fma_f32 v196, v196, v184, v185
    v_cvt_pk_bf16_f32 v178, v195, v196
    v_lshlrev_b32 v195, 16, v179
    v_mfma_f32_16x16x32_bf16 v[132:135], v[76:79], v[56:59], v[132:135]
    v_and_b32 v196, 0xffff0000, v179
    v_fma_f32 v195, v195, v184, v185
    v_fma_f32 v196, v196, v184, v185
    v_cvt_pk_bf16_f32 v179, v195, v196
    v_mfma_f32_16x16x32_bf16 v[136:139], v[80:83], v[52:55], v[136:139]
    ds_write_b128 v194, v[176:179] offset:0
    v_lshlrev_b32 v195, 16, v180
    v_and_b32 v196, 0xffff0000, v180
    v_fma_f32 v195, v195, v186, v187
    v_mfma_f32_16x16x32_bf16 v[140:143], v[80:83], v[56:59], v[140:143]
    v_fma_f32 v196, v196, v186, v187
    v_cvt_pk_bf16_f32 v180, v195, v196
    v_lshlrev_b32 v195, 16, v181
    v_and_b32 v196, 0xffff0000, v181
    v_mfma_f32_16x16x32_bf16 v[144:147], v[84:87], v[52:55], v[144:147]
    v_fma_f32 v195, v195, v186, v187
    v_fma_f32 v196, v196, v186, v187
    v_cvt_pk_bf16_f32 v181, v195, v196
    v_lshlrev_b32 v195, 16, v182
    v_mfma_f32_16x16x32_bf16 v[148:151], v[84:87], v[56:59], v[148:151]
    v_and_b32 v196, 0xffff0000, v182
    v_fma_f32 v195, v195, v186, v187
    v_fma_f32 v196, v196, v186, v187
    v_cvt_pk_bf16_f32 v182, v195, v196
    v_mfma_f32_16x16x32_bf16 v[152:155], v[88:91], v[52:55], v[152:155]
    v_lshlrev_b32 v195, 16, v183
    v_and_b32 v196, 0xffff0000, v183
    v_fma_f32 v195, v195, v186, v187
    v_fma_f32 v196, v196, v186, v187
    v_mfma_f32_16x16x32_bf16 v[156:159], v[88:91], v[56:59], v[156:159]
    v_cvt_pk_bf16_f32 v183, v195, v196
    ds_write_b128 v194, v[180:183] offset:8192
    s_mov_b32 s72, 1024
    buffer_load_dwordx4 v[176:179], v192, s[40:43], s72 offen
    v_mfma_f32_16x16x32_bf16 v[160:163], v[92:95], v[52:55], v[160:163]
    s_mov_b32 s72, 74752
    buffer_load_dwordx4 v[180:183], v192, s[40:43], s72 offen
    v_mfma_f32_16x16x32_bf16 v[164:167], v[92:95], v[56:59], v[164:167]
    s_waitcnt lgkmcnt(0)
    v_mfma_f32_16x16x32_bf16 v[96:99], v[16:19], v[8:11], v[96:99]
    ds_read_b128 v[52:55], v199 offset:0
    v_mfma_f32_16x16x32_bf16 v[100:103], v[16:19], v[12:15], v[100:103]
    ds_read_b128 v[56:59], v199 offset:2048
    v_mfma_f32_16x16x32_bf16 v[104:107], v[20:23], v[8:11], v[104:107]
    ds_read_b128 v[60:63], v201 offset:0
    v_mfma_f32_16x16x32_bf16 v[108:111], v[20:23], v[12:15], v[108:111]
    ds_read_b128 v[64:67], v201 offset:2048
    v_mfma_f32_16x16x32_bf16 v[112:115], v[24:27], v[8:11], v[112:115]
    ds_read_b128 v[68:71], v201 offset:4096
    v_mfma_f32_16x16x32_bf16 v[116:119], v[24:27], v[12:15], v[116:119]
    ds_read_b128 v[72:75], v201 offset:6144
    v_mfma_f32_16x16x32_bf16 v[120:123], v[28:31], v[8:11], v[120:123]
    ds_read_b128 v[76:79], v201 offset:8192
    v_mfma_f32_16x16x32_bf16 v[124:127], v[28:31], v[12:15], v[124:127]
    ds_read_b128 v[80:83], v201 offset:10240
    v_mfma_f32_16x16x32_bf16 v[128:131], v[32:35], v[8:11], v[128:131]
    ds_read_b128 v[84:87], v201 offset:12288
    v_mfma_f32_16x16x32_bf16 v[132:135], v[32:35], v[12:15], v[132:135]
    ds_read_b128 v[88:91], v201 offset:14336
    v_mfma_f32_16x16x32_bf16 v[136:139], v[36:39], v[8:11], v[136:139]
    ds_read_b128 v[92:95], v201 offset:16384
    v_mfma_f32_16x16x32_bf16 v[140:143], v[36:39], v[12:15], v[140:143]
    v_mfma_f32_16x16x32_bf16 v[144:147], v[40:43], v[8:11], v[144:147]
    v_mfma_f32_16x16x32_bf16 v[148:151], v[40:43], v[12:15], v[148:151]
    v_mfma_f32_16x16x32_bf16 v[152:155], v[44:47], v[8:11], v[152:155]
    v_mfma_f32_16x16x32_bf16 v[156:159], v[44:47], v[12:15], v[156:159]
    v_mfma_f32_16x16x32_bf16 v[160:163], v[48:51], v[8:11], v[160:163]
    v_mfma_f32_16x16x32_bf16 v[164:167], v[48:51], v[12:15], v[164:167]
    s_waitcnt vmcnt(8) lgkmcnt(0)
    s_barrier
    ds_read_b128 v[8:11], v202 offset:0
    ds_read_b128 v[12:15], v202 offset:2048
    ds_read_b128 v[16:19], v204 offset:0
    ds_read_b128 v[20:23], v204 offset:2048
    v_mfma_f32_16x16x32_bf16 v[96:99], v[60:63], v[52:55], v[96:99]
    ds_read_b128 v[24:27], v204 offset:4096
    ds_read_b128 v[28:31], v204 offset:6144
    ds_read_b128 v[32:35], v204 offset:8192
    ds_read_b128 v[36:39], v204 offset:10240
    v_mfma_f32_16x16x32_bf16 v[100:103], v[60:63], v[56:59], v[100:103]
    ds_read_b128 v[40:43], v204 offset:12288
    ds_read_b128 v[44:47], v204 offset:14336
    ds_read_b128 v[48:51], v204 offset:16384
    s_add_u32 m0, s65, 69632
    v_mfma_f32_16x16x32_bf16 v[104:107], v[64:67], v[52:55], v[104:107]
    s_mov_b32 s72, 896
    buffer_load_dwordx4 v193, s[44:47], s72 offen lds
    s_add_u32 m0, s65, 77824
    s_mov_b32 s72, 74624
    v_mfma_f32_16x16x32_bf16 v[108:111], v[64:67], v[56:59], v[108:111]
    buffer_load_dwordx4 v193, s[44:47], s72 offen lds
    s_add_u32 m0, s65, 86016
    s_mov_b32 s72, 148352
    buffer_load_dwordx4 v193, s[44:47], s72 offen lds
    v_mfma_f32_16x16x32_bf16 v[112:115], v[68:71], v[52:55], v[112:115]
    s_add_u32 m0, s65, 94208
    s_mov_b32 s72, 222080
    buffer_load_dwordx4 v193, s[44:47], s72 offen lds
    s_waitcnt vmcnt(10)
    v_mfma_f32_16x16x32_bf16 v[116:119], v[68:71], v[56:59], v[116:119]
    v_lshlrev_b32 v195, 16, v168
    v_and_b32 v196, 0xffff0000, v168
    v_fma_f32 v195, v195, v184, v185
    v_fma_f32 v196, v196, v184, v185
    v_mfma_f32_16x16x32_bf16 v[120:123], v[72:75], v[52:55], v[120:123]
    v_cvt_pk_bf16_f32 v168, v195, v196
    v_lshlrev_b32 v195, 16, v169
    v_and_b32 v196, 0xffff0000, v169
    v_fma_f32 v195, v195, v184, v185
    v_mfma_f32_16x16x32_bf16 v[124:127], v[72:75], v[56:59], v[124:127]
    v_fma_f32 v196, v196, v184, v185
    v_cvt_pk_bf16_f32 v169, v195, v196
    v_lshlrev_b32 v195, 16, v170
    v_and_b32 v196, 0xffff0000, v170
    v_mfma_f32_16x16x32_bf16 v[128:131], v[76:79], v[52:55], v[128:131]
    v_fma_f32 v195, v195, v184, v185
    v_fma_f32 v196, v196, v184, v185
    v_cvt_pk_bf16_f32 v170, v195, v196
    v_lshlrev_b32 v195, 16, v171
    v_mfma_f32_16x16x32_bf16 v[132:135], v[76:79], v[56:59], v[132:135]
    v_and_b32 v196, 0xffff0000, v171
    v_fma_f32 v195, v195, v184, v185
    v_fma_f32 v196, v196, v184, v185
    v_cvt_pk_bf16_f32 v171, v195, v196
    v_mfma_f32_16x16x32_bf16 v[136:139], v[80:83], v[52:55], v[136:139]
    ds_write_b128 v194, v[168:171] offset:53248
    v_lshlrev_b32 v195, 16, v172
    v_and_b32 v196, 0xffff0000, v172
    v_fma_f32 v195, v195, v186, v187
    v_mfma_f32_16x16x32_bf16 v[140:143], v[80:83], v[56:59], v[140:143]
    v_fma_f32 v196, v196, v186, v187
    v_cvt_pk_bf16_f32 v172, v195, v196
    v_lshlrev_b32 v195, 16, v173
    v_and_b32 v196, 0xffff0000, v173
    v_mfma_f32_16x16x32_bf16 v[144:147], v[84:87], v[52:55], v[144:147]
    v_fma_f32 v195, v195, v186, v187
    v_fma_f32 v196, v196, v186, v187
    v_cvt_pk_bf16_f32 v173, v195, v196
    v_lshlrev_b32 v195, 16, v174
    v_mfma_f32_16x16x32_bf16 v[148:151], v[84:87], v[56:59], v[148:151]
    v_and_b32 v196, 0xffff0000, v174
    v_fma_f32 v195, v195, v186, v187
    v_fma_f32 v196, v196, v186, v187
    v_cvt_pk_bf16_f32 v174, v195, v196
    v_mfma_f32_16x16x32_bf16 v[152:155], v[88:91], v[52:55], v[152:155]
    v_lshlrev_b32 v195, 16, v175
    v_and_b32 v196, 0xffff0000, v175
    v_fma_f32 v195, v195, v186, v187
    v_fma_f32 v196, v196, v186, v187
    v_mfma_f32_16x16x32_bf16 v[156:159], v[88:91], v[56:59], v[156:159]
    v_cvt_pk_bf16_f32 v175, v195, v196
    ds_write_b128 v194, v[172:175] offset:61440
    v_mfma_f32_16x16x32_bf16 v[160:163], v[92:95], v[52:55], v[160:163]
    v_mfma_f32_16x16x32_bf16 v[164:167], v[92:95], v[56:59], v[164:167]
    s_waitcnt lgkmcnt(0)
    v_mfma_f32_16x16x32_bf16 v[96:99], v[16:19], v[8:11], v[96:99]
    ds_read_b128 v[52:55], v203 offset:0
    v_mfma_f32_16x16x32_bf16 v[100:103], v[16:19], v[12:15], v[100:103]
    ds_read_b128 v[56:59], v203 offset:2048
    v_mfma_f32_16x16x32_bf16 v[104:107], v[20:23], v[8:11], v[104:107]
    ds_read_b128 v[60:63], v205 offset:0
    v_mfma_f32_16x16x32_bf16 v[108:111], v[20:23], v[12:15], v[108:111]
    ds_read_b128 v[64:67], v205 offset:2048
    v_mfma_f32_16x16x32_bf16 v[112:115], v[24:27], v[8:11], v[112:115]
    ds_read_b128 v[68:71], v205 offset:4096
    v_mfma_f32_16x16x32_bf16 v[116:119], v[24:27], v[12:15], v[116:119]
    ds_read_b128 v[72:75], v205 offset:6144
    v_mfma_f32_16x16x32_bf16 v[120:123], v[28:31], v[8:11], v[120:123]
    ds_read_b128 v[76:79], v205 offset:8192
    v_mfma_f32_16x16x32_bf16 v[124:127], v[28:31], v[12:15], v[124:127]
    ds_read_b128 v[80:83], v205 offset:10240
    v_mfma_f32_16x16x32_bf16 v[128:131], v[32:35], v[8:11], v[128:131]
    ds_read_b128 v[84:87], v205 offset:12288
    v_mfma_f32_16x16x32_bf16 v[132:135], v[32:35], v[12:15], v[132:135]
    ds_read_b128 v[88:91], v205 offset:14336
    v_mfma_f32_16x16x32_bf16 v[136:139], v[36:39], v[8:11], v[136:139]
    ds_read_b128 v[92:95], v205 offset:16384
    v_mfma_f32_16x16x32_bf16 v[140:143], v[36:39], v[12:15], v[140:143]
    v_mfma_f32_16x16x32_bf16 v[144:147], v[40:43], v[8:11], v[144:147]
    v_mfma_f32_16x16x32_bf16 v[148:151], v[40:43], v[12:15], v[148:151]
    v_mfma_f32_16x16x32_bf16 v[152:155], v[44:47], v[8:11], v[152:155]
    v_mfma_f32_16x16x32_bf16 v[156:159], v[44:47], v[12:15], v[156:159]
    v_mfma_f32_16x16x32_bf16 v[160:163], v[48:51], v[8:11], v[160:163]
    v_mfma_f32_16x16x32_bf16 v[164:167], v[48:51], v[12:15], v[164:167]
    s_waitcnt vmcnt(6) lgkmcnt(0)
    s_barrier
    ds_read_b128 v[8:11], v4 offset:0
    ds_read_b128 v[12:15], v4 offset:2048
    ds_read_b128 v[16:19], v2 offset:0
    ds_read_b128 v[20:23], v2 offset:2048
    v_mfma_f32_16x16x32_bf16 v[96:99], v[60:63], v[52:55], v[96:99]
    ds_read_b128 v[24:27], v2 offset:4096
    ds_read_b128 v[28:31], v2 offset:6144
    ds_read_b128 v[32:35], v2 offset:8192
    ds_read_b128 v[36:39], v2 offset:10240
    v_mfma_f32_16x16x32_bf16 v[100:103], v[60:63], v[56:59], v[100:103]
    ds_read_b128 v[40:43], v2 offset:12288
    ds_read_b128 v[44:47], v2 offset:14336
    ds_read_b128 v[48:51], v2 offset:16384
    s_add_u32 m0, s65, 122880
    v_mfma_f32_16x16x32_bf16 v[104:107], v[64:67], v[52:55], v[104:107]
    s_mov_b32 s72, 1024
    buffer_load_dwordx4 v193, s[44:47], s72 offen lds
    s_add_u32 m0, s65, 131072
    s_mov_b32 s72, 74752
    v_mfma_f32_16x16x32_bf16 v[108:111], v[64:67], v[56:59], v[108:111]
    buffer_load_dwordx4 v193, s[44:47], s72 offen lds
    s_add_u32 m0, s65, 139264
    s_mov_b32 s72, 148480
    buffer_load_dwordx4 v193, s[44:47], s72 offen lds
    v_mfma_f32_16x16x32_bf16 v[112:115], v[68:71], v[52:55], v[112:115]
    s_add_u32 m0, s65, 147456
    s_mov_b32 s72, 222208
    buffer_load_dwordx4 v193, s[44:47], s72 offen lds
    s_waitcnt vmcnt(8)
    v_mfma_f32_16x16x32_bf16 v[116:119], v[68:71], v[56:59], v[116:119]
    v_lshlrev_b32 v195, 16, v176
    v_and_b32 v196, 0xffff0000, v176
    v_fma_f32 v195, v195, v184, v185
    v_fma_f32 v196, v196, v184, v185
    v_mfma_f32_16x16x32_bf16 v[120:123], v[72:75], v[52:55], v[120:123]
    v_cvt_pk_bf16_f32 v176, v195, v196
    v_lshlrev_b32 v195, 16, v177
    v_and_b32 v196, 0xffff0000, v177
    v_fma_f32 v195, v195, v184, v185
    v_mfma_f32_16x16x32_bf16 v[124:127], v[72:75], v[56:59], v[124:127]
    v_fma_f32 v196, v196, v184, v185
    v_cvt_pk_bf16_f32 v177, v195, v196
    v_lshlrev_b32 v195, 16, v178
    v_and_b32 v196, 0xffff0000, v178
    v_mfma_f32_16x16x32_bf16 v[128:131], v[76:79], v[52:55], v[128:131]
    v_fma_f32 v195, v195, v184, v185
    v_fma_f32 v196, v196, v184, v185
    v_cvt_pk_bf16_f32 v178, v195, v196
    v_lshlrev_b32 v195, 16, v179
    v_mfma_f32_16x16x32_bf16 v[132:135], v[76:79], v[56:59], v[132:135]
    v_and_b32 v196, 0xffff0000, v179
    v_fma_f32 v195, v195, v184, v185
    v_fma_f32 v196, v196, v184, v185
    v_cvt_pk_bf16_f32 v179, v195, v196
    v_mfma_f32_16x16x32_bf16 v[136:139], v[80:83], v[52:55], v[136:139]
    ds_write_b128 v197, v[176:179] offset:0
    v_lshlrev_b32 v195, 16, v180
    v_and_b32 v196, 0xffff0000, v180
    v_fma_f32 v195, v195, v186, v187
    v_mfma_f32_16x16x32_bf16 v[140:143], v[80:83], v[56:59], v[140:143]
    v_fma_f32 v196, v196, v186, v187
    v_cvt_pk_bf16_f32 v180, v195, v196
    v_lshlrev_b32 v195, 16, v181
    v_and_b32 v196, 0xffff0000, v181
    v_mfma_f32_16x16x32_bf16 v[144:147], v[84:87], v[52:55], v[144:147]
    v_fma_f32 v195, v195, v186, v187
    v_fma_f32 v196, v196, v186, v187
    v_cvt_pk_bf16_f32 v181, v195, v196
    v_lshlrev_b32 v195, 16, v182
    v_mfma_f32_16x16x32_bf16 v[148:151], v[84:87], v[56:59], v[148:151]
    v_and_b32 v196, 0xffff0000, v182
    v_fma_f32 v195, v195, v186, v187
    v_fma_f32 v196, v196, v186, v187
    v_cvt_pk_bf16_f32 v182, v195, v196
    v_mfma_f32_16x16x32_bf16 v[152:155], v[88:91], v[52:55], v[152:155]
    v_lshlrev_b32 v195, 16, v183
    v_and_b32 v196, 0xffff0000, v183
    v_fma_f32 v195, v195, v186, v187
    v_fma_f32 v196, v196, v186, v187
    v_mfma_f32_16x16x32_bf16 v[156:159], v[88:91], v[56:59], v[156:159]
    v_cvt_pk_bf16_f32 v183, v195, v196
    ds_write_b128 v197, v[180:183] offset:8192
    v_mfma_f32_16x16x32_bf16 v[160:163], v[92:95], v[52:55], v[160:163]
    v_mfma_f32_16x16x32_bf16 v[164:167], v[92:95], v[56:59], v[164:167]
    s_waitcnt lgkmcnt(0)
    v_mfma_f32_16x16x32_bf16 v[96:99], v[16:19], v[8:11], v[96:99]
    ds_read_b128 v[52:55], v5 offset:0
    v_mfma_f32_16x16x32_bf16 v[100:103], v[16:19], v[12:15], v[100:103]
    ds_read_b128 v[56:59], v5 offset:2048
    v_mfma_f32_16x16x32_bf16 v[104:107], v[20:23], v[8:11], v[104:107]
    ds_read_b128 v[60:63], v3 offset:0
    v_mfma_f32_16x16x32_bf16 v[108:111], v[20:23], v[12:15], v[108:111]
    ds_read_b128 v[64:67], v3 offset:2048
    v_mfma_f32_16x16x32_bf16 v[112:115], v[24:27], v[8:11], v[112:115]
    ds_read_b128 v[68:71], v3 offset:4096
    v_mfma_f32_16x16x32_bf16 v[116:119], v[24:27], v[12:15], v[116:119]
    ds_read_b128 v[72:75], v3 offset:6144
    v_mfma_f32_16x16x32_bf16 v[120:123], v[28:31], v[8:11], v[120:123]
    ds_read_b128 v[76:79], v3 offset:8192
    v_mfma_f32_16x16x32_bf16 v[124:127], v[28:31], v[12:15], v[124:127]
    ds_read_b128 v[80:83], v3 offset:10240
    v_mfma_f32_16x16x32_bf16 v[128:131], v[32:35], v[8:11], v[128:131]
    ds_read_b128 v[84:87], v3 offset:12288
    v_mfma_f32_16x16x32_bf16 v[132:135], v[32:35], v[12:15], v[132:135]
    ds_read_b128 v[88:91], v3 offset:14336
    v_mfma_f32_16x16x32_bf16 v[136:139], v[36:39], v[8:11], v[136:139]
    ds_read_b128 v[92:95], v3 offset:16384
    v_mfma_f32_16x16x32_bf16 v[140:143], v[36:39], v[12:15], v[140:143]
    v_mfma_f32_16x16x32_bf16 v[144:147], v[40:43], v[8:11], v[144:147]
    v_mfma_f32_16x16x32_bf16 v[148:151], v[40:43], v[12:15], v[148:151]
    v_mfma_f32_16x16x32_bf16 v[152:155], v[44:47], v[8:11], v[152:155]
    v_mfma_f32_16x16x32_bf16 v[156:159], v[44:47], v[12:15], v[156:159]
    v_mfma_f32_16x16x32_bf16 v[160:163], v[48:51], v[8:11], v[160:163]
    v_mfma_f32_16x16x32_bf16 v[164:167], v[48:51], v[12:15], v[164:167]
    s_waitcnt vmcnt(4) lgkmcnt(0)
    s_barrier
    ds_read_b128 v[8:11], v198 offset:0
    v_mfma_f32_16x16x32_bf16 v[96:99], v[60:63], v[52:55], v[96:99]
    ds_read_b128 v[12:15], v198 offset:2048
    v_mfma_f32_16x16x32_bf16 v[100:103], v[60:63], v[56:59], v[100:103]
    ds_read_b128 v[16:19], v200 offset:0
    v_mfma_f32_16x16x32_bf16 v[104:107], v[64:67], v[52:55], v[104:107]
    ds_read_b128 v[20:23], v200 offset:2048
    v_mfma_f32_16x16x32_bf16 v[108:111], v[64:67], v[56:59], v[108:111]
    ds_read_b128 v[24:27], v200 offset:4096
    v_mfma_f32_16x16x32_bf16 v[112:115], v[68:71], v[52:55], v[112:115]
    ds_read_b128 v[28:31], v200 offset:6144
    v_mfma_f32_16x16x32_bf16 v[116:119], v[68:71], v[56:59], v[116:119]
    ds_read_b128 v[32:35], v200 offset:8192
    v_mfma_f32_16x16x32_bf16 v[120:123], v[72:75], v[52:55], v[120:123]
    ds_read_b128 v[36:39], v200 offset:10240
    v_mfma_f32_16x16x32_bf16 v[124:127], v[72:75], v[56:59], v[124:127]
    ds_read_b128 v[40:43], v200 offset:12288
    v_mfma_f32_16x16x32_bf16 v[128:131], v[76:79], v[52:55], v[128:131]
    ds_read_b128 v[44:47], v200 offset:14336
    v_mfma_f32_16x16x32_bf16 v[132:135], v[76:79], v[56:59], v[132:135]
    ds_read_b128 v[48:51], v200 offset:16384
    v_mfma_f32_16x16x32_bf16 v[136:139], v[80:83], v[52:55], v[136:139]
    v_mfma_f32_16x16x32_bf16 v[140:143], v[80:83], v[56:59], v[140:143]
    v_mfma_f32_16x16x32_bf16 v[144:147], v[84:87], v[52:55], v[144:147]
    v_mfma_f32_16x16x32_bf16 v[148:151], v[84:87], v[56:59], v[148:151]
    v_mfma_f32_16x16x32_bf16 v[152:155], v[88:91], v[52:55], v[152:155]
    v_mfma_f32_16x16x32_bf16 v[156:159], v[88:91], v[56:59], v[156:159]
    v_mfma_f32_16x16x32_bf16 v[160:163], v[92:95], v[52:55], v[160:163]
    v_mfma_f32_16x16x32_bf16 v[164:167], v[92:95], v[56:59], v[164:167]
    s_waitcnt lgkmcnt(0)
    v_mfma_f32_16x16x32_bf16 v[96:99], v[16:19], v[8:11], v[96:99]
    ds_read_b128 v[52:55], v199 offset:0
    v_mfma_f32_16x16x32_bf16 v[100:103], v[16:19], v[12:15], v[100:103]
    ds_read_b128 v[56:59], v199 offset:2048
    v_mfma_f32_16x16x32_bf16 v[104:107], v[20:23], v[8:11], v[104:107]
    ds_read_b128 v[60:63], v201 offset:0
    v_mfma_f32_16x16x32_bf16 v[108:111], v[20:23], v[12:15], v[108:111]
    ds_read_b128 v[64:67], v201 offset:2048
    v_mfma_f32_16x16x32_bf16 v[112:115], v[24:27], v[8:11], v[112:115]
    ds_read_b128 v[68:71], v201 offset:4096
    v_mfma_f32_16x16x32_bf16 v[116:119], v[24:27], v[12:15], v[116:119]
    ds_read_b128 v[72:75], v201 offset:6144
    v_mfma_f32_16x16x32_bf16 v[120:123], v[28:31], v[8:11], v[120:123]
    ds_read_b128 v[76:79], v201 offset:8192
    v_mfma_f32_16x16x32_bf16 v[124:127], v[28:31], v[12:15], v[124:127]
    ds_read_b128 v[80:83], v201 offset:10240
    v_mfma_f32_16x16x32_bf16 v[128:131], v[32:35], v[8:11], v[128:131]
    ds_read_b128 v[84:87], v201 offset:12288
    v_mfma_f32_16x16x32_bf16 v[132:135], v[32:35], v[12:15], v[132:135]
    ds_read_b128 v[88:91], v201 offset:14336
    v_mfma_f32_16x16x32_bf16 v[136:139], v[36:39], v[8:11], v[136:139]
    ds_read_b128 v[92:95], v201 offset:16384
    v_mfma_f32_16x16x32_bf16 v[140:143], v[36:39], v[12:15], v[140:143]
    v_mfma_f32_16x16x32_bf16 v[144:147], v[40:43], v[8:11], v[144:147]
    v_mfma_f32_16x16x32_bf16 v[148:151], v[40:43], v[12:15], v[148:151]
    v_mfma_f32_16x16x32_bf16 v[152:155], v[44:47], v[8:11], v[152:155]
    v_mfma_f32_16x16x32_bf16 v[156:159], v[44:47], v[12:15], v[156:159]
    v_mfma_f32_16x16x32_bf16 v[160:163], v[48:51], v[8:11], v[160:163]
    v_mfma_f32_16x16x32_bf16 v[164:167], v[48:51], v[12:15], v[164:167]
    s_waitcnt vmcnt(0) lgkmcnt(0)
    s_barrier
    ds_read_b128 v[8:11], v202 offset:0
    v_mfma_f32_16x16x32_bf16 v[96:99], v[60:63], v[52:55], v[96:99]
    ds_read_b128 v[12:15], v202 offset:2048
    v_mfma_f32_16x16x32_bf16 v[100:103], v[60:63], v[56:59], v[100:103]
    ds_read_b128 v[16:19], v204 offset:0
    v_mfma_f32_16x16x32_bf16 v[104:107], v[64:67], v[52:55], v[104:107]
    ds_read_b128 v[20:23], v204 offset:2048
    v_mfma_f32_16x16x32_bf16 v[108:111], v[64:67], v[56:59], v[108:111]
    ds_read_b128 v[24:27], v204 offset:4096
    v_mfma_f32_16x16x32_bf16 v[112:115], v[68:71], v[52:55], v[112:115]
    ds_read_b128 v[28:31], v204 offset:6144
    v_mfma_f32_16x16x32_bf16 v[116:119], v[68:71], v[56:59], v[116:119]
    ds_read_b128 v[32:35], v204 offset:8192
    v_mfma_f32_16x16x32_bf16 v[120:123], v[72:75], v[52:55], v[120:123]
    ds_read_b128 v[36:39], v204 offset:10240
    v_mfma_f32_16x16x32_bf16 v[124:127], v[72:75], v[56:59], v[124:127]
    ds_read_b128 v[40:43], v204 offset:12288
    v_mfma_f32_16x16x32_bf16 v[128:131], v[76:79], v[52:55], v[128:131]
    ds_read_b128 v[44:47], v204 offset:14336
    v_mfma_f32_16x16x32_bf16 v[132:135], v[76:79], v[56:59], v[132:135]
    ds_read_b128 v[48:51], v204 offset:16384
    v_mfma_f32_16x16x32_bf16 v[136:139], v[80:83], v[52:55], v[136:139]
    v_mfma_f32_16x16x32_bf16 v[140:143], v[80:83], v[56:59], v[140:143]
    v_mfma_f32_16x16x32_bf16 v[144:147], v[84:87], v[52:55], v[144:147]
    v_mfma_f32_16x16x32_bf16 v[148:151], v[84:87], v[56:59], v[148:151]
    v_mfma_f32_16x16x32_bf16 v[152:155], v[88:91], v[52:55], v[152:155]
    v_mfma_f32_16x16x32_bf16 v[156:159], v[88:91], v[56:59], v[156:159]
    v_mfma_f32_16x16x32_bf16 v[160:163], v[92:95], v[52:55], v[160:163]
    v_mfma_f32_16x16x32_bf16 v[164:167], v[92:95], v[56:59], v[164:167]
    s_waitcnt lgkmcnt(0)
    v_mfma_f32_16x16x32_bf16 v[96:99], v[16:19], v[8:11], v[96:99]
    ds_read_b128 v[52:55], v203 offset:0
    v_mfma_f32_16x16x32_bf16 v[100:103], v[16:19], v[12:15], v[100:103]
    ds_read_b128 v[56:59], v203 offset:2048
    v_mfma_f32_16x16x32_bf16 v[104:107], v[20:23], v[8:11], v[104:107]
    ds_read_b128 v[60:63], v205 offset:0
    v_mfma_f32_16x16x32_bf16 v[108:111], v[20:23], v[12:15], v[108:111]
    ds_read_b128 v[64:67], v205 offset:2048
    v_mfma_f32_16x16x32_bf16 v[112:115], v[24:27], v[8:11], v[112:115]
    ds_read_b128 v[68:71], v205 offset:4096
    v_mfma_f32_16x16x32_bf16 v[116:119], v[24:27], v[12:15], v[116:119]
    ds_read_b128 v[72:75], v205 offset:6144
    v_mfma_f32_16x16x32_bf16 v[120:123], v[28:31], v[8:11], v[120:123]
    ds_read_b128 v[76:79], v205 offset:8192
    v_mfma_f32_16x16x32_bf16 v[124:127], v[28:31], v[12:15], v[124:127]
    ds_read_b128 v[80:83], v205 offset:10240
    v_mfma_f32_16x16x32_bf16 v[128:131], v[32:35], v[8:11], v[128:131]
    ds_read_b128 v[84:87], v205 offset:12288
    v_mfma_f32_16x16x32_bf16 v[132:135], v[32:35], v[12:15], v[132:135]
    ds_read_b128 v[88:91], v205 offset:14336
    v_mfma_f32_16x16x32_bf16 v[136:139], v[36:39], v[8:11], v[136:139]
    ds_read_b128 v[92:95], v205 offset:16384
    v_mfma_f32_16x16x32_bf16 v[140:143], v[36:39], v[12:15], v[140:143]
    v_mfma_f32_16x16x32_bf16 v[144:147], v[40:43], v[8:11], v[144:147]
    v_mfma_f32_16x16x32_bf16 v[148:151], v[40:43], v[12:15], v[148:151]
    v_mfma_f32_16x16x32_bf16 v[152:155], v[44:47], v[8:11], v[152:155]
    v_mfma_f32_16x16x32_bf16 v[156:159], v[44:47], v[12:15], v[156:159]
    v_mfma_f32_16x16x32_bf16 v[160:163], v[48:51], v[8:11], v[160:163]
    v_mfma_f32_16x16x32_bf16 v[164:167], v[48:51], v[12:15], v[164:167]
    s_waitcnt vmcnt(0) lgkmcnt(0)
    s_barrier
    v_mfma_f32_16x16x32_bf16 v[96:99], v[60:63], v[52:55], v[96:99]
    v_mfma_f32_16x16x32_bf16 v[100:103], v[60:63], v[56:59], v[100:103]
    v_mfma_f32_16x16x32_bf16 v[104:107], v[64:67], v[52:55], v[104:107]
    v_mfma_f32_16x16x32_bf16 v[108:111], v[64:67], v[56:59], v[108:111]
    v_mfma_f32_16x16x32_bf16 v[112:115], v[68:71], v[52:55], v[112:115]
    v_mfma_f32_16x16x32_bf16 v[116:119], v[68:71], v[56:59], v[116:119]
    v_mfma_f32_16x16x32_bf16 v[120:123], v[72:75], v[52:55], v[120:123]
    v_mfma_f32_16x16x32_bf16 v[124:127], v[72:75], v[56:59], v[124:127]
    v_mfma_f32_16x16x32_bf16 v[128:131], v[76:79], v[52:55], v[128:131]
    v_mfma_f32_16x16x32_bf16 v[132:135], v[76:79], v[56:59], v[132:135]
    v_mfma_f32_16x16x32_bf16 v[136:139], v[80:83], v[52:55], v[136:139]
    v_mfma_f32_16x16x32_bf16 v[140:143], v[80:83], v[56:59], v[140:143]
    v_mfma_f32_16x16x32_bf16 v[144:147], v[84:87], v[52:55], v[144:147]
    v_mfma_f32_16x16x32_bf16 v[148:151], v[84:87], v[56:59], v[148:151]
    v_mfma_f32_16x16x32_bf16 v[152:155], v[88:91], v[52:55], v[152:155]
    v_mfma_f32_16x16x32_bf16 v[156:159], v[88:91], v[56:59], v[156:159]
    v_mfma_f32_16x16x32_bf16 v[160:163], v[92:95], v[52:55], v[160:163]
    v_mfma_f32_16x16x32_bf16 v[164:167], v[92:95], v[56:59], v[164:167]
    s_waitcnt vmcnt(0) lgkmcnt(0)
    s_barrier
b1_kernel_z1epi:
    s_mov_b32 s98, 0xbdd2d3e8
    v_mov_b32 v7, 0xc0135761
    v_and_b32 v2, 15, v1
    v_mul_u32_u24 v2, 304, v2
    v_lshrrev_b32 v3, 4, v1
    v_lshlrev_b32 v3, 3, v3
    v_add_u32 v2, v2, v3
    s_mul_i32 s72, s60, 9728
    v_add_u32 v2, s72, v2
    v_mul_f32 v8, v96, v96
    v_mul_f32 v9, v97, v97
    v_mul_f32 v10, v98, v98
    v_mul_f32 v11, v99, v99
    v_fma_f32 v8, v8, s98, v7
    v_fma_f32 v9, v9, s98, v7
    v_fma_f32 v10, v10, s98, v7
    v_fma_f32 v11, v11, s98, v7
    v_mul_f32 v8, v8, v96
    v_mul_f32 v9, v9, v97
    v_mul_f32 v10, v10, v98
    v_mul_f32 v11, v11, v99
    v_exp_f32 v8, v8
    v_exp_f32 v9, v9
    v_exp_f32 v10, v10
    v_exp_f32 v11, v11
    v_add_f32 v8, 1.0, v8
    v_add_f32 v9, 1.0, v9
    v_add_f32 v10, 1.0, v10
    v_add_f32 v11, 1.0, v11
    v_rcp_f32 v8, v8
    v_rcp_f32 v9, v9
    v_rcp_f32 v10, v10
    v_rcp_f32 v11, v11
    v_mul_f32 v96, v96, v8
    v_mul_f32 v97, v97, v9
    v_mul_f32 v98, v98, v10
    v_mul_f32 v99, v99, v11
    v_cvt_pk_bf16_f32 v96, v96, v97
    v_cvt_pk_bf16_f32 v97, v98, v99
    ds_write_b64 v2, v[96:97] offset:0
    v_mul_f32 v8, v100, v100
    v_mul_f32 v9, v101, v101
    v_mul_f32 v10, v102, v102
    v_mul_f32 v11, v103, v103
    v_fma_f32 v8, v8, s98, v7
    v_fma_f32 v9, v9, s98, v7
    v_fma_f32 v10, v10, s98, v7
    v_fma_f32 v11, v11, s98, v7
    v_mul_f32 v8, v8, v100
    v_mul_f32 v9, v9, v101
    v_mul_f32 v10, v10, v102
    v_mul_f32 v11, v11, v103
    v_exp_f32 v8, v8
    v_exp_f32 v9, v9
    v_exp_f32 v10, v10
    v_exp_f32 v11, v11
    v_add_f32 v8, 1.0, v8
    v_add_f32 v9, 1.0, v9
    v_add_f32 v10, 1.0, v10
    v_add_f32 v11, 1.0, v11
    v_rcp_f32 v8, v8
    v_rcp_f32 v9, v9
    v_rcp_f32 v10, v10
    v_rcp_f32 v11, v11
    v_mul_f32 v100, v100, v8
    v_mul_f32 v101, v101, v9
    v_mul_f32 v102, v102, v10
    v_mul_f32 v103, v103, v11
    v_cvt_pk_bf16_f32 v100, v100, v101
    v_cvt_pk_bf16_f32 v101, v102, v103
    ds_write_b64 v2, v[100:101] offset:4864
    v_mul_f32 v8, v104, v104
    v_mul_f32 v9, v105, v105
    v_mul_f32 v10, v106, v106
    v_mul_f32 v11, v107, v107
    v_fma_f32 v8, v8, s98, v7
    v_fma_f32 v9, v9, s98, v7
    v_fma_f32 v10, v10, s98, v7
    v_fma_f32 v11, v11, s98, v7
    v_mul_f32 v8, v8, v104
    v_mul_f32 v9, v9, v105
    v_mul_f32 v10, v10, v106
    v_mul_f32 v11, v11, v107
    v_exp_f32 v8, v8
    v_exp_f32 v9, v9
    v_exp_f32 v10, v10
    v_exp_f32 v11, v11
    v_add_f32 v8, 1.0, v8
    v_add_f32 v9, 1.0, v9
    v_add_f32 v10, 1.0, v10
    v_add_f32 v11, 1.0, v11
    v_rcp_f32 v8, v8
    v_rcp_f32 v9, v9
    v_rcp_f32 v10, v10
    v_rcp_f32 v11, v11
    v_mul_f32 v104, v104, v8
    v_mul_f32 v105, v105, v9
    v_mul_f32 v106, v106, v10
    v_mul_f32 v107, v107, v11
    v_cvt_pk_bf16_f32 v104, v104, v105
    v_cvt_pk_bf16_f32 v105, v106, v107
    ds_write_b64 v2, v[104:105] offset:32
    v_mul_f32 v8, v108, v108
    v_mul_f32 v9, v109, v109
    v_mul_f32 v10, v110, v110
    v_mul_f32 v11, v111, v111
    v_fma_f32 v8, v8, s98, v7
    v_fma_f32 v9, v9, s98, v7
    v_fma_f32 v10, v10, s98, v7
    v_fma_f32 v11, v11, s98, v7
    v_mul_f32 v8, v8, v108
    v_mul_f32 v9, v9, v109
    v_mul_f32 v10, v10, v110
    v_mul_f32 v11, v11, v111
    v_exp_f32 v8, v8
    v_exp_f32 v9, v9
    v_exp_f32 v10, v10
    v_exp_f32 v11, v11
    v_add_f32 v8, 1.0, v8
    v_add_f32 v9, 1.0, v9
    v_add_f32 v10, 1.0, v10
    v_add_f32 v11, 1.0, v11
    v_rcp_f32 v8, v8
    v_rcp_f32 v9, v9
    v_rcp_f32 v10, v10
    v_rcp_f32 v11, v11
    v_mul_f32 v108, v108, v8
    v_mul_f32 v109, v109, v9
    v_mul_f32 v110, v110, v10
    v_mul_f32 v111, v111, v11
    v_cvt_pk_bf16_f32 v108, v108, v109
    v_cvt_pk_bf16_f32 v109, v110, v111
    ds_write_b64 v2, v[108:109] offset:4896
    v_mul_f32 v8, v112, v112
    v_mul_f32 v9, v113, v113
    v_mul_f32 v10, v114, v114
    v_mul_f32 v11, v115, v115
    v_fma_f32 v8, v8, s98, v7
    v_fma_f32 v9, v9, s98, v7
    v_fma_f32 v10, v10, s98, v7
    v_fma_f32 v11, v11, s98, v7
    v_mul_f32 v8, v8, v112
    v_mul_f32 v9, v9, v113
    v_mul_f32 v10, v10, v114
    v_mul_f32 v11, v11, v115
    v_exp_f32 v8, v8
    v_exp_f32 v9, v9
    v_exp_f32 v10, v10
    v_exp_f32 v11, v11
    v_add_f32 v8, 1.0, v8
    v_add_f32 v9, 1.0, v9
    v_add_f32 v10, 1.0, v10
    v_add_f32 v11, 1.0, v11
    v_rcp_f32 v8, v8
    v_rcp_f32 v9, v9
    v_rcp_f32 v10, v10
    v_rcp_f32 v11, v11
    v_mul_f32 v112, v112, v8
    v_mul_f32 v113, v113, v9
    v_mul_f32 v114, v114, v10
    v_mul_f32 v115, v115, v11
    v_cvt_pk_bf16_f32 v112, v112, v113
    v_cvt_pk_bf16_f32 v113, v114, v115
    ds_write_b64 v2, v[112:113] offset:64
    v_mul_f32 v8, v116, v116
    v_mul_f32 v9, v117, v117
    v_mul_f32 v10, v118, v118
    v_mul_f32 v11, v119, v119
    v_fma_f32 v8, v8, s98, v7
    v_fma_f32 v9, v9, s98, v7
    v_fma_f32 v10, v10, s98, v7
    v_fma_f32 v11, v11, s98, v7
    v_mul_f32 v8, v8, v116
    v_mul_f32 v9, v9, v117
    v_mul_f32 v10, v10, v118
    v_mul_f32 v11, v11, v119
    v_exp_f32 v8, v8
    v_exp_f32 v9, v9
    v_exp_f32 v10, v10
    v_exp_f32 v11, v11
    v_add_f32 v8, 1.0, v8
    v_add_f32 v9, 1.0, v9
    v_add_f32 v10, 1.0, v10
    v_add_f32 v11, 1.0, v11
    v_rcp_f32 v8, v8
    v_rcp_f32 v9, v9
    v_rcp_f32 v10, v10
    v_rcp_f32 v11, v11
    v_mul_f32 v116, v116, v8
    v_mul_f32 v117, v117, v9
    v_mul_f32 v118, v118, v10
    v_mul_f32 v119, v119, v11
    v_cvt_pk_bf16_f32 v116, v116, v117
    v_cvt_pk_bf16_f32 v117, v118, v119
    ds_write_b64 v2, v[116:117] offset:4928
    v_mul_f32 v8, v120, v120
    v_mul_f32 v9, v121, v121
    v_mul_f32 v10, v122, v122
    v_mul_f32 v11, v123, v123
    v_fma_f32 v8, v8, s98, v7
    v_fma_f32 v9, v9, s98, v7
    v_fma_f32 v10, v10, s98, v7
    v_fma_f32 v11, v11, s98, v7
    v_mul_f32 v8, v8, v120
    v_mul_f32 v9, v9, v121
    v_mul_f32 v10, v10, v122
    v_mul_f32 v11, v11, v123
    v_exp_f32 v8, v8
    v_exp_f32 v9, v9
    v_exp_f32 v10, v10
    v_exp_f32 v11, v11
    v_add_f32 v8, 1.0, v8
    v_add_f32 v9, 1.0, v9
    v_add_f32 v10, 1.0, v10
    v_add_f32 v11, 1.0, v11
    v_rcp_f32 v8, v8
    v_rcp_f32 v9, v9
    v_rcp_f32 v10, v10
    v_rcp_f32 v11, v11
    v_mul_f32 v120, v120, v8
    v_mul_f32 v121, v121, v9
    v_mul_f32 v122, v122, v10
    v_mul_f32 v123, v123, v11
    v_cvt_pk_bf16_f32 v120, v120, v121
    v_cvt_pk_bf16_f32 v121, v122, v123
    ds_write_b64 v2, v[120:121] offset:96
    v_mul_f32 v8, v124, v124
    v_mul_f32 v9, v125, v125
    v_mul_f32 v10, v126, v126
    v_mul_f32 v11, v127, v127
    v_fma_f32 v8, v8, s98, v7
    v_fma_f32 v9, v9, s98, v7
    v_fma_f32 v10, v10, s98, v7
    v_fma_f32 v11, v11, s98, v7
    v_mul_f32 v8, v8, v124
    v_mul_f32 v9, v9, v125
    v_mul_f32 v10, v10, v126
    v_mul_f32 v11, v11, v127
    v_exp_f32 v8, v8
    v_exp_f32 v9, v9
    v_exp_f32 v10, v10
    v_exp_f32 v11, v11
    v_add_f32 v8, 1.0, v8
    v_add_f32 v9, 1.0, v9
    v_add_f32 v10, 1.0, v10
    v_add_f32 v11, 1.0, v11
    v_rcp_f32 v8, v8
    v_rcp_f32 v9, v9
    v_rcp_f32 v10, v10
    v_rcp_f32 v11, v11
    v_mul_f32 v124, v124, v8
    v_mul_f32 v125, v125, v9
    v_mul_f32 v126, v126, v10
    v_mul_f32 v127, v127, v11
    v_cvt_pk_bf16_f32 v124, v124, v125
    v_cvt_pk_bf16_f32 v125, v126, v127
    ds_write_b64 v2, v[124:125] offset:4960
    v_mul_f32 v8, v128, v128
    v_mul_f32 v9, v129, v129
    v_mul_f32 v10, v130, v130
    v_mul_f32 v11, v131, v131
    v_fma_f32 v8, v8, s98, v7
    v_fma_f32 v9, v9, s98, v7
    v_fma_f32 v10, v10, s98, v7
    v_fma_f32 v11, v11, s98, v7
    v_mul_f32 v8, v8, v128
    v_mul_f32 v9, v9, v129
    v_mul_f32 v10, v10, v130
    v_mul_f32 v11, v11, v131
    v_exp_f32 v8, v8
    v_exp_f32 v9, v9
    v_exp_f32 v10, v10
    v_exp_f32 v11, v11
    v_add_f32 v8, 1.0, v8
    v_add_f32 v9, 1.0, v9
    v_add_f32 v10, 1.0, v10
    v_add_f32 v11, 1.0, v11
    v_rcp_f32 v8, v8
    v_rcp_f32 v9, v9
    v_rcp_f32 v10, v10
    v_rcp_f32 v11, v11
    v_mul_f32 v128, v128, v8
    v_mul_f32 v129, v129, v9
    v_mul_f32 v130, v130, v10
    v_mul_f32 v131, v131, v11
    v_cvt_pk_bf16_f32 v128, v128, v129
    v_cvt_pk_bf16_f32 v129, v130, v131
    ds_write_b64 v2, v[128:129] offset:128
    v_mul_f32 v8, v132, v132
    v_mul_f32 v9, v133, v133
    v_mul_f32 v10, v134, v134
    v_mul_f32 v11, v135, v135
    v_fma_f32 v8, v8, s98, v7
    v_fma_f32 v9, v9, s98, v7
    v_fma_f32 v10, v10, s98, v7
    v_fma_f32 v11, v11, s98, v7
    v_mul_f32 v8, v8, v132
    v_mul_f32 v9, v9, v133
    v_mul_f32 v10, v10, v134
    v_mul_f32 v11, v11, v135
    v_exp_f32 v8, v8
    v_exp_f32 v9, v9
    v_exp_f32 v10, v10
    v_exp_f32 v11, v11
    v_add_f32 v8, 1.0, v8
    v_add_f32 v9, 1.0, v9
    v_add_f32 v10, 1.0, v10
    v_add_f32 v11, 1.0, v11
    v_rcp_f32 v8, v8
    v_rcp_f32 v9, v9
    v_rcp_f32 v10, v10
    v_rcp_f32 v11, v11
    v_mul_f32 v132, v132, v8
    v_mul_f32 v133, v133, v9
    v_mul_f32 v134, v134, v10
    v_mul_f32 v135, v135, v11
    v_cvt_pk_bf16_f32 v132, v132, v133
    v_cvt_pk_bf16_f32 v133, v134, v135
    ds_write_b64 v2, v[132:133] offset:4992
    v_mul_f32 v8, v136, v136
    v_mul_f32 v9, v137, v137
    v_mul_f32 v10, v138, v138
    v_mul_f32 v11, v139, v139
    v_fma_f32 v8, v8, s98, v7
    v_fma_f32 v9, v9, s98, v7
    v_fma_f32 v10, v10, s98, v7
    v_fma_f32 v11, v11, s98, v7
    v_mul_f32 v8, v8, v136
    v_mul_f32 v9, v9, v137
    v_mul_f32 v10, v10, v138
    v_mul_f32 v11, v11, v139
    v_exp_f32 v8, v8
    v_exp_f32 v9, v9
    v_exp_f32 v10, v10
    v_exp_f32 v11, v11
    v_add_f32 v8, 1.0, v8
    v_add_f32 v9, 1.0, v9
    v_add_f32 v10, 1.0, v10
    v_add_f32 v11, 1.0, v11
    v_rcp_f32 v8, v8
    v_rcp_f32 v9, v9
    v_rcp_f32 v10, v10
    v_rcp_f32 v11, v11
    v_mul_f32 v136, v136, v8
    v_mul_f32 v137, v137, v9
    v_mul_f32 v138, v138, v10
    v_mul_f32 v139, v139, v11
    v_cvt_pk_bf16_f32 v136, v136, v137
    v_cvt_pk_bf16_f32 v137, v138, v139
    ds_write_b64 v2, v[136:137] offset:160
    v_mul_f32 v8, v140, v140
    v_mul_f32 v9, v141, v141
    v_mul_f32 v10, v142, v142
    v_mul_f32 v11, v143, v143
    v_fma_f32 v8, v8, s98, v7
    v_fma_f32 v9, v9, s98, v7
    v_fma_f32 v10, v10, s98, v7
    v_fma_f32 v11, v11, s98, v7
    v_mul_f32 v8, v8, v140
    v_mul_f32 v9, v9, v141
    v_mul_f32 v10, v10, v142
    v_mul_f32 v11, v11, v143
    v_exp_f32 v8, v8
    v_exp_f32 v9, v9
    v_exp_f32 v10, v10
    v_exp_f32 v11, v11
    v_add_f32 v8, 1.0, v8
    v_add_f32 v9, 1.0, v9
    v_add_f32 v10, 1.0, v10
    v_add_f32 v11, 1.0, v11
    v_rcp_f32 v8, v8
    v_rcp_f32 v9, v9
    v_rcp_f32 v10, v10
    v_rcp_f32 v11, v11
    v_mul_f32 v140, v140, v8
    v_mul_f32 v141, v141, v9
    v_mul_f32 v142, v142, v10
    v_mul_f32 v143, v143, v11
    v_cvt_pk_bf16_f32 v140, v140, v141
    v_cvt_pk_bf16_f32 v141, v142, v143
    ds_write_b64 v2, v[140:141] offset:5024
    v_mul_f32 v8, v144, v144
    v_mul_f32 v9, v145, v145
    v_mul_f32 v10, v146, v146
    v_mul_f32 v11, v147, v147
    v_fma_f32 v8, v8, s98, v7
    v_fma_f32 v9, v9, s98, v7
    v_fma_f32 v10, v10, s98, v7
    v_fma_f32 v11, v11, s98, v7
    v_mul_f32 v8, v8, v144
    v_mul_f32 v9, v9, v145
    v_mul_f32 v10, v10, v146
    v_mul_f32 v11, v11, v147
    v_exp_f32 v8, v8
    v_exp_f32 v9, v9
    v_exp_f32 v10, v10
    v_exp_f32 v11, v11
    v_add_f32 v8, 1.0, v8
    v_add_f32 v9, 1.0, v9
    v_add_f32 v10, 1.0, v10
    v_add_f32 v11, 1.0, v11
    v_rcp_f32 v8, v8
    v_rcp_f32 v9, v9
    v_rcp_f32 v10, v10
    v_rcp_f32 v11, v11
    v_mul_f32 v144, v144, v8
    v_mul_f32 v145, v145, v9
    v_mul_f32 v146, v146, v10
    v_mul_f32 v147, v147, v11
    v_cvt_pk_bf16_f32 v144, v144, v145
    v_cvt_pk_bf16_f32 v145, v146, v147
    ds_write_b64 v2, v[144:145] offset:192
    v_mul_f32 v8, v148, v148
    v_mul_f32 v9, v149, v149
    v_mul_f32 v10, v150, v150
    v_mul_f32 v11, v151, v151
    v_fma_f32 v8, v8, s98, v7
    v_fma_f32 v9, v9, s98, v7
    v_fma_f32 v10, v10, s98, v7
    v_fma_f32 v11, v11, s98, v7
    v_mul_f32 v8, v8, v148
    v_mul_f32 v9, v9, v149
    v_mul_f32 v10, v10, v150
    v_mul_f32 v11, v11, v151
    v_exp_f32 v8, v8
    v_exp_f32 v9, v9
    v_exp_f32 v10, v10
    v_exp_f32 v11, v11
    v_add_f32 v8, 1.0, v8
    v_add_f32 v9, 1.0, v9
    v_add_f32 v10, 1.0, v10
    v_add_f32 v11, 1.0, v11
    v_rcp_f32 v8, v8
    v_rcp_f32 v9, v9
    v_rcp_f32 v10, v10
    v_rcp_f32 v11, v11
    v_mul_f32 v148, v148, v8
    v_mul_f32 v149, v149, v9
    v_mul_f32 v150, v150, v10
    v_mul_f32 v151, v151, v11
    v_cvt_pk_bf16_f32 v148, v148, v149
    v_cvt_pk_bf16_f32 v149, v150, v151
    ds_write_b64 v2, v[148:149] offset:5056
    v_mul_f32 v8, v152, v152
    v_mul_f32 v9, v153, v153
    v_mul_f32 v10, v154, v154
    v_mul_f32 v11, v155, v155
    v_fma_f32 v8, v8, s98, v7
    v_fma_f32 v9, v9, s98, v7
    v_fma_f32 v10, v10, s98, v7
    v_fma_f32 v11, v11, s98, v7
    v_mul_f32 v8, v8, v152
    v_mul_f32 v9, v9, v153
    v_mul_f32 v10, v10, v154
    v_mul_f32 v11, v11, v155
    v_exp_f32 v8, v8
    v_exp_f32 v9, v9
    v_exp_f32 v10, v10
    v_exp_f32 v11, v11
    v_add_f32 v8, 1.0, v8
    v_add_f32 v9, 1.0, v9
    v_add_f32 v10, 1.0, v10
    v_add_f32 v11, 1.0, v11
    v_rcp_f32 v8, v8
    v_rcp_f32 v9, v9
    v_rcp_f32 v10, v10
    v_rcp_f32 v11, v11
    v_mul_f32 v152, v152, v8
    v_mul_f32 v153, v153, v9
    v_mul_f32 v154, v154, v10
    v_mul_f32 v155, v155, v11
    v_cvt_pk_bf16_f32 v152, v152, v153
    v_cvt_pk_bf16_f32 v153, v154, v155
    ds_write_b64 v2, v[152:153] offset:224
    v_mul_f32 v8, v156, v156
    v_mul_f32 v9, v157, v157
    v_mul_f32 v10, v158, v158
    v_mul_f32 v11, v159, v159
    v_fma_f32 v8, v8, s98, v7
    v_fma_f32 v9, v9, s98, v7
    v_fma_f32 v10, v10, s98, v7
    v_fma_f32 v11, v11, s98, v7
    v_mul_f32 v8, v8, v156
    v_mul_f32 v9, v9, v157
    v_mul_f32 v10, v10, v158
    v_mul_f32 v11, v11, v159
    v_exp_f32 v8, v8
    v_exp_f32 v9, v9
    v_exp_f32 v10, v10
    v_exp_f32 v11, v11
    v_add_f32 v8, 1.0, v8
    v_add_f32 v9, 1.0, v9
    v_add_f32 v10, 1.0, v10
    v_add_f32 v11, 1.0, v11
    v_rcp_f32 v8, v8
    v_rcp_f32 v9, v9
    v_rcp_f32 v10, v10
    v_rcp_f32 v11, v11
    v_mul_f32 v156, v156, v8
    v_mul_f32 v157, v157, v9
    v_mul_f32 v158, v158, v10
    v_mul_f32 v159, v159, v11
    v_cvt_pk_bf16_f32 v156, v156, v157
    v_cvt_pk_bf16_f32 v157, v158, v159
    ds_write_b64 v2, v[156:157] offset:5088
    v_mul_f32 v8, v160, v160
    v_mul_f32 v9, v161, v161
    v_mul_f32 v10, v162, v162
    v_mul_f32 v11, v163, v163
    v_fma_f32 v8, v8, s98, v7
    v_fma_f32 v9, v9, s98, v7
    v_fma_f32 v10, v10, s98, v7
    v_fma_f32 v11, v11, s98, v7
    v_mul_f32 v8, v8, v160
    v_mul_f32 v9, v9, v161
    v_mul_f32 v10, v10, v162
    v_mul_f32 v11, v11, v163
    v_exp_f32 v8, v8
    v_exp_f32 v9, v9
    v_exp_f32 v10, v10
    v_exp_f32 v11, v11
    v_add_f32 v8, 1.0, v8
    v_add_f32 v9, 1.0, v9
    v_add_f32 v10, 1.0, v10
    v_add_f32 v11, 1.0, v11
    v_rcp_f32 v8, v8
    v_rcp_f32 v9, v9
    v_rcp_f32 v10, v10
    v_rcp_f32 v11, v11
    v_mul_f32 v160, v160, v8
    v_mul_f32 v161, v161, v9
    v_mul_f32 v162, v162, v10
    v_mul_f32 v163, v163, v11
    v_cvt_pk_bf16_f32 v160, v160, v161
    v_cvt_pk_bf16_f32 v161, v162, v163
    ds_write_b64 v2, v[160:161] offset:256
    v_mul_f32 v8, v164, v164
    v_mul_f32 v9, v165, v165
    v_mul_f32 v10, v166, v166
    v_mul_f32 v11, v167, v167
    v_fma_f32 v8, v8, s98, v7
    v_fma_f32 v9, v9, s98, v7
    v_fma_f32 v10, v10, s98, v7
    v_fma_f32 v11, v11, s98, v7
    v_mul_f32 v8, v8, v164
    v_mul_f32 v9, v9, v165
    v_mul_f32 v10, v10, v166
    v_mul_f32 v11, v11, v167
    v_exp_f32 v8, v8
    v_exp_f32 v9, v9
    v_exp_f32 v10, v10
    v_exp_f32 v11, v11
    v_add_f32 v8, 1.0, v8
    v_add_f32 v9, 1.0, v9
    v_add_f32 v10, 1.0, v10
    v_add_f32 v11, 1.0, v11
    v_rcp_f32 v8, v8
    v_rcp_f32 v9, v9
    v_rcp_f32 v10, v10
    v_rcp_f32 v11, v11
    v_mul_f32 v164, v164, v8
    v_mul_f32 v165, v165, v9
    v_mul_f32 v166, v166, v10
    v_mul_f32 v167, v167, v11
    v_cvt_pk_bf16_f32 v164, v164, v165
    v_cvt_pk_bf16_f32 v165, v166, v167
    ds_write_b64 v2, v[164:165] offset:5120
    s_waitcnt lgkmcnt(0)
    s_lshl_b32 s68, s61, 7
    s_lshl_b32 s69, s70, 5
    s_add_u32 s68, s68, s69
    s_mul_i32 s73, s68, 4608
    s_mul_i32 s69, s62, 576
    s_add_u32 s73, s73, s69
    s_mul_i32 s69, s71, 288
    s_add_u32 s73, s73, s69
    s_mov_b32 s100, 58255
    s_mov_b32 s101, 4608
    v_add_u32 v8, 0, v1
    v_mul_lo_u32 v9, v8, s100
    v_lshrrev_b32 v9, 20, v9
    v_mul_u32_u24 v10, 18, v9
    v_sub_u32 v10, v8, v10
    v_lshlrev_b32 v10, 4, v10
    v_mul_u32_u24 v11, 304, v9
    v_add_u32 v11, v11, v10
    v_add_u32 v12, s72, v11
    v_mul_lo_u32 v11, v9, s101
    v_add_u32 v11, v11, v10
    v_add_u32 v13, s73, v11
    ds_read_b128 v[40:43], v12
    v_add_u32 v8, 64, v1
    v_mul_lo_u32 v9, v8, s100
    v_lshrrev_b32 v9, 20, v9
    v_mul_u32_u24 v10, 18, v9
    v_sub_u32 v10, v8, v10
    v_lshlrev_b32 v10, 4, v10
    v_mul_u32_u24 v11, 304, v9
    v_add_u32 v11, v11, v10
    v_add_u32 v14, s72, v11
    v_mul_lo_u32 v11, v9, s101
    v_add_u32 v11, v11, v10
    v_add_u32 v15, s73, v11
    ds_read_b128 v[44:47], v14
    v_add_u32 v8, 128, v1
    v_mul_lo_u32 v9, v8, s100
    v_lshrrev_b32 v9, 20, v9
    v_mul_u32_u24 v10, 18, v9
    v_sub_u32 v10, v8, v10
    v_lshlrev_b32 v10, 4, v10
    v_mul_u32_u24 v11, 304, v9
    v_add_u32 v11, v11, v10
    v_add_u32 v16, s72, v11
    v_mul_lo_u32 v11, v9, s101
    v_add_u32 v11, v11, v10
    v_add_u32 v17, s73, v11
    ds_read_b128 v[48:51], v16
    v_add_u32 v8, 192, v1
    v_mul_lo_u32 v9, v8, s100
    v_lshrrev_b32 v9, 20, v9
    v_mul_u32_u24 v10, 18, v9
    v_sub_u32 v10, v8, v10
    v_lshlrev_b32 v10, 4, v10
    v_mul_u32_u24 v11, 304, v9
    v_add_u32 v11, v11, v10
    v_add_u32 v18, s72, v11
    v_mul_lo_u32 v11, v9, s101
    v_add_u32 v11, v11, v10
    v_add_u32 v19, s73, v11
    ds_read_b128 v[52:55], v18
    v_add_u32 v8, 256, v1
    v_mul_lo_u32 v9, v8, s100
    v_lshrrev_b32 v9, 20, v9
    v_mul_u32_u24 v10, 18, v9
    v_sub_u32 v10, v8, v10
    v_lshlrev_b32 v10, 4, v10
    v_mul_u32_u24 v11, 304, v9
    v_add_u32 v11, v11, v10
    v_add_u32 v20, s72, v11
    v_mul_lo_u32 v11, v9, s101
    v_add_u32 v11, v11, v10
    v_add_u32 v21, s73, v11
    ds_read_b128 v[56:59], v20
    v_add_u32 v8, 320, v1
    v_mul_lo_u32 v9, v8, s100
    v_lshrrev_b32 v9, 20, v9
    v_mul_u32_u24 v10, 18, v9
    v_sub_u32 v10, v8, v10
    v_lshlrev_b32 v10, 4, v10
    v_mul_u32_u24 v11, 304, v9
    v_add_u32 v11, v11, v10
    v_add_u32 v22, s72, v11
    v_mul_lo_u32 v11, v9, s101
    v_add_u32 v11, v11, v10
    v_add_u32 v23, s73, v11
    ds_read_b128 v[60:63], v22
    v_add_u32 v8, 384, v1
    v_mul_lo_u32 v9, v8, s100
    v_lshrrev_b32 v9, 20, v9
    v_mul_u32_u24 v10, 18, v9
    v_sub_u32 v10, v8, v10
    v_lshlrev_b32 v10, 4, v10
    v_mul_u32_u24 v11, 304, v9
    v_add_u32 v11, v11, v10
    v_add_u32 v24, s72, v11
    v_mul_lo_u32 v11, v9, s101
    v_add_u32 v11, v11, v10
    v_add_u32 v25, s73, v11
    ds_read_b128 v[64:67], v24
    v_add_u32 v8, 448, v1
    v_mul_lo_u32 v9, v8, s100
    v_lshrrev_b32 v9, 20, v9
    v_mul_u32_u24 v10, 18, v9
    v_sub_u32 v10, v8, v10
    v_lshlrev_b32 v10, 4, v10
    v_mul_u32_u24 v11, 304, v9
    v_add_u32 v11, v11, v10
    v_add_u32 v26, s72, v11
    v_mul_lo_u32 v11, v9, s101
    v_add_u32 v11, v11, v10
    v_add_u32 v27, s73, v11
    ds_read_b128 v[68:71], v26
    v_add_u32 v8, 512, v1
    v_mul_lo_u32 v9, v8, s100
    v_lshrrev_b32 v9, 20, v9
    v_mul_u32_u24 v10, 18, v9
    v_sub_u32 v10, v8, v10
    v_lshlrev_b32 v10, 4, v10
    v_mul_u32_u24 v11, 304, v9
    v_add_u32 v11, v11, v10
    v_add_u32 v28, s72, v11
    v_mul_lo_u32 v11, v9, s101
    v_add_u32 v11, v11, v10
    v_add_u32 v29, s73, v11
    ds_read_b128 v[72:75], v28
    s_waitcnt lgkmcnt(8)
    buffer_store_dwordx4 v[40:43], v13, s[48:51], 0 offen
    s_waitcnt lgkmcnt(7)
    buffer_store_dwordx4 v[44:47], v15, s[48:51], 0 offen
    s_waitcnt lgkmcnt(6)
    buffer_store_dwordx4 v[48:51], v17, s[48:51], 0 offen
    s_waitcnt lgkmcnt(5)
    buffer_store_dwordx4 v[52:55], v19, s[48:51], 0 offen
    s_waitcnt lgkmcnt(4)
    buffer_store_dwordx4 v[56:59], v21, s[48:51], 0 offen
    s_waitcnt lgkmcnt(3)
    buffer_store_dwordx4 v[60:63], v23, s[48:51], 0 offen
    s_waitcnt lgkmcnt(2)
    buffer_store_dwordx4 v[64:67], v25, s[48:51], 0 offen
    s_waitcnt lgkmcnt(1)
    buffer_store_dwordx4 v[68:71], v27, s[48:51], 0 offen
    s_waitcnt lgkmcnt(0)
    buffer_store_dwordx4 v[72:75], v29, s[48:51], 0 offen
    s_endpgm
b1_kernel_z2:
    s_cmp_ge_u32 s60, 4
    s_cbranch_scc1 b1_kernel_z2q4
    s_add_u32 m0, s65, 16384
    s_mov_b32 s72, 0
    buffer_load_dwordx4 v193, s[44:47], s72 offen lds
    s_add_u32 m0, s65, 24576
    s_mov_b32 s72, 73728
    buffer_load_dwordx4 v193, s[44:47], s72 offen lds
    s_add_u32 m0, s65, 32768
    s_mov_b32 s72, 147456
    buffer_load_dwordx4 v193, s[44:47], s72 offen lds
    s_add_u32 m0, s65, 40960
    s_mov_b32 s72, 221184
    buffer_load_dwordx4 v193, s[44:47], s72 offen lds
    s_add_u32 m0, s65, 49152
    s_mov_b32 s72, 294912
    buffer_load_dwordx4 v193, s[44:47], s72 offen lds
    s_add_u32 m0, s65, 69632
    s_mov_b32 s72, 128
    buffer_load_dwordx4 v193, s[44:47], s72 offen lds
    s_add_u32 m0, s65, 77824
    s_mov_b32 s72, 73856
    buffer_load_dwordx4 v193, s[44:47], s72 offen lds
    s_add_u32 m0, s65, 86016
    s_mov_b32 s72, 147584
    buffer_load_dwordx4 v193, s[44:47], s72 offen lds
    s_add_u32 m0, s65, 94208
    s_mov_b32 s72, 221312
    buffer_load_dwordx4 v193, s[44:47], s72 offen lds
    s_add_u32 m0, s65, 102400
    s_mov_b32 s72, 295040
    buffer_load_dwordx4 v193, s[44:47], s72 offen lds
    s_add_u32 m0, s65, 122880
    s_mov_b32 s72, 256
    buffer_load_dwordx4 v193, s[44:47], s72 offen lds
    s_add_u32 m0, s65, 131072
    s_mov_b32 s72, 73984
    buffer_load_dwordx4 v193, s[44:47], s72 offen lds
    s_add_u32 m0, s65, 139264
    s_mov_b32 s72, 147712
    buffer_load_dwordx4 v193, s[44:47], s72 offen lds
    s_add_u32 m0, s65, 147456
    s_mov_b32 s72, 221440
    buffer_load_dwordx4 v193, s[44:47], s72 offen lds
    s_add_u32 m0, s65, 155648
    s_mov_b32 s72, 295168
    buffer_load_dwordx4 v193, s[44:47], s72 offen lds
    s_mov_b32 s72, 384
    buffer_load_dwordx4 v[168:171], v192, s[40:43], s72 offen
    s_mov_b32 s72, 74112
    buffer_load_dwordx4 v[172:175], v192, s[40:43], s72 offen
    s_mov_b32 s72, 512
    buffer_load_dwordx4 v[176:179], v192, s[40:43], s72 offen
    s_mov_b32 s72, 74240
    buffer_load_dwordx4 v[180:183], v192, s[40:43], s72 offen
    s_mov_b32 s87, 0x3ae38e39
    s_waitcnt vmcnt(25)
    v_add_f32 v8, v8, v10
    v_add_f32 v9, v9, v11
    v_add_f32 v8, v8, v12
    v_add_f32 v9, v9, v13
    v_add_f32 v8, v8, v14
    v_add_f32 v9, v9, v15
    v_add_f32 v8, v8, v16
    v_add_f32 v9, v9, v17
    v_add_f32 v8, v8, v18
    v_add_f32 v9, v9, v19
    v_add_f32 v8, v8, v20
    v_add_f32 v9, v9, v21
    v_add_f32 v8, v8, v22
    v_add_f32 v9, v9, v23
    v_mul_f32 v8, s87, v8
    v_mul_f32 v9, s87, v9
    v_fma_f32 v9, -v8, v8, v9
    v_max_f32 v9, 0, v9
    v_add_f32 v9, 0x3727c5ac, v9
    v_rsq_f32 v184, v9
    s_nop 0
    v_mul_f32 v185, v8, v184
    v_sub_f32 v185, 0, v185
    v_add_f32 v24, v24, v26
    v_add_f32 v25, v25, v27
    v_add_f32 v24, v24, v28
    v_add_f32 v25, v25, v29
    v_add_f32 v24, v24, v30
    v_add_f32 v25, v25, v31
    v_add_f32 v24, v24, v32
    v_add_f32 v25, v25, v33
    v_add_f32 v24, v24, v34
    v_add_f32 v25, v25, v35
    v_add_f32 v24, v24, v36
    v_add_f32 v25, v25, v37
    v_add_f32 v24, v24, v38
    v_add_f32 v25, v25, v39
    v_mul_f32 v24, s87, v24
    v_mul_f32 v25, s87, v25
    v_fma_f32 v25, -v24, v24, v25
    v_max_f32 v25, 0, v25
    v_add_f32 v25, 0x3727c5ac, v25
    v_rsq_f32 v186, v25
    s_nop 0
    v_mul_f32 v187, v24, v186
    v_sub_f32 v187, 0, v187
    s_waitcnt vmcnt(19)
    v_lshlrev_b32 v195, 16, v48
    v_and_b32 v196, 0xffff0000, v48
    v_fma_f32 v195, v195, v184, v185
    v_fma_f32 v196, v196, v184, v185
    v_cvt_pk_bf16_f32 v48, v195, v196
    v_lshlrev_b32 v195, 16, v49
    v_and_b32 v196, 0xffff0000, v49
    v_fma_f32 v195, v195, v184, v185
    v_fma_f32 v196, v196, v184, v185
    v_cvt_pk_bf16_f32 v49, v195, v196
    v_lshlrev_b32 v195, 16, v50
    v_and_b32 v196, 0xffff0000, v50
    v_fma_f32 v195, v195, v184, v185
    v_fma_f32 v196, v196, v184, v185
    v_cvt_pk_bf16_f32 v50, v195, v196
    v_lshlrev_b32 v195, 16, v51
    v_and_b32 v196, 0xffff0000, v51
    v_fma_f32 v195, v195, v184, v185
    v_fma_f32 v196, v196, v184, v185
    v_cvt_pk_bf16_f32 v51, v195, v196
    ds_write_b128 v194, v[48:51] offset:0
    v_lshlrev_b32 v195, 16, v52
    v_and_b32 v196, 0xffff0000, v52
    v_fma_f32 v195, v195, v186, v187
    v_fma_f32 v196, v196, v186, v187
    v_cvt_pk_bf16_f32 v52, v195, v196
    v_lshlrev_b32 v195, 16, v53
    v_and_b32 v196, 0xffff0000, v53
    v_fma_f32 v195, v195, v186, v187
    v_fma_f32 v196, v196, v186, v187
    v_cvt_pk_bf16_f32 v53, v195, v196
    v_lshlrev_b32 v195, 16, v54
    v_and_b32 v196, 0xffff0000, v54
    v_fma_f32 v195, v195, v186, v187
    v_fma_f32 v196, v196, v186, v187
    v_cvt_pk_bf16_f32 v54, v195, v196
    v_lshlrev_b32 v195, 16, v55
    v_and_b32 v196, 0xffff0000, v55
    v_fma_f32 v195, v195, v186, v187
    v_fma_f32 v196, v196, v186, v187
    v_cvt_pk_bf16_f32 v55, v195, v196
    ds_write_b128 v194, v[52:55] offset:8192
    v_lshlrev_b32 v195, 16, v56
    v_and_b32 v196, 0xffff0000, v56
    v_fma_f32 v195, v195, v184, v185
    v_fma_f32 v196, v196, v184, v185
    v_cvt_pk_bf16_f32 v56, v195, v196
    v_lshlrev_b32 v195, 16, v57
    v_and_b32 v196, 0xffff0000, v57
    v_fma_f32 v195, v195, v184, v185
    v_fma_f32 v196, v196, v184, v185
    v_cvt_pk_bf16_f32 v57, v195, v196
    v_lshlrev_b32 v195, 16, v58
    v_and_b32 v196, 0xffff0000, v58
    v_fma_f32 v195, v195, v184, v185
    v_fma_f32 v196, v196, v184, v185
    v_cvt_pk_bf16_f32 v58, v195, v196
    v_lshlrev_b32 v195, 16, v59
    v_and_b32 v196, 0xffff0000, v59
    v_fma_f32 v195, v195, v184, v185
    v_fma_f32 v196, v196, v184, v185
    v_cvt_pk_bf16_f32 v59, v195, v196
    ds_write_b128 v194, v[56:59] offset:53248
    v_lshlrev_b32 v195, 16, v60
    v_and_b32 v196, 0xffff0000, v60
    v_fma_f32 v195, v195, v186, v187
    v_fma_f32 v196, v196, v186, v187
    v_cvt_pk_bf16_f32 v60, v195, v196
    v_lshlrev_b32 v195, 16, v61
    v_and_b32 v196, 0xffff0000, v61
    v_fma_f32 v195, v195, v186, v187
    v_fma_f32 v196, v196, v186, v187
    v_cvt_pk_bf16_f32 v61, v195, v196
    v_lshlrev_b32 v195, 16, v62
    v_and_b32 v196, 0xffff0000, v62
    v_fma_f32 v195, v195, v186, v187
    v_fma_f32 v196, v196, v186, v187
    v_cvt_pk_bf16_f32 v62, v195, v196
    v_lshlrev_b32 v195, 16, v63
    v_and_b32 v196, 0xffff0000, v63
    v_fma_f32 v195, v195, v186, v187
    v_fma_f32 v196, v196, v186, v187
    v_cvt_pk_bf16_f32 v63, v195, v196
    ds_write_b128 v194, v[60:63] offset:61440
    v_lshlrev_b32 v195, 16, v64
    v_and_b32 v196, 0xffff0000, v64
    v_fma_f32 v195, v195, v184, v185
    v_fma_f32 v196, v196, v184, v185
    v_cvt_pk_bf16_f32 v64, v195, v196
    v_lshlrev_b32 v195, 16, v65
    v_and_b32 v196, 0xffff0000, v65
    v_fma_f32 v195, v195, v184, v185
    v_fma_f32 v196, v196, v184, v185
    v_cvt_pk_bf16_f32 v65, v195, v196
    v_lshlrev_b32 v195, 16, v66
    v_and_b32 v196, 0xffff0000, v66
    v_fma_f32 v195, v195, v184, v185
    v_fma_f32 v196, v196, v184, v185
    v_cvt_pk_bf16_f32 v66, v195, v196
    v_lshlrev_b32 v195, 16, v67
    v_and_b32 v196, 0xffff0000, v67
    v_fma_f32 v195, v195, v184, v185
    v_fma_f32 v196, v196, v184, v185
    v_cvt_pk_bf16_f32 v67, v195, v196
    ds_write_b128 v197, v[64:67] offset:0
    v_lshlrev_b32 v195, 16, v68
    v_and_b32 v196, 0xffff0000, v68
    v_fma_f32 v195, v195, v186, v187
    v_fma_f32 v196, v196, v186, v187
    v_cvt_pk_bf16_f32 v68, v195, v196
    v_lshlrev_b32 v195, 16, v69
    v_and_b32 v196, 0xffff0000, v69
    v_fma_f32 v195, v195, v186, v187
    v_fma_f32 v196, v196, v186, v187
    v_cvt_pk_bf16_f32 v69, v195, v196
    v_lshlrev_b32 v195, 16, v70
    v_and_b32 v196, 0xffff0000, v70
    v_fma_f32 v195, v195, v186, v187
    v_fma_f32 v196, v196, v186, v187
    v_cvt_pk_bf16_f32 v70, v195, v196
    v_lshlrev_b32 v195, 16, v71
    v_and_b32 v196, 0xffff0000, v71
    v_fma_f32 v195, v195, v186, v187
    v_fma_f32 v196, v196, v186, v187
    v_cvt_pk_bf16_f32 v71, v195, v196
    ds_write_b128 v197, v[68:71] offset:8192
    v_and_b32 v8, 15, v1
    v_lshlrev_b32 v8, 3, v8
    v_lshrrev_b32 v9, 4, v1
    v_lshrrev_b32 v10, 1, v1
    v_and_b32 v10, 7, v10
    v_xor_b32 v9, v9, v10
    v_add_u32 v8, v8, v9
    v_lshlrev_b32 v2, 4, v8
    v_xor_b32 v3, 64, v2
    s_lshl_b32 s68, s70, 12
    v_add_u32 v4, s68, v2
    v_add_u32 v5, s68, v3
    s_mul_i32 s68, s71, 18432
    s_add_u32 s68, s68, 16384
    v_add_u32 v2, s68, v2
    v_add_u32 v3, s68, v3
    v_add_u32 v198, 53248, v4
    v_add_u32 v199, 53248, v5
    v_add_u32 v200, 53248, v2
    v_add_u32 v201, 53248, v3
    v_add_u32 v202, 106496, v4
    v_add_u32 v203, 106496, v5
    v_add_u32 v204, 106496, v2
    v_add_u32 v205, 106496, v3
    v_mov_b32 v96, 0
    v_mov_b32 v97, 0
    v_mov_b32 v98, 0
    v_mov_b32 v99, 0
    v_mov_b32 v100, 0
    v_mov_b32 v101, 0
    v_mov_b32 v102, 0
    v_mov_b32 v103, 0
    v_mov_b32 v104, 0
    v_mov_b32 v105, 0
    v_mov_b32 v106, 0
    v_mov_b32 v107, 0
    v_mov_b32 v108, 0
    v_mov_b32 v109, 0
    v_mov_b32 v110, 0
    v_mov_b32 v111, 0
    v_mov_b32 v112, 0
    v_mov_b32 v113, 0
    v_mov_b32 v114, 0
    v_mov_b32 v115, 0
    v_mov_b32 v116, 0
    v_mov_b32 v117, 0
    v_mov_b32 v118, 0
    v_mov_b32 v119, 0
    v_mov_b32 v120, 0
    v_mov_b32 v121, 0
    v_mov_b32 v122, 0
    v_mov_b32 v123, 0
    v_mov_b32 v124, 0
    v_mov_b32 v125, 0
    v_mov_b32 v126, 0
    v_mov_b32 v127, 0
    v_mov_b32 v128, 0
    v_mov_b32 v129, 0
    v_mov_b32 v130, 0
    v_mov_b32 v131, 0
    v_mov_b32 v132, 0
    v_mov_b32 v133, 0
    v_mov_b32 v134, 0
    v_mov_b32 v135, 0
    v_mov_b32 v136, 0
    v_mov_b32 v137, 0
    v_mov_b32 v138, 0
    v_mov_b32 v139, 0
    v_mov_b32 v140, 0
    v_mov_b32 v141, 0
    v_mov_b32 v142, 0
    v_mov_b32 v143, 0
    v_mov_b32 v144, 0
    v_mov_b32 v145, 0
    v_mov_b32 v146, 0
    v_mov_b32 v147, 0
    v_mov_b32 v148, 0
    v_mov_b32 v149, 0
    v_mov_b32 v150, 0
    v_mov_b32 v151, 0
    v_mov_b32 v152, 0
    v_mov_b32 v153, 0
    v_mov_b32 v154, 0
    v_mov_b32 v155, 0
    v_mov_b32 v156, 0
    v_mov_b32 v157, 0
    v_mov_b32 v158, 0
    v_mov_b32 v159, 0
    v_mov_b32 v160, 0
    v_mov_b32 v161, 0
    v_mov_b32 v162, 0
    v_mov_b32 v163, 0
    v_mov_b32 v164, 0
    v_mov_b32 v165, 0
    v_mov_b32 v166, 0
    v_mov_b32 v167, 0
    s_waitcnt vmcnt(14) lgkmcnt(0)
    s_barrier
    ds_read_b128 v[8:11], v4 offset:0
    ds_read_b128 v[12:15], v4 offset:2048
    ds_read_b128 v[16:19], v2 offset:0
    ds_read_b128 v[20:23], v2 offset:2048
    ds_read_b128 v[24:27], v2 offset:4096
    ds_read_b128 v[28:31], v2 offset:6144
    ds_read_b128 v[32:35], v2 offset:8192
    ds_read_b128 v[36:39], v2 offset:10240
    ds_read_b128 v[40:43], v2 offset:12288
    ds_read_b128 v[44:47], v2 offset:14336
    ds_read_b128 v[48:51], v2 offset:16384
    s_waitcnt lgkmcnt(0)
    v_mfma_f32_16x16x32_bf16 v[96:99], v[8:11], v[16:19], v[96:99]
    ds_read_b128 v[52:55], v5 offset:0
    v_mfma_f32_16x16x32_bf16 v[100:103], v[12:15], v[16:19], v[100:103]
    ds_read_b128 v[56:59], v5 offset:2048
    v_mfma_f32_16x16x32_bf16 v[104:107], v[8:11], v[20:23], v[104:107]
    ds_read_b128 v[60:63], v3 offset:0
    v_mfma_f32_16x16x32_bf16 v[108:111], v[12:15], v[20:23], v[108:111]
    ds_read_b128 v[64:67], v3 offset:2048
    v_mfma_f32_16x16x32_bf16 v[112:115], v[8:11], v[24:27], v[112:115]
    ds_read_b128 v[68:71], v3 offset:4096
    v_mfma_f32_16x16x32_bf16 v[116:119], v[12:15], v[24:27], v[116:119]
    ds_read_b128 v[72:75], v3 offset:6144
    v_mfma_f32_16x16x32_bf16 v[120:123], v[8:11], v[28:31], v[120:123]
    ds_read_b128 v[76:79], v3 offset:8192
    v_mfma_f32_16x16x32_bf16 v[124:127], v[12:15], v[28:31], v[124:127]
    ds_read_b128 v[80:83], v3 offset:10240
    v_mfma_f32_16x16x32_bf16 v[128:131], v[8:11], v[32:35], v[128:131]
    ds_read_b128 v[84:87], v3 offset:12288
    v_mfma_f32_16x16x32_bf16 v[132:135], v[12:15], v[32:35], v[132:135]
    ds_read_b128 v[88:91], v3 offset:14336
    v_mfma_f32_16x16x32_bf16 v[136:139], v[8:11], v[36:39], v[136:139]
    ds_read_b128 v[92:95], v3 offset:16384
    v_mfma_f32_16x16x32_bf16 v[140:143], v[12:15], v[36:39], v[140:143]
    v_mfma_f32_16x16x32_bf16 v[144:147], v[8:11], v[40:43], v[144:147]
    v_mfma_f32_16x16x32_bf16 v[148:151], v[12:15], v[40:43], v[148:151]
    v_mfma_f32_16x16x32_bf16 v[152:155], v[8:11], v[44:47], v[152:155]
    v_mfma_f32_16x16x32_bf16 v[156:159], v[12:15], v[44:47], v[156:159]
    v_mfma_f32_16x16x32_bf16 v[160:163], v[8:11], v[48:51], v[160:163]
    v_mfma_f32_16x16x32_bf16 v[164:167], v[12:15], v[48:51], v[164:167]
    s_waitcnt vmcnt(9) lgkmcnt(0)
    s_barrier
    ds_read_b128 v[8:11], v198 offset:0
    ds_read_b128 v[12:15], v198 offset:2048
    ds_read_b128 v[16:19], v200 offset:0
    ds_read_b128 v[20:23], v200 offset:2048
    ds_read_b128 v[24:27], v200 offset:4096
    v_mfma_f32_16x16x32_bf16 v[96:99], v[52:55], v[60:63], v[96:99]
    ds_read_b128 v[28:31], v200 offset:6144
    ds_read_b128 v[32:35], v200 offset:8192
    ds_read_b128 v[36:39], v200 offset:10240
    ds_read_b128 v[40:43], v200 offset:12288
    ds_read_b128 v[44:47], v200 offset:14336
    v_mfma_f32_16x16x32_bf16 v[100:103], v[56:59], v[60:63], v[100:103]
    ds_read_b128 v[48:51], v200 offset:16384
    s_add_u32 m0, s65, 16384
    s_mov_b32 s72, 384
    buffer_load_dwordx4 v193, s[44:47], s72 offen lds
    s_add_u32 m0, s65, 24576
    v_mfma_f32_16x16x32_bf16 v[104:107], v[52:55], v[64:67], v[104:107]
    s_mov_b32 s72, 74112
    buffer_load_dwordx4 v193, s[44:47], s72 offen lds
    s_add_u32 m0, s65, 32768
    s_mov_b32 s72, 147840
    buffer_load_dwordx4 v193, s[44:47], s72 offen lds
    v_mfma_f32_16x16x32_bf16 v[108:111], v[56:59], v[64:67], v[108:111]
    s_add_u32 m0, s65, 40960
    s_mov_b32 s72, 221568
    buffer_load_dwordx4 v193, s[44:47], s72 offen lds
    s_add_u32 m0, s65, 49152
    s_mov_b32 s72, 295296
    v_mfma_f32_16x16x32_bf16 v[112:115], v[52:55], v[68:71], v[112:115]
    buffer_load_dwordx4 v193, s[44:47], s72 offen lds
    s_waitcnt vmcnt(7)
    v_lshlrev_b32 v195, 16, v168
    v_and_b32 v196, 0xffff0000, v168
    v_fma_f32 v195, v195, v184, v185
    v_mfma_f32_16x16x32_bf16 v[116:119], v[56:59], v[68:71], v[116:119]
    v_fma_f32 v196, v196, v184, v185
    v_cvt_pk_bf16_f32 v168, v195, v196
    v_lshlrev_b32 v195, 16, v169
    v_and_b32 v196, 0xffff0000, v169
    v_fma_f32 v195, v195, v184, v185
    v_mfma_f32_16x16x32_bf16 v[120:123], v[52:55], v[72:75], v[120:123]
    v_fma_f32 v196, v196, v184, v185
    v_cvt_pk_bf16_f32 v169, v195, v196
    v_lshlrev_b32 v195, 16, v170
    v_and_b32 v196, 0xffff0000, v170
    v_fma_f32 v195, v195, v184, v185
    v_mfma_f32_16x16x32_bf16 v[124:127], v[56:59], v[72:75], v[124:127]
    v_fma_f32 v196, v196, v184, v185
    v_cvt_pk_bf16_f32 v170, v195, v196
    v_lshlrev_b32 v195, 16, v171
    v_and_b32 v196, 0xffff0000, v171
    v_fma_f32 v195, v195, v184, v185
    v_mfma_f32_16x16x32_bf16 v[128:131], v[52:55], v[76:79], v[128:131]
    v_fma_f32 v196, v196, v184, v185
    v_cvt_pk_bf16_f32 v171, v195, v196
    ds_write_b128 v194, v[168:171] offset:0
    v_lshlrev_b32 v195, 16, v172
    v_and_b32 v196, 0xffff0000, v172
    v_mfma_f32_16x16x32_bf16 v[132:135], v[56:59], v[76:79], v[132:135]
    v_fma_f32 v195, v195, v186, v187
    v_fma_f32 v196, v196, v186, v187
    v_cvt_pk_bf16_f32 v172, v195, v196
    v_lshlrev_b32 v195, 16, v173
    v_and_b32 v196, 0xffff0000, v173
    v_mfma_f32_16x16x32_bf16 v[136:139], v[52:55], v[80:83], v[136:139]
    v_fma_f32 v195, v195, v186, v187
    v_fma_f32 v196, v196, v186, v187
    v_cvt_pk_bf16_f32 v173, v195, v196
    v_lshlrev_b32 v195, 16, v174
    v_and_b32 v196, 0xffff0000, v174
    v_mfma_f32_16x16x32_bf16 v[140:143], v[56:59], v[80:83], v[140:143]
    v_fma_f32 v195, v195, v186, v187
    v_fma_f32 v196, v196, v186, v187
    v_cvt_pk_bf16_f32 v174, v195, v196
    v_lshlrev_b32 v195, 16, v175
    v_and_b32 v196, 0xffff0000, v175
    v_mfma_f32_16x16x32_bf16 v[144:147], v[52:55], v[84:87], v[144:147]
    v_fma_f32 v195, v195, v186, v187
    v_fma_f32 v196, v196, v186, v187
    v_cvt_pk_bf16_f32 v175, v195, v196
    ds_write_b128 v194, v[172:175] offset:8192
    s_mov_b32 s72, 640
    v_mfma_f32_16x16x32_bf16 v[148:151], v[56:59], v[84:87], v[148:151]
    buffer_load_dwordx4 v[168:171], v192, s[40:43], s72 offen
    s_mov_b32 s72, 74368
    buffer_load_dwordx4 v[172:175], v192, s[40:43], s72 offen
    v_mfma_f32_16x16x32_bf16 v[152:155], v[52:55], v[88:91], v[152:155]
    v_mfma_f32_16x16x32_bf16 v[156:159], v[56:59], v[88:91], v[156:159]
    v_mfma_f32_16x16x32_bf16 v[160:163], v[52:55], v[92:95], v[160:163]
    v_mfma_f32_16x16x32_bf16 v[164:167], v[56:59], v[92:95], v[164:167]
    s_waitcnt lgkmcnt(0)
    v_mfma_f32_16x16x32_bf16 v[96:99], v[8:11], v[16:19], v[96:99]
    ds_read_b128 v[52:55], v199 offset:0
    v_mfma_f32_16x16x32_bf16 v[100:103], v[12:15], v[16:19], v[100:103]
    ds_read_b128 v[56:59], v199 offset:2048
    v_mfma_f32_16x16x32_bf16 v[104:107], v[8:11], v[20:23], v[104:107]
    ds_read_b128 v[60:63], v201 offset:0
    v_mfma_f32_16x16x32_bf16 v[108:111], v[12:15], v[20:23], v[108:111]
    ds_read_b128 v[64:67], v201 offset:2048
    v_mfma_f32_16x16x32_bf16 v[112:115], v[8:11], v[24:27], v[112:115]
    ds_read_b128 v[68:71], v201 offset:4096
    v_mfma_f32_16x16x32_bf16 v[116:119], v[12:15], v[24:27], v[116:119]
    ds_read_b128 v[72:75], v201 offset:6144
    v_mfma_f32_16x16x32_bf16 v[120:123], v[8:11], v[28:31], v[120:123]
    ds_read_b128 v[76:79], v201 offset:8192
    v_mfma_f32_16x16x32_bf16 v[124:127], v[12:15], v[28:31], v[124:127]
    ds_read_b128 v[80:83], v201 offset:10240
    v_mfma_f32_16x16x32_bf16 v[128:131], v[8:11], v[32:35], v[128:131]
    ds_read_b128 v[84:87], v201 offset:12288
    v_mfma_f32_16x16x32_bf16 v[132:135], v[12:15], v[32:35], v[132:135]
    ds_read_b128 v[88:91], v201 offset:14336
    v_mfma_f32_16x16x32_bf16 v[136:139], v[8:11], v[36:39], v[136:139]
    ds_read_b128 v[92:95], v201 offset:16384
    v_mfma_f32_16x16x32_bf16 v[140:143], v[12:15], v[36:39], v[140:143]
    v_mfma_f32_16x16x32_bf16 v[144:147], v[8:11], v[40:43], v[144:147]
    v_mfma_f32_16x16x32_bf16 v[148:151], v[12:15], v[40:43], v[148:151]
    v_mfma_f32_16x16x32_bf16 v[152:155], v[8:11], v[44:47], v[152:155]
    v_mfma_f32_16x16x32_bf16 v[156:159], v[12:15], v[44:47], v[156:159]
    v_mfma_f32_16x16x32_bf16 v[160:163], v[8:11], v[48:51], v[160:163]
    v_mfma_f32_16x16x32_bf16 v[164:167], v[12:15], v[48:51], v[164:167]
    s_waitcnt vmcnt(11) lgkmcnt(0)
    s_barrier
    ds_read_b128 v[8:11], v202 offset:0
    ds_read_b128 v[12:15], v202 offset:2048
    ds_read_b128 v[16:19], v204 offset:0
    ds_read_b128 v[20:23], v204 offset:2048
    ds_read_b128 v[24:27], v204 offset:4096
    v_mfma_f32_16x16x32_bf16 v[96:99], v[52:55], v[60:63], v[96:99]
    ds_read_b128 v[28:31], v204 offset:6144
    ds_read_b128 v[32:35], v204 offset:8192
    ds_read_b128 v[36:39], v204 offset:10240
    ds_read_b128 v[40:43], v204 offset:12288
    ds_read_b128 v[44:47], v204 offset:14336
    v_mfma_f32_16x16x32_bf16 v[100:103], v[56:59], v[60:63], v[100:103]
    ds_read_b128 v[48:51], v204 offset:16384
    s_add_u32 m0, s65, 69632
    s_mov_b32 s72, 512
    buffer_load_dwordx4 v193, s[44:47], s72 offen lds
    s_add_u32 m0, s65, 77824
    v_mfma_f32_16x16x32_bf16 v[104:107], v[52:55], v[64:67], v[104:107]
    s_mov_b32 s72, 74240
    buffer_load_dwordx4 v193, s[44:47], s72 offen lds
    s_add_u32 m0, s65, 86016
    s_mov_b32 s72, 147968
    buffer_load_dwordx4 v193, s[44:47], s72 offen lds
    v_mfma_f32_16x16x32_bf16 v[108:111], v[56:59], v[64:67], v[108:111]
    s_add_u32 m0, s65, 94208
    s_mov_b32 s72, 221696
    buffer_load_dwordx4 v193, s[44:47], s72 offen lds
    s_add_u32 m0, s65, 102400
    s_mov_b32 s72, 295424
    v_mfma_f32_16x16x32_bf16 v[112:115], v[52:55], v[68:71], v[112:115]
    buffer_load_dwordx4 v193, s[44:47], s72 offen lds
    s_waitcnt vmcnt(12)
    v_lshlrev_b32 v195, 16, v176
    v_and_b32 v196, 0xffff0000, v176
    v_fma_f32 v195, v195, v184, v185
    v_mfma_f32_16x16x32_bf16 v[116:119], v[56:59], v[68:71], v[116:119]
    v_fma_f32 v196, v196, v184, v185
    v_cvt_pk_bf16_f32 v176, v195, v196
    v_lshlrev_b32 v195, 16, v177
    v_and_b32 v196, 0xffff0000, v177
    v_fma_f32 v195, v195, v184, v185
    v_mfma_f32_16x16x32_bf16 v[120:123], v[52:55], v[72:75], v[120:123]
    v_fma_f32 v196, v196, v184, v185
    v_cvt_pk_bf16_f32 v177, v195, v196
    v_lshlrev_b32 v195, 16, v178
    v_and_b32 v196, 0xffff0000, v178
    v_fma_f32 v195, v195, v184, v185
    v_mfma_f32_16x16x32_bf16 v[124:127], v[56:59], v[72:75], v[124:127]
    v_fma_f32 v196, v196, v184, v185
    v_cvt_pk_bf16_f32 v178, v195, v196
    v_lshlrev_b32 v195, 16, v179
    v_and_b32 v196, 0xffff0000, v179
    v_fma_f32 v195, v195, v184, v185
    v_mfma_f32_16x16x32_bf16 v[128:131], v[52:55], v[76:79], v[128:131]
    v_fma_f32 v196, v196, v184, v185
    v_cvt_pk_bf16_f32 v179, v195, v196
    ds_write_b128 v194, v[176:179] offset:53248
    v_lshlrev_b32 v195, 16, v180
    v_and_b32 v196, 0xffff0000, v180
    v_mfma_f32_16x16x32_bf16 v[132:135], v[56:59], v[76:79], v[132:135]
    v_fma_f32 v195, v195, v186, v187
    v_fma_f32 v196, v196, v186, v187
    v_cvt_pk_bf16_f32 v180, v195, v196
    v_lshlrev_b32 v195, 16, v181
    v_and_b32 v196, 0xffff0000, v181
    v_mfma_f32_16x16x32_bf16 v[136:139], v[52:55], v[80:83], v[136:139]
    v_fma_f32 v195, v195, v186, v187
    v_fma_f32 v196, v196, v186, v187
    v_cvt_pk_bf16_f32 v181, v195, v196
    v_lshlrev_b32 v195, 16, v182
    v_and_b32 v196, 0xffff0000, v182
    v_mfma_f32_16x16x32_bf16 v[140:143], v[56:59], v[80:83], v[140:143]
    v_fma_f32 v195, v195, v186, v187
    v_fma_f32 v196, v196, v186, v187
    v_cvt_pk_bf16_f32 v182, v195, v196
    v_lshlrev_b32 v195, 16, v183
    v_and_b32 v196, 0xffff0000, v183
    v_mfma_f32_16x16x32_bf16 v[144:147], v[52:55], v[84:87], v[144:147]
    v_fma_f32 v195, v195, v186, v187
    v_fma_f32 v196, v196, v186, v187
    v_cvt_pk_bf16_f32 v183, v195, v196
    ds_write_b128 v194, v[180:183] offset:61440
    s_mov_b32 s72, 768
    v_mfma_f32_16x16x32_bf16 v[148:151], v[56:59], v[84:87], v[148:151]
    buffer_load_dwordx4 v[176:179], v192, s[40:43], s72 offen
    s_mov_b32 s72, 74496
    buffer_load_dwordx4 v[180:183], v192, s[40:43], s72 offen
    v_mfma_f32_16x16x32_bf16 v[152:155], v[52:55], v[88:91], v[152:155]
    v_mfma_f32_16x16x32_bf16 v[156:159], v[56:59], v[88:91], v[156:159]
    v_mfma_f32_16x16x32_bf16 v[160:163], v[52:55], v[92:95], v[160:163]
    v_mfma_f32_16x16x32_bf16 v[164:167], v[56:59], v[92:95], v[164:167]
    s_waitcnt lgkmcnt(0)
    v_mfma_f32_16x16x32_bf16 v[96:99], v[8:11], v[16:19], v[96:99]
    ds_read_b128 v[52:55], v203 offset:0
    v_mfma_f32_16x16x32_bf16 v[100:103], v[12:15], v[16:19], v[100:103]
    ds_read_b128 v[56:59], v203 offset:2048
    v_mfma_f32_16x16x32_bf16 v[104:107], v[8:11], v[20:23], v[104:107]
    ds_read_b128 v[60:63], v205 offset:0
    v_mfma_f32_16x16x32_bf16 v[108:111], v[12:15], v[20:23], v[108:111]
    ds_read_b128 v[64:67], v205 offset:2048
    v_mfma_f32_16x16x32_bf16 v[112:115], v[8:11], v[24:27], v[112:115]
    ds_read_b128 v[68:71], v205 offset:4096
    v_mfma_f32_16x16x32_bf16 v[116:119], v[12:15], v[24:27], v[116:119]
    ds_read_b128 v[72:75], v205 offset:6144
    v_mfma_f32_16x16x32_bf16 v[120:123], v[8:11], v[28:31], v[120:123]
    ds_read_b128 v[76:79], v205 offset:8192
    v_mfma_f32_16x16x32_bf16 v[124:127], v[12:15], v[28:31], v[124:127]
    ds_read_b128 v[80:83], v205 offset:10240
    v_mfma_f32_16x16x32_bf16 v[128:131], v[8:11], v[32:35], v[128:131]
    ds_read_b128 v[84:87], v205 offset:12288
    v_mfma_f32_16x16x32_bf16 v[132:135], v[12:15], v[32:35], v[132:135]
    ds_read_b128 v[88:91], v205 offset:14336
    v_mfma_f32_16x16x32_bf16 v[136:139], v[8:11], v[36:39], v[136:139]
    ds_read_b128 v[92:95], v205 offset:16384
    v_mfma_f32_16x16x32_bf16 v[140:143], v[12:15], v[36:39], v[140:143]
    v_mfma_f32_16x16x32_bf16 v[144:147], v[8:11], v[40:43], v[144:147]
    v_mfma_f32_16x16x32_bf16 v[148:151], v[12:15], v[40:43], v[148:151]
    v_mfma_f32_16x16x32_bf16 v[152:155], v[8:11], v[44:47], v[152:155]
    v_mfma_f32_16x16x32_bf16 v[156:159], v[12:15], v[44:47], v[156:159]
    v_mfma_f32_16x16x32_bf16 v[160:163], v[8:11], v[48:51], v[160:163]
    v_mfma_f32_16x16x32_bf16 v[164:167], v[12:15], v[48:51], v[164:167]
    s_waitcnt vmcnt(9) lgkmcnt(0)
    s_barrier
    ds_read_b128 v[8:11], v4 offset:0
    ds_read_b128 v[12:15], v4 offset:2048
    ds_read_b128 v[16:19], v2 offset:0
    ds_read_b128 v[20:23], v2 offset:2048
    ds_read_b128 v[24:27], v2 offset:4096
    v_mfma_f32_16x16x32_bf16 v[96:99], v[52:55], v[60:63], v[96:99]
    ds_read_b128 v[28:31], v2 offset:6144
    ds_read_b128 v[32:35], v2 offset:8192
    ds_read_b128 v[36:39], v2 offset:10240
    ds_read_b128 v[40:43], v2 offset:12288
    ds_read_b128 v[44:47], v2 offset:14336
    v_mfma_f32_16x16x32_bf16 v[100:103], v[56:59], v[60:63], v[100:103]
    ds_read_b128 v[48:51], v2 offset:16384
    s_add_u32 m0, s65, 122880
    s_mov_b32 s72, 640
    buffer_load_dwordx4 v193, s[44:47], s72 offen lds
    s_add_u32 m0, s65, 131072
    v_mfma_f32_16x16x32_bf16 v[104:107], v[52:55], v[64:67], v[104:107]
    s_mov_b32 s72, 74368
    buffer_load_dwordx4 v193, s[44:47], s72 offen lds
    s_add_u32 m0, s65, 139264
    s_mov_b32 s72, 148096
    buffer_load_dwordx4 v193, s[44:47], s72 offen lds
    v_mfma_f32_16x16x32_bf16 v[108:111], v[56:59], v[64:67], v[108:111]
    s_add_u32 m0, s65, 147456
    s_mov_b32 s72, 221824
    buffer_load_dwordx4 v193, s[44:47], s72 offen lds
    s_add_u32 m0, s65, 155648
    s_mov_b32 s72, 295552
    v_mfma_f32_16x16x32_bf16 v[112:115], v[52:55], v[68:71], v[112:115]
    buffer_load_dwordx4 v193, s[44:47], s72 offen lds
    s_waitcnt vmcnt(12)
    v_lshlrev_b32 v195, 16, v168
    v_and_b32 v196, 0xffff0000, v168
    v_fma_f32 v195, v195, v184, v185
    v_mfma_f32_16x16x32_bf16 v[116:119], v[56:59], v[68:71], v[116:119]
    v_fma_f32 v196, v196, v184, v185
    v_cvt_pk_bf16_f32 v168, v195, v196
    v_lshlrev_b32 v195, 16, v169
    v_and_b32 v196, 0xffff0000, v169
    v_fma_f32 v195, v195, v184, v185
    v_mfma_f32_16x16x32_bf16 v[120:123], v[52:55], v[72:75], v[120:123]
    v_fma_f32 v196, v196, v184, v185
    v_cvt_pk_bf16_f32 v169, v195, v196
    v_lshlrev_b32 v195, 16, v170
    v_and_b32 v196, 0xffff0000, v170
    v_fma_f32 v195, v195, v184, v185
    v_mfma_f32_16x16x32_bf16 v[124:127], v[56:59], v[72:75], v[124:127]
    v_fma_f32 v196, v196, v184, v185
    v_cvt_pk_bf16_f32 v170, v195, v196
    v_lshlrev_b32 v195, 16, v171
    v_and_b32 v196, 0xffff0000, v171
    v_fma_f32 v195, v195, v184, v185
    v_mfma_f32_16x16x32_bf16 v[128:131], v[52:55], v[76:79], v[128:131]
    v_fma_f32 v196, v196, v184, v185
    v_cvt_pk_bf16_f32 v171, v195, v196
    ds_write_b128 v197, v[168:171] offset:0
    v_lshlrev_b32 v195, 16, v172
    v_and_b32 v196, 0xffff0000, v172
    v_mfma_f32_16x16x32_bf16 v[132:135], v[56:59], v[76:79], v[132:135]
    v_fma_f32 v195, v195, v186, v187
    v_fma_f32 v196, v196, v186, v187
    v_cvt_pk_bf16_f32 v172, v195, v196
    v_lshlrev_b32 v195, 16, v173
    v_and_b32 v196, 0xffff0000, v173
    v_mfma_f32_16x16x32_bf16 v[136:139], v[52:55], v[80:83], v[136:139]
    v_fma_f32 v195, v195, v186, v187
    v_fma_f32 v196, v196, v186, v187
    v_cvt_pk_bf16_f32 v173, v195, v196
    v_lshlrev_b32 v195, 16, v174
    v_and_b32 v196, 0xffff0000, v174
    v_mfma_f32_16x16x32_bf16 v[140:143], v[56:59], v[80:83], v[140:143]
    v_fma_f32 v195, v195, v186, v187
    v_fma_f32 v196, v196, v186, v187
    v_cvt_pk_bf16_f32 v174, v195, v196
    v_lshlrev_b32 v195, 16, v175
    v_and_b32 v196, 0xffff0000, v175
    v_mfma_f32_16x16x32_bf16 v[144:147], v[52:55], v[84:87], v[144:147]
    v_fma_f32 v195, v195, v186, v187
    v_fma_f32 v196, v196, v186, v187
    v_cvt_pk_bf16_f32 v175, v195, v196
    ds_write_b128 v197, v[172:175] offset:8192
    s_mov_b32 s72, 896
    v_mfma_f32_16x16x32_bf16 v[148:151], v[56:59], v[84:87], v[148:151]
    buffer_load_dwordx4 v[168:171], v192, s[40:43], s72 offen
    s_mov_b32 s72, 74624
    buffer_load_dwordx4 v[172:175], v192, s[40:43], s72 offen
    v_mfma_f32_16x16x32_bf16 v[152:155], v[52:55], v[88:91], v[152:155]
    v_mfma_f32_16x16x32_bf16 v[156:159], v[56:59], v[88:91], v[156:159]
    v_mfma_f32_16x16x32_bf16 v[160:163], v[52:55], v[92:95], v[160:163]
    v_mfma_f32_16x16x32_bf16 v[164:167], v[56:59], v[92:95], v[164:167]
    s_waitcnt lgkmcnt(0)
    v_mfma_f32_16x16x32_bf16 v[96:99], v[8:11], v[16:19], v[96:99]
    ds_read_b128 v[52:55], v5 offset:0
    v_mfma_f32_16x16x32_bf16 v[100:103], v[12:15], v[16:19], v[100:103]
    ds_read_b128 v[56:59], v5 offset:2048
    v_mfma_f32_16x16x32_bf16 v[104:107], v[8:11], v[20:23], v[104:107]
    ds_read_b128 v[60:63], v3 offset:0
    v_mfma_f32_16x16x32_bf16 v[108:111], v[12:15], v[20:23], v[108:111]
    ds_read_b128 v[64:67], v3 offset:2048
    v_mfma_f32_16x16x32_bf16 v[112:115], v[8:11], v[24:27], v[112:115]
    ds_read_b128 v[68:71], v3 offset:4096
    v_mfma_f32_16x16x32_bf16 v[116:119], v[12:15], v[24:27], v[116:119]
    ds_read_b128 v[72:75], v3 offset:6144
    v_mfma_f32_16x16x32_bf16 v[120:123], v[8:11], v[28:31], v[120:123]
    ds_read_b128 v[76:79], v3 offset:8192
    v_mfma_f32_16x16x32_bf16 v[124:127], v[12:15], v[28:31], v[124:127]
    ds_read_b128 v[80:83], v3 offset:10240
    v_mfma_f32_16x16x32_bf16 v[128:131], v[8:11], v[32:35], v[128:131]
    ds_read_b128 v[84:87], v3 offset:12288
    v_mfma_f32_16x16x32_bf16 v[132:135], v[12:15], v[32:35], v[132:135]
    ds_read_b128 v[88:91], v3 offset:14336
    v_mfma_f32_16x16x32_bf16 v[136:139], v[8:11], v[36:39], v[136:139]
    ds_read_b128 v[92:95], v3 offset:16384
    v_mfma_f32_16x16x32_bf16 v[140:143], v[12:15], v[36:39], v[140:143]
    v_mfma_f32_16x16x32_bf16 v[144:147], v[8:11], v[40:43], v[144:147]
    v_mfma_f32_16x16x32_bf16 v[148:151], v[12:15], v[40:43], v[148:151]
    v_mfma_f32_16x16x32_bf16 v[152:155], v[8:11], v[44:47], v[152:155]
    v_mfma_f32_16x16x32_bf16 v[156:159], v[12:15], v[44:47], v[156:159]
    v_mfma_f32_16x16x32_bf16 v[160:163], v[8:11], v[48:51], v[160:163]
    v_mfma_f32_16x16x32_bf16 v[164:167], v[12:15], v[48:51], v[164:167]
    s_waitcnt vmcnt(9) lgkmcnt(0)
    s_barrier
    ds_read_b128 v[8:11], v198 offset:0
    ds_read_b128 v[12:15], v198 offset:2048
    ds_read_b128 v[16:19], v200 offset:0
    ds_read_b128 v[20:23], v200 offset:2048
    ds_read_b128 v[24:27], v200 offset:4096
    v_mfma_f32_16x16x32_bf16 v[96:99], v[52:55], v[60:63], v[96:99]
    ds_read_b128 v[28:31], v200 offset:6144
    ds_read_b128 v[32:35], v200 offset:8192
    ds_read_b128 v[36:39], v200 offset:10240
    ds_read_b128 v[40:43], v200 offset:12288
    ds_read_b128 v[44:47], v200 offset:14336
    v_mfma_f32_16x16x32_bf16 v[100:103], v[56:59], v[60:63], v[100:103]
    ds_read_b128 v[48:51], v200 offset:16384
    s_add_u32 m0, s65, 16384
    s_mov_b32 s72, 768
    buffer_load_dwordx4 v193, s[44:47], s72 offen lds
    s_add_u32 m0, s65, 24576
    v_mfma_f32_16x16x32_bf16 v[104:107], v[52:55], v[64:67], v[104:107]
    s_mov_b32 s72, 74496
    buffer_load_dwordx4 v193, s[44:47], s72 offen lds
    s_add_u32 m0, s65, 32768
    s_mov_b32 s72, 148224
    buffer_load_dwordx4 v193, s[44:47], s72 offen lds
    v_mfma_f32_16x16x32_bf16 v[108:111], v[56:59], v[64:67], v[108:111]
    s_add_u32 m0, s65, 40960
    s_mov_b32 s72, 221952
    buffer_load_dwordx4 v193, s[44:47], s72 offen lds
    s_add_u32 m0, s65, 49152
    s_mov_b32 s72, 295680
    v_mfma_f32_16x16x32_bf16 v[112:115], v[52:55], v[68:71], v[112:115]
    buffer_load_dwordx4 v193, s[44:47], s72 offen lds
    s_waitcnt vmcnt(12)
    v_lshlrev_b32 v195, 16, v176
    v_and_b32 v196, 0xffff0000, v176
    v_fma_f32 v195, v195, v184, v185
    v_mfma_f32_16x16x32_bf16 v[116:119], v[56:59], v[68:71], v[116:119]
    v_fma_f32 v196, v196, v184, v185
    v_cvt_pk_bf16_f32 v176, v195, v196
    v_lshlrev_b32 v195, 16, v177
    v_and_b32 v196, 0xffff0000, v177
    v_fma_f32 v195, v195, v184, v185
    v_mfma_f32_16x16x32_bf16 v[120:123], v[52:55], v[72:75], v[120:123]
    v_fma_f32 v196, v196, v184, v185
    v_cvt_pk_bf16_f32 v177, v195, v196
    v_lshlrev_b32 v195, 16, v178
    v_and_b32 v196, 0xffff0000, v178
    v_fma_f32 v195, v195, v184, v185
    v_mfma_f32_16x16x32_bf16 v[124:127], v[56:59], v[72:75], v[124:127]
    v_fma_f32 v196, v196, v184, v185
    v_cvt_pk_bf16_f32 v178, v195, v196
    v_lshlrev_b32 v195, 16, v179
    v_and_b32 v196, 0xffff0000, v179
    v_fma_f32 v195, v195, v184, v185
    v_mfma_f32_16x16x32_bf16 v[128:131], v[52:55], v[76:79], v[128:131]
    v_fma_f32 v196, v196, v184, v185
    v_cvt_pk_bf16_f32 v179, v195, v196
    ds_write_b128 v194, v[176:179] offset:0
    v_lshlrev_b32 v195, 16, v180
    v_and_b32 v196, 0xffff0000, v180
    v_mfma_f32_16x16x32_bf16 v[132:135], v[56:59], v[76:79], v[132:135]
    v_fma_f32 v195, v195, v186, v187
    v_fma_f32 v196, v196, v186, v187
    v_cvt_pk_bf16_f32 v180, v195, v196
    v_lshlrev_b32 v195, 16, v181
    v_and_b32 v196, 0xffff0000, v181
    v_mfma_f32_16x16x32_bf16 v[136:139], v[52:55], v[80:83], v[136:139]
    v_fma_f32 v195, v195, v186, v187
    v_fma_f32 v196, v196, v186, v187
    v_cvt_pk_bf16_f32 v181, v195, v196
    v_lshlrev_b32 v195, 16, v182
    v_and_b32 v196, 0xffff0000, v182
    v_mfma_f32_16x16x32_bf16 v[140:143], v[56:59], v[80:83], v[140:143]
    v_fma_f32 v195, v195, v186, v187
    v_fma_f32 v196, v196, v186, v187
    v_cvt_pk_bf16_f32 v182, v195, v196
    v_lshlrev_b32 v195, 16, v183
    v_and_b32 v196, 0xffff0000, v183
    v_mfma_f32_16x16x32_bf16 v[144:147], v[52:55], v[84:87], v[144:147]
    v_fma_f32 v195, v195, v186, v187
    v_fma_f32 v196, v196, v186, v187
    v_cvt_pk_bf16_f32 v183, v195, v196
    ds_write_b128 v194, v[180:183] offset:8192
    s_mov_b32 s72, 1024
    v_mfma_f32_16x16x32_bf16 v[148:151], v[56:59], v[84:87], v[148:151]
    buffer_load_dwordx4 v[176:179], v192, s[40:43], s72 offen
    s_mov_b32 s72, 74752
    buffer_load_dwordx4 v[180:183], v192, s[40:43], s72 offen
    v_mfma_f32_16x16x32_bf16 v[152:155], v[52:55], v[88:91], v[152:155]
    v_mfma_f32_16x16x32_bf16 v[156:159], v[56:59], v[88:91], v[156:159]
    v_mfma_f32_16x16x32_bf16 v[160:163], v[52:55], v[92:95], v[160:163]
    v_mfma_f32_16x16x32_bf16 v[164:167], v[56:59], v[92:95], v[164:167]
    s_waitcnt lgkmcnt(0)
    v_mfma_f32_16x16x32_bf16 v[96:99], v[8:11], v[16:19], v[96:99]
    ds_read_b128 v[52:55], v199 offset:0
    v_mfma_f32_16x16x32_bf16 v[100:103], v[12:15], v[16:19], v[100:103]
    ds_read_b128 v[56:59], v199 offset:2048
    v_mfma_f32_16x16x32_bf16 v[104:107], v[8:11], v[20:23], v[104:107]
    ds_read_b128 v[60:63], v201 offset:0
    v_mfma_f32_16x16x32_bf16 v[108:111], v[12:15], v[20:23], v[108:111]
    ds_read_b128 v[64:67], v201 offset:2048
    v_mfma_f32_16x16x32_bf16 v[112:115], v[8:11], v[24:27], v[112:115]
    ds_read_b128 v[68:71], v201 offset:4096
    v_mfma_f32_16x16x32_bf16 v[116:119], v[12:15], v[24:27], v[116:119]
    ds_read_b128 v[72:75], v201 offset:6144
    v_mfma_f32_16x16x32_bf16 v[120:123], v[8:11], v[28:31], v[120:123]
    ds_read_b128 v[76:79], v201 offset:8192
    v_mfma_f32_16x16x32_bf16 v[124:127], v[12:15], v[28:31], v[124:127]
    ds_read_b128 v[80:83], v201 offset:10240
    v_mfma_f32_16x16x32_bf16 v[128:131], v[8:11], v[32:35], v[128:131]
    ds_read_b128 v[84:87], v201 offset:12288
    v_mfma_f32_16x16x32_bf16 v[132:135], v[12:15], v[32:35], v[132:135]
    ds_read_b128 v[88:91], v201 offset:14336
    v_mfma_f32_16x16x32_bf16 v[136:139], v[8:11], v[36:39], v[136:139]
    ds_read_b128 v[92:95], v201 offset:16384
    v_mfma_f32_16x16x32_bf16 v[140:143], v[12:15], v[36:39], v[140:143]
    v_mfma_f32_16x16x32_bf16 v[144:147], v[8:11], v[40:43], v[144:147]
    v_mfma_f32_16x16x32_bf16 v[148:151], v[12:15], v[40:43], v[148:151]
    v_mfma_f32_16x16x32_bf16 v[152:155], v[8:11], v[44:47], v[152:155]
    v_mfma_f32_16x16x32_bf16 v[156:159], v[12:15], v[44:47], v[156:159]
    v_mfma_f32_16x16x32_bf16 v[160:163], v[8:11], v[48:51], v[160:163]
    v_mfma_f32_16x16x32_bf16 v[164:167], v[12:15], v[48:51], v[164:167]
    s_waitcnt vmcnt(9) lgkmcnt(0)
    s_barrier
    ds_read_b128 v[8:11], v202 offset:0
    ds_read_b128 v[12:15], v202 offset:2048
    ds_read_b128 v[16:19], v204 offset:0
    ds_read_b128 v[20:23], v204 offset:2048
    v_mfma_f32_16x16x32_bf16 v[96:99], v[52:55], v[60:63], v[96:99]
    ds_read_b128 v[24:27], v204 offset:4096
    ds_read_b128 v[28:31], v204 offset:6144
    ds_read_b128 v[32:35], v204 offset:8192
    ds_read_b128 v[36:39], v204 offset:10240
    v_mfma_f32_16x16x32_bf16 v[100:103], v[56:59], v[60:63], v[100:103]
    ds_read_b128 v[40:43], v204 offset:12288
    ds_read_b128 v[44:47], v204 offset:14336
    ds_read_b128 v[48:51], v204 offset:16384
    s_add_u32 m0, s65, 69632
    v_mfma_f32_16x16x32_bf16 v[104:107], v[52:55], v[64:67], v[104:107]
    s_mov_b32 s72, 896
    buffer_load_dwordx4 v193, s[44:47], s72 offen lds
    s_add_u32 m0, s65, 77824
    s_mov_b32 s72, 74624
    v_mfma_f32_16x16x32_bf16 v[108:111], v[56:59], v[64:67], v[108:111]
    buffer_load_dwordx4 v193, s[44:47], s72 offen lds
    s_add_u32 m0, s65, 86016
    s_mov_b32 s72, 148352
    buffer_load_dwordx4 v193, s[44:47], s72 offen lds
    v_mfma_f32_16x16x32_bf16 v[112:115], v[52:55], v[68:71], v[112:115]
    s_add_u32 m0, s65, 94208
    s_mov_b32 s72, 222080
    buffer_load_dwordx4 v193, s[44:47], s72 offen lds
    s_add_u32 m0, s65, 102400
    v_mfma_f32_16x16x32_bf16 v[116:119], v[56:59], v[68:71], v[116:119]
    s_mov_b32 s72, 295808
    buffer_load_dwordx4 v193, s[44:47], s72 offen lds
    s_waitcnt vmcnt(12)
    v_lshlrev_b32 v195, 16, v168
    v_mfma_f32_16x16x32_bf16 v[120:123], v[52:55], v[72:75], v[120:123]
    v_and_b32 v196, 0xffff0000, v168
    v_fma_f32 v195, v195, v184, v185
    v_fma_f32 v196, v196, v184, v185
    v_cvt_pk_bf16_f32 v168, v195, v196
    v_mfma_f32_16x16x32_bf16 v[124:127], v[56:59], v[72:75], v[124:127]
    v_lshlrev_b32 v195, 16, v169
    v_and_b32 v196, 0xffff0000, v169
    v_fma_f32 v195, v195, v184, v185
    v_fma_f32 v196, v196, v184, v185
    v_mfma_f32_16x16x32_bf16 v[128:131], v[52:55], v[76:79], v[128:131]
    v_cvt_pk_bf16_f32 v169, v195, v196
    v_lshlrev_b32 v195, 16, v170
    v_and_b32 v196, 0xffff0000, v170
    v_fma_f32 v195, v195, v184, v185
    v_mfma_f32_16x16x32_bf16 v[132:135], v[56:59], v[76:79], v[132:135]
    v_fma_f32 v196, v196, v184, v185
    v_cvt_pk_bf16_f32 v170, v195, v196
    v_lshlrev_b32 v195, 16, v171
    v_and_b32 v196, 0xffff0000, v171
    v_mfma_f32_16x16x32_bf16 v[136:139], v[52:55], v[80:83], v[136:139]
    v_fma_f32 v195, v195, v184, v185
    v_fma_f32 v196, v196, v184, v185
    v_cvt_pk_bf16_f32 v171, v195, v196
    ds_write_b128 v194, v[168:171] offset:53248
    v_mfma_f32_16x16x32_bf16 v[140:143], v[56:59], v[80:83], v[140:143]
    v_lshlrev_b32 v195, 16, v172
    v_and_b32 v196, 0xffff0000, v172
    v_fma_f32 v195, v195, v186, v187
    v_fma_f32 v196, v196, v186, v187
    v_mfma_f32_16x16x32_bf16 v[144:147], v[52:55], v[84:87], v[144:147]
    v_cvt_pk_bf16_f32 v172, v195, v196
    v_lshlrev_b32 v195, 16, v173
    v_and_b32 v196, 0xffff0000, v173
    v_fma_f32 v195, v195, v186, v187
    v_mfma_f32_16x16x32_bf16 v[148:151], v[56:59], v[84:87], v[148:151]
    v_fma_f32 v196, v196, v186, v187
    v_cvt_pk_bf16_f32 v173, v195, v196
    v_lshlrev_b32 v195, 16, v174
    v_and_b32 v196, 0xffff0000, v174
    v_mfma_f32_16x16x32_bf16 v[152:155], v[52:55], v[88:91], v[152:155]
    v_fma_f32 v195, v195, v186, v187
    v_fma_f32 v196, v196, v186, v187
    v_cvt_pk_bf16_f32 v174, v195, v196
    v_lshlrev_b32 v195, 16, v175
    v_mfma_f32_16x16x32_bf16 v[156:159], v[56:59], v[88:91], v[156:159]
    v_and_b32 v196, 0xffff0000, v175
    v_fma_f32 v195, v195, v186, v187
    v_fma_f32 v196, v196, v186, v187
    v_cvt_pk_bf16_f32 v175, v195, v196
    v_mfma_f32_16x16x32_bf16 v[160:163], v[52:55], v[92:95], v[160:163]
    ds_write_b128 v194, v[172:175] offset:61440
    v_mfma_f32_16x16x32_bf16 v[164:167], v[56:59], v[92:95], v[164:167]
    s_waitcnt lgkmcnt(0)
    v_mfma_f32_16x16x32_bf16 v[96:99], v[8:11], v[16:19], v[96:99]
    ds_read_b128 v[52:55], v203 offset:0
    v_mfma_f32_16x16x32_bf16 v[100:103], v[12:15], v[16:19], v[100:103]
    ds_read_b128 v[56:59], v203 offset:2048
    v_mfma_f32_16x16x32_bf16 v[104:107], v[8:11], v[20:23], v[104:107]
    ds_read_b128 v[60:63], v205 offset:0
    v_mfma_f32_16x16x32_bf16 v[108:111], v[12:15], v[20:23], v[108:111]
    ds_read_b128 v[64:67], v205 offset:2048
    v_mfma_f32_16x16x32_bf16 v[112:115], v[8:11], v[24:27], v[112:115]
    ds_read_b128 v[68:71], v205 offset:4096
    v_mfma_f32_16x16x32_bf16 v[116:119], v[12:15], v[24:27], v[116:119]
    ds_read_b128 v[72:75], v205 offset:6144
    v_mfma_f32_16x16x32_bf16 v[120:123], v[8:11], v[28:31], v[120:123]
    ds_read_b128 v[76:79], v205 offset:8192
    v_mfma_f32_16x16x32_bf16 v[124:127], v[12:15], v[28:31], v[124:127]
    ds_read_b128 v[80:83], v205 offset:10240
    v_mfma_f32_16x16x32_bf16 v[128:131], v[8:11], v[32:35], v[128:131]
    ds_read_b128 v[84:87], v205 offset:12288
    v_mfma_f32_16x16x32_bf16 v[132:135], v[12:15], v[32:35], v[132:135]
    ds_read_b128 v[88:91], v205 offset:14336
    v_mfma_f32_16x16x32_bf16 v[136:139], v[8:11], v[36:39], v[136:139]
    ds_read_b128 v[92:95], v205 offset:16384
    v_mfma_f32_16x16x32_bf16 v[140:143], v[12:15], v[36:39], v[140:143]
    v_mfma_f32_16x16x32_bf16 v[144:147], v[8:11], v[40:43], v[144:147]
    v_mfma_f32_16x16x32_bf16 v[148:151], v[12:15], v[40:43], v[148:151]
    v_mfma_f32_16x16x32_bf16 v[152:155], v[8:11], v[44:47], v[152:155]
    v_mfma_f32_16x16x32_bf16 v[156:159], v[12:15], v[44:47], v[156:159]
    v_mfma_f32_16x16x32_bf16 v[160:163], v[8:11], v[48:51], v[160:163]
    v_mfma_f32_16x16x32_bf16 v[164:167], v[12:15], v[48:51], v[164:167]
    s_waitcnt vmcnt(7) lgkmcnt(0)
    s_barrier
    ds_read_b128 v[8:11], v4 offset:0
    ds_read_b128 v[12:15], v4 offset:2048
    ds_read_b128 v[16:19], v2 offset:0
    ds_read_b128 v[20:23], v2 offset:2048
    v_mfma_f32_16x16x32_bf16 v[96:99], v[52:55], v[60:63], v[96:99]
    ds_read_b128 v[24:27], v2 offset:4096
    ds_read_b128 v[28:31], v2 offset:6144
    ds_read_b128 v[32:35], v2 offset:8192
    ds_read_b128 v[36:39], v2 offset:10240
    v_mfma_f32_16x16x32_bf16 v[100:103], v[56:59], v[60:63], v[100:103]
    ds_read_b128 v[40:43], v2 offset:12288
    ds_read_b128 v[44:47], v2 offset:14336
    ds_read_b128 v[48:51], v2 offset:16384
    s_add_u32 m0, s65, 122880
    v_mfma_f32_16x16x32_bf16 v[104:107], v[52:55], v[64:67], v[104:107]
    s_mov_b32 s72, 1024
    buffer_load_dwordx4 v193, s[44:47], s72 offen lds
    s_add_u32 m0, s65, 131072
    s_mov_b32 s72, 74752
    v_mfma_f32_16x16x32_bf16 v[108:111], v[56:59], v[64:67], v[108:111]
    buffer_load_dwordx4 v193, s[44:47], s72 offen lds
    s_add_u32 m0, s65, 139264
    s_mov_b32 s72, 148480
    buffer_load_dwordx4 v193, s[44:47], s72 offen lds
    v_mfma_f32_16x16x32_bf16 v[112:115], v[52:55], v[68:71], v[112:115]
    s_add_u32 m0, s65, 147456
    s_mov_b32 s72, 222208
    buffer_load_dwordx4 v193, s[44:47], s72 offen lds
    s_add_u32 m0, s65, 155648
    v_mfma_f32_16x16x32_bf16 v[116:119], v[56:59], v[68:71], v[116:119]
    s_mov_b32 s72, 295936
    buffer_load_dwordx4 v193, s[44:47], s72 offen lds
    s_waitcnt vmcnt(10)
    v_lshlrev_b32 v195, 16, v176
    v_mfma_f32_16x16x32_bf16 v[120:123], v[52:55], v[72:75], v[120:123]
    v_and_b32 v196, 0xffff0000, v176
    v_fma_f32 v195, v195, v184, v185
    v_fma_f32 v196, v196, v184, v185
    v_cvt_pk_bf16_f32 v176, v195, v196
    v_mfma_f32_16x16x32_bf16 v[124:127], v[56:59], v[72:75], v[124:127]
    v_lshlrev_b32 v195, 16, v177
    v_and_b32 v196, 0xffff0000, v177
    v_fma_f32 v195, v195, v184, v185
    v_fma_f32 v196, v196, v184, v185
    v_mfma_f32_16x16x32_bf16 v[128:131], v[52:55], v[76:79], v[128:131]
    v_cvt_pk_bf16_f32 v177, v195, v196
    v_lshlrev_b32 v195, 16, v178
    v_and_b32 v196, 0xffff0000, v178
    v_fma_f32 v195, v195, v184, v185
    v_mfma_f32_16x16x32_bf16 v[132:135], v[56:59], v[76:79], v[132:135]
    v_fma_f32 v196, v196, v184, v185
    v_cvt_pk_bf16_f32 v178, v195, v196
    v_lshlrev_b32 v195, 16, v179
    v_and_b32 v196, 0xffff0000, v179
    v_mfma_f32_16x16x32_bf16 v[136:139], v[52:55], v[80:83], v[136:139]
    v_fma_f32 v195, v195, v184, v185
    v_fma_f32 v196, v196, v184, v185
    v_cvt_pk_bf16_f32 v179, v195, v196
    ds_write_b128 v197, v[176:179] offset:0
    v_mfma_f32_16x16x32_bf16 v[140:143], v[56:59], v[80:83], v[140:143]
    v_lshlrev_b32 v195, 16, v180
    v_and_b32 v196, 0xffff0000, v180
    v_fma_f32 v195, v195, v186, v187
    v_fma_f32 v196, v196, v186, v187
    v_mfma_f32_16x16x32_bf16 v[144:147], v[52:55], v[84:87], v[144:147]
    v_cvt_pk_bf16_f32 v180, v195, v196
    v_lshlrev_b32 v195, 16, v181
    v_and_b32 v196, 0xffff0000, v181
    v_fma_f32 v195, v195, v186, v187
    v_mfma_f32_16x16x32_bf16 v[148:151], v[56:59], v[84:87], v[148:151]
    v_fma_f32 v196, v196, v186, v187
    v_cvt_pk_bf16_f32 v181, v195, v196
    v_lshlrev_b32 v195, 16, v182
    v_and_b32 v196, 0xffff0000, v182
    v_mfma_f32_16x16x32_bf16 v[152:155], v[52:55], v[88:91], v[152:155]
    v_fma_f32 v195, v195, v186, v187
    v_fma_f32 v196, v196, v186, v187
    v_cvt_pk_bf16_f32 v182, v195, v196
    v_lshlrev_b32 v195, 16, v183
    v_mfma_f32_16x16x32_bf16 v[156:159], v[56:59], v[88:91], v[156:159]
    v_and_b32 v196, 0xffff0000, v183
    v_fma_f32 v195, v195, v186, v187
    v_fma_f32 v196, v196, v186, v187
    v_cvt_pk_bf16_f32 v183, v195, v196
    v_mfma_f32_16x16x32_bf16 v[160:163], v[52:55], v[92:95], v[160:163]
    ds_write_b128 v197, v[180:183] offset:8192
    v_mfma_f32_16x16x32_bf16 v[164:167], v[56:59], v[92:95], v[164:167]
    s_waitcnt lgkmcnt(0)
    v_mfma_f32_16x16x32_bf16 v[96:99], v[8:11], v[16:19], v[96:99]
    ds_read_b128 v[52:55], v5 offset:0
    v_mfma_f32_16x16x32_bf16 v[100:103], v[12:15], v[16:19], v[100:103]
    ds_read_b128 v[56:59], v5 offset:2048
    v_mfma_f32_16x16x32_bf16 v[104:107], v[8:11], v[20:23], v[104:107]
    ds_read_b128 v[60:63], v3 offset:0
    v_mfma_f32_16x16x32_bf16 v[108:111], v[12:15], v[20:23], v[108:111]
    ds_read_b128 v[64:67], v3 offset:2048
    v_mfma_f32_16x16x32_bf16 v[112:115], v[8:11], v[24:27], v[112:115]
    ds_read_b128 v[68:71], v3 offset:4096
    v_mfma_f32_16x16x32_bf16 v[116:119], v[12:15], v[24:27], v[116:119]
    ds_read_b128 v[72:75], v3 offset:6144
    v_mfma_f32_16x16x32_bf16 v[120:123], v[8:11], v[28:31], v[120:123]
    ds_read_b128 v[76:79], v3 offset:8192
    v_mfma_f32_16x16x32_bf16 v[124:127], v[12:15], v[28:31], v[124:127]
    ds_read_b128 v[80:83], v3 offset:10240
    v_mfma_f32_16x16x32_bf16 v[128:131], v[8:11], v[32:35], v[128:131]
    ds_read_b128 v[84:87], v3 offset:12288
    v_mfma_f32_16x16x32_bf16 v[132:135], v[12:15], v[32:35], v[132:135]
    ds_read_b128 v[88:91], v3 offset:14336
    v_mfma_f32_16x16x32_bf16 v[136:139], v[8:11], v[36:39], v[136:139]
    ds_read_b128 v[92:95], v3 offset:16384
    v_mfma_f32_16x16x32_bf16 v[140:143], v[12:15], v[36:39], v[140:143]
    v_mfma_f32_16x16x32_bf16 v[144:147], v[8:11], v[40:43], v[144:147]
    v_mfma_f32_16x16x32_bf16 v[148:151], v[12:15], v[40:43], v[148:151]
    v_mfma_f32_16x16x32_bf16 v[152:155], v[8:11], v[44:47], v[152:155]
    v_mfma_f32_16x16x32_bf16 v[156:159], v[12:15], v[44:47], v[156:159]
    v_mfma_f32_16x16x32_bf16 v[160:163], v[8:11], v[48:51], v[160:163]
    v_mfma_f32_16x16x32_bf16 v[164:167], v[12:15], v[48:51], v[164:167]
    s_waitcnt vmcnt(5) lgkmcnt(0)
    s_barrier
    ds_read_b128 v[8:11], v198 offset:0
    v_mfma_f32_16x16x32_bf16 v[96:99], v[52:55], v[60:63], v[96:99]
    ds_read_b128 v[12:15], v198 offset:2048
    v_mfma_f32_16x16x32_bf16 v[100:103], v[56:59], v[60:63], v[100:103]
    ds_read_b128 v[16:19], v200 offset:0
    v_mfma_f32_16x16x32_bf16 v[104:107], v[52:55], v[64:67], v[104:107]
    ds_read_b128 v[20:23], v200 offset:2048
    v_mfma_f32_16x16x32_bf16 v[108:111], v[56:59], v[64:67], v[108:111]
    ds_read_b128 v[24:27], v200 offset:4096
    v_mfma_f32_16x16x32_bf16 v[112:115], v[52:55], v[68:71], v[112:115]
    ds_read_b128 v[28:31], v200 offset:6144
    v_mfma_f32_16x16x32_bf16 v[116:119], v[56:59], v[68:71], v[116:119]
    ds_read_b128 v[32:35], v200 offset:8192
    v_mfma_f32_16x16x32_bf16 v[120:123], v[52:55], v[72:75], v[120:123]
    ds_read_b128 v[36:39], v200 offset:10240
    v_mfma_f32_16x16x32_bf16 v[124:127], v[56:59], v[72:75], v[124:127]
    ds_read_b128 v[40:43], v200 offset:12288
    v_mfma_f32_16x16x32_bf16 v[128:131], v[52:55], v[76:79], v[128:131]
    ds_read_b128 v[44:47], v200 offset:14336
    v_mfma_f32_16x16x32_bf16 v[132:135], v[56:59], v[76:79], v[132:135]
    ds_read_b128 v[48:51], v200 offset:16384
    v_mfma_f32_16x16x32_bf16 v[136:139], v[52:55], v[80:83], v[136:139]
    v_mfma_f32_16x16x32_bf16 v[140:143], v[56:59], v[80:83], v[140:143]
    v_mfma_f32_16x16x32_bf16 v[144:147], v[52:55], v[84:87], v[144:147]
    v_mfma_f32_16x16x32_bf16 v[148:151], v[56:59], v[84:87], v[148:151]
    v_mfma_f32_16x16x32_bf16 v[152:155], v[52:55], v[88:91], v[152:155]
    v_mfma_f32_16x16x32_bf16 v[156:159], v[56:59], v[88:91], v[156:159]
    v_mfma_f32_16x16x32_bf16 v[160:163], v[52:55], v[92:95], v[160:163]
    v_mfma_f32_16x16x32_bf16 v[164:167], v[56:59], v[92:95], v[164:167]
    s_waitcnt lgkmcnt(0)
    v_mfma_f32_16x16x32_bf16 v[96:99], v[8:11], v[16:19], v[96:99]
    ds_read_b128 v[52:55], v199 offset:0
    v_mfma_f32_16x16x32_bf16 v[100:103], v[12:15], v[16:19], v[100:103]
    ds_read_b128 v[56:59], v199 offset:2048
    v_mfma_f32_16x16x32_bf16 v[104:107], v[8:11], v[20:23], v[104:107]
    ds_read_b128 v[60:63], v201 offset:0
    v_mfma_f32_16x16x32_bf16 v[108:111], v[12:15], v[20:23], v[108:111]
    ds_read_b128 v[64:67], v201 offset:2048
    v_mfma_f32_16x16x32_bf16 v[112:115], v[8:11], v[24:27], v[112:115]
    ds_read_b128 v[68:71], v201 offset:4096
    v_mfma_f32_16x16x32_bf16 v[116:119], v[12:15], v[24:27], v[116:119]
    ds_read_b128 v[72:75], v201 offset:6144
    v_mfma_f32_16x16x32_bf16 v[120:123], v[8:11], v[28:31], v[120:123]
    ds_read_b128 v[76:79], v201 offset:8192
    v_mfma_f32_16x16x32_bf16 v[124:127], v[12:15], v[28:31], v[124:127]
    ds_read_b128 v[80:83], v201 offset:10240
    v_mfma_f32_16x16x32_bf16 v[128:131], v[8:11], v[32:35], v[128:131]
    ds_read_b128 v[84:87], v201 offset:12288
    v_mfma_f32_16x16x32_bf16 v[132:135], v[12:15], v[32:35], v[132:135]
    ds_read_b128 v[88:91], v201 offset:14336
    v_mfma_f32_16x16x32_bf16 v[136:139], v[8:11], v[36:39], v[136:139]
    ds_read_b128 v[92:95], v201 offset:16384
    v_mfma_f32_16x16x32_bf16 v[140:143], v[12:15], v[36:39], v[140:143]
    v_mfma_f32_16x16x32_bf16 v[144:147], v[8:11], v[40:43], v[144:147]
    v_mfma_f32_16x16x32_bf16 v[148:151], v[12:15], v[40:43], v[148:151]
    v_mfma_f32_16x16x32_bf16 v[152:155], v[8:11], v[44:47], v[152:155]
    v_mfma_f32_16x16x32_bf16 v[156:159], v[12:15], v[44:47], v[156:159]
    v_mfma_f32_16x16x32_bf16 v[160:163], v[8:11], v[48:51], v[160:163]
    v_mfma_f32_16x16x32_bf16 v[164:167], v[12:15], v[48:51], v[164:167]
    s_waitcnt vmcnt(0) lgkmcnt(0)
    s_barrier
    ds_read_b128 v[8:11], v202 offset:0
    v_mfma_f32_16x16x32_bf16 v[96:99], v[52:55], v[60:63], v[96:99]
    ds_read_b128 v[12:15], v202 offset:2048
    v_mfma_f32_16x16x32_bf16 v[100:103], v[56:59], v[60:63], v[100:103]
    ds_read_b128 v[16:19], v204 offset:0
    v_mfma_f32_16x16x32_bf16 v[104:107], v[52:55], v[64:67], v[104:107]
    ds_read_b128 v[20:23], v204 offset:2048
    v_mfma_f32_16x16x32_bf16 v[108:111], v[56:59], v[64:67], v[108:111]
    ds_read_b128 v[24:27], v204 offset:4096
    v_mfma_f32_16x16x32_bf16 v[112:115], v[52:55], v[68:71], v[112:115]
    ds_read_b128 v[28:31], v204 offset:6144
    v_mfma_f32_16x16x32_bf16 v[116:119], v[56:59], v[68:71], v[116:119]
    ds_read_b128 v[32:35], v204 offset:8192
    v_mfma_f32_16x16x32_bf16 v[120:123], v[52:55], v[72:75], v[120:123]
    ds_read_b128 v[36:39], v204 offset:10240
    v_mfma_f32_16x16x32_bf16 v[124:127], v[56:59], v[72:75], v[124:127]
    ds_read_b128 v[40:43], v204 offset:12288
    v_mfma_f32_16x16x32_bf16 v[128:131], v[52:55], v[76:79], v[128:131]
    ds_read_b128 v[44:47], v204 offset:14336
    v_mfma_f32_16x16x32_bf16 v[132:135], v[56:59], v[76:79], v[132:135]
    ds_read_b128 v[48:51], v204 offset:16384
    v_mfma_f32_16x16x32_bf16 v[136:139], v[52:55], v[80:83], v[136:139]
    v_mfma_f32_16x16x32_bf16 v[140:143], v[56:59], v[80:83], v[140:143]
    v_mfma_f32_16x16x32_bf16 v[144:147], v[52:55], v[84:87], v[144:147]
    v_mfma_f32_16x16x32_bf16 v[148:151], v[56:59], v[84:87], v[148:151]
    v_mfma_f32_16x16x32_bf16 v[152:155], v[52:55], v[88:91], v[152:155]
    v_mfma_f32_16x16x32_bf16 v[156:159], v[56:59], v[88:91], v[156:159]
    v_mfma_f32_16x16x32_bf16 v[160:163], v[52:55], v[92:95], v[160:163]
    v_mfma_f32_16x16x32_bf16 v[164:167], v[56:59], v[92:95], v[164:167]
    s_waitcnt lgkmcnt(0)
    v_mfma_f32_16x16x32_bf16 v[96:99], v[8:11], v[16:19], v[96:99]
    ds_read_b128 v[52:55], v203 offset:0
    v_mfma_f32_16x16x32_bf16 v[100:103], v[12:15], v[16:19], v[100:103]
    ds_read_b128 v[56:59], v203 offset:2048
    v_mfma_f32_16x16x32_bf16 v[104:107], v[8:11], v[20:23], v[104:107]
    ds_read_b128 v[60:63], v205 offset:0
    v_mfma_f32_16x16x32_bf16 v[108:111], v[12:15], v[20:23], v[108:111]
    ds_read_b128 v[64:67], v205 offset:2048
    v_mfma_f32_16x16x32_bf16 v[112:115], v[8:11], v[24:27], v[112:115]
    ds_read_b128 v[68:71], v205 offset:4096
    v_mfma_f32_16x16x32_bf16 v[116:119], v[12:15], v[24:27], v[116:119]
    ds_read_b128 v[72:75], v205 offset:6144
    v_mfma_f32_16x16x32_bf16 v[120:123], v[8:11], v[28:31], v[120:123]
    ds_read_b128 v[76:79], v205 offset:8192
    v_mfma_f32_16x16x32_bf16 v[124:127], v[12:15], v[28:31], v[124:127]
    ds_read_b128 v[80:83], v205 offset:10240
    v_mfma_f32_16x16x32_bf16 v[128:131], v[8:11], v[32:35], v[128:131]
    ds_read_b128 v[84:87], v205 offset:12288
    v_mfma_f32_16x16x32_bf16 v[132:135], v[12:15], v[32:35], v[132:135]
    ds_read_b128 v[88:91], v205 offset:14336
    v_mfma_f32_16x16x32_bf16 v[136:139], v[8:11], v[36:39], v[136:139]
    ds_read_b128 v[92:95], v205 offset:16384
    v_mfma_f32_16x16x32_bf16 v[140:143], v[12:15], v[36:39], v[140:143]
    v_mfma_f32_16x16x32_bf16 v[144:147], v[8:11], v[40:43], v[144:147]
    v_mfma_f32_16x16x32_bf16 v[148:151], v[12:15], v[40:43], v[148:151]
    v_mfma_f32_16x16x32_bf16 v[152:155], v[8:11], v[44:47], v[152:155]
    v_mfma_f32_16x16x32_bf16 v[156:159], v[12:15], v[44:47], v[156:159]
    v_mfma_f32_16x16x32_bf16 v[160:163], v[8:11], v[48:51], v[160:163]
    v_mfma_f32_16x16x32_bf16 v[164:167], v[12:15], v[48:51], v[164:167]
    s_waitcnt vmcnt(0) lgkmcnt(0)
    s_barrier
    v_mfma_f32_16x16x32_bf16 v[96:99], v[52:55], v[60:63], v[96:99]
    v_mfma_f32_16x16x32_bf16 v[100:103], v[56:59], v[60:63], v[100:103]
    v_mfma_f32_16x16x32_bf16 v[104:107], v[52:55], v[64:67], v[104:107]
    v_mfma_f32_16x16x32_bf16 v[108:111], v[56:59], v[64:67], v[108:111]
    v_mfma_f32_16x16x32_bf16 v[112:115], v[52:55], v[68:71], v[112:115]
    v_mfma_f32_16x16x32_bf16 v[116:119], v[56:59], v[68:71], v[116:119]
    v_mfma_f32_16x16x32_bf16 v[120:123], v[52:55], v[72:75], v[120:123]
    v_mfma_f32_16x16x32_bf16 v[124:127], v[56:59], v[72:75], v[124:127]
    v_mfma_f32_16x16x32_bf16 v[128:131], v[52:55], v[76:79], v[128:131]
    v_mfma_f32_16x16x32_bf16 v[132:135], v[56:59], v[76:79], v[132:135]
    v_mfma_f32_16x16x32_bf16 v[136:139], v[52:55], v[80:83], v[136:139]
    v_mfma_f32_16x16x32_bf16 v[140:143], v[56:59], v[80:83], v[140:143]
    v_mfma_f32_16x16x32_bf16 v[144:147], v[52:55], v[84:87], v[144:147]
    v_mfma_f32_16x16x32_bf16 v[148:151], v[56:59], v[84:87], v[148:151]
    v_mfma_f32_16x16x32_bf16 v[152:155], v[52:55], v[88:91], v[152:155]
    v_mfma_f32_16x16x32_bf16 v[156:159], v[56:59], v[88:91], v[156:159]
    v_mfma_f32_16x16x32_bf16 v[160:163], v[52:55], v[92:95], v[160:163]
    v_mfma_f32_16x16x32_bf16 v[164:167], v[56:59], v[92:95], v[164:167]
    s_waitcnt vmcnt(0) lgkmcnt(0)
    s_barrier
    s_branch b1_kernel_z2epi
b1_kernel_z2q4:
    s_add_u32 m0, s65, 16384
    s_mov_b32 s72, 0
    buffer_load_dwordx4 v193, s[44:47], s72 offen lds
    s_add_u32 m0, s65, 24576
    s_mov_b32 s72, 73728
    buffer_load_dwordx4 v193, s[44:47], s72 offen lds
    s_add_u32 m0, s65, 32768
    s_mov_b32 s72, 147456
    buffer_load_dwordx4 v193, s[44:47], s72 offen lds
    s_add_u32 m0, s65, 40960
    s_mov_b32 s72, 221184
    buffer_load_dwordx4 v193, s[44:47], s72 offen lds
    s_add_u32 m0, s65, 69632
    s_mov_b32 s72, 128
    buffer_load_dwordx4 v193, s[44:47], s72 offen lds
    s_add_u32 m0, s65, 77824
    s_mov_b32 s72, 73856
    buffer_load_dwordx4 v193, s[44:47], s72 offen lds
    s_add_u32 m0, s65, 86016
    s_mov_b32 s72, 147584
    buffer_load_dwordx4 v193, s[44:47], s72 offen lds
    s_add_u32 m0, s65, 94208
    s_mov_b32 s72, 221312
    buffer_load_dwordx4 v193, s[44:47], s72 offen lds
    s_add_u32 m0, s65, 122880
    s_mov_b32 s72, 256
    buffer_load_dwordx4 v193, s[44:47], s72 offen lds
    s_add_u32 m0, s65, 131072
    s_mov_b32 s72, 73984
    buffer_load_dwordx4 v193, s[44:47], s72 offen lds
    s_add_u32 m0, s65, 139264
    s_mov_b32 s72, 147712
    buffer_load_dwordx4 v193, s[44:47], s72 offen lds
    s_add_u32 m0, s65, 147456
    s_mov_b32 s72, 221440
    buffer_load_dwordx4 v193, s[44:47], s72 offen lds
    s_mov_b32 s72, 384
    buffer_load_dwordx4 v[168:171], v192, s[40:43], s72 offen
    s_mov_b32 s72, 74112
    buffer_load_dwordx4 v[172:175], v192, s[40:43], s72 offen
    s_mov_b32 s72, 512
    buffer_load_dwordx4 v[176:179], v192, s[40:43], s72 offen
    s_mov_b32 s72, 74240
    buffer_load_dwordx4 v[180:183], v192, s[40:43], s72 offen
    s_mov_b32 s87, 0x3ae38e39
    s_waitcnt vmcnt(22)
    v_add_f32 v8, v8, v10
    v_add_f32 v9, v9, v11
    v_add_f32 v8, v8, v12
    v_add_f32 v9, v9, v13
    v_add_f32 v8, v8, v14
    v_add_f32 v9, v9, v15
    v_add_f32 v8, v8, v16
    v_add_f32 v9, v9, v17
    v_add_f32 v8, v8, v18
    v_add_f32 v9, v9, v19
    v_add_f32 v8, v8, v20
    v_add_f32 v9, v9, v21
    v_add_f32 v8, v8, v22
    v_add_f32 v9, v9, v23
    v_mul_f32 v8, s87, v8
    v_mul_f32 v9, s87, v9
    v_fma_f32 v9, -v8, v8, v9
    v_max_f32 v9, 0, v9
    v_add_f32 v9, 0x3727c5ac, v9
    v_rsq_f32 v184, v9
    s_nop 0
    v_mul_f32 v185, v8, v184
    v_sub_f32 v185, 0, v185
    v_add_f32 v24, v24, v26
    v_add_f32 v25, v25, v27
    v_add_f32 v24, v24, v28
    v_add_f32 v25, v25, v29
    v_add_f32 v24, v24, v30
    v_add_f32 v25, v25, v31
    v_add_f32 v24, v24, v32
    v_add_f32 v25, v25, v33
    v_add_f32 v24, v24, v34
    v_add_f32 v25, v25, v35
    v_add_f32 v24, v24, v36
    v_add_f32 v25, v25, v37
    v_add_f32 v24, v24, v38
    v_add_f32 v25, v25, v39
    v_mul_f32 v24, s87, v24
    v_mul_f32 v25, s87, v25
    v_fma_f32 v25, -v24, v24, v25
    v_max_f32 v25, 0, v25
    v_add_f32 v25, 0x3727c5ac, v25
    v_rsq_f32 v186, v25
    s_nop 0
    v_mul_f32 v187, v24, v186
    v_sub_f32 v187, 0, v187
    s_waitcnt vmcnt(16)
    v_lshlrev_b32 v195, 16, v48
    v_and_b32 v196, 0xffff0000, v48
    v_fma_f32 v195, v195, v184, v185
    v_fma_f32 v196, v196, v184, v185
    v_cvt_pk_bf16_f32 v48, v195, v196
    v_lshlrev_b32 v195, 16, v49
    v_and_b32 v196, 0xffff0000, v49
    v_fma_f32 v195, v195, v184, v185
    v_fma_f32 v196, v196, v184, v185
    v_cvt_pk_bf16_f32 v49, v195, v196
    v_lshlrev_b32 v195, 16, v50
    v_and_b32 v196, 0xffff0000, v50
    v_fma_f32 v195, v195, v184, v185
    v_fma_f32 v196, v196, v184, v185
    v_cvt_pk_bf16_f32 v50, v195, v196
    v_lshlrev_b32 v195, 16, v51
    v_and_b32 v196, 0xffff0000, v51
    v_fma_f32 v195, v195, v184, v185
    v_fma_f32 v196, v196, v184, v185
    v_cvt_pk_bf16_f32 v51, v195, v196
    ds_write_b128 v194, v[48:51] offset:0
    v_lshlrev_b32 v195, 16, v52
    v_and_b32 v196, 0xffff0000, v52
    v_fma_f32 v195, v195, v186, v187
    v_fma_f32 v196, v196, v186, v187
    v_cvt_pk_bf16_f32 v52, v195, v196
    v_lshlrev_b32 v195, 16, v53
    v_and_b32 v196, 0xffff0000, v53
    v_fma_f32 v195, v195, v186, v187
    v_fma_f32 v196, v196, v186, v187
    v_cvt_pk_bf16_f32 v53, v195, v196
    v_lshlrev_b32 v195, 16, v54
    v_and_b32 v196, 0xffff0000, v54
    v_fma_f32 v195, v195, v186, v187
    v_fma_f32 v196, v196, v186, v187
    v_cvt_pk_bf16_f32 v54, v195, v196
    v_lshlrev_b32 v195, 16, v55
    v_and_b32 v196, 0xffff0000, v55
    v_fma_f32 v195, v195, v186, v187
    v_fma_f32 v196, v196, v186, v187
    v_cvt_pk_bf16_f32 v55, v195, v196
    ds_write_b128 v194, v[52:55] offset:8192
    v_lshlrev_b32 v195, 16, v56
    v_and_b32 v196, 0xffff0000, v56
    v_fma_f32 v195, v195, v184, v185
    v_fma_f32 v196, v196, v184, v185
    v_cvt_pk_bf16_f32 v56, v195, v196
    v_lshlrev_b32 v195, 16, v57
    v_and_b32 v196, 0xffff0000, v57
    v_fma_f32 v195, v195, v184, v185
    v_fma_f32 v196, v196, v184, v185
    v_cvt_pk_bf16_f32 v57, v195, v196
    v_lshlrev_b32 v195, 16, v58
    v_and_b32 v196, 0xffff0000, v58
    v_fma_f32 v195, v195, v184, v185
    v_fma_f32 v196, v196, v184, v185
    v_cvt_pk_bf16_f32 v58, v195, v196
    v_lshlrev_b32 v195, 16, v59
    v_and_b32 v196, 0xffff0000, v59
    v_fma_f32 v195, v195, v184, v185
    v_fma_f32 v196, v196, v184, v185
    v_cvt_pk_bf16_f32 v59, v195, v196
    ds_write_b128 v194, v[56:59] offset:53248
    v_lshlrev_b32 v195, 16, v60
    v_and_b32 v196, 0xffff0000, v60
    v_fma_f32 v195, v195, v186, v187
    v_fma_f32 v196, v196, v186, v187
    v_cvt_pk_bf16_f32 v60, v195, v196
    v_lshlrev_b32 v195, 16, v61
    v_and_b32 v196, 0xffff0000, v61
    v_fma_f32 v195, v195, v186, v187
    v_fma_f32 v196, v196, v186, v187
    v_cvt_pk_bf16_f32 v61, v195, v196
    v_lshlrev_b32 v195, 16, v62
    v_and_b32 v196, 0xffff0000, v62
    v_fma_f32 v195, v195, v186, v187
    v_fma_f32 v196, v196, v186, v187
    v_cvt_pk_bf16_f32 v62, v195, v196
    v_lshlrev_b32 v195, 16, v63
    v_and_b32 v196, 0xffff0000, v63
    v_fma_f32 v195, v195, v186, v187
    v_fma_f32 v196, v196, v186, v187
    v_cvt_pk_bf16_f32 v63, v195, v196
    ds_write_b128 v194, v[60:63] offset:61440
    v_lshlrev_b32 v195, 16, v64
    v_and_b32 v196, 0xffff0000, v64
    v_fma_f32 v195, v195, v184, v185
    v_fma_f32 v196, v196, v184, v185
    v_cvt_pk_bf16_f32 v64, v195, v196
    v_lshlrev_b32 v195, 16, v65
    v_and_b32 v196, 0xffff0000, v65
    v_fma_f32 v195, v195, v184, v185
    v_fma_f32 v196, v196, v184, v185
    v_cvt_pk_bf16_f32 v65, v195, v196
    v_lshlrev_b32 v195, 16, v66
    v_and_b32 v196, 0xffff0000, v66
    v_fma_f32 v195, v195, v184, v185
    v_fma_f32 v196, v196, v184, v185
    v_cvt_pk_bf16_f32 v66, v195, v196
    v_lshlrev_b32 v195, 16, v67
    v_and_b32 v196, 0xffff0000, v67
    v_fma_f32 v195, v195, v184, v185
    v_fma_f32 v196, v196, v184, v185
    v_cvt_pk_bf16_f32 v67, v195, v196
    ds_write_b128 v197, v[64:67] offset:0
    v_lshlrev_b32 v195, 16, v68
    v_and_b32 v196, 0xffff0000, v68
    v_fma_f32 v195, v195, v186, v187
    v_fma_f32 v196, v196, v186, v187
    v_cvt_pk_bf16_f32 v68, v195, v196
    v_lshlrev_b32 v195, 16, v69
    v_and_b32 v196, 0xffff0000, v69
    v_fma_f32 v195, v195, v186, v187
    v_fma_f32 v196, v196, v186, v187
    v_cvt_pk_bf16_f32 v69, v195, v196
    v_lshlrev_b32 v195, 16, v70
    v_and_b32 v196, 0xffff0000, v70
    v_fma_f32 v195, v195, v186, v187
    v_fma_f32 v196, v196, v186, v187
    v_cvt_pk_bf16_f32 v70, v195, v196
    v_lshlrev_b32 v195, 16, v71
    v_and_b32 v196, 0xffff0000, v71
    v_fma_f32 v195, v195, v186, v187
    v_fma_f32 v196, v196, v186, v187
    v_cvt_pk_bf16_f32 v71, v195, v196
    ds_write_b128 v197, v[68:71] offset:8192
    v_and_b32 v8, 15, v1
    v_lshlrev_b32 v8, 3, v8
    v_lshrrev_b32 v9, 4, v1
    v_lshrrev_b32 v10, 1, v1
    v_and_b32 v10, 7, v10
    v_xor_b32 v9, v9, v10
    v_add_u32 v8, v8, v9
    v_lshlrev_b32 v2, 4, v8
    v_xor_b32 v3, 64, v2
    s_lshl_b32 s68, s70, 12
    v_add_u32 v4, s68, v2
    v_add_u32 v5, s68, v3
    s_mul_i32 s68, s71, 18432
    s_add_u32 s68, s68, 16384
    v_add_u32 v2, s68, v2
    v_add_u32 v3, s68, v3
    v_add_u32 v198, 53248, v4
    v_add_u32 v199, 53248, v5
    v_add_u32 v200, 53248, v2
    v_add_u32 v201, 53248, v3
    v_add_u32 v202, 106496, v4
    v_add_u32 v203, 106496, v5
    v_add_u32 v204, 106496, v2
    v_add_u32 v205, 106496, v3
    v_mov_b32 v96, 0
    v_mov_b32 v97, 0
    v_mov_b32 v98, 0
    v_mov_b32 v99, 0
    v_mov_b32 v100, 0
    v_mov_b32 v101, 0
    v_mov_b32 v102, 0
    v_mov_b32 v103, 0
    v_mov_b32 v104, 0
    v_mov_b32 v105, 0
    v_mov_b32 v106, 0
    v_mov_b32 v107, 0
    v_mov_b32 v108, 0
    v_mov_b32 v109, 0
    v_mov_b32 v110, 0
    v_mov_b32 v111, 0
    v_mov_b32 v112, 0
    v_mov_b32 v113, 0
    v_mov_b32 v114, 0
    v_mov_b32 v115, 0
    v_mov_b32 v116, 0
    v_mov_b32 v117, 0
    v_mov_b32 v118, 0
    v_mov_b32 v119, 0
    v_mov_b32 v120, 0
    v_mov_b32 v121, 0
    v_mov_b32 v122, 0
    v_mov_b32 v123, 0
    v_mov_b32 v124, 0
    v_mov_b32 v125, 0
    v_mov_b32 v126, 0
    v_mov_b32 v127, 0
    v_mov_b32 v128, 0
    v_mov_b32 v129, 0
    v_mov_b32 v130, 0
    v_mov_b32 v131, 0
    v_mov_b32 v132, 0
    v_mov_b32 v133, 0
    v_mov_b32 v134, 0
    v_mov_b32 v135, 0
    v_mov_b32 v136, 0
    v_mov_b32 v137, 0
    v_mov_b32 v138, 0
    v_mov_b32 v139, 0
    v_mov_b32 v140, 0
    v_mov_b32 v141, 0
    v_mov_b32 v142, 0
    v_mov_b32 v143, 0
    v_mov_b32 v144, 0
    v_mov_b32 v145, 0
    v_mov_b32 v146, 0
    v_mov_b32 v147, 0
    v_mov_b32 v148, 0
    v_mov_b32 v149, 0
    v_mov_b32 v150, 0
    v_mov_b32 v151, 0
    v_mov_b32 v152, 0
    v_mov_b32 v153, 0
    v_mov_b32 v154, 0
    v_mov_b32 v155, 0
    v_mov_b32 v156, 0
    v_mov_b32 v157, 0
    v_mov_b32 v158, 0
    v_mov_b32 v159, 0
    v_mov_b32 v160, 0
    v_mov_b32 v161, 0
    v_mov_b32 v162, 0
    v_mov_b32 v163, 0
    v_mov_b32 v164, 0
    v_mov_b32 v165, 0
    v_mov_b32 v166, 0
    v_mov_b32 v167, 0
    s_waitcnt vmcnt(12) lgkmcnt(0)
    s_barrier
    ds_read_b128 v[8:11], v4 offset:0
    ds_read_b128 v[12:15], v4 offset:2048
    ds_read_b128 v[16:19], v2 offset:0
    ds_read_b128 v[20:23], v2 offset:2048
    ds_read_b128 v[24:27], v2 offset:4096
    ds_read_b128 v[28:31], v2 offset:6144
    ds_read_b128 v[32:35], v2 offset:8192
    ds_read_b128 v[36:39], v2 offset:10240
    ds_read_b128 v[40:43], v2 offset:12288
    ds_read_b128 v[44:47], v2 offset:14336
    ds_read_b128 v[48:51], v2 offset:16384
    s_waitcnt lgkmcnt(0)
    v_mfma_f32_16x16x32_bf16 v[96:99], v[8:11], v[16:19], v[96:99]
    ds_read_b128 v[52:55], v5 offset:0
    v_mfma_f32_16x16x32_bf16 v[100:103], v[12:15], v[16:19], v[100:103]
    ds_read_b128 v[56:59], v5 offset:2048
    v_mfma_f32_16x16x32_bf16 v[104:107], v[8:11], v[20:23], v[104:107]
    ds_read_b128 v[60:63], v3 offset:0
    v_mfma_f32_16x16x32_bf16 v[108:111], v[12:15], v[20:23], v[108:111]
    ds_read_b128 v[64:67], v3 offset:2048
    v_mfma_f32_16x16x32_bf16 v[112:115], v[8:11], v[24:27], v[112:115]
    ds_read_b128 v[68:71], v3 offset:4096
    v_mfma_f32_16x16x32_bf16 v[116:119], v[12:15], v[24:27], v[116:119]
    ds_read_b128 v[72:75], v3 offset:6144
    v_mfma_f32_16x16x32_bf16 v[120:123], v[8:11], v[28:31], v[120:123]
    ds_read_b128 v[76:79], v3 offset:8192
    v_mfma_f32_16x16x32_bf16 v[124:127], v[12:15], v[28:31], v[124:127]
    ds_read_b128 v[80:83], v3 offset:10240
    v_mfma_f32_16x16x32_bf16 v[128:131], v[8:11], v[32:35], v[128:131]
    ds_read_b128 v[84:87], v3 offset:12288
    v_mfma_f32_16x16x32_bf16 v[132:135], v[12:15], v[32:35], v[132:135]
    ds_read_b128 v[88:91], v3 offset:14336
    v_mfma_f32_16x16x32_bf16 v[136:139], v[8:11], v[36:39], v[136:139]
    ds_read_b128 v[92:95], v3 offset:16384
    v_mfma_f32_16x16x32_bf16 v[140:143], v[12:15], v[36:39], v[140:143]
    v_mfma_f32_16x16x32_bf16 v[144:147], v[8:11], v[40:43], v[144:147]
    v_mfma_f32_16x16x32_bf16 v[148:151], v[12:15], v[40:43], v[148:151]
    v_mfma_f32_16x16x32_bf16 v[152:155], v[8:11], v[44:47], v[152:155]
    v_mfma_f32_16x16x32_bf16 v[156:159], v[12:15], v[44:47], v[156:159]
    v_mfma_f32_16x16x32_bf16 v[160:163], v[8:11], v[48:51], v[160:163]
    v_mfma_f32_16x16x32_bf16 v[164:167], v[12:15], v[48:51], v[164:167]
    s_waitcnt vmcnt(8) lgkmcnt(0)
    s_barrier
    ds_read_b128 v[8:11], v198 offset:0
    ds_read_b128 v[12:15], v198 offset:2048
    ds_read_b128 v[16:19], v200 offset:0
    ds_read_b128 v[20:23], v200 offset:2048
    v_mfma_f32_16x16x32_bf16 v[96:99], v[52:55], v[60:63], v[96:99]
    ds_read_b128 v[24:27], v200 offset:4096
    ds_read_b128 v[28:31], v200 offset:6144
    ds_read_b128 v[32:35], v200 offset:8192
    ds_read_b128 v[36:39], v200 offset:10240
    v_mfma_f32_16x16x32_bf16 v[100:103], v[56:59], v[60:63], v[100:103]
    ds_read_b128 v[40:43], v200 offset:12288
    ds_read_b128 v[44:47], v200 offset:14336
    ds_read_b128 v[48:51], v200 offset:16384
    s_add_u32 m0, s65, 16384
    v_mfma_f32_16x16x32_bf16 v[104:107], v[52:55], v[64:67], v[104:107]
    s_mov_b32 s72, 384
    buffer_load_dwordx4 v193, s[44:47], s72 offen lds
    s_add_u32 m0, s65, 24576
    s_mov_b32 s72, 74112
    v_mfma_f32_16x16x32_bf16 v[108:111], v[56:59], v[64:67], v[108:111]
    buffer_load_dwordx4 v193, s[44:47], s72 offen lds
    s_add_u32 m0, s65, 32768
    s_mov_b32 s72, 147840
    buffer_load_dwordx4 v193, s[44:47], s72 offen lds
    v_mfma_f32_16x16x32_bf16 v[112:115], v[52:55], v[68:71], v[112:115]
    s_add_u32 m0, s65, 40960
    s_mov_b32 s72, 221568
    buffer_load_dwordx4 v193, s[44:47], s72 offen lds
    s_waitcnt vmcnt(6)
    v_mfma_f32_16x16x32_bf16 v[116:119], v[56:59], v[68:71], v[116:119]
    v_lshlrev_b32 v195, 16, v168
    v_and_b32 v196, 0xffff0000, v168
    v_fma_f32 v195, v195, v184, v185
    v_fma_f32 v196, v196, v184, v185
    v_mfma_f32_16x16x32_bf16 v[120:123], v[52:55], v[72:75], v[120:123]
    v_cvt_pk_bf16_f32 v168, v195, v196
    v_lshlrev_b32 v195, 16, v169
    v_and_b32 v196, 0xffff0000, v169
    v_fma_f32 v195, v195, v184, v185
    v_mfma_f32_16x16x32_bf16 v[124:127], v[56:59], v[72:75], v[124:127]
    v_fma_f32 v196, v196, v184, v185
    v_cvt_pk_bf16_f32 v169, v195, v196
    v_lshlrev_b32 v195, 16, v170
    v_and_b32 v196, 0xffff0000, v170
    v_mfma_f32_16x16x32_bf16 v[128:131], v[52:55], v[76:79], v[128:131]
    v_fma_f32 v195, v195, v184, v185
    v_fma_f32 v196, v196, v184, v185
    v_cvt_pk_bf16_f32 v170, v195, v196
    v_lshlrev_b32 v195, 16, v171
    v_mfma_f32_16x16x32_bf16 v[132:135], v[56:59], v[76:79], v[132:135]
    v_and_b32 v196, 0xffff0000, v171
    v_fma_f32 v195, v195, v184, v185
    v_fma_f32 v196, v196, v184, v185
    v_cvt_pk_bf16_f32 v171, v195, v196
    v_mfma_f32_16x16x32_bf16 v[136:139], v[52:55], v[80:83], v[136:139]
    ds_write_b128 v194, v[168:171] offset:0
    v_lshlrev_b32 v195, 16, v172
    v_and_b32 v196, 0xffff0000, v172
    v_fma_f32 v195, v195, v186, v187
    v_mfma_f32_16x16x32_bf16 v[140:143], v[56:59], v[80:83], v[140:143]
    v_fma_f32 v196, v196, v186, v187
    v_cvt_pk_bf16_f32 v172, v195, v196
    v_lshlrev_b32 v195, 16, v173
    v_and_b32 v196, 0xffff0000, v173
    v_mfma_f32_16x16x32_bf16 v[144:147], v[52:55], v[84:87], v[144:147]
    v_fma_f32 v195, v195, v186, v187
    v_fma_f32 v196, v196, v186, v187
    v_cvt_pk_bf16_f32 v173, v195, v196
    v_lshlrev_b32 v195, 16, v174
    v_mfma_f32_16x16x32_bf16 v[148:151], v[56:59], v[84:87], v[148:151]
    v_and_b32 v196, 0xffff0000, v174
    v_fma_f32 v195, v195, v186, v187
    v_fma_f32 v196, v196, v186, v187
    v_cvt_pk_bf16_f32 v174, v195, v196
    v_mfma_f32_16x16x32_bf16 v[152:155], v[52:55], v[88:91], v[152:155]
    v_lshlrev_b32 v195, 16, v175
    v_and_b32 v196, 0xffff0000, v175
    v_fma_f32 v195, v195, v186, v187
    v_fma_f32 v196, v196, v186, v187
    v_mfma_f32_16x16x32_bf16 v[156:159], v[56:59], v[88:91], v[156:159]
    v_cvt_pk_bf16_f32 v175, v195, v196
    ds_write_b128 v194, v[172:175] offset:8192
    s_mov_b32 s72, 640
    buffer_load_dwordx4 v[168:171], v192, s[40:43], s72 offen
    v_mfma_f32_16x16x32_bf16 v[160:163], v[52:55], v[92:95], v[160:163]
    s_mov_b32 s72, 74368
    buffer_load_dwordx4 v[172:175], v192, s[40:43], s72 offen
    v_mfma_f32_16x16x32_bf16 v[164:167], v[56:59], v[92:95], v[164:167]
    s_waitcnt lgkmcnt(0)
    v_mfma_f32_16x16x32_bf16 v[96:99], v[8:11], v[16:19], v[96:99]
    ds_read_b128 v[52:55], v199 offset:0
    v_mfma_f32_16x16x32_bf16 v[100:103], v[12:15], v[16:19], v[100:103]
    ds_read_b128 v[56:59], v199 offset:2048
    v_mfma_f32_16x16x32_bf16 v[104:107], v[8:11], v[20:23], v[104:107]
    ds_read_b128 v[60:63], v201 offset:0
    v_mfma_f32_16x16x32_bf16 v[108:111], v[12:15], v[20:23], v[108:111]
    ds_read_b128 v[64:67], v201 offset:2048
    v_mfma_f32_16x16x32_bf16 v[112:115], v[8:11], v[24:27], v[112:115]
    ds_read_b128 v[68:71], v201 offset:4096
    v_mfma_f32_16x16x32_bf16 v[116:119], v[12:15], v[24:27], v[116:119]
    ds_read_b128 v[72:75], v201 offset:6144
    v_mfma_f32_16x16x32_bf16 v[120:123], v[8:11], v[28:31], v[120:123]
    ds_read_b128 v[76:79], v201 offset:8192
    v_mfma_f32_16x16x32_bf16 v[124:127], v[12:15], v[28:31], v[124:127]
    ds_read_b128 v[80:83], v201 offset:10240
    v_mfma_f32_16x16x32_bf16 v[128:131], v[8:11], v[32:35], v[128:131]
    ds_read_b128 v[84:87], v201 offset:12288
    v_mfma_f32_16x16x32_bf16 v[132:135], v[12:15], v[32:35], v[132:135]
    ds_read_b128 v[88:91], v201 offset:14336
    v_mfma_f32_16x16x32_bf16 v[136:139], v[8:11], v[36:39], v[136:139]
    ds_read_b128 v[92:95], v201 offset:16384
    v_mfma_f32_16x16x32_bf16 v[140:143], v[12:15], v[36:39], v[140:143]
    v_mfma_f32_16x16x32_bf16 v[144:147], v[8:11], v[40:43], v[144:147]
    v_mfma_f32_16x16x32_bf16 v[148:151], v[12:15], v[40:43], v[148:151]
    v_mfma_f32_16x16x32_bf16 v[152:155], v[8:11], v[44:47], v[152:155]
    v_mfma_f32_16x16x32_bf16 v[156:159], v[12:15], v[44:47], v[156:159]
    v_mfma_f32_16x16x32_bf16 v[160:163], v[8:11], v[48:51], v[160:163]
    v_mfma_f32_16x16x32_bf16 v[164:167], v[12:15], v[48:51], v[164:167]
    s_waitcnt vmcnt(10) lgkmcnt(0)
    s_barrier
    ds_read_b128 v[8:11], v202 offset:0
    ds_read_b128 v[12:15], v202 offset:2048
    ds_read_b128 v[16:19], v204 offset:0
    ds_read_b128 v[20:23], v204 offset:2048
    v_mfma_f32_16x16x32_bf16 v[96:99], v[52:55], v[60:63], v[96:99]
    ds_read_b128 v[24:27], v204 offset:4096
    ds_read_b128 v[28:31], v204 offset:6144
    ds_read_b128 v[32:35], v204 offset:8192
    ds_read_b128 v[36:39], v204 offset:10240
    v_mfma_f32_16x16x32_bf16 v[100:103], v[56:59], v[60:63], v[100:103]
    ds_read_b128 v[40:43], v204 offset:12288
    ds_read_b128 v[44:47], v204 offset:14336
    ds_read_b128 v[48:51], v204 offset:16384
    s_add_u32 m0, s65, 69632
    v_mfma_f32_16x16x32_bf16 v[104:107], v[52:55], v[64:67], v[104:107]
    s_mov_b32 s72, 512
    buffer_load_dwordx4 v193, s[44:47], s72 offen lds
    s_add_u32 m0, s65, 77824
    s_mov_b32 s72, 74240
    v_mfma_f32_16x16x32_bf16 v[108:111], v[56:59], v[64:67], v[108:111]
    buffer_load_dwordx4 v193, s[44:47], s72 offen lds
    s_add_u32 m0, s65, 86016
    s_mov_b32 s72, 147968
    buffer_load_dwordx4 v193, s[44:47], s72 offen lds
    v_mfma_f32_16x16x32_bf16 v[112:115], v[52:55], v[68:71], v[112:115]
    s_add_u32 m0, s65, 94208
    s_mov_b32 s72, 221696
    buffer_load_dwordx4 v193, s[44:47], s72 offen lds
    s_waitcnt vmcnt(10)
    v_mfma_f32_16x16x32_bf16 v[116:119], v[56:59], v[68:71], v[116:119]
    v_lshlrev_b32 v195, 16, v176
    v_and_b32 v196, 0xffff0000, v176
    v_fma_f32 v195, v195, v184, v185
    v_fma_f32 v196, v196, v184, v185
    v_mfma_f32_16x16x32_bf16 v[120:123], v[52:55], v[72:75], v[120:123]
    v_cvt_pk_bf16_f32 v176, v195, v196
    v_lshlrev_b32 v195, 16, v177
    v_and_b32 v196, 0xffff0000, v177
    v_fma_f32 v195, v195, v184, v185
    v_mfma_f32_16x16x32_bf16 v[124:127], v[56:59], v[72:75], v[124:127]
    v_fma_f32 v196, v196, v184, v185
    v_cvt_pk_bf16_f32 v177, v195, v196
    v_lshlrev_b32 v195, 16, v178
    v_and_b32 v196, 0xffff0000, v178
    v_mfma_f32_16x16x32_bf16 v[128:131], v[52:55], v[76:79], v[128:131]
    v_fma_f32 v195, v195, v184, v185
    v_fma_f32 v196, v196, v184, v185
    v_cvt_pk_bf16_f32 v178, v195, v196
    v_lshlrev_b32 v195, 16, v179
    v_mfma_f32_16x16x32_bf16 v[132:135], v[56:59], v[76:79], v[132:135]
    v_and_b32 v196, 0xffff0000, v179
    v_fma_f32 v195, v195, v184, v185
    v_fma_f32 v196, v196, v184, v185
    v_cvt_pk_bf16_f32 v179, v195, v196
    v_mfma_f32_16x16x32_bf16 v[136:139], v[52:55], v[80:83], v[136:139]
    ds_write_b128 v194, v[176:179] offset:53248
    v_lshlrev_b32 v195, 16, v180
    v_and_b32 v196, 0xffff0000, v180
    v_fma_f32 v195, v195, v186, v187
    v_mfma_f32_16x16x32_bf16 v[140:143], v[56:59], v[80:83], v[140:143]
    v_fma_f32 v196, v196, v186, v187
    v_cvt_pk_bf16_f32 v180, v195, v196
    v_lshlrev_b32 v195, 16, v181
    v_and_b32 v196, 0xffff0000, v181
    v_mfma_f32_16x16x32_bf16 v[144:147], v[52:55], v[84:87], v[144:147]
    v_fma_f32 v195, v195, v186, v187
    v_fma_f32 v196, v196, v186, v187
    v_cvt_pk_bf16_f32 v181, v195, v196
    v_lshlrev_b32 v195, 16, v182
    v_mfma_f32_16x16x32_bf16 v[148:151], v[56:59], v[84:87], v[148:151]
    v_and_b32 v196, 0xffff0000, v182
    v_fma_f32 v195, v195, v186, v187
    v_fma_f32 v196, v196, v186, v187
    v_cvt_pk_bf16_f32 v182, v195, v196
    v_mfma_f32_16x16x32_bf16 v[152:155], v[52:55], v[88:91], v[152:155]
    v_lshlrev_b32 v195, 16, v183
    v_and_b32 v196, 0xffff0000, v183
    v_fma_f32 v195, v195, v186, v187
    v_fma_f32 v196, v196, v186, v187
    v_mfma_f32_16x16x32_bf16 v[156:159], v[56:59], v[88:91], v[156:159]
    v_cvt_pk_bf16_f32 v183, v195, v196
    ds_write_b128 v194, v[180:183] offset:61440
    s_mov_b32 s72, 768
    buffer_load_dwordx4 v[176:179], v192, s[40:43], s72 offen
    v_mfma_f32_16x16x32_bf16 v[160:163], v[52:55], v[92:95], v[160:163]
    s_mov_b32 s72, 74496
    buffer_load_dwordx4 v[180:183], v192, s[40:43], s72 offen
    v_mfma_f32_16x16x32_bf16 v[164:167], v[56:59], v[92:95], v[164:167]
    s_waitcnt lgkmcnt(0)
    v_mfma_f32_16x16x32_bf16 v[96:99], v[8:11], v[16:19], v[96:99]
    ds_read_b128 v[52:55], v203 offset:0
    v_mfma_f32_16x16x32_bf16 v[100:103], v[12:15], v[16:19], v[100:103]
    ds_read_b128 v[56:59], v203 offset:2048
    v_mfma_f32_16x16x32_bf16 v[104:107], v[8:11], v[20:23], v[104:107]
    ds_read_b128 v[60:63], v205 offset:0
    v_mfma_f32_16x16x32_bf16 v[108:111], v[12:15], v[20:23], v[108:111]
    ds_read_b128 v[64:67], v205 offset:2048
    v_mfma_f32_16x16x32_bf16 v[112:115], v[8:11], v[24:27], v[112:115]
    ds_read_b128 v[68:71], v205 offset:4096
    v_mfma_f32_16x16x32_bf16 v[116:119], v[12:15], v[24:27], v[116:119]
    ds_read_b128 v[72:75], v205 offset:6144
    v_mfma_f32_16x16x32_bf16 v[120:123], v[8:11], v[28:31], v[120:123]
    ds_read_b128 v[76:79], v205 offset:8192
    v_mfma_f32_16x16x32_bf16 v[124:127], v[12:15], v[28:31], v[124:127]
    ds_read_b128 v[80:83], v205 offset:10240
    v_mfma_f32_16x16x32_bf16 v[128:131], v[8:11], v[32:35], v[128:131]
    ds_read_b128 v[84:87], v205 offset:12288
    v_mfma_f32_16x16x32_bf16 v[132:135], v[12:15], v[32:35], v[132:135]
    ds_read_b128 v[88:91], v205 offset:14336
    v_mfma_f32_16x16x32_bf16 v[136:139], v[8:11], v[36:39], v[136:139]
    ds_read_b128 v[92:95], v205 offset:16384
    v_mfma_f32_16x16x32_bf16 v[140:143], v[12:15], v[36:39], v[140:143]
    v_mfma_f32_16x16x32_bf16 v[144:147], v[8:11], v[40:43], v[144:147]
    v_mfma_f32_16x16x32_bf16 v[148:151], v[12:15], v[40:43], v[148:151]
    v_mfma_f32_16x16x32_bf16 v[152:155], v[8:11], v[44:47], v[152:155]
    v_mfma_f32_16x16x32_bf16 v[156:159], v[12:15], v[44:47], v[156:159]
    v_mfma_f32_16x16x32_bf16 v[160:163], v[8:11], v[48:51], v[160:163]
    v_mfma_f32_16x16x32_bf16 v[164:167], v[12:15], v[48:51], v[164:167]
    s_waitcnt vmcnt(8) lgkmcnt(0)
    s_barrier
    ds_read_b128 v[8:11], v4 offset:0
    ds_read_b128 v[12:15], v4 offset:2048
    ds_read_b128 v[16:19], v2 offset:0
    ds_read_b128 v[20:23], v2 offset:2048
    v_mfma_f32_16x16x32_bf16 v[96:99], v[52:55], v[60:63], v[96:99]
    ds_read_b128 v[24:27], v2 offset:4096
    ds_read_b128 v[28:31], v2 offset:6144
    ds_read_b128 v[32:35], v2 offset:8192
    ds_read_b128 v[36:39], v2 offset:10240
    v_mfma_f32_16x16x32_bf16 v[100:103], v[56:59], v[60:63], v[100:103]
    ds_read_b128 v[40:43], v2 offset:12288
    ds_read_b128 v[44:47], v2 offset:14336
    ds_read_b128 v[48:51], v2 offset:16384
    s_add_u32 m0, s65, 122880
    v_mfma_f32_16x16x32_bf16 v[104:107], v[52:55], v[64:67], v[104:107]
    s_mov_b32 s72, 640
    buffer_load_dwordx4 v193, s[44:47], s72 offen lds
    s_add_u32 m0, s65, 131072
    s_mov_b32 s72, 74368
    v_mfma_f32_16x16x32_bf16 v[108:111], v[56:59], v[64:67], v[108:111]
    buffer_load_dwordx4 v193, s[44:47], s72 offen lds
    s_add_u32 m0, s65, 139264
    s_mov_b32 s72, 148096
    buffer_load_dwordx4 v193, s[44:47], s72 offen lds
    v_mfma_f32_16x16x32_bf16 v[112:115], v[52:55], v[68:71], v[112:115]
    s_add_u32 m0, s65, 147456
    s_mov_b32 s72, 221824
    buffer_load_dwordx4 v193, s[44:47], s72 offen lds
    s_waitcnt vmcnt(10)
    v_mfma_f32_16x16x32_bf16 v[116:119], v[56:59], v[68:71], v[116:119]
    v_lshlrev_b32 v195, 16, v168
    v_and_b32 v196, 0xffff0000, v168
    v_fma_f32 v195, v195, v184, v185
    v_fma_f32 v196, v196, v184, v185
    v_mfma_f32_16x16x32_bf16 v[120:123], v[52:55], v[72:75], v[120:123]
    v_cvt_pk_bf16_f32 v168, v195, v196
    v_lshlrev_b32 v195, 16, v169
    v_and_b32 v196, 0xffff0000, v169
    v_fma_f32 v195, v195, v184, v185
    v_mfma_f32_16x16x32_bf16 v[124:127], v[56:59], v[72:75], v[124:127]
    v_fma_f32 v196, v196, v184, v185
    v_cvt_pk_bf16_f32 v169, v195, v196
    v_lshlrev_b32 v195, 16, v170
    v_and_b32 v196, 0xffff0000, v170
    v_mfma_f32_16x16x32_bf16 v[128:131], v[52:55], v[76:79], v[128:131]
    v_fma_f32 v195, v195, v184, v185
    v_fma_f32 v196, v196, v184, v185
    v_cvt_pk_bf16_f32 v170, v195, v196
    v_lshlrev_b32 v195, 16, v171
    v_mfma_f32_16x16x32_bf16 v[132:135], v[56:59], v[76:79], v[132:135]
    v_and_b32 v196, 0xffff0000, v171
    v_fma_f32 v195, v195, v184, v185
    v_fma_f32 v196, v196, v184, v185
    v_cvt_pk_bf16_f32 v171, v195, v196
    v_mfma_f32_16x16x32_bf16 v[136:139], v[52:55], v[80:83], v[136:139]
    ds_write_b128 v197, v[168:171] offset:0
    v_lshlrev_b32 v195, 16, v172
    v_and_b32 v196, 0xffff0000, v172
    v_fma_f32 v195, v195, v186, v187
    v_mfma_f32_16x16x32_bf16 v[140:143], v[56:59], v[80:83], v[140:143]
    v_fma_f32 v196, v196, v186, v187
    v_cvt_pk_bf16_f32 v172, v195, v196
    v_lshlrev_b32 v195, 16, v173
    v_and_b32 v196, 0xffff0000, v173
    v_mfma_f32_16x16x32_bf16 v[144:147], v[52:55], v[84:87], v[144:147]
    v_fma_f32 v195, v195, v186, v187
    v_fma_f32 v196, v196, v186, v187
    v_cvt_pk_bf16_f32 v173, v195, v196
    v_lshlrev_b32 v195, 16, v174
    v_mfma_f32_16x16x32_bf16 v[148:151], v[56:59], v[84:87], v[148:151]
    v_and_b32 v196, 0xffff0000, v174
    v_fma_f32 v195, v195, v186, v187
    v_fma_f32 v196, v196, v186, v187
    v_cvt_pk_bf16_f32 v174, v195, v196
    v_mfma_f32_16x16x32_bf16 v[152:155], v[52:55], v[88:91], v[152:155]
    v_lshlrev_b32 v195, 16, v175
    v_and_b32 v196, 0xffff0000, v175
    v_fma_f32 v195, v195, v186, v187
    v_fma_f32 v196, v196, v186, v187
    v_mfma_f32_16x16x32_bf16 v[156:159], v[56:59], v[88:91], v[156:159]
    v_cvt_pk_bf16_f32 v175, v195, v196
    ds_write_b128 v197, v[172:175] offset:8192
    s_mov_b32 s72, 896
    buffer_load_dwordx4 v[168:171], v192, s[40:43], s72 offen
    v_mfma_f32_16x16x32_bf16 v[160:163], v[52:55], v[92:95], v[160:163]
    s_mov_b32 s72, 74624
    buffer_load_dwordx4 v[172:175], v192, s[40:43], s72 offen
    v_mfma_f32_16x16x32_bf16 v[164:167], v[56:59], v[92:95], v[164:167]
    s_waitcnt lgkmcnt(0)
    v_mfma_f32_16x16x32_bf16 v[96:99], v[8:11], v[16:19], v[96:99]
    ds_read_b128 v[52:55], v5 offset:0
    v_mfma_f32_16x16x32_bf16 v[100:103], v[12:15], v[16:19], v[100:103]
    ds_read_b128 v[56:59], v5 offset:2048
    v_mfma_f32_16x16x32_bf16 v[104:107], v[8:11], v[20:23], v[104:107]
    ds_read_b128 v[60:63], v3 offset:0
    v_mfma_f32_16x16x32_bf16 v[108:111], v[12:15], v[20:23], v[108:111]
    ds_read_b128 v[64:67], v3 offset:2048
    v_mfma_f32_16x16x32_bf16 v[112:115], v[8:11], v[24:27], v[112:115]
    ds_read_b128 v[68:71], v3 offset:4096
    v_mfma_f32_16x16x32_bf16 v[116:119], v[12:15], v[24:27], v[116:119]
    ds_read_b128 v[72:75], v3 offset:6144
    v_mfma_f32_16x16x32_bf16 v[120:123], v[8:11], v[28:31], v[120:123]
    ds_read_b128 v[76:79], v3 offset:8192
    v_mfma_f32_16x16x32_bf16 v[124:127], v[12:15], v[28:31], v[124:127]
    ds_read_b128 v[80:83], v3 offset:10240
    v_mfma_f32_16x16x32_bf16 v[128:131], v[8:11], v[32:35], v[128:131]
    ds_read_b128 v[84:87], v3 offset:12288
    v_mfma_f32_16x16x32_bf16 v[132:135], v[12:15], v[32:35], v[132:135]
    ds_read_b128 v[88:91], v3 offset:14336
    v_mfma_f32_16x16x32_bf16 v[136:139], v[8:11], v[36:39], v[136:139]
    ds_read_b128 v[92:95], v3 offset:16384
    v_mfma_f32_16x16x32_bf16 v[140:143], v[12:15], v[36:39], v[140:143]
    v_mfma_f32_16x16x32_bf16 v[144:147], v[8:11], v[40:43], v[144:147]
    v_mfma_f32_16x16x32_bf16 v[148:151], v[12:15], v[40:43], v[148:151]
    v_mfma_f32_16x16x32_bf16 v[152:155], v[8:11], v[44:47], v[152:155]
    v_mfma_f32_16x16x32_bf16 v[156:159], v[12:15], v[44:47], v[156:159]
    v_mfma_f32_16x16x32_bf16 v[160:163], v[8:11], v[48:51], v[160:163]
    v_mfma_f32_16x16x32_bf16 v[164:167], v[12:15], v[48:51], v[164:167]
    s_waitcnt vmcnt(8) lgkmcnt(0)
    s_barrier
    ds_read_b128 v[8:11], v198 offset:0
    ds_read_b128 v[12:15], v198 offset:2048
    ds_read_b128 v[16:19], v200 offset:0
    ds_read_b128 v[20:23], v200 offset:2048
    v_mfma_f32_16x16x32_bf16 v[96:99], v[52:55], v[60:63], v[96:99]
    ds_read_b128 v[24:27], v200 offset:4096
    ds_read_b128 v[28:31], v200 offset:6144
    ds_read_b128 v[32:35], v200 offset:8192
    ds_read_b128 v[36:39], v200 offset:10240
    v_mfma_f32_16x16x32_bf16 v[100:103], v[56:59], v[60:63], v[100:103]
    ds_read_b128 v[40:43], v200 offset:12288
    ds_read_b128 v[44:47], v200 offset:14336
    ds_read_b128 v[48:51], v200 offset:16384
    s_add_u32 m0, s65, 16384
    v_mfma_f32_16x16x32_bf16 v[104:107], v[52:55], v[64:67], v[104:107]
    s_mov_b32 s72, 768
    buffer_load_dwordx4 v193, s[44:47], s72 offen lds
    s_add_u32 m0, s65, 24576
    s_mov_b32 s72, 74496
    v_mfma_f32_16x16x32_bf16 v[108:111], v[56:59], v[64:67], v[108:111]
    buffer_load_dwordx4 v193, s[44:47], s72 offen lds
    s_add_u32 m0, s65, 32768
    s_mov_b32 s72, 148224
    buffer_load_dwordx4 v193, s[44:47], s72 offen lds
    v_mfma_f32_16x16x32_bf16 v[112:115], v[52:55], v[68:71], v[112:115]
    s_add_u32 m0, s65, 40960
    s_mov_b32 s72, 221952
    buffer_load_dwordx4 v193, s[44:47], s72 offen lds
    s_waitcnt vmcnt(10)
    v_mfma_f32_16x16x32_bf16 v[116:119], v[56:59], v[68:71], v[116:119]
    v_lshlrev_b32 v195, 16, v176
    v_and_b32 v196, 0xffff0000, v176
    v_fma_f32 v195, v195, v184, v185
    v_fma_f32 v196, v196, v184, v185
    v_mfma_f32_16x16x32_bf16 v[120:123], v[52:55], v[72:75], v[120:123]
    v_cvt_pk_bf16_f32 v176, v195, v196
    v_lshlrev_b32 v195, 16, v177
    v_and_b32 v196, 0xffff0000, v177
    v_fma_f32 v195, v195, v184, v185
    v_mfma_f32_16x16x32_bf16 v[124:127], v[56:59], v[72:75], v[124:127]
    v_fma_f32 v196, v196, v184, v185
    v_cvt_pk_bf16_f32 v177, v195, v196
    v_lshlrev_b32 v195, 16, v178
    v_and_b32 v196, 0xffff0000, v178
    v_mfma_f32_16x16x32_bf16 v[128:131], v[52:55], v[76:79], v[128:131]
    v_fma_f32 v195, v195, v184, v185
    v_fma_f32 v196, v196, v184, v185
    v_cvt_pk_bf16_f32 v178, v195, v196
    v_lshlrev_b32 v195, 16, v179
    v_mfma_f32_16x16x32_bf16 v[132:135], v[56:59], v[76:79], v[132:135]
    v_and_b32 v196, 0xffff0000, v179
    v_fma_f32 v195, v195, v184, v185
    v_fma_f32 v196, v196, v184, v185
    v_cvt_pk_bf16_f32 v179, v195, v196
    v_mfma_f32_16x16x32_bf16 v[136:139], v[52:55], v[80:83], v[136:139]
    ds_write_b128 v194, v[176:179] offset:0
    v_lshlrev_b32 v195, 16, v180
    v_and_b32 v196, 0xffff0000, v180
    v_fma_f32 v195, v195, v186, v187
    v_mfma_f32_16x16x32_bf16 v[140:143], v[56:59], v[80:83], v[140:143]
    v_fma_f32 v196, v196, v186, v187
    v_cvt_pk_bf16_f32 v180, v195, v196
    v_lshlrev_b32 v195, 16, v181
    v_and_b32 v196, 0xffff0000, v181
    v_mfma_f32_16x16x32_bf16 v[144:147], v[52:55], v[84:87], v[144:147]
    v_fma_f32 v195, v195, v186, v187
    v_fma_f32 v196, v196, v186, v187
    v_cvt_pk_bf16_f32 v181, v195, v196
    v_lshlrev_b32 v195, 16, v182
    v_mfma_f32_16x16x32_bf16 v[148:151], v[56:59], v[84:87], v[148:151]
    v_and_b32 v196, 0xffff0000, v182
    v_fma_f32 v195, v195, v186, v187
    v_fma_f32 v196, v196, v186, v187
    v_cvt_pk_bf16_f32 v182, v195, v196
    v_mfma_f32_16x16x32_bf16 v[152:155], v[52:55], v[88:91], v[152:155]
    v_lshlrev_b32 v195, 16, v183
    v_and_b32 v196, 0xffff0000, v183
    v_fma_f32 v195, v195, v186, v187
    v_fma_f32 v196, v196, v186, v187
    v_mfma_f32_16x16x32_bf16 v[156:159], v[56:59], v[88:91], v[156:159]
    v_cvt_pk_bf16_f32 v183, v195, v196
    ds_write_b128 v194, v[180:183] offset:8192
    s_mov_b32 s72, 1024
    buffer_load_dwordx4 v[176:179], v192, s[40:43], s72 offen
    v_mfma_f32_16x16x32_bf16 v[160:163], v[52:55], v[92:95], v[160:163]
    s_mov_b32 s72, 74752
    buffer_load_dwordx4 v[180:183], v192, s[40:43], s72 offen
    v_mfma_f32_16x16x32_bf16 v[164:167], v[56:59], v[92:95], v[164:167]
    s_waitcnt lgkmcnt(0)
    v_mfma_f32_16x16x32_bf16 v[96:99], v[8:11], v[16:19], v[96:99]
    ds_read_b128 v[52:55], v199 offset:0
    v_mfma_f32_16x16x32_bf16 v[100:103], v[12:15], v[16:19], v[100:103]
    ds_read_b128 v[56:59], v199 offset:2048
    v_mfma_f32_16x16x32_bf16 v[104:107], v[8:11], v[20:23], v[104:107]
    ds_read_b128 v[60:63], v201 offset:0
    v_mfma_f32_16x16x32_bf16 v[108:111], v[12:15], v[20:23], v[108:111]
    ds_read_b128 v[64:67], v201 offset:2048
    v_mfma_f32_16x16x32_bf16 v[112:115], v[8:11], v[24:27], v[112:115]
    ds_read_b128 v[68:71], v201 offset:4096
    v_mfma_f32_16x16x32_bf16 v[116:119], v[12:15], v[24:27], v[116:119]
    ds_read_b128 v[72:75], v201 offset:6144
    v_mfma_f32_16x16x32_bf16 v[120:123], v[8:11], v[28:31], v[120:123]
    ds_read_b128 v[76:79], v201 offset:8192
    v_mfma_f32_16x16x32_bf16 v[124:127], v[12:15], v[28:31], v[124:127]
    ds_read_b128 v[80:83], v201 offset:10240
    v_mfma_f32_16x16x32_bf16 v[128:131], v[8:11], v[32:35], v[128:131]
    ds_read_b128 v[84:87], v201 offset:12288
    v_mfma_f32_16x16x32_bf16 v[132:135], v[12:15], v[32:35], v[132:135]
    ds_read_b128 v[88:91], v201 offset:14336
    v_mfma_f32_16x16x32_bf16 v[136:139], v[8:11], v[36:39], v[136:139]
    ds_read_b128 v[92:95], v201 offset:16384
    v_mfma_f32_16x16x32_bf16 v[140:143], v[12:15], v[36:39], v[140:143]
    v_mfma_f32_16x16x32_bf16 v[144:147], v[8:11], v[40:43], v[144:147]
    v_mfma_f32_16x16x32_bf16 v[148:151], v[12:15], v[40:43], v[148:151]
    v_mfma_f32_16x16x32_bf16 v[152:155], v[8:11], v[44:47], v[152:155]
    v_mfma_f32_16x16x32_bf16 v[156:159], v[12:15], v[44:47], v[156:159]
    v_mfma_f32_16x16x32_bf16 v[160:163], v[8:11], v[48:51], v[160:163]
    v_mfma_f32_16x16x32_bf16 v[164:167], v[12:15], v[48:51], v[164:167]
    s_waitcnt vmcnt(8) lgkmcnt(0)
    s_barrier
    ds_read_b128 v[8:11], v202 offset:0
    ds_read_b128 v[12:15], v202 offset:2048
    ds_read_b128 v[16:19], v204 offset:0
    ds_read_b128 v[20:23], v204 offset:2048
    v_mfma_f32_16x16x32_bf16 v[96:99], v[52:55], v[60:63], v[96:99]
    ds_read_b128 v[24:27], v204 offset:4096
    ds_read_b128 v[28:31], v204 offset:6144
    ds_read_b128 v[32:35], v204 offset:8192
    ds_read_b128 v[36:39], v204 offset:10240
    v_mfma_f32_16x16x32_bf16 v[100:103], v[56:59], v[60:63], v[100:103]
    ds_read_b128 v[40:43], v204 offset:12288
    ds_read_b128 v[44:47], v204 offset:14336
    ds_read_b128 v[48:51], v204 offset:16384
    s_add_u32 m0, s65, 69632
    v_mfma_f32_16x16x32_bf16 v[104:107], v[52:55], v[64:67], v[104:107]
    s_mov_b32 s72, 896
    buffer_load_dwordx4 v193, s[44:47], s72 offen lds
    s_add_u32 m0, s65, 77824
    s_mov_b32 s72, 74624
    v_mfma_f32_16x16x32_bf16 v[108:111], v[56:59], v[64:67], v[108:111]
    buffer_load_dwordx4 v193, s[44:47], s72 offen lds
    s_add_u32 m0, s65, 86016
    s_mov_b32 s72, 148352
    buffer_load_dwordx4 v193, s[44:47], s72 offen lds
    v_mfma_f32_16x16x32_bf16 v[112:115], v[52:55], v[68:71], v[112:115]
    s_add_u32 m0, s65, 94208
    s_mov_b32 s72, 222080
    buffer_load_dwordx4 v193, s[44:47], s72 offen lds
    s_waitcnt vmcnt(10)
    v_mfma_f32_16x16x32_bf16 v[116:119], v[56:59], v[68:71], v[116:119]
    v_lshlrev_b32 v195, 16, v168
    v_and_b32 v196, 0xffff0000, v168
    v_fma_f32 v195, v195, v184, v185
    v_fma_f32 v196, v196, v184, v185
    v_mfma_f32_16x16x32_bf16 v[120:123], v[52:55], v[72:75], v[120:123]
    v_cvt_pk_bf16_f32 v168, v195, v196
    v_lshlrev_b32 v195, 16, v169
    v_and_b32 v196, 0xffff0000, v169
    v_fma_f32 v195, v195, v184, v185
    v_mfma_f32_16x16x32_bf16 v[124:127], v[56:59], v[72:75], v[124:127]
    v_fma_f32 v196, v196, v184, v185
    v_cvt_pk_bf16_f32 v169, v195, v196
    v_lshlrev_b32 v195, 16, v170
    v_and_b32 v196, 0xffff0000, v170
    v_mfma_f32_16x16x32_bf16 v[128:131], v[52:55], v[76:79], v[128:131]
    v_fma_f32 v195, v195, v184, v185
    v_fma_f32 v196, v196, v184, v185
    v_cvt_pk_bf16_f32 v170, v195, v196
    v_lshlrev_b32 v195, 16, v171
    v_mfma_f32_16x16x32_bf16 v[132:135], v[56:59], v[76:79], v[132:135]
    v_and_b32 v196, 0xffff0000, v171
    v_fma_f32 v195, v195, v184, v185
    v_fma_f32 v196, v196, v184, v185
    v_cvt_pk_bf16_f32 v171, v195, v196
    v_mfma_f32_16x16x32_bf16 v[136:139], v[52:55], v[80:83], v[136:139]
    ds_write_b128 v194, v[168:171] offset:53248
    v_lshlrev_b32 v195, 16, v172
    v_and_b32 v196, 0xffff0000, v172
    v_fma_f32 v195, v195, v186, v187
    v_mfma_f32_16x16x32_bf16 v[140:143], v[56:59], v[80:83], v[140:143]
    v_fma_f32 v196, v196, v186, v187
    v_cvt_pk_bf16_f32 v172, v195, v196
    v_lshlrev_b32 v195, 16, v173
    v_and_b32 v196, 0xffff0000, v173
    v_mfma_f32_16x16x32_bf16 v[144:147], v[52:55], v[84:87], v[144:147]
    v_fma_f32 v195, v195, v186, v187
    v_fma_f32 v196, v196, v186, v187
    v_cvt_pk_bf16_f32 v173, v195, v196
    v_lshlrev_b32 v195, 16, v174
    v_mfma_f32_16x16x32_bf16 v[148:151], v[56:59], v[84:87], v[148:151]
    v_and_b32 v196, 0xffff0000, v174
    v_fma_f32 v195, v195, v186, v187
    v_fma_f32 v196, v196, v186, v187
    v_cvt_pk_bf16_f32 v174, v195, v196
    v_mfma_f32_16x16x32_bf16 v[152:155], v[52:55], v[88:91], v[152:155]
    v_lshlrev_b32 v195, 16, v175
    v_and_b32 v196, 0xffff0000, v175
    v_fma_f32 v195, v195, v186, v187
    v_fma_f32 v196, v196, v186, v187
    v_mfma_f32_16x16x32_bf16 v[156:159], v[56:59], v[88:91], v[156:159]
    v_cvt_pk_bf16_f32 v175, v195, v196
    ds_write_b128 v194, v[172:175] offset:61440
    v_mfma_f32_16x16x32_bf16 v[160:163], v[52:55], v[92:95], v[160:163]
    v_mfma_f32_16x16x32_bf16 v[164:167], v[56:59], v[92:95], v[164:167]
    s_waitcnt lgkmcnt(0)
    v_mfma_f32_16x16x32_bf16 v[96:99], v[8:11], v[16:19], v[96:99]
    ds_read_b128 v[52:55], v203 offset:0
    v_mfma_f32_16x16x32_bf16 v[100:103], v[12:15], v[16:19], v[100:103]
    ds_read_b128 v[56:59], v203 offset:2048
    v_mfma_f32_16x16x32_bf16 v[104:107], v[8:11], v[20:23], v[104:107]
    ds_read_b128 v[60:63], v205 offset:0
    v_mfma_f32_16x16x32_bf16 v[108:111], v[12:15], v[20:23], v[108:111]
    ds_read_b128 v[64:67], v205 offset:2048
    v_mfma_f32_16x16x32_bf16 v[112:115], v[8:11], v[24:27], v[112:115]
    ds_read_b128 v[68:71], v205 offset:4096
    v_mfma_f32_16x16x32_bf16 v[116:119], v[12:15], v[24:27], v[116:119]
    ds_read_b128 v[72:75], v205 offset:6144
    v_mfma_f32_16x16x32_bf16 v[120:123], v[8:11], v[28:31], v[120:123]
    ds_read_b128 v[76:79], v205 offset:8192
    v_mfma_f32_16x16x32_bf16 v[124:127], v[12:15], v[28:31], v[124:127]
    ds_read_b128 v[80:83], v205 offset:10240
    v_mfma_f32_16x16x32_bf16 v[128:131], v[8:11], v[32:35], v[128:131]
    ds_read_b128 v[84:87], v205 offset:12288
    v_mfma_f32_16x16x32_bf16 v[132:135], v[12:15], v[32:35], v[132:135]
    ds_read_b128 v[88:91], v205 offset:14336
    v_mfma_f32_16x16x32_bf16 v[136:139], v[8:11], v[36:39], v[136:139]
    ds_read_b128 v[92:95], v205 offset:16384
    v_mfma_f32_16x16x32_bf16 v[140:143], v[12:15], v[36:39], v[140:143]
    v_mfma_f32_16x16x32_bf16 v[144:147], v[8:11], v[40:43], v[144:147]
    v_mfma_f32_16x16x32_bf16 v[148:151], v[12:15], v[40:43], v[148:151]
    v_mfma_f32_16x16x32_bf16 v[152:155], v[8:11], v[44:47], v[152:155]
    v_mfma_f32_16x16x32_bf16 v[156:159], v[12:15], v[44:47], v[156:159]
    v_mfma_f32_16x16x32_bf16 v[160:163], v[8:11], v[48:51], v[160:163]
    v_mfma_f32_16x16x32_bf16 v[164:167], v[12:15], v[48:51], v[164:167]
    s_waitcnt vmcnt(6) lgkmcnt(0)
    s_barrier
    ds_read_b128 v[8:11], v4 offset:0
    ds_read_b128 v[12:15], v4 offset:2048
    ds_read_b128 v[16:19], v2 offset:0
    ds_read_b128 v[20:23], v2 offset:2048
    v_mfma_f32_16x16x32_bf16 v[96:99], v[52:55], v[60:63], v[96:99]
    ds_read_b128 v[24:27], v2 offset:4096
    ds_read_b128 v[28:31], v2 offset:6144
    ds_read_b128 v[32:35], v2 offset:8192
    ds_read_b128 v[36:39], v2 offset:10240
    v_mfma_f32_16x16x32_bf16 v[100:103], v[56:59], v[60:63], v[100:103]
    ds_read_b128 v[40:43], v2 offset:12288
    ds_read_b128 v[44:47], v2 offset:14336
    ds_read_b128 v[48:51], v2 offset:16384
    s_add_u32 m0, s65, 122880
    v_mfma_f32_16x16x32_bf16 v[104:107], v[52:55], v[64:67], v[104:107]
    s_mov_b32 s72, 1024
    buffer_load_dwordx4 v193, s[44:47], s72 offen lds
    s_add_u32 m0, s65, 131072
    s_mov_b32 s72, 74752
    v_mfma_f32_16x16x32_bf16 v[108:111], v[56:59], v[64:67], v[108:111]
    buffer_load_dwordx4 v193, s[44:47], s72 offen lds
    s_add_u32 m0, s65, 139264
    s_mov_b32 s72, 148480
    buffer_load_dwordx4 v193, s[44:47], s72 offen lds
    v_mfma_f32_16x16x32_bf16 v[112:115], v[52:55], v[68:71], v[112:115]
    s_add_u32 m0, s65, 147456
    s_mov_b32 s72, 222208
    buffer_load_dwordx4 v193, s[44:47], s72 offen lds
    s_waitcnt vmcnt(8)
    v_mfma_f32_16x16x32_bf16 v[116:119], v[56:59], v[68:71], v[116:119]
    v_lshlrev_b32 v195, 16, v176
    v_and_b32 v196, 0xffff0000, v176
    v_fma_f32 v195, v195, v184, v185
    v_fma_f32 v196, v196, v184, v185
    v_mfma_f32_16x16x32_bf16 v[120:123], v[52:55], v[72:75], v[120:123]
    v_cvt_pk_bf16_f32 v176, v195, v196
    v_lshlrev_b32 v195, 16, v177
    v_and_b32 v196, 0xffff0000, v177
    v_fma_f32 v195, v195, v184, v185
    v_mfma_f32_16x16x32_bf16 v[124:127], v[56:59], v[72:75], v[124:127]
    v_fma_f32 v196, v196, v184, v185
    v_cvt_pk_bf16_f32 v177, v195, v196
    v_lshlrev_b32 v195, 16, v178
    v_and_b32 v196, 0xffff0000, v178
    v_mfma_f32_16x16x32_bf16 v[128:131], v[52:55], v[76:79], v[128:131]
    v_fma_f32 v195, v195, v184, v185
    v_fma_f32 v196, v196, v184, v185
    v_cvt_pk_bf16_f32 v178, v195, v196
    v_lshlrev_b32 v195, 16, v179
    v_mfma_f32_16x16x32_bf16 v[132:135], v[56:59], v[76:79], v[132:135]
    v_and_b32 v196, 0xffff0000, v179
    v_fma_f32 v195, v195, v184, v185
    v_fma_f32 v196, v196, v184, v185
    v_cvt_pk_bf16_f32 v179, v195, v196
    v_mfma_f32_16x16x32_bf16 v[136:139], v[52:55], v[80:83], v[136:139]
    ds_write_b128 v197, v[176:179] offset:0
    v_lshlrev_b32 v195, 16, v180
    v_and_b32 v196, 0xffff0000, v180
    v_fma_f32 v195, v195, v186, v187
    v_mfma_f32_16x16x32_bf16 v[140:143], v[56:59], v[80:83], v[140:143]
    v_fma_f32 v196, v196, v186, v187
    v_cvt_pk_bf16_f32 v180, v195, v196
    v_lshlrev_b32 v195, 16, v181
    v_and_b32 v196, 0xffff0000, v181
    v_mfma_f32_16x16x32_bf16 v[144:147], v[52:55], v[84:87], v[144:147]
    v_fma_f32 v195, v195, v186, v187
    v_fma_f32 v196, v196, v186, v187
    v_cvt_pk_bf16_f32 v181, v195, v196
    v_lshlrev_b32 v195, 16, v182
    v_mfma_f32_16x16x32_bf16 v[148:151], v[56:59], v[84:87], v[148:151]
    v_and_b32 v196, 0xffff0000, v182
    v_fma_f32 v195, v195, v186, v187
    v_fma_f32 v196, v196, v186, v187
    v_cvt_pk_bf16_f32 v182, v195, v196
    v_mfma_f32_16x16x32_bf16 v[152:155], v[52:55], v[88:91], v[152:155]
    v_lshlrev_b32 v195, 16, v183
    v_and_b32 v196, 0xffff0000, v183
    v_fma_f32 v195, v195, v186, v187
    v_fma_f32 v196, v196, v186, v187
    v_mfma_f32_16x16x32_bf16 v[156:159], v[56:59], v[88:91], v[156:159]
    v_cvt_pk_bf16_f32 v183, v195, v196
    ds_write_b128 v197, v[180:183] offset:8192
    v_mfma_f32_16x16x32_bf16 v[160:163], v[52:55], v[92:95], v[160:163]
    v_mfma_f32_16x16x32_bf16 v[164:167], v[56:59], v[92:95], v[164:167]
    s_waitcnt lgkmcnt(0)
    v_mfma_f32_16x16x32_bf16 v[96:99], v[8:11], v[16:19], v[96:99]
    ds_read_b128 v[52:55], v5 offset:0
    v_mfma_f32_16x16x32_bf16 v[100:103], v[12:15], v[16:19], v[100:103]
    ds_read_b128 v[56:59], v5 offset:2048
    v_mfma_f32_16x16x32_bf16 v[104:107], v[8:11], v[20:23], v[104:107]
    ds_read_b128 v[60:63], v3 offset:0
    v_mfma_f32_16x16x32_bf16 v[108:111], v[12:15], v[20:23], v[108:111]
    ds_read_b128 v[64:67], v3 offset:2048
    v_mfma_f32_16x16x32_bf16 v[112:115], v[8:11], v[24:27], v[112:115]
    ds_read_b128 v[68:71], v3 offset:4096
    v_mfma_f32_16x16x32_bf16 v[116:119], v[12:15], v[24:27], v[116:119]
    ds_read_b128 v[72:75], v3 offset:6144
    v_mfma_f32_16x16x32_bf16 v[120:123], v[8:11], v[28:31], v[120:123]
    ds_read_b128 v[76:79], v3 offset:8192
    v_mfma_f32_16x16x32_bf16 v[124:127], v[12:15], v[28:31], v[124:127]
    ds_read_b128 v[80:83], v3 offset:10240
    v_mfma_f32_16x16x32_bf16 v[128:131], v[8:11], v[32:35], v[128:131]
    ds_read_b128 v[84:87], v3 offset:12288
    v_mfma_f32_16x16x32_bf16 v[132:135], v[12:15], v[32:35], v[132:135]
    ds_read_b128 v[88:91], v3 offset:14336
    v_mfma_f32_16x16x32_bf16 v[136:139], v[8:11], v[36:39], v[136:139]
    ds_read_b128 v[92:95], v3 offset:16384
    v_mfma_f32_16x16x32_bf16 v[140:143], v[12:15], v[36:39], v[140:143]
    v_mfma_f32_16x16x32_bf16 v[144:147], v[8:11], v[40:43], v[144:147]
    v_mfma_f32_16x16x32_bf16 v[148:151], v[12:15], v[40:43], v[148:151]
    v_mfma_f32_16x16x32_bf16 v[152:155], v[8:11], v[44:47], v[152:155]
    v_mfma_f32_16x16x32_bf16 v[156:159], v[12:15], v[44:47], v[156:159]
    v_mfma_f32_16x16x32_bf16 v[160:163], v[8:11], v[48:51], v[160:163]
    v_mfma_f32_16x16x32_bf16 v[164:167], v[12:15], v[48:51], v[164:167]
    s_waitcnt vmcnt(4) lgkmcnt(0)
    s_barrier
    ds_read_b128 v[8:11], v198 offset:0
    v_mfma_f32_16x16x32_bf16 v[96:99], v[52:55], v[60:63], v[96:99]
    ds_read_b128 v[12:15], v198 offset:2048
    v_mfma_f32_16x16x32_bf16 v[100:103], v[56:59], v[60:63], v[100:103]
    ds_read_b128 v[16:19], v200 offset:0
    v_mfma_f32_16x16x32_bf16 v[104:107], v[52:55], v[64:67], v[104:107]
    ds_read_b128 v[20:23], v200 offset:2048
    v_mfma_f32_16x16x32_bf16 v[108:111], v[56:59], v[64:67], v[108:111]
    ds_read_b128 v[24:27], v200 offset:4096
    v_mfma_f32_16x16x32_bf16 v[112:115], v[52:55], v[68:71], v[112:115]
    ds_read_b128 v[28:31], v200 offset:6144
    v_mfma_f32_16x16x32_bf16 v[116:119], v[56:59], v[68:71], v[116:119]
    ds_read_b128 v[32:35], v200 offset:8192
    v_mfma_f32_16x16x32_bf16 v[120:123], v[52:55], v[72:75], v[120:123]
    ds_read_b128 v[36:39], v200 offset:10240
    v_mfma_f32_16x16x32_bf16 v[124:127], v[56:59], v[72:75], v[124:127]
    ds_read_b128 v[40:43], v200 offset:12288
    v_mfma_f32_16x16x32_bf16 v[128:131], v[52:55], v[76:79], v[128:131]
    ds_read_b128 v[44:47], v200 offset:14336
    v_mfma_f32_16x16x32_bf16 v[132:135], v[56:59], v[76:79], v[132:135]
    ds_read_b128 v[48:51], v200 offset:16384
    v_mfma_f32_16x16x32_bf16 v[136:139], v[52:55], v[80:83], v[136:139]
    v_mfma_f32_16x16x32_bf16 v[140:143], v[56:59], v[80:83], v[140:143]
    v_mfma_f32_16x16x32_bf16 v[144:147], v[52:55], v[84:87], v[144:147]
    v_mfma_f32_16x16x32_bf16 v[148:151], v[56:59], v[84:87], v[148:151]
    v_mfma_f32_16x16x32_bf16 v[152:155], v[52:55], v[88:91], v[152:155]
    v_mfma_f32_16x16x32_bf16 v[156:159], v[56:59], v[88:91], v[156:159]
    v_mfma_f32_16x16x32_bf16 v[160:163], v[52:55], v[92:95], v[160:163]
    v_mfma_f32_16x16x32_bf16 v[164:167], v[56:59], v[92:95], v[164:167]
    s_waitcnt lgkmcnt(0)
    v_mfma_f32_16x16x32_bf16 v[96:99], v[8:11], v[16:19], v[96:99]
    ds_read_b128 v[52:55], v199 offset:0
    v_mfma_f32_16x16x32_bf16 v[100:103], v[12:15], v[16:19], v[100:103]
    ds_read_b128 v[56:59], v199 offset:2048
    v_mfma_f32_16x16x32_bf16 v[104:107], v[8:11], v[20:23], v[104:107]
    ds_read_b128 v[60:63], v201 offset:0
    v_mfma_f32_16x16x32_bf16 v[108:111], v[12:15], v[20:23], v[108:111]
    ds_read_b128 v[64:67], v201 offset:2048
    v_mfma_f32_16x16x32_bf16 v[112:115], v[8:11], v[24:27], v[112:115]
    ds_read_b128 v[68:71], v201 offset:4096
    v_mfma_f32_16x16x32_bf16 v[116:119], v[12:15], v[24:27], v[116:119]
    ds_read_b128 v[72:75], v201 offset:6144
    v_mfma_f32_16x16x32_bf16 v[120:123], v[8:11], v[28:31], v[120:123]
    ds_read_b128 v[76:79], v201 offset:8192
    v_mfma_f32_16x16x32_bf16 v[124:127], v[12:15], v[28:31], v[124:127]
    ds_read_b128 v[80:83], v201 offset:10240
    v_mfma_f32_16x16x32_bf16 v[128:131], v[8:11], v[32:35], v[128:131]
    ds_read_b128 v[84:87], v201 offset:12288
    v_mfma_f32_16x16x32_bf16 v[132:135], v[12:15], v[32:35], v[132:135]
    ds_read_b128 v[88:91], v201 offset:14336
    v_mfma_f32_16x16x32_bf16 v[136:139], v[8:11], v[36:39], v[136:139]
    ds_read_b128 v[92:95], v201 offset:16384
    v_mfma_f32_16x16x32_bf16 v[140:143], v[12:15], v[36:39], v[140:143]
    v_mfma_f32_16x16x32_bf16 v[144:147], v[8:11], v[40:43], v[144:147]
    v_mfma_f32_16x16x32_bf16 v[148:151], v[12:15], v[40:43], v[148:151]
    v_mfma_f32_16x16x32_bf16 v[152:155], v[8:11], v[44:47], v[152:155]
    v_mfma_f32_16x16x32_bf16 v[156:159], v[12:15], v[44:47], v[156:159]
    v_mfma_f32_16x16x32_bf16 v[160:163], v[8:11], v[48:51], v[160:163]
    v_mfma_f32_16x16x32_bf16 v[164:167], v[12:15], v[48:51], v[164:167]
    s_waitcnt vmcnt(0) lgkmcnt(0)
    s_barrier
    ds_read_b128 v[8:11], v202 offset:0
    v_mfma_f32_16x16x32_bf16 v[96:99], v[52:55], v[60:63], v[96:99]
    ds_read_b128 v[12:15], v202 offset:2048
    v_mfma_f32_16x16x32_bf16 v[100:103], v[56:59], v[60:63], v[100:103]
    ds_read_b128 v[16:19], v204 offset:0
    v_mfma_f32_16x16x32_bf16 v[104:107], v[52:55], v[64:67], v[104:107]
    ds_read_b128 v[20:23], v204 offset:2048
    v_mfma_f32_16x16x32_bf16 v[108:111], v[56:59], v[64:67], v[108:111]
    ds_read_b128 v[24:27], v204 offset:4096
    v_mfma_f32_16x16x32_bf16 v[112:115], v[52:55], v[68:71], v[112:115]
    ds_read_b128 v[28:31], v204 offset:6144
    v_mfma_f32_16x16x32_bf16 v[116:119], v[56:59], v[68:71], v[116:119]
    ds_read_b128 v[32:35], v204 offset:8192
    v_mfma_f32_16x16x32_bf16 v[120:123], v[52:55], v[72:75], v[120:123]
    ds_read_b128 v[36:39], v204 offset:10240
    v_mfma_f32_16x16x32_bf16 v[124:127], v[56:59], v[72:75], v[124:127]
    ds_read_b128 v[40:43], v204 offset:12288
    v_mfma_f32_16x16x32_bf16 v[128:131], v[52:55], v[76:79], v[128:131]
    ds_read_b128 v[44:47], v204 offset:14336
    v_mfma_f32_16x16x32_bf16 v[132:135], v[56:59], v[76:79], v[132:135]
    ds_read_b128 v[48:51], v204 offset:16384
    v_mfma_f32_16x16x32_bf16 v[136:139], v[52:55], v[80:83], v[136:139]
    v_mfma_f32_16x16x32_bf16 v[140:143], v[56:59], v[80:83], v[140:143]
    v_mfma_f32_16x16x32_bf16 v[144:147], v[52:55], v[84:87], v[144:147]
    v_mfma_f32_16x16x32_bf16 v[148:151], v[56:59], v[84:87], v[148:151]
    v_mfma_f32_16x16x32_bf16 v[152:155], v[52:55], v[88:91], v[152:155]
    v_mfma_f32_16x16x32_bf16 v[156:159], v[56:59], v[88:91], v[156:159]
    v_mfma_f32_16x16x32_bf16 v[160:163], v[52:55], v[92:95], v[160:163]
    v_mfma_f32_16x16x32_bf16 v[164:167], v[56:59], v[92:95], v[164:167]
    s_waitcnt lgkmcnt(0)
    v_mfma_f32_16x16x32_bf16 v[96:99], v[8:11], v[16:19], v[96:99]
    ds_read_b128 v[52:55], v203 offset:0
    v_mfma_f32_16x16x32_bf16 v[100:103], v[12:15], v[16:19], v[100:103]
    ds_read_b128 v[56:59], v203 offset:2048
    v_mfma_f32_16x16x32_bf16 v[104:107], v[8:11], v[20:23], v[104:107]
    ds_read_b128 v[60:63], v205 offset:0
    v_mfma_f32_16x16x32_bf16 v[108:111], v[12:15], v[20:23], v[108:111]
    ds_read_b128 v[64:67], v205 offset:2048
    v_mfma_f32_16x16x32_bf16 v[112:115], v[8:11], v[24:27], v[112:115]
    ds_read_b128 v[68:71], v205 offset:4096
    v_mfma_f32_16x16x32_bf16 v[116:119], v[12:15], v[24:27], v[116:119]
    ds_read_b128 v[72:75], v205 offset:6144
    v_mfma_f32_16x16x32_bf16 v[120:123], v[8:11], v[28:31], v[120:123]
    ds_read_b128 v[76:79], v205 offset:8192
    v_mfma_f32_16x16x32_bf16 v[124:127], v[12:15], v[28:31], v[124:127]
    ds_read_b128 v[80:83], v205 offset:10240
    v_mfma_f32_16x16x32_bf16 v[128:131], v[8:11], v[32:35], v[128:131]
    ds_read_b128 v[84:87], v205 offset:12288
    v_mfma_f32_16x16x32_bf16 v[132:135], v[12:15], v[32:35], v[132:135]
    ds_read_b128 v[88:91], v205 offset:14336
    v_mfma_f32_16x16x32_bf16 v[136:139], v[8:11], v[36:39], v[136:139]
    ds_read_b128 v[92:95], v205 offset:16384
    v_mfma_f32_16x16x32_bf16 v[140:143], v[12:15], v[36:39], v[140:143]
    v_mfma_f32_16x16x32_bf16 v[144:147], v[8:11], v[40:43], v[144:147]
    v_mfma_f32_16x16x32_bf16 v[148:151], v[12:15], v[40:43], v[148:151]
    v_mfma_f32_16x16x32_bf16 v[152:155], v[8:11], v[44:47], v[152:155]
    v_mfma_f32_16x16x32_bf16 v[156:159], v[12:15], v[44:47], v[156:159]
    v_mfma_f32_16x16x32_bf16 v[160:163], v[8:11], v[48:51], v[160:163]
    v_mfma_f32_16x16x32_bf16 v[164:167], v[12:15], v[48:51], v[164:167]
    s_waitcnt vmcnt(0) lgkmcnt(0)
    s_barrier
    v_mfma_f32_16x16x32_bf16 v[96:99], v[52:55], v[60:63], v[96:99]
    v_mfma_f32_16x16x32_bf16 v[100:103], v[56:59], v[60:63], v[100:103]
    v_mfma_f32_16x16x32_bf16 v[104:107], v[52:55], v[64:67], v[104:107]
    v_mfma_f32_16x16x32_bf16 v[108:111], v[56:59], v[64:67], v[108:111]
    v_mfma_f32_16x16x32_bf16 v[112:115], v[52:55], v[68:71], v[112:115]
    v_mfma_f32_16x16x32_bf16 v[116:119], v[56:59], v[68:71], v[116:119]
    v_mfma_f32_16x16x32_bf16 v[120:123], v[52:55], v[72:75], v[120:123]
    v_mfma_f32_16x16x32_bf16 v[124:127], v[56:59], v[72:75], v[124:127]
    v_mfma_f32_16x16x32_bf16 v[128:131], v[52:55], v[76:79], v[128:131]
    v_mfma_f32_16x16x32_bf16 v[132:135], v[56:59], v[76:79], v[132:135]
    v_mfma_f32_16x16x32_bf16 v[136:139], v[52:55], v[80:83], v[136:139]
    v_mfma_f32_16x16x32_bf16 v[140:143], v[56:59], v[80:83], v[140:143]
    v_mfma_f32_16x16x32_bf16 v[144:147], v[52:55], v[84:87], v[144:147]
    v_mfma_f32_16x16x32_bf16 v[148:151], v[56:59], v[84:87], v[148:151]
    v_mfma_f32_16x16x32_bf16 v[152:155], v[52:55], v[88:91], v[152:155]
    v_mfma_f32_16x16x32_bf16 v[156:159], v[56:59], v[88:91], v[156:159]
    v_mfma_f32_16x16x32_bf16 v[160:163], v[52:55], v[92:95], v[160:163]
    v_mfma_f32_16x16x32_bf16 v[164:167], v[56:59], v[92:95], v[164:167]
    s_waitcnt vmcnt(0) lgkmcnt(0)
    s_barrier
b1_kernel_z2epi:
    s_mov_b32 s98, 0xbdd2d3e8
    v_mov_b32 v7, 0xc0135761
    v_and_b32 v2, 15, v1
    s_mul_i32 s72, s71, 144
    v_add_u32 v2, s72, v2
    v_mul_u32_u24 v2, 272, v2
    v_lshrrev_b32 v3, 4, v1
    v_lshlrev_b32 v3, 3, v3
    v_add_u32 v2, v2, v3
    s_lshl_b32 s72, s70, 6
    v_add_u32 v2, s72, v2
    v_mov_b32 v16, 0
    v_mov_b32 v17, 0
    v_mov_b32 v18, 0
    v_mov_b32 v19, 0
    v_mov_b32 v20, 0
    v_mov_b32 v21, 0
    v_mov_b32 v22, 0
    v_mov_b32 v23, 0
    v_mov_b32 v24, 0
    v_mov_b32 v25, 0
    v_mov_b32 v26, 0
    v_mov_b32 v27, 0
    v_mov_b32 v28, 0
    v_mov_b32 v29, 0
    v_mov_b32 v30, 0
    v_mov_b32 v31, 0
    v_mul_f32 v8, v96, v96
    v_mul_f32 v9, v97, v97
    v_mul_f32 v10, v98, v98
    v_mul_f32 v11, v99, v99
    v_fma_f32 v8, v8, s98, v7
    v_fma_f32 v9, v9, s98, v7
    v_fma_f32 v10, v10, s98, v7
    v_fma_f32 v11, v11, s98, v7
    v_mul_f32 v8, v8, v96
    v_mul_f32 v9, v9, v97
    v_mul_f32 v10, v10, v98
    v_mul_f32 v11, v11, v99
    v_exp_f32 v8, v8
    v_exp_f32 v9, v9
    v_exp_f32 v10, v10
    v_exp_f32 v11, v11
    v_add_f32 v8, 1.0, v8
    v_add_f32 v9, 1.0, v9
    v_add_f32 v10, 1.0, v10
    v_add_f32 v11, 1.0, v11
    v_rcp_f32 v8, v8
    v_rcp_f32 v9, v9
    v_rcp_f32 v10, v10
    v_rcp_f32 v11, v11
    v_mul_f32 v96, v96, v8
    v_mul_f32 v97, v97, v9
    v_mul_f32 v98, v98, v10
    v_mul_f32 v99, v99, v11
    v_cvt_pk_bf16_f32 v96, v96, v97
    v_cvt_pk_bf16_f32 v97, v98, v99
    ds_write_b64 v2, v[96:97] offset:0
    v_lshlrev_b32 v8, 16, v96
    v_and_b32 v9, 0xffff0000, v96
    v_lshlrev_b32 v10, 16, v97
    v_and_b32 v11, 0xffff0000, v97
    v_add_f32 v16, v16, v8
    v_fmac_f32 v24, v8, v8
    v_add_f32 v17, v17, v9
    v_fmac_f32 v25, v9, v9
    v_add_f32 v18, v18, v10
    v_fmac_f32 v26, v10, v10
    v_add_f32 v19, v19, v11
    v_fmac_f32 v27, v11, v11
    v_mul_f32 v8, v100, v100
    v_mul_f32 v9, v101, v101
    v_mul_f32 v10, v102, v102
    v_mul_f32 v11, v103, v103
    v_fma_f32 v8, v8, s98, v7
    v_fma_f32 v9, v9, s98, v7
    v_fma_f32 v10, v10, s98, v7
    v_fma_f32 v11, v11, s98, v7
    v_mul_f32 v8, v8, v100
    v_mul_f32 v9, v9, v101
    v_mul_f32 v10, v10, v102
    v_mul_f32 v11, v11, v103
    v_exp_f32 v8, v8
    v_exp_f32 v9, v9
    v_exp_f32 v10, v10
    v_exp_f32 v11, v11
    v_add_f32 v8, 1.0, v8
    v_add_f32 v9, 1.0, v9
    v_add_f32 v10, 1.0, v10
    v_add_f32 v11, 1.0, v11
    v_rcp_f32 v8, v8
    v_rcp_f32 v9, v9
    v_rcp_f32 v10, v10
    v_rcp_f32 v11, v11
    v_mul_f32 v100, v100, v8
    v_mul_f32 v101, v101, v9
    v_mul_f32 v102, v102, v10
    v_mul_f32 v103, v103, v11
    v_cvt_pk_bf16_f32 v100, v100, v101
    v_cvt_pk_bf16_f32 v101, v102, v103
    ds_write_b64 v2, v[100:101] offset:32
    v_lshlrev_b32 v8, 16, v100
    v_and_b32 v9, 0xffff0000, v100
    v_lshlrev_b32 v10, 16, v101
    v_and_b32 v11, 0xffff0000, v101
    v_add_f32 v20, v20, v8
    v_fmac_f32 v28, v8, v8
    v_add_f32 v21, v21, v9
    v_fmac_f32 v29, v9, v9
    v_add_f32 v22, v22, v10
    v_fmac_f32 v30, v10, v10
    v_add_f32 v23, v23, v11
    v_fmac_f32 v31, v11, v11
    v_mul_f32 v8, v104, v104
    v_mul_f32 v9, v105, v105
    v_mul_f32 v10, v106, v106
    v_mul_f32 v11, v107, v107
    v_fma_f32 v8, v8, s98, v7
    v_fma_f32 v9, v9, s98, v7
    v_fma_f32 v10, v10, s98, v7
    v_fma_f32 v11, v11, s98, v7
    v_mul_f32 v8, v8, v104
    v_mul_f32 v9, v9, v105
    v_mul_f32 v10, v10, v106
    v_mul_f32 v11, v11, v107
    v_exp_f32 v8, v8
    v_exp_f32 v9, v9
    v_exp_f32 v10, v10
    v_exp_f32 v11, v11
    v_add_f32 v8, 1.0, v8
    v_add_f32 v9, 1.0, v9
    v_add_f32 v10, 1.0, v10
    v_add_f32 v11, 1.0, v11
    v_rcp_f32 v8, v8
    v_rcp_f32 v9, v9
    v_rcp_f32 v10, v10
    v_rcp_f32 v11, v11
    v_mul_f32 v104, v104, v8
    v_mul_f32 v105, v105, v9
    v_mul_f32 v106, v106, v10
    v_mul_f32 v107, v107, v11
    v_cvt_pk_bf16_f32 v104, v104, v105
    v_cvt_pk_bf16_f32 v105, v106, v107
    ds_write_b64 v2, v[104:105] offset:4352
    v_lshlrev_b32 v8, 16, v104
    v_and_b32 v9, 0xffff0000, v104
    v_lshlrev_b32 v10, 16, v105
    v_and_b32 v11, 0xffff0000, v105
    v_add_f32 v16, v16, v8
    v_fmac_f32 v24, v8, v8
    v_add_f32 v17, v17, v9
    v_fmac_f32 v25, v9, v9
    v_add_f32 v18, v18, v10
    v_fmac_f32 v26, v10, v10
    v_add_f32 v19, v19, v11
    v_fmac_f32 v27, v11, v11
    v_mul_f32 v8, v108, v108
    v_mul_f32 v9, v109, v109
    v_mul_f32 v10, v110, v110
    v_mul_f32 v11, v111, v111
    v_fma_f32 v8, v8, s98, v7
    v_fma_f32 v9, v9, s98, v7
    v_fma_f32 v10, v10, s98, v7
    v_fma_f32 v11, v11, s98, v7
    v_mul_f32 v8, v8, v108
    v_mul_f32 v9, v9, v109
    v_mul_f32 v10, v10, v110
    v_mul_f32 v11, v11, v111
    v_exp_f32 v8, v8
    v_exp_f32 v9, v9
    v_exp_f32 v10, v10
    v_exp_f32 v11, v11
    v_add_f32 v8, 1.0, v8
    v_add_f32 v9, 1.0, v9
    v_add_f32 v10, 1.0, v10
    v_add_f32 v11, 1.0, v11
    v_rcp_f32 v8, v8
    v_rcp_f32 v9, v9
    v_rcp_f32 v10, v10
    v_rcp_f32 v11, v11
    v_mul_f32 v108, v108, v8
    v_mul_f32 v109, v109, v9
    v_mul_f32 v110, v110, v10
    v_mul_f32 v111, v111, v11
    v_cvt_pk_bf16_f32 v108, v108, v109
    v_cvt_pk_bf16_f32 v109, v110, v111
    ds_write_b64 v2, v[108:109] offset:4384
    v_lshlrev_b32 v8, 16, v108
    v_and_b32 v9, 0xffff0000, v108
    v_lshlrev_b32 v10, 16, v109
    v_and_b32 v11, 0xffff0000, v109
    v_add_f32 v20, v20, v8
    v_fmac_f32 v28, v8, v8
    v_add_f32 v21, v21, v9
    v_fmac_f32 v29, v9, v9
    v_add_f32 v22, v22, v10
    v_fmac_f32 v30, v10, v10
    v_add_f32 v23, v23, v11
    v_fmac_f32 v31, v11, v11
    v_mul_f32 v8, v112, v112
    v_mul_f32 v9, v113, v113
    v_mul_f32 v10, v114, v114
    v_mul_f32 v11, v115, v115
    v_fma_f32 v8, v8, s98, v7
    v_fma_f32 v9, v9, s98, v7
    v_fma_f32 v10, v10, s98, v7
    v_fma_f32 v11, v11, s98, v7
    v_mul_f32 v8, v8, v112
    v_mul_f32 v9, v9, v113
    v_mul_f32 v10, v10, v114
    v_mul_f32 v11, v11, v115
    v_exp_f32 v8, v8
    v_exp_f32 v9, v9
    v_exp_f32 v10, v10
    v_exp_f32 v11, v11
    v_add_f32 v8, 1.0, v8
    v_add_f32 v9, 1.0, v9
    v_add_f32 v10, 1.0, v10
    v_add_f32 v11, 1.0, v11
    v_rcp_f32 v8, v8
    v_rcp_f32 v9, v9
    v_rcp_f32 v10, v10
    v_rcp_f32 v11, v11
    v_mul_f32 v112, v112, v8
    v_mul_f32 v113, v113, v9
    v_mul_f32 v114, v114, v10
    v_mul_f32 v115, v115, v11
    v_cvt_pk_bf16_f32 v112, v112, v113
    v_cvt_pk_bf16_f32 v113, v114, v115
    ds_write_b64 v2, v[112:113] offset:8704
    v_lshlrev_b32 v8, 16, v112
    v_and_b32 v9, 0xffff0000, v112
    v_lshlrev_b32 v10, 16, v113
    v_and_b32 v11, 0xffff0000, v113
    v_add_f32 v16, v16, v8
    v_fmac_f32 v24, v8, v8
    v_add_f32 v17, v17, v9
    v_fmac_f32 v25, v9, v9
    v_add_f32 v18, v18, v10
    v_fmac_f32 v26, v10, v10
    v_add_f32 v19, v19, v11
    v_fmac_f32 v27, v11, v11
    v_mul_f32 v8, v116, v116
    v_mul_f32 v9, v117, v117
    v_mul_f32 v10, v118, v118
    v_mul_f32 v11, v119, v119
    v_fma_f32 v8, v8, s98, v7
    v_fma_f32 v9, v9, s98, v7
    v_fma_f32 v10, v10, s98, v7
    v_fma_f32 v11, v11, s98, v7
    v_mul_f32 v8, v8, v116
    v_mul_f32 v9, v9, v117
    v_mul_f32 v10, v10, v118
    v_mul_f32 v11, v11, v119
    v_exp_f32 v8, v8
    v_exp_f32 v9, v9
    v_exp_f32 v10, v10
    v_exp_f32 v11, v11
    v_add_f32 v8, 1.0, v8
    v_add_f32 v9, 1.0, v9
    v_add_f32 v10, 1.0, v10
    v_add_f32 v11, 1.0, v11
    v_rcp_f32 v8, v8
    v_rcp_f32 v9, v9
    v_rcp_f32 v10, v10
    v_rcp_f32 v11, v11
    v_mul_f32 v116, v116, v8
    v_mul_f32 v117, v117, v9
    v_mul_f32 v118, v118, v10
    v_mul_f32 v119, v119, v11
    v_cvt_pk_bf16_f32 v116, v116, v117
    v_cvt_pk_bf16_f32 v117, v118, v119
    ds_write_b64 v2, v[116:117] offset:8736
    v_lshlrev_b32 v8, 16, v116
    v_and_b32 v9, 0xffff0000, v116
    v_lshlrev_b32 v10, 16, v117
    v_and_b32 v11, 0xffff0000, v117
    v_add_f32 v20, v20, v8
    v_fmac_f32 v28, v8, v8
    v_add_f32 v21, v21, v9
    v_fmac_f32 v29, v9, v9
    v_add_f32 v22, v22, v10
    v_fmac_f32 v30, v10, v10
    v_add_f32 v23, v23, v11
    v_fmac_f32 v31, v11, v11
    v_mul_f32 v8, v120, v120
    v_mul_f32 v9, v121, v121
    v_mul_f32 v10, v122, v122
    v_mul_f32 v11, v123, v123
    v_fma_f32 v8, v8, s98, v7
    v_fma_f32 v9, v9, s98, v7
    v_fma_f32 v10, v10, s98, v7
    v_fma_f32 v11, v11, s98, v7
    v_mul_f32 v8, v8, v120
    v_mul_f32 v9, v9, v121
    v_mul_f32 v10, v10, v122
    v_mul_f32 v11, v11, v123
    v_exp_f32 v8, v8
    v_exp_f32 v9, v9
    v_exp_f32 v10, v10
    v_exp_f32 v11, v11
    v_add_f32 v8, 1.0, v8
    v_add_f32 v9, 1.0, v9
    v_add_f32 v10, 1.0, v10
    v_add_f32 v11, 1.0, v11
    v_rcp_f32 v8, v8
    v_rcp_f32 v9, v9
    v_rcp_f32 v10, v10
    v_rcp_f32 v11, v11
    v_mul_f32 v120, v120, v8
    v_mul_f32 v121, v121, v9
    v_mul_f32 v122, v122, v10
    v_mul_f32 v123, v123, v11
    v_cvt_pk_bf16_f32 v120, v120, v121
    v_cvt_pk_bf16_f32 v121, v122, v123
    ds_write_b64 v2, v[120:121] offset:13056
    v_lshlrev_b32 v8, 16, v120
    v_and_b32 v9, 0xffff0000, v120
    v_lshlrev_b32 v10, 16, v121
    v_and_b32 v11, 0xffff0000, v121
    v_add_f32 v16, v16, v8
    v_fmac_f32 v24, v8, v8
    v_add_f32 v17, v17, v9
    v_fmac_f32 v25, v9, v9
    v_add_f32 v18, v18, v10
    v_fmac_f32 v26, v10, v10
    v_add_f32 v19, v19, v11
    v_fmac_f32 v27, v11, v11
    v_mul_f32 v8, v124, v124
    v_mul_f32 v9, v125, v125
    v_mul_f32 v10, v126, v126
    v_mul_f32 v11, v127, v127
    v_fma_f32 v8, v8, s98, v7
    v_fma_f32 v9, v9, s98, v7
    v_fma_f32 v10, v10, s98, v7
    v_fma_f32 v11, v11, s98, v7
    v_mul_f32 v8, v8, v124
    v_mul_f32 v9, v9, v125
    v_mul_f32 v10, v10, v126
    v_mul_f32 v11, v11, v127
    v_exp_f32 v8, v8
    v_exp_f32 v9, v9
    v_exp_f32 v10, v10
    v_exp_f32 v11, v11
    v_add_f32 v8, 1.0, v8
    v_add_f32 v9, 1.0, v9
    v_add_f32 v10, 1.0, v10
    v_add_f32 v11, 1.0, v11
    v_rcp_f32 v8, v8
    v_rcp_f32 v9, v9
    v_rcp_f32 v10, v10
    v_rcp_f32 v11, v11
    v_mul_f32 v124, v124, v8
    v_mul_f32 v125, v125, v9
    v_mul_f32 v126, v126, v10
    v_mul_f32 v127, v127, v11
    v_cvt_pk_bf16_f32 v124, v124, v125
    v_cvt_pk_bf16_f32 v125, v126, v127
    ds_write_b64 v2, v[124:125] offset:13088
    v_lshlrev_b32 v8, 16, v124
    v_and_b32 v9, 0xffff0000, v124
    v_lshlrev_b32 v10, 16, v125
    v_and_b32 v11, 0xffff0000, v125
    v_add_f32 v20, v20, v8
    v_fmac_f32 v28, v8, v8
    v_add_f32 v21, v21, v9
    v_fmac_f32 v29, v9, v9
    v_add_f32 v22, v22, v10
    v_fmac_f32 v30, v10, v10
    v_add_f32 v23, v23, v11
    v_fmac_f32 v31, v11, v11
    v_mul_f32 v8, v128, v128
    v_mul_f32 v9, v129, v129
    v_mul_f32 v10, v130, v130
    v_mul_f32 v11, v131, v131
    v_fma_f32 v8, v8, s98, v7
    v_fma_f32 v9, v9, s98, v7
    v_fma_f32 v10, v10, s98, v7
    v_fma_f32 v11, v11, s98, v7
    v_mul_f32 v8, v8, v128
    v_mul_f32 v9, v9, v129
    v_mul_f32 v10, v10, v130
    v_mul_f32 v11, v11, v131
    v_exp_f32 v8, v8
    v_exp_f32 v9, v9
    v_exp_f32 v10, v10
    v_exp_f32 v11, v11
    v_add_f32 v8, 1.0, v8
    v_add_f32 v9, 1.0, v9
    v_add_f32 v10, 1.0, v10
    v_add_f32 v11, 1.0, v11
    v_rcp_f32 v8, v8
    v_rcp_f32 v9, v9
    v_rcp_f32 v10, v10
    v_rcp_f32 v11, v11
    v_mul_f32 v128, v128, v8
    v_mul_f32 v129, v129, v9
    v_mul_f32 v130, v130, v10
    v_mul_f32 v131, v131, v11
    v_cvt_pk_bf16_f32 v128, v128, v129
    v_cvt_pk_bf16_f32 v129, v130, v131
    ds_write_b64 v2, v[128:129] offset:17408
    v_lshlrev_b32 v8, 16, v128
    v_and_b32 v9, 0xffff0000, v128
    v_lshlrev_b32 v10, 16, v129
    v_and_b32 v11, 0xffff0000, v129
    v_add_f32 v16, v16, v8
    v_fmac_f32 v24, v8, v8
    v_add_f32 v17, v17, v9
    v_fmac_f32 v25, v9, v9
    v_add_f32 v18, v18, v10
    v_fmac_f32 v26, v10, v10
    v_add_f32 v19, v19, v11
    v_fmac_f32 v27, v11, v11
    v_mul_f32 v8, v132, v132
    v_mul_f32 v9, v133, v133
    v_mul_f32 v10, v134, v134
    v_mul_f32 v11, v135, v135
    v_fma_f32 v8, v8, s98, v7
    v_fma_f32 v9, v9, s98, v7
    v_fma_f32 v10, v10, s98, v7
    v_fma_f32 v11, v11, s98, v7
    v_mul_f32 v8, v8, v132
    v_mul_f32 v9, v9, v133
    v_mul_f32 v10, v10, v134
    v_mul_f32 v11, v11, v135
    v_exp_f32 v8, v8
    v_exp_f32 v9, v9
    v_exp_f32 v10, v10
    v_exp_f32 v11, v11
    v_add_f32 v8, 1.0, v8
    v_add_f32 v9, 1.0, v9
    v_add_f32 v10, 1.0, v10
    v_add_f32 v11, 1.0, v11
    v_rcp_f32 v8, v8
    v_rcp_f32 v9, v9
    v_rcp_f32 v10, v10
    v_rcp_f32 v11, v11
    v_mul_f32 v132, v132, v8
    v_mul_f32 v133, v133, v9
    v_mul_f32 v134, v134, v10
    v_mul_f32 v135, v135, v11
    v_cvt_pk_bf16_f32 v132, v132, v133
    v_cvt_pk_bf16_f32 v133, v134, v135
    ds_write_b64 v2, v[132:133] offset:17440
    v_lshlrev_b32 v8, 16, v132
    v_and_b32 v9, 0xffff0000, v132
    v_lshlrev_b32 v10, 16, v133
    v_and_b32 v11, 0xffff0000, v133
    v_add_f32 v20, v20, v8
    v_fmac_f32 v28, v8, v8
    v_add_f32 v21, v21, v9
    v_fmac_f32 v29, v9, v9
    v_add_f32 v22, v22, v10
    v_fmac_f32 v30, v10, v10
    v_add_f32 v23, v23, v11
    v_fmac_f32 v31, v11, v11
    v_mul_f32 v8, v136, v136
    v_mul_f32 v9, v137, v137
    v_mul_f32 v10, v138, v138
    v_mul_f32 v11, v139, v139
    v_fma_f32 v8, v8, s98, v7
    v_fma_f32 v9, v9, s98, v7
    v_fma_f32 v10, v10, s98, v7
    v_fma_f32 v11, v11, s98, v7
    v_mul_f32 v8, v8, v136
    v_mul_f32 v9, v9, v137
    v_mul_f32 v10, v10, v138
    v_mul_f32 v11, v11, v139
    v_exp_f32 v8, v8
    v_exp_f32 v9, v9
    v_exp_f32 v10, v10
    v_exp_f32 v11, v11
    v_add_f32 v8, 1.0, v8
    v_add_f32 v9, 1.0, v9
    v_add_f32 v10, 1.0, v10
    v_add_f32 v11, 1.0, v11
    v_rcp_f32 v8, v8
    v_rcp_f32 v9, v9
    v_rcp_f32 v10, v10
    v_rcp_f32 v11, v11
    v_mul_f32 v136, v136, v8
    v_mul_f32 v137, v137, v9
    v_mul_f32 v138, v138, v10
    v_mul_f32 v139, v139, v11
    v_cvt_pk_bf16_f32 v136, v136, v137
    v_cvt_pk_bf16_f32 v137, v138, v139
    ds_write_b64 v2, v[136:137] offset:21760
    v_lshlrev_b32 v8, 16, v136
    v_and_b32 v9, 0xffff0000, v136
    v_lshlrev_b32 v10, 16, v137
    v_and_b32 v11, 0xffff0000, v137
    v_add_f32 v16, v16, v8
    v_fmac_f32 v24, v8, v8
    v_add_f32 v17, v17, v9
    v_fmac_f32 v25, v9, v9
    v_add_f32 v18, v18, v10
    v_fmac_f32 v26, v10, v10
    v_add_f32 v19, v19, v11
    v_fmac_f32 v27, v11, v11
    v_mul_f32 v8, v140, v140
    v_mul_f32 v9, v141, v141
    v_mul_f32 v10, v142, v142
    v_mul_f32 v11, v143, v143
    v_fma_f32 v8, v8, s98, v7
    v_fma_f32 v9, v9, s98, v7
    v_fma_f32 v10, v10, s98, v7
    v_fma_f32 v11, v11, s98, v7
    v_mul_f32 v8, v8, v140
    v_mul_f32 v9, v9, v141
    v_mul_f32 v10, v10, v142
    v_mul_f32 v11, v11, v143
    v_exp_f32 v8, v8
    v_exp_f32 v9, v9
    v_exp_f32 v10, v10
    v_exp_f32 v11, v11
    v_add_f32 v8, 1.0, v8
    v_add_f32 v9, 1.0, v9
    v_add_f32 v10, 1.0, v10
    v_add_f32 v11, 1.0, v11
    v_rcp_f32 v8, v8
    v_rcp_f32 v9, v9
    v_rcp_f32 v10, v10
    v_rcp_f32 v11, v11
    v_mul_f32 v140, v140, v8
    v_mul_f32 v141, v141, v9
    v_mul_f32 v142, v142, v10
    v_mul_f32 v143, v143, v11
    v_cvt_pk_bf16_f32 v140, v140, v141
    v_cvt_pk_bf16_f32 v141, v142, v143
    ds_write_b64 v2, v[140:141] offset:21792
    v_lshlrev_b32 v8, 16, v140
    v_and_b32 v9, 0xffff0000, v140
    v_lshlrev_b32 v10, 16, v141
    v_and_b32 v11, 0xffff0000, v141
    v_add_f32 v20, v20, v8
    v_fmac_f32 v28, v8, v8
    v_add_f32 v21, v21, v9
    v_fmac_f32 v29, v9, v9
    v_add_f32 v22, v22, v10
    v_fmac_f32 v30, v10, v10
    v_add_f32 v23, v23, v11
    v_fmac_f32 v31, v11, v11
    v_mul_f32 v8, v144, v144
    v_mul_f32 v9, v145, v145
    v_mul_f32 v10, v146, v146
    v_mul_f32 v11, v147, v147
    v_fma_f32 v8, v8, s98, v7
    v_fma_f32 v9, v9, s98, v7
    v_fma_f32 v10, v10, s98, v7
    v_fma_f32 v11, v11, s98, v7
    v_mul_f32 v8, v8, v144
    v_mul_f32 v9, v9, v145
    v_mul_f32 v10, v10, v146
    v_mul_f32 v11, v11, v147
    v_exp_f32 v8, v8
    v_exp_f32 v9, v9
    v_exp_f32 v10, v10
    v_exp_f32 v11, v11
    v_add_f32 v8, 1.0, v8
    v_add_f32 v9, 1.0, v9
    v_add_f32 v10, 1.0, v10
    v_add_f32 v11, 1.0, v11
    v_rcp_f32 v8, v8
    v_rcp_f32 v9, v9
    v_rcp_f32 v10, v10
    v_rcp_f32 v11, v11
    v_mul_f32 v144, v144, v8
    v_mul_f32 v145, v145, v9
    v_mul_f32 v146, v146, v10
    v_mul_f32 v147, v147, v11
    v_cvt_pk_bf16_f32 v144, v144, v145
    v_cvt_pk_bf16_f32 v145, v146, v147
    ds_write_b64 v2, v[144:145] offset:26112
    v_lshlrev_b32 v8, 16, v144
    v_and_b32 v9, 0xffff0000, v144
    v_lshlrev_b32 v10, 16, v145
    v_and_b32 v11, 0xffff0000, v145
    v_add_f32 v16, v16, v8
    v_fmac_f32 v24, v8, v8
    v_add_f32 v17, v17, v9
    v_fmac_f32 v25, v9, v9
    v_add_f32 v18, v18, v10
    v_fmac_f32 v26, v10, v10
    v_add_f32 v19, v19, v11
    v_fmac_f32 v27, v11, v11
    v_mul_f32 v8, v148, v148
    v_mul_f32 v9, v149, v149
    v_mul_f32 v10, v150, v150
    v_mul_f32 v11, v151, v151
    v_fma_f32 v8, v8, s98, v7
    v_fma_f32 v9, v9, s98, v7
    v_fma_f32 v10, v10, s98, v7
    v_fma_f32 v11, v11, s98, v7
    v_mul_f32 v8, v8, v148
    v_mul_f32 v9, v9, v149
    v_mul_f32 v10, v10, v150
    v_mul_f32 v11, v11, v151
    v_exp_f32 v8, v8
    v_exp_f32 v9, v9
    v_exp_f32 v10, v10
    v_exp_f32 v11, v11
    v_add_f32 v8, 1.0, v8
    v_add_f32 v9, 1.0, v9
    v_add_f32 v10, 1.0, v10
    v_add_f32 v11, 1.0, v11
    v_rcp_f32 v8, v8
    v_rcp_f32 v9, v9
    v_rcp_f32 v10, v10
    v_rcp_f32 v11, v11
    v_mul_f32 v148, v148, v8
    v_mul_f32 v149, v149, v9
    v_mul_f32 v150, v150, v10
    v_mul_f32 v151, v151, v11
    v_cvt_pk_bf16_f32 v148, v148, v149
    v_cvt_pk_bf16_f32 v149, v150, v151
    ds_write_b64 v2, v[148:149] offset:26144
    v_lshlrev_b32 v8, 16, v148
    v_and_b32 v9, 0xffff0000, v148
    v_lshlrev_b32 v10, 16, v149
    v_and_b32 v11, 0xffff0000, v149
    v_add_f32 v20, v20, v8
    v_fmac_f32 v28, v8, v8
    v_add_f32 v21, v21, v9
    v_fmac_f32 v29, v9, v9
    v_add_f32 v22, v22, v10
    v_fmac_f32 v30, v10, v10
    v_add_f32 v23, v23, v11
    v_fmac_f32 v31, v11, v11
    v_mul_f32 v8, v152, v152
    v_mul_f32 v9, v153, v153
    v_mul_f32 v10, v154, v154
    v_mul_f32 v11, v155, v155
    v_fma_f32 v8, v8, s98, v7
    v_fma_f32 v9, v9, s98, v7
    v_fma_f32 v10, v10, s98, v7
    v_fma_f32 v11, v11, s98, v7
    v_mul_f32 v8, v8, v152
    v_mul_f32 v9, v9, v153
    v_mul_f32 v10, v10, v154
    v_mul_f32 v11, v11, v155
    v_exp_f32 v8, v8
    v_exp_f32 v9, v9
    v_exp_f32 v10, v10
    v_exp_f32 v11, v11
    v_add_f32 v8, 1.0, v8
    v_add_f32 v9, 1.0, v9
    v_add_f32 v10, 1.0, v10
    v_add_f32 v11, 1.0, v11
    v_rcp_f32 v8, v8
    v_rcp_f32 v9, v9
    v_rcp_f32 v10, v10
    v_rcp_f32 v11, v11
    v_mul_f32 v152, v152, v8
    v_mul_f32 v153, v153, v9
    v_mul_f32 v154, v154, v10
    v_mul_f32 v155, v155, v11
    v_cvt_pk_bf16_f32 v152, v152, v153
    v_cvt_pk_bf16_f32 v153, v154, v155
    ds_write_b64 v2, v[152:153] offset:30464
    v_lshlrev_b32 v8, 16, v152
    v_and_b32 v9, 0xffff0000, v152
    v_lshlrev_b32 v10, 16, v153
    v_and_b32 v11, 0xffff0000, v153
    v_add_f32 v16, v16, v8
    v_fmac_f32 v24, v8, v8
    v_add_f32 v17, v17, v9
    v_fmac_f32 v25, v9, v9
    v_add_f32 v18, v18, v10
    v_fmac_f32 v26, v10, v10
    v_add_f32 v19, v19, v11
    v_fmac_f32 v27, v11, v11
    v_mul_f32 v8, v156, v156
    v_mul_f32 v9, v157, v157
    v_mul_f32 v10, v158, v158
    v_mul_f32 v11, v159, v159
    v_fma_f32 v8, v8, s98, v7
    v_fma_f32 v9, v9, s98, v7
    v_fma_f32 v10, v10, s98, v7
    v_fma_f32 v11, v11, s98, v7
    v_mul_f32 v8, v8, v156
    v_mul_f32 v9, v9, v157
    v_mul_f32 v10, v10, v158
    v_mul_f32 v11, v11, v159
    v_exp_f32 v8, v8
    v_exp_f32 v9, v9
    v_exp_f32 v10, v10
    v_exp_f32 v11, v11
    v_add_f32 v8, 1.0, v8
    v_add_f32 v9, 1.0, v9
    v_add_f32 v10, 1.0, v10
    v_add_f32 v11, 1.0, v11
    v_rcp_f32 v8, v8
    v_rcp_f32 v9, v9
    v_rcp_f32 v10, v10
    v_rcp_f32 v11, v11
    v_mul_f32 v156, v156, v8
    v_mul_f32 v157, v157, v9
    v_mul_f32 v158, v158, v10
    v_mul_f32 v159, v159, v11
    v_cvt_pk_bf16_f32 v156, v156, v157
    v_cvt_pk_bf16_f32 v157, v158, v159
    ds_write_b64 v2, v[156:157] offset:30496
    v_lshlrev_b32 v8, 16, v156
    v_and_b32 v9, 0xffff0000, v156
    v_lshlrev_b32 v10, 16, v157
    v_and_b32 v11, 0xffff0000, v157
    v_add_f32 v20, v20, v8
    v_fmac_f32 v28, v8, v8
    v_add_f32 v21, v21, v9
    v_fmac_f32 v29, v9, v9
    v_add_f32 v22, v22, v10
    v_fmac_f32 v30, v10, v10
    v_add_f32 v23, v23, v11
    v_fmac_f32 v31, v11, v11
    v_mul_f32 v8, v160, v160
    v_mul_f32 v9, v161, v161
    v_mul_f32 v10, v162, v162
    v_mul_f32 v11, v163, v163
    v_fma_f32 v8, v8, s98, v7
    v_fma_f32 v9, v9, s98, v7
    v_fma_f32 v10, v10, s98, v7
    v_fma_f32 v11, v11, s98, v7
    v_mul_f32 v8, v8, v160
    v_mul_f32 v9, v9, v161
    v_mul_f32 v10, v10, v162
    v_mul_f32 v11, v11, v163
    v_exp_f32 v8, v8
    v_exp_f32 v9, v9
    v_exp_f32 v10, v10
    v_exp_f32 v11, v11
    v_add_f32 v8, 1.0, v8
    v_add_f32 v9, 1.0, v9
    v_add_f32 v10, 1.0, v10
    v_add_f32 v11, 1.0, v11
    v_rcp_f32 v8, v8
    v_rcp_f32 v9, v9
    v_rcp_f32 v10, v10
    v_rcp_f32 v11, v11
    v_mul_f32 v160, v160, v8
    v_mul_f32 v161, v161, v9
    v_mul_f32 v162, v162, v10
    v_mul_f32 v163, v163, v11
    v_cvt_pk_bf16_f32 v160, v160, v161
    v_cvt_pk_bf16_f32 v161, v162, v163
    ds_write_b64 v2, v[160:161] offset:34816
    v_lshlrev_b32 v8, 16, v160
    v_and_b32 v9, 0xffff0000, v160
    v_lshlrev_b32 v10, 16, v161
    v_and_b32 v11, 0xffff0000, v161
    v_add_f32 v16, v16, v8
    v_fmac_f32 v24, v8, v8
    v_add_f32 v17, v17, v9
    v_fmac_f32 v25, v9, v9
    v_add_f32 v18, v18, v10
    v_fmac_f32 v26, v10, v10
    v_add_f32 v19, v19, v11
    v_fmac_f32 v27, v11, v11
    v_mul_f32 v8, v164, v164
    v_mul_f32 v9, v165, v165
    v_mul_f32 v10, v166, v166
    v_mul_f32 v11, v167, v167
    v_fma_f32 v8, v8, s98, v7
    v_fma_f32 v9, v9, s98, v7
    v_fma_f32 v10, v10, s98, v7
    v_fma_f32 v11, v11, s98, v7
    v_mul_f32 v8, v8, v164
    v_mul_f32 v9, v9, v165
    v_mul_f32 v10, v10, v166
    v_mul_f32 v11, v11, v167
    v_exp_f32 v8, v8
    v_exp_f32 v9, v9
    v_exp_f32 v10, v10
    v_exp_f32 v11, v11
    v_add_f32 v8, 1.0, v8
    v_add_f32 v9, 1.0, v9
    v_add_f32 v10, 1.0, v10
    v_add_f32 v11, 1.0, v11
    v_rcp_f32 v8, v8
    v_rcp_f32 v9, v9
    v_rcp_f32 v10, v10
    v_rcp_f32 v11, v11
    v_mul_f32 v164, v164, v8
    v_mul_f32 v165, v165, v9
    v_mul_f32 v166, v166, v10
    v_mul_f32 v167, v167, v11
    v_cvt_pk_bf16_f32 v164, v164, v165
    v_cvt_pk_bf16_f32 v165, v166, v167
    ds_write_b64 v2, v[164:165] offset:34848
    v_lshlrev_b32 v8, 16, v164
    v_and_b32 v9, 0xffff0000, v164
    v_lshlrev_b32 v10, 16, v165
    v_and_b32 v11, 0xffff0000, v165
    v_add_f32 v20, v20, v8
    v_fmac_f32 v28, v8, v8
    v_add_f32 v21, v21, v9
    v_fmac_f32 v29, v9, v9
    v_add_f32 v22, v22, v10
    v_fmac_f32 v30, v10, v10
    v_add_f32 v23, v23, v11
    v_fmac_f32 v31, v11, v11
    s_nop 1
    v_add_f32_dpp v16, v16, v16 row_ror:8 row_mask:0xf bank_mask:0xf
    v_add_f32_dpp v17, v17, v17 row_ror:8 row_mask:0xf bank_mask:0xf
    v_add_f32_dpp v18, v18, v18 row_ror:8 row_mask:0xf bank_mask:0xf
    v_add_f32_dpp v19, v19, v19 row_ror:8 row_mask:0xf bank_mask:0xf
    v_add_f32_dpp v20, v20, v20 row_ror:8 row_mask:0xf bank_mask:0xf
    v_add_f32_dpp v21, v21, v21 row_ror:8 row_mask:0xf bank_mask:0xf
    v_add_f32_dpp v22, v22, v22 row_ror:8 row_mask:0xf bank_mask:0xf
    v_add_f32_dpp v23, v23, v23 row_ror:8 row_mask:0xf bank_mask:0xf
    v_add_f32_dpp v24, v24, v24 row_ror:8 row_mask:0xf bank_mask:0xf
    v_add_f32_dpp v25, v25, v25 row_ror:8 row_mask:0xf bank_mask:0xf
    v_add_f32_dpp v26, v26, v26 row_ror:8 row_mask:0xf bank_mask:0xf
    v_add_f32_dpp v27, v27, v27 row_ror:8 row_mask:0xf bank_mask:0xf
    v_add_f32_dpp v28, v28, v28 row_ror:8 row_mask:0xf bank_mask:0xf
    v_add_f32_dpp v29, v29, v29 row_ror:8 row_mask:0xf bank_mask:0xf
    v_add_f32_dpp v30, v30, v30 row_ror:8 row_mask:0xf bank_mask:0xf
    v_add_f32_dpp v31, v31, v31 row_ror:8 row_mask:0xf bank_mask:0xf
    s_nop 1
    v_add_f32_dpp v16, v16, v16 row_ror:4 row_mask:0xf bank_mask:0xf
    v_add_f32_dpp v17, v17, v17 row_ror:4 row_mask:0xf bank_mask:0xf
    v_add_f32_dpp v18, v18, v18 row_ror:4 row_mask:0xf bank_mask:0xf
    v_add_f32_dpp v19, v19, v19 row_ror:4 row_mask:0xf bank_mask:0xf
    v_add_f32_dpp v20, v20, v20 row_ror:4 row_mask:0xf bank_mask:0xf
    v_add_f32_dpp v21, v21, v21 row_ror:4 row_mask:0xf bank_mask:0xf
    v_add_f32_dpp v22, v22, v22 row_ror:4 row_mask:0xf bank_mask:0xf
    v_add_f32_dpp v23, v23, v23 row_ror:4 row_mask:0xf bank_mask:0xf
    v_add_f32_dpp v24, v24, v24 row_ror:4 row_mask:0xf bank_mask:0xf
    v_add_f32_dpp v25, v25, v25 row_ror:4 row_mask:0xf bank_mask:0xf
    v_add_f32_dpp v26, v26, v26 row_ror:4 row_mask:0xf bank_mask:0xf
    v_add_f32_dpp v27, v27, v27 row_ror:4 row_mask:0xf bank_mask:0xf
    v_add_f32_dpp v28, v28, v28 row_ror:4 row_mask:0xf bank_mask:0xf
    v_add_f32_dpp v29, v29, v29 row_ror:4 row_mask:0xf bank_mask:0xf
    v_add_f32_dpp v30, v30, v30 row_ror:4 row_mask:0xf bank_mask:0xf
    v_add_f32_dpp v31, v31, v31 row_ror:4 row_mask:0xf bank_mask:0xf
    s_nop 1
    v_add_f32_dpp v16, v16, v16 row_ror:2 row_mask:0xf bank_mask:0xf
    v_add_f32_dpp v17, v17, v17 row_ror:2 row_mask:0xf bank_mask:0xf
    v_add_f32_dpp v18, v18, v18 row_ror:2 row_mask:0xf bank_mask:0xf
    v_add_f32_dpp v19, v19, v19 row_ror:2 row_mask:0xf bank_mask:0xf
    v_add_f32_dpp v20, v20, v20 row_ror:2 row_mask:0xf bank_mask:0xf
    v_add_f32_dpp v21, v21, v21 row_ror:2 row_mask:0xf bank_mask:0xf
    v_add_f32_dpp v22, v22, v22 row_ror:2 row_mask:0xf bank_mask:0xf
    v_add_f32_dpp v23, v23, v23 row_ror:2 row_mask:0xf bank_mask:0xf
    v_add_f32_dpp v24, v24, v24 row_ror:2 row_mask:0xf bank_mask:0xf
    v_add_f32_dpp v25, v25, v25 row_ror:2 row_mask:0xf bank_mask:0xf
    v_add_f32_dpp v26, v26, v26 row_ror:2 row_mask:0xf bank_mask:0xf
    v_add_f32_dpp v27, v27, v27 row_ror:2 row_mask:0xf bank_mask:0xf
    v_add_f32_dpp v28, v28, v28 row_ror:2 row_mask:0xf bank_mask:0xf
    v_add_f32_dpp v29, v29, v29 row_ror:2 row_mask:0xf bank_mask:0xf
    v_add_f32_dpp v30, v30, v30 row_ror:2 row_mask:0xf bank_mask:0xf
    v_add_f32_dpp v31, v31, v31 row_ror:2 row_mask:0xf bank_mask:0xf
    s_nop 1
    v_add_f32_dpp v16, v16, v16 row_ror:1 row_mask:0xf bank_mask:0xf
    v_add_f32_dpp v17, v17, v17 row_ror:1 row_mask:0xf bank_mask:0xf
    v_add_f32_dpp v18, v18, v18 row_ror:1 row_mask:0xf bank_mask:0xf
    v_add_f32_dpp v19, v19, v19 row_ror:1 row_mask:0xf bank_mask:0xf
    v_add_f32_dpp v20, v20, v20 row_ror:1 row_mask:0xf bank_mask:0xf
    v_add_f32_dpp v21, v21, v21 row_ror:1 row_mask:0xf bank_mask:0xf
    v_add_f32_dpp v22, v22, v22 row_ror:1 row_mask:0xf bank_mask:0xf
    v_add_f32_dpp v23, v23, v23 row_ror:1 row_mask:0xf bank_mask:0xf
    v_add_f32_dpp v24, v24, v24 row_ror:1 row_mask:0xf bank_mask:0xf
    v_add_f32_dpp v25, v25, v25 row_ror:1 row_mask:0xf bank_mask:0xf
    v_add_f32_dpp v26, v26, v26 row_ror:1 row_mask:0xf bank_mask:0xf
    v_add_f32_dpp v27, v27, v27 row_ror:1 row_mask:0xf bank_mask:0xf
    v_add_f32_dpp v28, v28, v28 row_ror:1 row_mask:0xf bank_mask:0xf
    v_add_f32_dpp v29, v29, v29 row_ror:1 row_mask:0xf bank_mask:0xf
    v_add_f32_dpp v30, v30, v30 row_ror:1 row_mask:0xf bank_mask:0xf
    v_add_f32_dpp v31, v31, v31 row_ror:1 row_mask:0xf bank_mask:0xf
    v_lshrrev_b32 v3, 4, v1
    v_lshlrev_b32 v3, 2, v3
    s_lshl_b32 s68, s61, 7
    s_lshl_b32 s69, s70, 5
    s_add_u32 s68, s68, s69
    v_add_u32 v3, s68, v3
    v_lshlrev_b32 v3, 7, v3
    s_sub_u32 s68, s62, 8
    s_lshl_b32 s68, s68, 1
    s_add_u32 s68, s68, s71
    s_lshl_b32 s68, s68, 3
    v_add_u32 v3, s68, v3
    v_and_b32 v4, 15, v1
    v_cmp_eq_u32 vcc, 0, v4
    s_and_saveexec_b64 s[74:75], vcc
    v_mov_b32 v32, v16
    v_mov_b32 v33, v24
    buffer_store_dwordx2 v[32:33], v3, s[56:59], 0 offen offset:0 sc0 sc1
    v_mov_b32 v34, v17
    v_mov_b32 v35, v25
    buffer_store_dwordx2 v[34:35], v3, s[56:59], 0 offen offset:128 sc0 sc1
    v_mov_b32 v36, v18
    v_mov_b32 v37, v26
    buffer_store_dwordx2 v[36:37], v3, s[56:59], 0 offen offset:256 sc0 sc1
    v_mov_b32 v38, v19
    v_mov_b32 v39, v27
    buffer_store_dwordx2 v[38:39], v3, s[56:59], 0 offen offset:384 sc0 sc1
    v_mov_b32 v40, v20
    v_mov_b32 v41, v28
    buffer_store_dwordx2 v[40:41], v3, s[56:59], 0 offen offset:2048 sc0 sc1
    v_mov_b32 v42, v21
    v_mov_b32 v43, v29
    buffer_store_dwordx2 v[42:43], v3, s[56:59], 0 offen offset:2176 sc0 sc1
    v_mov_b32 v44, v22
    v_mov_b32 v45, v30
    buffer_store_dwordx2 v[44:45], v3, s[56:59], 0 offen offset:2304 sc0 sc1
    v_mov_b32 v46, v23
    v_mov_b32 v47, v31
    buffer_store_dwordx2 v[46:47], v3, s[56:59], 0 offen offset:2432 sc0 sc1
    s_mov_b64 exec, s[74:75]
    s_waitcnt vmcnt(0) lgkmcnt(0)
    s_barrier
    s_cmp_lg_u32 s60, 0
    s_cbranch_scc1 b1_kernel_noarr
    v_mov_b32 v4, 1
    s_lshl_b32 s68, s61, 2
    v_mov_b32 v5, s68
    v_cmp_eq_u32 vcc, 0, v1
    s_and_saveexec_b64 s[74:75], vcc
    buffer_atomic_add v4, v5, s[80:83], 0 offen sc1
b1_kernel_spin:
    buffer_load_dword v4, v5, s[80:83], 0 offen sc0 sc1
    s_waitcnt vmcnt(0)
    v_readfirstlane_b32 s72, v4
    s_cmp_ge_u32 s72, 8
    s_cbranch_scc1 b1_kernel_spun
    s_sleep 4
    s_branch b1_kernel_spin
b1_kernel_spun:
    s_mov_b64 exec, s[74:75]
b1_kernel_noarr:
    s_barrier
    s_cmp_ge_u32 s60, 2
    s_cbranch_scc1 b1_kernel_nofin
    s_lshl_b32 s68, s61, 7
    v_add_u32 v5, s68, v0
    v_lshlrev_b32 v6, 7, v5
    s_mov_b32 s73, 0x39e38e39
    buffer_load_dwordx4 v[48:51], v6, s[56:59], 0 offen offset:0 sc0 sc1
    buffer_load_dwordx4 v[52:55], v6, s[56:59], 0 offen offset:16 sc0 sc1
    buffer_load_dwordx4 v[56:59], v6, s[56:59], 0 offen offset:32 sc0 sc1
    buffer_load_dwordx4 v[60:63], v6, s[56:59], 0 offen offset:48 sc0 sc1
    buffer_load_dwordx4 v[64:67], v6, s[56:59], 0 offen offset:64 sc0 sc1
    buffer_load_dwordx4 v[68:71], v6, s[56:59], 0 offen offset:80 sc0 sc1
    buffer_load_dwordx4 v[72:75], v6, s[56:59], 0 offen offset:96 sc0 sc1
    buffer_load_dwordx4 v[76:79], v6, s[56:59], 0 offen offset:112 sc0 sc1
    s_waitcnt vmcnt(0)
    v_add_f32 v48, v48, v50
    v_add_f32 v49, v49, v51
    v_add_f32 v48, v48, v52
    v_add_f32 v49, v49, v53
    v_add_f32 v48, v48, v54
    v_add_f32 v49, v49, v55
    v_add_f32 v48, v48, v56
    v_add_f32 v49, v49, v57
    v_add_f32 v48, v48, v58
    v_add_f32 v49, v49, v59
    v_add_f32 v48, v48, v60
    v_add_f32 v49, v49, v61
    v_add_f32 v48, v48, v62
    v_add_f32 v49, v49, v63
    v_add_f32 v48, v48, v64
    v_add_f32 v49, v49, v65
    v_add_f32 v48, v48, v66
    v_add_f32 v49, v49, v67
    v_add_f32 v48, v48, v68
    v_add_f32 v49, v49, v69
    v_add_f32 v48, v48, v70
    v_add_f32 v49, v49, v71
    v_add_f32 v48, v48, v72
    v_add_f32 v49, v49, v73
    v_add_f32 v48, v48, v74
    v_add_f32 v49, v49, v75
    v_add_f32 v48, v48, v76
    v_add_f32 v49, v49, v77
    v_add_f32 v48, v48, v78
    v_add_f32 v49, v49, v79
    v_mul_f32 v48, s73, v48
    v_mul_f32 v49, s73, v49
    v_fma_f32 v49, -v48, v48, v49
    v_max_f32 v49, 0, v49
    v_add_f32 v49, 0x3727c5ac, v49
    v_rsq_f32 v50, v49
    s_nop 0
    v_mul_f32 v51, v48, v50
    v_sub_f32 v51, 0, v51
    v_lshlrev_b32 v52, 3, v0
    v_add_u32 v52, 40960, v52
    ds_write_b64 v52, v[50:51] offset:40960
    s_waitcnt lgkmcnt(0)
b1_kernel_nofin:
    s_waitcnt lgkmcnt(0)
    s_barrier
    v_and_b32 v4, 15, v1
    v_lshlrev_b32 v4, 6, v4
    v_add_u32 v4, 40960, v4
    ds_read_b128 v[80:83], v4 offset:40960
    ds_read_b128 v[84:87], v4 offset:40976
    ds_read_b128 v[88:91], v4 offset:40992
    ds_read_b128 v[92:95], v4 offset:41008
    s_mul_i32 s72, s60, 9792
    s_sub_u32 s68, s62, 8
    s_mul_i32 s68, s68, 288
    s_mul_i32 s69, s60, 36
    s_add_u32 s68, s68, s69
    s_lshl_b32 s73, s68, 12
    s_lshl_b32 s69, s61, 8
    s_add_u32 s73, s73, s69
    s_mov_b32 s100, 65537
    s_mov_b32 s101, 4096
    v_add_u32 v8, 0, v1
    v_mul_lo_u32 v9, v8, s100
    v_lshrrev_b32 v9, 20, v9
    v_mul_u32_u24 v10, 16, v9
    v_sub_u32 v10, v8, v10
    v_lshlrev_b32 v10, 4, v10
    v_mul_u32_u24 v11, 272, v9
    v_add_u32 v11, v11, v10
    v_add_u32 v12, s72, v11
    v_mul_lo_u32 v11, v9, s101
    v_add_u32 v11, v11, v10
    v_add_u32 v13, s73, v11
    ds_read_b128 v[40:43], v12
    v_add_u32 v8, 64, v1
    v_mul_lo_u32 v9, v8, s100
    v_lshrrev_b32 v9, 20, v9
    v_mul_u32_u24 v10, 16, v9
    v_sub_u32 v10, v8, v10
    v_lshlrev_b32 v10, 4, v10
    v_mul_u32_u24 v11, 272, v9
    v_add_u32 v11, v11, v10
    v_add_u32 v14, s72, v11
    v_mul_lo_u32 v11, v9, s101
    v_add_u32 v11, v11, v10
    v_add_u32 v15, s73, v11
    ds_read_b128 v[44:47], v14
    v_add_u32 v8, 128, v1
    v_mul_lo_u32 v9, v8, s100
    v_lshrrev_b32 v9, 20, v9
    v_mul_u32_u24 v10, 16, v9
    v_sub_u32 v10, v8, v10
    v_lshlrev_b32 v10, 4, v10
    v_mul_u32_u24 v11, 272, v9
    v_add_u32 v11, v11, v10
    v_add_u32 v16, s72, v11
    v_mul_lo_u32 v11, v9, s101
    v_add_u32 v11, v11, v10
    v_add_u32 v17, s73, v11
    ds_read_b128 v[48:51], v16
    v_add_u32 v8, 192, v1
    v_mul_lo_u32 v9, v8, s100
    v_lshrrev_b32 v9, 20, v9
    v_mul_u32_u24 v10, 16, v9
    v_sub_u32 v10, v8, v10
    v_lshlrev_b32 v10, 4, v10
    v_mul_u32_u24 v11, 272, v9
    v_add_u32 v11, v11, v10
    v_add_u32 v18, s72, v11
    v_mul_lo_u32 v11, v9, s101
    v_add_u32 v11, v11, v10
    v_add_u32 v19, s73, v11
    ds_read_b128 v[52:55], v18
    v_add_u32 v8, 256, v1
    v_mul_lo_u32 v9, v8, s100
    v_lshrrev_b32 v9, 20, v9
    v_mul_u32_u24 v10, 16, v9
    v_sub_u32 v10, v8, v10
    v_lshlrev_b32 v10, 4, v10
    v_mul_u32_u24 v11, 272, v9
    v_add_u32 v11, v11, v10
    v_add_u32 v20, s72, v11
    v_mul_lo_u32 v11, v9, s101
    v_add_u32 v11, v11, v10
    v_add_u32 v21, s73, v11
    ds_read_b128 v[56:59], v20
    v_add_u32 v8, 320, v1
    v_mul_lo_u32 v9, v8, s100
    v_lshrrev_b32 v9, 20, v9
    v_mul_u32_u24 v10, 16, v9
    v_sub_u32 v10, v8, v10
    v_lshlrev_b32 v10, 4, v10
    v_mul_u32_u24 v11, 272, v9
    v_add_u32 v11, v11, v10
    v_add_u32 v22, s72, v11
    v_mul_lo_u32 v11, v9, s101
    v_add_u32 v11, v11, v10
    v_add_u32 v23, s73, v11
    ds_read_b128 v[60:63], v22
    v_add_u32 v8, 384, v1
    v_mul_lo_u32 v9, v8, s100
    v_lshrrev_b32 v9, 20, v9
    v_mul_u32_u24 v10, 16, v9
    v_sub_u32 v10, v8, v10
    v_lshlrev_b32 v10, 4, v10
    v_mul_u32_u24 v11, 272, v9
    v_add_u32 v11, v11, v10
    v_add_u32 v24, s72, v11
    v_mul_lo_u32 v11, v9, s101
    v_add_u32 v11, v11, v10
    v_add_u32 v25, s73, v11
    ds_read_b128 v[64:67], v24
    v_add_u32 v8, 448, v1
    v_mul_lo_u32 v9, v8, s100
    v_lshrrev_b32 v9, 20, v9
    v_mul_u32_u24 v10, 16, v9
    v_sub_u32 v10, v8, v10
    v_lshlrev_b32 v10, 4, v10
    v_mul_u32_u24 v11, 272, v9
    v_add_u32 v11, v11, v10
    v_add_u32 v26, s72, v11
    v_mul_lo_u32 v11, v9, s101
    v_add_u32 v11, v11, v10
    v_add_u32 v27, s73, v11
    ds_read_b128 v[68:71], v26
    v_add_u32 v8, 512, v1
    v_mul_lo_u32 v9, v8, s100
    v_lshrrev_b32 v9, 20, v9
    v_mul_u32_u24 v10, 16, v9
    v_sub_u32 v10, v8, v10
    v_lshlrev_b32 v10, 4, v10
    v_mul_u32_u24 v11, 272, v9
    v_add_u32 v11, v11, v10
    v_add_u32 v28, s72, v11
    v_mul_lo_u32 v11, v9, s101
    v_add_u32 v11, v11, v10
    v_add_u32 v29, s73, v11
    ds_read_b128 v[72:75], v28
    s_waitcnt lgkmcnt(8)
    v_lshlrev_b32 v2, 16, v40
    v_and_b32 v3, 0xffff0000, v40
    v_fma_f32 v2, v2, v80, v81
    v_fma_f32 v3, v3, v82, v83
    v_cvt_pk_bf16_f32 v40, v2, v3
    v_lshlrev_b32 v2, 16, v41
    v_and_b32 v3, 0xffff0000, v41
    v_fma_f32 v2, v2, v84, v85
    v_fma_f32 v3, v3, v86, v87
    v_cvt_pk_bf16_f32 v41, v2, v3
    v_lshlrev_b32 v2, 16, v42
    v_and_b32 v3, 0xffff0000, v42
    v_fma_f32 v2, v2, v88, v89
    v_fma_f32 v3, v3, v90, v91
    v_cvt_pk_bf16_f32 v42, v2, v3
    v_lshlrev_b32 v2, 16, v43
    v_and_b32 v3, 0xffff0000, v43
    v_fma_f32 v2, v2, v92, v93
    v_fma_f32 v3, v3, v94, v95
    v_cvt_pk_bf16_f32 v43, v2, v3
    buffer_store_dwordx4 v[40:43], v13, s[52:55], 0 offen
    s_waitcnt lgkmcnt(7)
    v_lshlrev_b32 v2, 16, v44
    v_and_b32 v3, 0xffff0000, v44
    v_fma_f32 v2, v2, v80, v81
    v_fma_f32 v3, v3, v82, v83
    v_cvt_pk_bf16_f32 v44, v2, v3
    v_lshlrev_b32 v2, 16, v45
    v_and_b32 v3, 0xffff0000, v45
    v_fma_f32 v2, v2, v84, v85
    v_fma_f32 v3, v3, v86, v87
    v_cvt_pk_bf16_f32 v45, v2, v3
    v_lshlrev_b32 v2, 16, v46
    v_and_b32 v3, 0xffff0000, v46
    v_fma_f32 v2, v2, v88, v89
    v_fma_f32 v3, v3, v90, v91
    v_cvt_pk_bf16_f32 v46, v2, v3
    v_lshlrev_b32 v2, 16, v47
    v_and_b32 v3, 0xffff0000, v47
    v_fma_f32 v2, v2, v92, v93
    v_fma_f32 v3, v3, v94, v95
    v_cvt_pk_bf16_f32 v47, v2, v3
    buffer_store_dwordx4 v[44:47], v15, s[52:55], 0 offen
    s_waitcnt lgkmcnt(6)
    v_lshlrev_b32 v2, 16, v48
    v_and_b32 v3, 0xffff0000, v48
    v_fma_f32 v2, v2, v80, v81
    v_fma_f32 v3, v3, v82, v83
    v_cvt_pk_bf16_f32 v48, v2, v3
    v_lshlrev_b32 v2, 16, v49
    v_and_b32 v3, 0xffff0000, v49
    v_fma_f32 v2, v2, v84, v85
    v_fma_f32 v3, v3, v86, v87
    v_cvt_pk_bf16_f32 v49, v2, v3
    v_lshlrev_b32 v2, 16, v50
    v_and_b32 v3, 0xffff0000, v50
    v_fma_f32 v2, v2, v88, v89
    v_fma_f32 v3, v3, v90, v91
    v_cvt_pk_bf16_f32 v50, v2, v3
    v_lshlrev_b32 v2, 16, v51
    v_and_b32 v3, 0xffff0000, v51
    v_fma_f32 v2, v2, v92, v93
    v_fma_f32 v3, v3, v94, v95
    v_cvt_pk_bf16_f32 v51, v2, v3
    buffer_store_dwordx4 v[48:51], v17, s[52:55], 0 offen
    s_waitcnt lgkmcnt(5)
    v_lshlrev_b32 v2, 16, v52
    v_and_b32 v3, 0xffff0000, v52
    v_fma_f32 v2, v2, v80, v81
    v_fma_f32 v3, v3, v82, v83
    v_cvt_pk_bf16_f32 v52, v2, v3
    v_lshlrev_b32 v2, 16, v53
    v_and_b32 v3, 0xffff0000, v53
    v_fma_f32 v2, v2, v84, v85
    v_fma_f32 v3, v3, v86, v87
    v_cvt_pk_bf16_f32 v53, v2, v3
    v_lshlrev_b32 v2, 16, v54
    v_and_b32 v3, 0xffff0000, v54
    v_fma_f32 v2, v2, v88, v89
    v_fma_f32 v3, v3, v90, v91
    v_cvt_pk_bf16_f32 v54, v2, v3
    v_lshlrev_b32 v2, 16, v55
    v_and_b32 v3, 0xffff0000, v55
    v_fma_f32 v2, v2, v92, v93
    v_fma_f32 v3, v3, v94, v95
    v_cvt_pk_bf16_f32 v55, v2, v3
    buffer_store_dwordx4 v[52:55], v19, s[52:55], 0 offen
    s_waitcnt lgkmcnt(4)
    v_lshlrev_b32 v2, 16, v56
    v_and_b32 v3, 0xffff0000, v56
    v_fma_f32 v2, v2, v80, v81
    v_fma_f32 v3, v3, v82, v83
    v_cvt_pk_bf16_f32 v56, v2, v3
    v_lshlrev_b32 v2, 16, v57
    v_and_b32 v3, 0xffff0000, v57
    v_fma_f32 v2, v2, v84, v85
    v_fma_f32 v3, v3, v86, v87
    v_cvt_pk_bf16_f32 v57, v2, v3
    v_lshlrev_b32 v2, 16, v58
    v_and_b32 v3, 0xffff0000, v58
    v_fma_f32 v2, v2, v88, v89
    v_fma_f32 v3, v3, v90, v91
    v_cvt_pk_bf16_f32 v58, v2, v3
    v_lshlrev_b32 v2, 16, v59
    v_and_b32 v3, 0xffff0000, v59
    v_fma_f32 v2, v2, v92, v93
    v_fma_f32 v3, v3, v94, v95
    v_cvt_pk_bf16_f32 v59, v2, v3
    buffer_store_dwordx4 v[56:59], v21, s[52:55], 0 offen
    s_waitcnt lgkmcnt(3)
    v_lshlrev_b32 v2, 16, v60
    v_and_b32 v3, 0xffff0000, v60
    v_fma_f32 v2, v2, v80, v81
    v_fma_f32 v3, v3, v82, v83
    v_cvt_pk_bf16_f32 v60, v2, v3
    v_lshlrev_b32 v2, 16, v61
    v_and_b32 v3, 0xffff0000, v61
    v_fma_f32 v2, v2, v84, v85
    v_fma_f32 v3, v3, v86, v87
    v_cvt_pk_bf16_f32 v61, v2, v3
    v_lshlrev_b32 v2, 16, v62
    v_and_b32 v3, 0xffff0000, v62
    v_fma_f32 v2, v2, v88, v89
    v_fma_f32 v3, v3, v90, v91
    v_cvt_pk_bf16_f32 v62, v2, v3
    v_lshlrev_b32 v2, 16, v63
    v_and_b32 v3, 0xffff0000, v63
    v_fma_f32 v2, v2, v92, v93
    v_fma_f32 v3, v3, v94, v95
    v_cvt_pk_bf16_f32 v63, v2, v3
    buffer_store_dwordx4 v[60:63], v23, s[52:55], 0 offen
    s_waitcnt lgkmcnt(2)
    v_lshlrev_b32 v2, 16, v64
    v_and_b32 v3, 0xffff0000, v64
    v_fma_f32 v2, v2, v80, v81
    v_fma_f32 v3, v3, v82, v83
    v_cvt_pk_bf16_f32 v64, v2, v3
    v_lshlrev_b32 v2, 16, v65
    v_and_b32 v3, 0xffff0000, v65
    v_fma_f32 v2, v2, v84, v85
    v_fma_f32 v3, v3, v86, v87
    v_cvt_pk_bf16_f32 v65, v2, v3
    v_lshlrev_b32 v2, 16, v66
    v_and_b32 v3, 0xffff0000, v66
    v_fma_f32 v2, v2, v88, v89
    v_fma_f32 v3, v3, v90, v91
    v_cvt_pk_bf16_f32 v66, v2, v3
    v_lshlrev_b32 v2, 16, v67
    v_and_b32 v3, 0xffff0000, v67
    v_fma_f32 v2, v2, v92, v93
    v_fma_f32 v3, v3, v94, v95
    v_cvt_pk_bf16_f32 v67, v2, v3
    buffer_store_dwordx4 v[64:67], v25, s[52:55], 0 offen
    s_waitcnt lgkmcnt(1)
    v_lshlrev_b32 v2, 16, v68
    v_and_b32 v3, 0xffff0000, v68
    v_fma_f32 v2, v2, v80, v81
    v_fma_f32 v3, v3, v82, v83
    v_cvt_pk_bf16_f32 v68, v2, v3
    v_lshlrev_b32 v2, 16, v69
    v_and_b32 v3, 0xffff0000, v69
    v_fma_f32 v2, v2, v84, v85
    v_fma_f32 v3, v3, v86, v87
    v_cvt_pk_bf16_f32 v69, v2, v3
    v_lshlrev_b32 v2, 16, v70
    v_and_b32 v3, 0xffff0000, v70
    v_fma_f32 v2, v2, v88, v89
    v_fma_f32 v3, v3, v90, v91
    v_cvt_pk_bf16_f32 v70, v2, v3
    v_lshlrev_b32 v2, 16, v71
    v_and_b32 v3, 0xffff0000, v71
    v_fma_f32 v2, v2, v92, v93
    v_fma_f32 v3, v3, v94, v95
    v_cvt_pk_bf16_f32 v71, v2, v3
    buffer_store_dwordx4 v[68:71], v27, s[52:55], 0 offen
    s_waitcnt lgkmcnt(0)
    v_lshlrev_b32 v2, 16, v72
    v_and_b32 v3, 0xffff0000, v72
    v_fma_f32 v2, v2, v80, v81
    v_fma_f32 v3, v3, v82, v83
    v_cvt_pk_bf16_f32 v72, v2, v3
    v_lshlrev_b32 v2, 16, v73
    v_and_b32 v3, 0xffff0000, v73
    v_fma_f32 v2, v2, v84, v85
    v_fma_f32 v3, v3, v86, v87
    v_cvt_pk_bf16_f32 v73, v2, v3
    v_lshlrev_b32 v2, 16, v74
    v_and_b32 v3, 0xffff0000, v74
    v_fma_f32 v2, v2, v88, v89
    v_fma_f32 v3, v3, v90, v91
    v_cvt_pk_bf16_f32 v74, v2, v3
    v_lshlrev_b32 v2, 16, v75
    v_and_b32 v3, 0xffff0000, v75
    v_fma_f32 v2, v2, v92, v93
    v_fma_f32 v3, v3, v94, v95
    v_cvt_pk_bf16_f32 v75, v2, v3
    buffer_store_dwordx4 v[72:75], v29, s[52:55], 0 offen
b1_kernel_end:
    s_endpgm
.section .rodata,"a"
.p2align 6
.amdhsa_kernel b1_kernel
  .amdhsa_next_free_vgpr 216
  .amdhsa_next_free_sgpr 102
  .amdhsa_accum_offset 216
  .amdhsa_group_segment_fixed_size 0
  .amdhsa_kernarg_size 96
  .amdhsa_user_sgpr_count 2
  .amdhsa_user_sgpr_kernarg_segment_ptr 1
  .amdhsa_system_sgpr_workgroup_id_x 1
  .amdhsa_float_denorm_mode_32 3
.end_amdhsa_kernel
.text

.globl b2_kernel
.p2align 8
.type b2_kernel,@function
b2_kernel:
    s_cmp_ge_u32 s2, 256
    s_cbranch_scc1 b2_kernel_end
    s_load_dwordx16 s[16:31], s[0:1], 0
    s_load_dwordx8 s[32:39], s[0:1], 64
    v_and_b32 v1, 63, v0
    v_lshrrev_b32 v2, 6, v0
    s_nop 0
    v_readfirstlane_b32 s60, v2
    s_and_b32 s68, s2, 7
    s_lshr_b32 s69, s2, 3
    s_and_b32 s61, s68, 3
    s_lshl_b32 s61, s61, 2
    s_and_b32 s70, s69, 3
    s_add_u32 s61, s61, s70
    s_lshr_b32 s62, s68, 2
    s_lshl_b32 s62, s62, 3
    s_lshr_b32 s70, s69, 2
    s_add_u32 s62, s62, s70
    s_waitcnt lgkmcnt(0)
    s_mov_b32 s40, s28
    s_mov_b32 s41, s29
    s_and_b32 s41, s41, 0xffff
    s_mov_b32 s42, 8388608
    s_mov_b32 s43, 0x00020000
    s_add_u32 s44, s38, 37748736
    s_addc_u32 s45, s39, 0
    s_and_b32 s45, s45, 0xffff
    s_mov_b32 s46, 9437184
    s_mov_b32 s47, 0x00020000
    s_add_u32 s48, s38, 16777216
    s_addc_u32 s49, s39, 0
    s_and_b32 s49, s49, 0xffff
    s_mov_b32 s50, 9437184
    s_mov_b32 s51, 0x00020000
    s_add_u32 s52, s38, 50331648
    s_addc_u32 s53, s39, 0
    s_and_b32 s53, s53, 0xffff
    s_mov_b32 s54, 9437184
    s_mov_b32 s55, 0x00020000
    s_mov_b32 s56, s30
    s_mov_b32 s57, s31
    s_and_b32 s57, s57, 0xffff
    s_mov_b32 s58, 4096
    s_mov_b32 s59, 0x00020000
    s_cmp_lt_u32 s60, 4
    s_cbranch_scc1 b2_kernel_comp
    s_sub_u32 s60, s60, 4
    v_lshrrev_b32 v2, 3, v1
    s_lshl_b32 s100, s60, 3
    v_add_u32 v2, s100, v2
    v_lshrrev_b32 v3, 1, v2
    v_and_b32 v3, 7, v3
    v_and_b32 v4, 7, v1
    v_xor_b32 v3, v3, v4
    v_lshlrev_b32 v3, 4, v3
    s_mov_b32 s100, 4096
    v_mul_lo_u32 v2, v2, s100
    v_add_u32 v10, v2, v3
    s_lshl_b32 s68, s61, 19
    v_add_u32 v10, s68, v10
    v_add_u32 v11, 131072, v10
    v_add_u32 v12, 262144, v10
    v_add_u32 v13, 393216, v10
    v_lshrrev_b32 v2, 3, v1
    s_lshl_b32 s100, s60, 3
    v_add_u32 v2, s100, v2
    v_lshrrev_b32 v3, 1, v2
    v_and_b32 v3, 7, v3
    v_and_b32 v4, 7, v1
    v_xor_b32 v3, v3, v4
    v_lshlrev_b32 v3, 4, v3
    s_mov_b32 s100, 4096
    v_mul_lo_u32 v2, v2, s100
    v_add_u32 v14, v2, v3
    s_mul_i32 s68, s62, 589824
    v_add_u32 v14, s68, v14
    v_add_u32 v15, 131072, v14
    v_add_u32 v16, 262144, v14
    v_add_u32 v17, 393216, v14
    v_add_u32 v18, 524288, v14
    s_mov_b32 s63, 0
    s_lshl_b32 s65, s60, 10
    s_add_u32 m0, s65, 0
    s_nop 0
    buffer_load_dwordx4 v10, s[40:43], s63 offen lds
    s_add_u32 m0, s65, 4096
    s_nop 0
    buffer_load_dwordx4 v11, s[40:43], s63 offen lds
    s_add_u32 m0, s65, 8192
    s_nop 0
    buffer_load_dwordx4 v12, s[40:43], s63 offen lds
    s_add_u32 m0, s65, 12288
    s_nop 0
    buffer_load_dwordx4 v13, s[40:43], s63 offen lds
    s_add_u32 m0, s65, 16384
    s_nop 0
    buffer_load_dwordx4 v14, s[44:47], s63 offen lds
    s_add_u32 m0, s65, 20480
    s_nop 0
    buffer_load_dwordx4 v15, s[44:47], s63 offen lds
    s_add_u32 m0, s65, 24576
    s_nop 0
    buffer_load_dwordx4 v16, s[44:47], s63 offen lds
    s_add_u32 m0, s65, 28672
    s_nop 0
    buffer_load_dwordx4 v17, s[44:47], s63 offen lds
    s_add_u32 m0, s65, 32768
    s_nop 0
    buffer_load_dwordx4 v18, s[44:47], s63 offen lds
    s_add_u32 s63, s63, 128
    s_add_u32 s65, s65, 36864
    s_cmp_ge_u32 s65, 110592
    s_cselect_b32 s68, 110592, 0
    s_sub_u32 s65, s65, s68
    s_add_u32 m0, s65, 0
    s_nop 0
    buffer_load_dwordx4 v10, s[40:43], s63 offen lds
    s_add_u32 m0, s65, 4096
    s_nop 0
    buffer_load_dwordx4 v11, s[40:43], s63 offen lds
    s_add_u32 m0, s65, 8192
    s_nop 0
    buffer_load_dwordx4 v12, s[40:43], s63 offen lds
    s_add_u32 m0, s65, 12288
    s_nop 0
    buffer_load_dwordx4 v13, s[40:43], s63 offen lds
    s_add_u32 m0, s65, 16384
    s_nop 0
    buffer_load_dwordx4 v14, s[44:47], s63 offen lds
    s_add_u32 m0, s65, 20480
    s_nop 0
    buffer_load_dwordx4 v15, s[44:47], s63 offen lds
    s_add_u32 m0, s65, 24576
    s_nop 0
    buffer_load_dwordx4 v16, s[44:47], s63 offen lds
    s_add_u32 m0, s65, 28672
    s_nop 0
    buffer_load_dwordx4 v17, s[44:47], s63 offen lds
    s_add_u32 m0, s65, 32768
    s_nop 0
    buffer_load_dwordx4 v18, s[44:47], s63 offen lds
    s_add_u32 s63, s63, 128
    s_add_u32 s65, s65, 36864
    s_cmp_ge_u32 s65, 110592
    s_cselect_b32 s68, 110592, 0
    s_sub_u32 s65, s65, s68
    s_add_u32 m0, s65, 0
    s_nop 0
    buffer_load_dwordx4 v10, s[40:43], s63 offen lds
    s_add_u32 m0, s65, 4096
    s_nop 0
    buffer_load_dwordx4 v11, s[40:43], s63 offen lds
    s_add_u32 m0, s65, 8192
    s_nop 0
    buffer_load_dwordx4 v12, s[40:43], s63 offen lds
    s_add_u32 m0, s65, 12288
    s_nop 0
    buffer_load_dwordx4 v13, s[40:43], s63 offen lds
    s_add_u32 m0, s65, 16384
    s_nop 0
    buffer_load_dwordx4 v14, s[44:47], s63 offen lds
    s_add_u32 m0, s65, 20480
    s_nop 0
    buffer_load_dwordx4 v15, s[44:47], s63 offen lds
    s_add_u32 m0, s65, 24576
    s_nop 0
    buffer_load_dwordx4 v16, s[44:47], s63 offen lds
    s_add_u32 m0, s65, 28672
    s_nop 0
    buffer_load_dwordx4 v17, s[44:47], s63 offen lds
    s_add_u32 m0, s65, 32768
    s_nop 0
    buffer_load_dwordx4 v18, s[44:47], s63 offen lds
    s_add_u32 s63, s63, 128
    s_add_u32 s65, s65, 36864
    s_cmp_ge_u32 s65, 110592
    s_cselect_b32 s68, 110592, 0
    s_sub_u32 s65, s65, s68
    s_waitcnt vmcnt(18)
    s_barrier
    s_mov_b32 s67, 0
b2_kernel_lloop:
    s_waitcnt vmcnt(9)
    s_barrier
    s_add_u32 m0, s65, 0
    s_nop 0
    buffer_load_dwordx4 v10, s[40:43], s63 offen lds
    s_add_u32 m0, s65, 4096
    s_nop 0
    buffer_load_dwordx4 v11, s[40:43], s63 offen lds
    s_add_u32 m0, s65, 8192
    s_nop 0
    buffer_load_dwordx4 v12, s[40:43], s63 offen lds
    s_add_u32 m0, s65, 12288
    s_nop 0
    buffer_load_dwordx4 v13, s[40:43], s63 offen lds
    s_add_u32 m0, s65, 16384
    s_nop 0
    buffer_load_dwordx4 v14, s[44:47], s63 offen lds
    s_add_u32 m0, s65, 20480
    s_nop 0
    buffer_load_dwordx4 v15, s[44:47], s63 offen lds
    s_add_u32 m0, s65, 24576
    s_nop 0
    buffer_load_dwordx4 v16, s[44:47], s63 offen lds
    s_add_u32 m0, s65, 28672
    s_nop 0
    buffer_load_dwordx4 v17, s[44:47], s63 offen lds
    s_add_u32 m0, s65, 32768
    s_nop 0
    buffer_load_dwordx4 v18, s[44:47], s63 offen lds
    s_add_u32 s63, s63, 128
    s_add_u32 s65, s65, 36864
    s_cmp_ge_u32 s65, 110592
    s_cselect_b32 s68, 110592, 0
    s_sub_u32 s65, s65, s68
    s_add_u32 s67, s67, 1
    s_cmp_lt_u32 s67, 32
    s_cbranch_scc1 b2_kernel_lloop
    s_waitcnt vmcnt(0)
    s_barrier
    s_endpgm
b2_kernel_comp:
    v_and_b32 v2, 15, v1
    s_lshl_b32 s68, s61, 7
    s_lshl_b32 s69, s60, 5
    s_add_u32 s68, s68, s69
    v_add_u32 v2, s68, v2
    v_lshlrev_b32 v4, 1, v2
    v_add_u32 v5, 32, v4
    buffer_load_ushort v236, v4, s[56:59], 0 offen
    buffer_load_ushort v237, v5, s[56:59], 0 offen
    v_mul_u32_u24 v2, 4608, v2
    v_lshrrev_b32 v3, 4, v1
    v_lshlrev_b32 v3, 3, v3
    v_add_u32 v2, v2, v3
    s_mul_i32 s69, s62, 288
    v_add_u32 v2, s69, v2
    v_add_u32 v3, 73728, v2
    buffer_load_dwordx2 v[200:201], v2, s[48:51], 0 offen offset:0
    buffer_load_dwordx2 v[202:203], v3, s[48:51], 0 offen offset:0
    buffer_load_dwordx2 v[204:205], v2, s[48:51], 0 offen offset:32
    buffer_load_dwordx2 v[206:207], v3, s[48:51], 0 offen offset:32
    buffer_load_dwordx2 v[208:209], v2, s[48:51], 0 offen offset:64
    buffer_load_dwordx2 v[210:211], v3, s[48:51], 0 offen offset:64
    buffer_load_dwordx2 v[212:213], v2, s[48:51], 0 offen offset:96
    buffer_load_dwordx2 v[214:215], v3, s[48:51], 0 offen offset:96
    buffer_load_dwordx2 v[216:217], v2, s[48:51], 0 offen offset:128
    buffer_load_dwordx2 v[218:219], v3, s[48:51], 0 offen offset:128
    buffer_load_dwordx2 v[220:221], v2, s[48:51], 0 offen offset:160
    buffer_load_dwordx2 v[222:223], v3, s[48:51], 0 offen offset:160
    buffer_load_dwordx2 v[224:225], v2, s[48:51], 0 offen offset:192
    buffer_load_dwordx2 v[226:227], v3, s[48:51], 0 offen offset:192
    buffer_load_dwordx2 v[228:229], v2, s[48:51], 0 offen offset:224
    buffer_load_dwordx2 v[230:231], v3, s[48:51], 0 offen offset:224
    buffer_load_dwordx2 v[232:233], v2, s[48:51], 0 offen offset:256
    buffer_load_dwordx2 v[234:235], v3, s[48:51], 0 offen offset:256
    v_and_b32 v2, 15, v1
    v_lshlrev_b32 v2, 3, v2
    v_lshrrev_b32 v3, 4, v1
    v_lshrrev_b32 v4, 1, v1
    v_and_b32 v4, 7, v4
    v_xor_b32 v3, v3, v4
    v_add_u32 v2, v2, v3
    v_lshlrev_b32 v26, 4, v2
    v_xor_b32 v27, 64, v26
    s_lshl_b32 s68, s60, 12
    v_add_u32 v20, s68, v26
    v_add_u32 v21, s68, v27
    v_mov_b32 v128, 0
    v_mov_b32 v129, 0
    v_mov_b32 v130, 0
    v_mov_b32 v131, 0
    v_mov_b32 v132, 0
    v_mov_b32 v133, 0
    v_mov_b32 v134, 0
    v_mov_b32 v135, 0
    v_mov_b32 v136, 0
    v_mov_b32 v137, 0
    v_mov_b32 v138, 0
    v_mov_b32 v139, 0
    v_mov_b32 v140, 0
    v_mov_b32 v141, 0
    v_mov_b32 v142, 0
    v_mov_b32 v143, 0
    v_mov_b32 v144, 0
    v_mov_b32 v145, 0
    v_mov_b32 v146, 0
    v_mov_b32 v147, 0
    v_mov_b32 v148, 0
    v_mov_b32 v149, 0
    v_mov_b32 v150, 0
    v_mov_b32 v151, 0
    v_mov_b32 v152, 0
    v_mov_b32 v153, 0
    v_mov_b32 v154, 0
    v_mov_b32 v155, 0
    v_mov_b32 v156, 0
    v_mov_b32 v157, 0
    v_mov_b32 v158, 0
    v_mov_b32 v159, 0
    v_mov_b32 v160, 0
    v_mov_b32 v161, 0
    v_mov_b32 v162, 0
    v_mov_b32 v163, 0
    v_mov_b32 v164, 0
    v_mov_b32 v165, 0
    v_mov_b32 v166, 0
    v_mov_b32 v167, 0
    v_mov_b32 v168, 0
    v_mov_b32 v169, 0
    v_mov_b32 v170, 0
    v_mov_b32 v171, 0
    v_mov_b32 v172, 0
    v_mov_b32 v173, 0
    v_mov_b32 v174, 0
    v_mov_b32 v175, 0
    v_mov_b32 v176, 0
    v_mov_b32 v177, 0
    v_mov_b32 v178, 0
    v_mov_b32 v179, 0
    v_mov_b32 v180, 0
    v_mov_b32 v181, 0
    v_mov_b32 v182, 0
    v_mov_b32 v183, 0
    v_mov_b32 v184, 0
    v_mov_b32 v185, 0
    v_mov_b32 v186, 0
    v_mov_b32 v187, 0
    v_mov_b32 v188, 0
    v_mov_b32 v189, 0
    v_mov_b32 v190, 0
    v_mov_b32 v191, 0
    v_mov_b32 v192, 0
    v_mov_b32 v193, 0
    v_mov_b32 v194, 0
    v_mov_b32 v195, 0
    v_mov_b32 v196, 0
    v_mov_b32 v197, 0
    v_mov_b32 v198, 0
    v_mov_b32 v199, 0
    s_mov_b32 s66, 0
    v_add_u32 v22, s66, v20
    v_add_u32 v23, s66, v21
    v_add_u32 v28, s66, v26
    v_add_u32 v29, s66, v27
    s_barrier
    ds_read_b128 v[32:35], v22 offset:0
    ds_read_b128 v[36:39], v22 offset:2048
    ds_read_b128 v[40:43], v28 offset:16384
    ds_read_b128 v[44:47], v28 offset:18432
    ds_read_b128 v[48:51], v28 offset:20480
    ds_read_b128 v[52:55], v28 offset:22528
    ds_read_b128 v[56:59], v28 offset:24576
    ds_read_b128 v[60:63], v28 offset:26624
    ds_read_b128 v[64:67], v28 offset:28672
    ds_read_b128 v[68:71], v28 offset:30720
    ds_read_b128 v[72:75], v28 offset:32768
    s_mov_b32 s67, 0
b2_kernel_loop:
    s_waitcnt lgkmcnt(0)
    v_mfma_f32_16x16x32_bf16 v[128:131], v[40:43], v[32:35], v[128:131]
    ds_read_b128 v[76:79], v23 offset:0
    v_mfma_f32_16x16x32_bf16 v[132:135], v[40:43], v[36:39], v[132:135]
    ds_read_b128 v[80:83], v23 offset:2048
    v_mfma_f32_16x16x32_bf16 v[136:139], v[44:47], v[32:35], v[136:139]
    ds_read_b128 v[84:87], v29 offset:16384
    v_mfma_f32_16x16x32_bf16 v[140:143], v[44:47], v[36:39], v[140:143]
    ds_read_b128 v[88:91], v29 offset:18432
    v_mfma_f32_16x16x32_bf16 v[144:147], v[48:51], v[32:35], v[144:147]
    ds_read_b128 v[92:95], v29 offset:20480
    v_mfma_f32_16x16x32_bf16 v[148:151], v[48:51], v[36:39], v[148:151]
    ds_read_b128 v[96:99], v29 offset:22528
    v_mfma_f32_16x16x32_bf16 v[152:155], v[52:55], v[32:35], v[152:155]
    ds_read_b128 v[100:103], v29 offset:24576
    v_mfma_f32_16x16x32_bf16 v[156:159], v[52:55], v[36:39], v[156:159]
    ds_read_b128 v[104:107], v29 offset:26624
    v_mfma_f32_16x16x32_bf16 v[160:163], v[56:59], v[32:35], v[160:163]
    ds_read_b128 v[108:111], v29 offset:28672
    v_mfma_f32_16x16x32_bf16 v[164:167], v[56:59], v[36:39], v[164:167]
    ds_read_b128 v[112:115], v29 offset:30720
    v_mfma_f32_16x16x32_bf16 v[168:171], v[60:63], v[32:35], v[168:171]
    ds_read_b128 v[116:119], v29 offset:32768
    v_mfma_f32_16x16x32_bf16 v[172:175], v[60:63], v[36:39], v[172:175]
    v_mfma_f32_16x16x32_bf16 v[176:179], v[64:67], v[32:35], v[176:179]
    v_mfma_f32_16x16x32_bf16 v[180:183], v[64:67], v[36:39], v[180:183]
    v_mfma_f32_16x16x32_bf16 v[184:187], v[68:71], v[32:35], v[184:187]
    v_mfma_f32_16x16x32_bf16 v[188:191], v[68:71], v[36:39], v[188:191]
    v_mfma_f32_16x16x32_bf16 v[192:195], v[72:75], v[32:35], v[192:195]
    v_mfma_f32_16x16x32_bf16 v[196:199], v[72:75], v[36:39], v[196:199]
    s_add_u32 s66, s66, 36864
    s_cmp_ge_u32 s66, 110592
    s_cselect_b32 s68, 110592, 0
    s_sub_u32 s66, s66, s68
    s_waitcnt lgkmcnt(0)
    v_add_u32 v22, s66, v20
    v_add_u32 v23, s66, v21
    v_add_u32 v28, s66, v26
    v_add_u32 v29, s66, v27
    s_barrier
    ds_read_b128 v[32:35], v22 offset:0
    ds_read_b128 v[36:39], v22 offset:2048
    v_mfma_f32_16x16x32_bf16 v[128:131], v[84:87], v[76:79], v[128:131]
    ds_read_b128 v[40:43], v28 offset:16384
    ds_read_b128 v[44:47], v28 offset:18432
    v_mfma_f32_16x16x32_bf16 v[132:135], v[84:87], v[80:83], v[132:135]
    ds_read_b128 v[48:51], v28 offset:20480
    ds_read_b128 v[52:55], v28 offset:22528
    v_mfma_f32_16x16x32_bf16 v[136:139], v[88:91], v[76:79], v[136:139]
    ds_read_b128 v[56:59], v28 offset:24576
    ds_read_b128 v[60:63], v28 offset:26624
    v_mfma_f32_16x16x32_bf16 v[140:143], v[88:91], v[80:83], v[140:143]
    ds_read_b128 v[64:67], v28 offset:28672
    ds_read_b128 v[68:71], v28 offset:30720
    v_mfma_f32_16x16x32_bf16 v[144:147], v[92:95], v[76:79], v[144:147]
    ds_read_b128 v[72:75], v28 offset:32768
    v_mfma_f32_16x16x32_bf16 v[148:151], v[92:95], v[80:83], v[148:151]
    v_mfma_f32_16x16x32_bf16 v[152:155], v[96:99], v[76:79], v[152:155]
    v_mfma_f32_16x16x32_bf16 v[156:159], v[96:99], v[80:83], v[156:159]
    v_mfma_f32_16x16x32_bf16 v[160:163], v[100:103], v[76:79], v[160:163]
    v_mfma_f32_16x16x32_bf16 v[164:167], v[100:103], v[80:83], v[164:167]
    v_mfma_f32_16x16x32_bf16 v[168:171], v[104:107], v[76:79], v[168:171]
    v_mfma_f32_16x16x32_bf16 v[172:175], v[104:107], v[80:83], v[172:175]
    v_mfma_f32_16x16x32_bf16 v[176:179], v[108:111], v[76:79], v[176:179]
    v_mfma_f32_16x16x32_bf16 v[180:183], v[108:111], v[80:83], v[180:183]
    v_mfma_f32_16x16x32_bf16 v[184:187], v[112:115], v[76:79], v[184:187]
    v_mfma_f32_16x16x32_bf16 v[188:191], v[112:115], v[80:83], v[188:191]
    v_mfma_f32_16x16x32_bf16 v[192:195], v[116:119], v[76:79], v[192:195]
    v_mfma_f32_16x16x32_bf16 v[196:199], v[116:119], v[80:83], v[196:199]
    s_add_u32 s67, s67, 1
    s_cmp_lt_u32 s67, 32
    s_cbranch_scc1 b2_kernel_loop
    s_waitcnt lgkmcnt(0)
    s_barrier
    s_waitcnt vmcnt(0)
    v_lshlrev_b32 v6, 16, v236
    v_lshlrev_b32 v7, 16, v237
    v_and_b32 v2, 15, v1
    s_lshl_b32 s68, s60, 5
    v_add_u32 v2, s68, v2
    v_mul_u32_u24 v2, 304, v2
    v_lshrrev_b32 v3, 4, v1
    v_lshlrev_b32 v3, 3, v3
    v_add_u32 v2, v2, v3
    v_lshlrev_b32 v8, 16, v200
    v_and_b32 v9, 0xffff0000, v200
    v_lshlrev_b32 v30, 16, v201
    v_and_b32 v31, 0xffff0000, v201
    v_add_f32 v128, v128, v6
    v_mul_f32 v128, v128, v8
    v_add_f32 v129, v129, v6
    v_mul_f32 v129, v129, v9
    v_add_f32 v130, v130, v6
    v_mul_f32 v130, v130, v30
    v_add_f32 v131, v131, v6
    v_mul_f32 v131, v131, v31
    v_cvt_pk_bf16_f32 v200, v128, v129
    v_cvt_pk_bf16_f32 v201, v130, v131
    ds_write_b64 v2, v[200:201] offset:0
    v_lshlrev_b32 v8, 16, v202
    v_and_b32 v9, 0xffff0000, v202
    v_lshlrev_b32 v30, 16, v203
    v_and_b32 v31, 0xffff0000, v203
    v_add_f32 v132, v132, v7
    v_mul_f32 v132, v132, v8
    v_add_f32 v133, v133, v7
    v_mul_f32 v133, v133, v9
    v_add_f32 v134, v134, v7
    v_mul_f32 v134, v134, v30
    v_add_f32 v135, v135, v7
    v_mul_f32 v135, v135, v31
    v_cvt_pk_bf16_f32 v202, v132, v133
    v_cvt_pk_bf16_f32 v203, v134, v135
    ds_write_b64 v2, v[202:203] offset:4864
    v_lshlrev_b32 v8, 16, v204
    v_and_b32 v9, 0xffff0000, v204
    v_lshlrev_b32 v30, 16, v205
    v_and_b32 v31, 0xffff0000, v205
    v_add_f32 v136, v136, v6
    v_mul_f32 v136, v136, v8
    v_add_f32 v137, v137, v6
    v_mul_f32 v137, v137, v9
    v_add_f32 v138, v138, v6
    v_mul_f32 v138, v138, v30
    v_add_f32 v139, v139, v6
    v_mul_f32 v139, v139, v31
    v_cvt_pk_bf16_f32 v204, v136, v137
    v_cvt_pk_bf16_f32 v205, v138, v139
    ds_write_b64 v2, v[204:205] offset:32
    v_lshlrev_b32 v8, 16, v206
    v_and_b32 v9, 0xffff0000, v206
    v_lshlrev_b32 v30, 16, v207
    v_and_b32 v31, 0xffff0000, v207
    v_add_f32 v140, v140, v7
    v_mul_f32 v140, v140, v8
    v_add_f32 v141, v141, v7
    v_mul_f32 v141, v141, v9
    v_add_f32 v142, v142, v7
    v_mul_f32 v142, v142, v30
    v_add_f32 v143, v143, v7
    v_mul_f32 v143, v143, v31
    v_cvt_pk_bf16_f32 v206, v140, v141
    v_cvt_pk_bf16_f32 v207, v142, v143
    ds_write_b64 v2, v[206:207] offset:4896
    v_lshlrev_b32 v8, 16, v208
    v_and_b32 v9, 0xffff0000, v208
    v_lshlrev_b32 v30, 16, v209
    v_and_b32 v31, 0xffff0000, v209
    v_add_f32 v144, v144, v6
    v_mul_f32 v144, v144, v8
    v_add_f32 v145, v145, v6
    v_mul_f32 v145, v145, v9
    v_add_f32 v146, v146, v6
    v_mul_f32 v146, v146, v30
    v_add_f32 v147, v147, v6
    v_mul_f32 v147, v147, v31
    v_cvt_pk_bf16_f32 v208, v144, v145
    v_cvt_pk_bf16_f32 v209, v146, v147
    ds_write_b64 v2, v[208:209] offset:64
    v_lshlrev_b32 v8, 16, v210
    v_and_b32 v9, 0xffff0000, v210
    v_lshlrev_b32 v30, 16, v211
    v_and_b32 v31, 0xffff0000, v211
    v_add_f32 v148, v148, v7
    v_mul_f32 v148, v148, v8
    v_add_f32 v149, v149, v7
    v_mul_f32 v149, v149, v9
    v_add_f32 v150, v150, v7
    v_mul_f32 v150, v150, v30
    v_add_f32 v151, v151, v7
    v_mul_f32 v151, v151, v31
    v_cvt_pk_bf16_f32 v210, v148, v149
    v_cvt_pk_bf16_f32 v211, v150, v151
    ds_write_b64 v2, v[210:211] offset:4928
    v_lshlrev_b32 v8, 16, v212
    v_and_b32 v9, 0xffff0000, v212
    v_lshlrev_b32 v30, 16, v213
    v_and_b32 v31, 0xffff0000, v213
    v_add_f32 v152, v152, v6
    v_mul_f32 v152, v152, v8
    v_add_f32 v153, v153, v6
    v_mul_f32 v153, v153, v9
    v_add_f32 v154, v154, v6
    v_mul_f32 v154, v154, v30
    v_add_f32 v155, v155, v6
    v_mul_f32 v155, v155, v31
    v_cvt_pk_bf16_f32 v212, v152, v153
    v_cvt_pk_bf16_f32 v213, v154, v155
    ds_write_b64 v2, v[212:213] offset:96
    v_lshlrev_b32 v8, 16, v214
    v_and_b32 v9, 0xffff0000, v214
    v_lshlrev_b32 v30, 16, v215
    v_and_b32 v31, 0xffff0000, v215
    v_add_f32 v156, v156, v7
    v_mul_f32 v156, v156, v8
    v_add_f32 v157, v157, v7
    v_mul_f32 v157, v157, v9
    v_add_f32 v158, v158, v7
    v_mul_f32 v158, v158, v30
    v_add_f32 v159, v159, v7
    v_mul_f32 v159, v159, v31
    v_cvt_pk_bf16_f32 v214, v156, v157
    v_cvt_pk_bf16_f32 v215, v158, v159
    ds_write_b64 v2, v[214:215] offset:4960
    v_lshlrev_b32 v8, 16, v216
    v_and_b32 v9, 0xffff0000, v216
    v_lshlrev_b32 v30, 16, v217
    v_and_b32 v31, 0xffff0000, v217
    v_add_f32 v160, v160, v6
    v_mul_f32 v160, v160, v8
    v_add_f32 v161, v161, v6
    v_mul_f32 v161, v161, v9
    v_add_f32 v162, v162, v6
    v_mul_f32 v162, v162, v30
    v_add_f32 v163, v163, v6
    v_mul_f32 v163, v163, v31
    v_cvt_pk_bf16_f32 v216, v160, v161
    v_cvt_pk_bf16_f32 v217, v162, v163
    ds_write_b64 v2, v[216:217] offset:128
    v_lshlrev_b32 v8, 16, v218
    v_and_b32 v9, 0xffff0000, v218
    v_lshlrev_b32 v30, 16, v219
    v_and_b32 v31, 0xffff0000, v219
    v_add_f32 v164, v164, v7
    v_mul_f32 v164, v164, v8
    v_add_f32 v165, v165, v7
    v_mul_f32 v165, v165, v9
    v_add_f32 v166, v166, v7
    v_mul_f32 v166, v166, v30
    v_add_f32 v167, v167, v7
    v_mul_f32 v167, v167, v31
    v_cvt_pk_bf16_f32 v218, v164, v165
    v_cvt_pk_bf16_f32 v219, v166, v167
    ds_write_b64 v2, v[218:219] offset:4992
    v_lshlrev_b32 v8, 16, v220
    v_and_b32 v9, 0xffff0000, v220
    v_lshlrev_b32 v30, 16, v221
    v_and_b32 v31, 0xffff0000, v221
    v_add_f32 v168, v168, v6
    v_mul_f32 v168, v168, v8
    v_add_f32 v169, v169, v6
    v_mul_f32 v169, v169, v9
    v_add_f32 v170, v170, v6
    v_mul_f32 v170, v170, v30
    v_add_f32 v171, v171, v6
    v_mul_f32 v171, v171, v31
    v_cvt_pk_bf16_f32 v220, v168, v169
    v_cvt_pk_bf16_f32 v221, v170, v171
    ds_write_b64 v2, v[220:221] offset:160
    v_lshlrev_b32 v8, 16, v222
    v_and_b32 v9, 0xffff0000, v222
    v_lshlrev_b32 v30, 16, v223
    v_and_b32 v31, 0xffff0000, v223
    v_add_f32 v172, v172, v7
    v_mul_f32 v172, v172, v8
    v_add_f32 v173, v173, v7
    v_mul_f32 v173, v173, v9
    v_add_f32 v174, v174, v7
    v_mul_f32 v174, v174, v30
    v_add_f32 v175, v175, v7
    v_mul_f32 v175, v175, v31
    v_cvt_pk_bf16_f32 v222, v172, v173
    v_cvt_pk_bf16_f32 v223, v174, v175
    ds_write_b64 v2, v[222:223] offset:5024
    v_lshlrev_b32 v8, 16, v224
    v_and_b32 v9, 0xffff0000, v224
    v_lshlrev_b32 v30, 16, v225
    v_and_b32 v31, 0xffff0000, v225
    v_add_f32 v176, v176, v6
    v_mul_f32 v176, v176, v8
    v_add_f32 v177, v177, v6
    v_mul_f32 v177, v177, v9
    v_add_f32 v178, v178, v6
    v_mul_f32 v178, v178, v30
    v_add_f32 v179, v179, v6
    v_mul_f32 v179, v179, v31
    v_cvt_pk_bf16_f32 v224, v176, v177
    v_cvt_pk_bf16_f32 v225, v178, v179
    ds_write_b64 v2, v[224:225] offset:192
    v_lshlrev_b32 v8, 16, v226
    v_and_b32 v9, 0xffff0000, v226
    v_lshlrev_b32 v30, 16, v227
    v_and_b32 v31, 0xffff0000, v227
    v_add_f32 v180, v180, v7
    v_mul_f32 v180, v180, v8
    v_add_f32 v181, v181, v7
    v_mul_f32 v181, v181, v9
    v_add_f32 v182, v182, v7
    v_mul_f32 v182, v182, v30
    v_add_f32 v183, v183, v7
    v_mul_f32 v183, v183, v31
    v_cvt_pk_bf16_f32 v226, v180, v181
    v_cvt_pk_bf16_f32 v227, v182, v183
    ds_write_b64 v2, v[226:227] offset:5056
    v_lshlrev_b32 v8, 16, v228
    v_and_b32 v9, 0xffff0000, v228
    v_lshlrev_b32 v30, 16, v229
    v_and_b32 v31, 0xffff0000, v229
    v_add_f32 v184, v184, v6
    v_mul_f32 v184, v184, v8
    v_add_f32 v185, v185, v6
    v_mul_f32 v185, v185, v9
    v_add_f32 v186, v186, v6
    v_mul_f32 v186, v186, v30
    v_add_f32 v187, v187, v6
    v_mul_f32 v187, v187, v31
    v_cvt_pk_bf16_f32 v228, v184, v185
    v_cvt_pk_bf16_f32 v229, v186, v187
    ds_write_b64 v2, v[228:229] offset:224
    v_lshlrev_b32 v8, 16, v230
    v_and_b32 v9, 0xffff0000, v230
    v_lshlrev_b32 v30, 16, v231
    v_and_b32 v31, 0xffff0000, v231
    v_add_f32 v188, v188, v7
    v_mul_f32 v188, v188, v8
    v_add_f32 v189, v189, v7
    v_mul_f32 v189, v189, v9
    v_add_f32 v190, v190, v7
    v_mul_f32 v190, v190, v30
    v_add_f32 v191, v191, v7
    v_mul_f32 v191, v191, v31
    v_cvt_pk_bf16_f32 v230, v188, v189
    v_cvt_pk_bf16_f32 v231, v190, v191
    ds_write_b64 v2, v[230:231] offset:5088
    v_lshlrev_b32 v8, 16, v232
    v_and_b32 v9, 0xffff0000, v232
    v_lshlrev_b32 v30, 16, v233
    v_and_b32 v31, 0xffff0000, v233
    v_add_f32 v192, v192, v6
    v_mul_f32 v192, v192, v8
    v_add_f32 v193, v193, v6
    v_mul_f32 v193, v193, v9
    v_add_f32 v194, v194, v6
    v_mul_f32 v194, v194, v30
    v_add_f32 v195, v195, v6
    v_mul_f32 v195, v195, v31
    v_cvt_pk_bf16_f32 v232, v192, v193
    v_cvt_pk_bf16_f32 v233, v194, v195
    ds_write_b64 v2, v[232:233] offset:256
    v_lshlrev_b32 v8, 16, v234
    v_and_b32 v9, 0xffff0000, v234
    v_lshlrev_b32 v30, 16, v235
    v_and_b32 v31, 0xffff0000, v235
    v_add_f32 v196, v196, v7
    v_mul_f32 v196, v196, v8
    v_add_f32 v197, v197, v7
    v_mul_f32 v197, v197, v9
    v_add_f32 v198, v198, v7
    v_mul_f32 v198, v198, v30
    v_add_f32 v199, v199, v7
    v_mul_f32 v199, v199, v31
    v_cvt_pk_bf16_f32 v234, v196, v197
    v_cvt_pk_bf16_f32 v235, v198, v199
    ds_write_b64 v2, v[234:235] offset:5120
    s_waitcnt lgkmcnt(0)
    s_mul_i32 s70, s60, 9728
    s_lshl_b32 s68, s61, 7
    s_lshl_b32 s69, s60, 5
    s_add_u32 s68, s68, s69
    s_mul_i32 s71, s68, 4608
    s_mul_i32 s69, s62, 288
    s_add_u32 s71, s71, s69
    s_mov_b32 s100, 58255
    s_mov_b32 s101, 4608
    v_add_u32 v32, 0, v1
    v_mul_lo_u32 v33, v32, s100
    v_lshrrev_b32 v33, 20, v33
    v_mul_u32_u24 v34, 18, v33
    v_sub_u32 v34, v32, v34
    v_lshlrev_b32 v34, 4, v34
    v_mul_u32_u24 v35, 304, v33
    v_add_u32 v35, v35, v34
    v_add_u32 v36, s70, v35
    v_mul_lo_u32 v35, v33, s101
    v_add_u32 v35, v35, v34
    v_add_u32 v37, s71, v35
    ds_read_b128 v[64:67], v36
    v_add_u32 v32, 64, v1
    v_mul_lo_u32 v33, v32, s100
    v_lshrrev_b32 v33, 20, v33
    v_mul_u32_u24 v34, 18, v33
    v_sub_u32 v34, v32, v34
    v_lshlrev_b32 v34, 4, v34
    v_mul_u32_u24 v35, 304, v33
    v_add_u32 v35, v35, v34
    v_add_u32 v38, s70, v35
    v_mul_lo_u32 v35, v33, s101
    v_add_u32 v35, v35, v34
    v_add_u32 v39, s71, v35
    ds_read_b128 v[68:71], v38
    v_add_u32 v32, 128, v1
    v_mul_lo_u32 v33, v32, s100
    v_lshrrev_b32 v33, 20, v33
    v_mul_u32_u24 v34, 18, v33
    v_sub_u32 v34, v32, v34
    v_lshlrev_b32 v34, 4, v34
    v_mul_u32_u24 v35, 304, v33
    v_add_u32 v35, v35, v34
    v_add_u32 v40, s70, v35
    v_mul_lo_u32 v35, v33, s101
    v_add_u32 v35, v35, v34
    v_add_u32 v41, s71, v35
    ds_read_b128 v[72:75], v40
    v_add_u32 v32, 192, v1
    v_mul_lo_u32 v33, v32, s100
    v_lshrrev_b32 v33, 20, v33
    v_mul_u32_u24 v34, 18, v33
    v_sub_u32 v34, v32, v34
    v_lshlrev_b32 v34, 4, v34
    v_mul_u32_u24 v35, 304, v33
    v_add_u32 v35, v35, v34
    v_add_u32 v42, s70, v35
    v_mul_lo_u32 v35, v33, s101
    v_add_u32 v35, v35, v34
    v_add_u32 v43, s71, v35
    ds_read_b128 v[76:79], v42
    v_add_u32 v32, 256, v1
    v_mul_lo_u32 v33, v32, s100
    v_lshrrev_b32 v33, 20, v33
    v_mul_u32_u24 v34, 18, v33
    v_sub_u32 v34, v32, v34
    v_lshlrev_b32 v34, 4, v34
    v_mul_u32_u24 v35, 304, v33
    v_add_u32 v35, v35, v34
    v_add_u32 v44, s70, v35
    v_mul_lo_u32 v35, v33, s101
    v_add_u32 v35, v35, v34
    v_add_u32 v45, s71, v35
    ds_read_b128 v[80:83], v44
    v_add_u32 v32, 320, v1
    v_mul_lo_u32 v33, v32, s100
    v_lshrrev_b32 v33, 20, v33
    v_mul_u32_u24 v34, 18, v33
    v_sub_u32 v34, v32, v34
    v_lshlrev_b32 v34, 4, v34
    v_mul_u32_u24 v35, 304, v33
    v_add_u32 v35, v35, v34
    v_add_u32 v46, s70, v35
    v_mul_lo_u32 v35, v33, s101
    v_add_u32 v35, v35, v34
    v_add_u32 v47, s71, v35
    ds_read_b128 v[84:87], v46
    v_add_u32 v32, 384, v1
    v_mul_lo_u32 v33, v32, s100
    v_lshrrev_b32 v33, 20, v33
    v_mul_u32_u24 v34, 18, v33
    v_sub_u32 v34, v32, v34
    v_lshlrev_b32 v34, 4, v34
    v_mul_u32_u24 v35, 304, v33
    v_add_u32 v35, v35, v34
    v_add_u32 v48, s70, v35
    v_mul_lo_u32 v35, v33, s101
    v_add_u32 v35, v35, v34
    v_add_u32 v49, s71, v35
    ds_read_b128 v[88:91], v48
    v_add_u32 v32, 448, v1
    v_mul_lo_u32 v33, v32, s100
    v_lshrrev_b32 v33, 20, v33
    v_mul_u32_u24 v34, 18, v33
    v_sub_u32 v34, v32, v34
    v_lshlrev_b32 v34, 4, v34
    v_mul_u32_u24 v35, 304, v33
    v_add_u32 v35, v35, v34
    v_add_u32 v50, s70, v35
    v_mul_lo_u32 v35, v33, s101
    v_add_u32 v35, v35, v34
    v_add_u32 v51, s71, v35
    ds_read_b128 v[92:95], v50
    v_add_u32 v32, 512, v1
    v_mul_lo_u32 v33, v32, s100
    v_lshrrev_b32 v33, 20, v33
    v_mul_u32_u24 v34, 18, v33
    v_sub_u32 v34, v32, v34
    v_lshlrev_b32 v34, 4, v34
    v_mul_u32_u24 v35, 304, v33
    v_add_u32 v35, v35, v34
    v_add_u32 v52, s70, v35
    v_mul_lo_u32 v35, v33, s101
    v_add_u32 v35, v35, v34
    v_add_u32 v53, s71, v35
    ds_read_b128 v[96:99], v52
    s_waitcnt lgkmcnt(8)
    buffer_store_dwordx4 v[64:67], v37, s[52:55], 0 offen
    s_waitcnt lgkmcnt(7)
    buffer_store_dwordx4 v[68:71], v39, s[52:55], 0 offen
    s_waitcnt lgkmcnt(6)
    buffer_store_dwordx4 v[72:75], v41, s[52:55], 0 offen
    s_waitcnt lgkmcnt(5)
    buffer_store_dwordx4 v[76:79], v43, s[52:55], 0 offen
    s_waitcnt lgkmcnt(4)
    buffer_store_dwordx4 v[80:83], v45, s[52:55], 0 offen
    s_waitcnt lgkmcnt(3)
    buffer_store_dwordx4 v[84:87], v47, s[52:55], 0 offen
    s_waitcnt lgkmcnt(2)
    buffer_store_dwordx4 v[88:91], v49, s[52:55], 0 offen
    s_waitcnt lgkmcnt(1)
    buffer_store_dwordx4 v[92:95], v51, s[52:55], 0 offen
    s_waitcnt lgkmcnt(0)
    buffer_store_dwordx4 v[96:99], v53, s[52:55], 0 offen
b2_kernel_end:
    s_endpgm
.section .rodata,"a"
.p2align 6
.amdhsa_kernel b2_kernel
  .amdhsa_next_free_vgpr 240
  .amdhsa_next_free_sgpr 102
  .amdhsa_accum_offset 240
  .amdhsa_group_segment_fixed_size 0
  .amdhsa_kernarg_size 96
  .amdhsa_user_sgpr_count 2
  .amdhsa_user_sgpr_kernarg_segment_ptr 1
  .amdhsa_system_sgpr_workgroup_id_x 1
  .amdhsa_float_denorm_mode_32 3
.end_amdhsa_kernel
.text

.globl b3_kernel
.p2align 8
.type b3_kernel,@function
b3_kernel:
    s_cmp_ge_u32 s2, 256
    s_cbranch_scc1 b3_kernel_end
    s_load_dwordx16 s[16:31], s[0:1], 0
    s_load_dwordx8 s[32:39], s[0:1], 64
    v_and_b32 v1, 63, v0
    v_lshrrev_b32 v2, 6, v0
    s_nop 0
    v_readfirstlane_b32 s60, v2
    s_and_b32 s62, s2, 3
    s_lshr_b32 s61, s2, 2
    s_waitcnt lgkmcnt(0)
    s_add_u32 s40, s38, 50331648
    s_addc_u32 s41, s39, 0
    s_and_b32 s41, s41, 0xffff
    s_mov_b32 s42, 9437184
    s_mov_b32 s43, 0x00020000
    s_add_u32 s44, s38, 77594624
    s_addc_u32 s45, s39, 0
    s_and_b32 s45, s45, 0xffff
    s_mov_b32 s46, 2654208
    s_mov_b32 s47, 0x00020000
    s_add_u32 s48, s38, 9437184
    s_addc_u32 s49, s39, 0
    s_and_b32 s49, s49, 0xffff
    s_mov_b32 s50, 2359296
    s_mov_b32 s51, 0x00020000
    s_mov_b32 s52, s34
    s_mov_b32 s53, s35
    s_and_b32 s53, s53, 0xffff
    s_mov_b32 s54, 2359296
    s_mov_b32 s55, 0x00020000
    s_cmp_lt_u32 s60, 4
    s_cbranch_scc1 b3_kernel_comp
    s_sub_u32 s60, s60, 4
    v_lshrrev_b32 v2, 3, v1
    s_lshl_b32 s100, s60, 3
    v_add_u32 v2, s100, v2
    v_lshrrev_b32 v3, 1, v2
    v_and_b32 v3, 7, v3
    v_and_b32 v4, 7, v1
    v_xor_b32 v3, v3, v4
    v_lshlrev_b32 v3, 4, v3
    s_mov_b32 s100, 4608
    v_mul_lo_u32 v2, v2, s100
    v_add_u32 v10, v2, v3
    s_mul_i32 s68, s61, 147456
    v_add_u32 v10, s68, v10
    v_add_u32 v11, 128, v10
    s_add_u32 s72, s60, 0
    s_cmp_ge_u32 s72, 18
    s_cselect_b32 s73, 18, 0
    s_cselect_b32 s74, 128, 0
    s_sub_u32 s72, s72, s73
    v_lshrrev_b32 v2, 3, v1
    s_lshl_b32 s100, s72, 3
    v_add_u32 v2, s100, v2
    v_lshrrev_b32 v3, 1, v2
    v_and_b32 v3, 7, v3
    v_and_b32 v4, 7, v1
    v_xor_b32 v3, v3, v4
    v_lshlrev_b32 v3, 4, v3
    s_mov_b32 s100, 4608
    v_mul_lo_u32 v2, v2, s100
    v_add_u32 v12, v2, v3
    s_mul_i32 s73, s62, 663552
    s_add_u32 s73, s73, s74
    v_add_u32 v12, s73, v12
    s_add_u32 s72, s60, 4
    s_cmp_ge_u32 s72, 18
    s_cselect_b32 s73, 18, 0
    s_cselect_b32 s74, 128, 0
    s_sub_u32 s72, s72, s73
    v_lshrrev_b32 v2, 3, v1
    s_lshl_b32 s100, s72, 3
    v_add_u32 v2, s100, v2
    v_lshrrev_b32 v3, 1, v2
    v_and_b32 v3, 7, v3
    v_and_b32 v4, 7, v1
    v_xor_b32 v3, v3, v4
    v_lshlrev_b32 v3, 4, v3
    s_mov_b32 s100, 4608
    v_mul_lo_u32 v2, v2, s100
    v_add_u32 v13, v2, v3
    s_mul_i32 s73, s62, 663552
    s_add_u32 s73, s73, s74
    v_add_u32 v13, s73, v13
    s_add_u32 s72, s60, 8
    s_cmp_ge_u32 s72, 18
    s_cselect_b32 s73, 18, 0
    s_cselect_b32 s74, 128, 0
    s_sub_u32 s72, s72, s73
    v_lshrrev_b32 v2, 3, v1
    s_lshl_b32 s100, s72, 3
    v_add_u32 v2, s100, v2
    v_lshrrev_b32 v3, 1, v2
    v_and_b32 v3, 7, v3
    v_and_b32 v4, 7, v1
    v_xor_b32 v3, v3, v4
    v_lshlrev_b32 v3, 4, v3
    s_mov_b32 s100, 4608
    v_mul_lo_u32 v2, v2, s100
    v_add_u32 v14, v2, v3
    s_mul_i32 s73, s62, 663552
    s_add_u32 s73, s73, s74
    v_add_u32 v14, s73, v14
    s_add_u32 s72, s60, 12
    s_cmp_ge_u32 s72, 18
    s_cselect_b32 s73, 18, 0
    s_cselect_b32 s74, 128, 0
    s_sub_u32 s72, s72, s73
    v_lshrrev_b32 v2, 3, v1
    s_lshl_b32 s100, s72, 3
    v_add_u32 v2, s100, v2
    v_lshrrev_b32 v3, 1, v2
    v_and_b32 v3, 7, v3
    v_and_b32 v4, 7, v1
    v_xor_b32 v3, v3, v4
    v_lshlrev_b32 v3, 4, v3
    s_mov_b32 s100, 4608
    v_mul_lo_u32 v2, v2, s100
    v_add_u32 v15, v2, v3
    s_mul_i32 s73, s62, 663552
    s_add_u32 s73, s73, s74
    v_add_u32 v15, s73, v15
    s_add_u32 s72, s60, 16
    s_cmp_ge_u32 s72, 18
    s_cselect_b32 s73, 18, 0
    s_cselect_b32 s74, 128, 0
    s_sub_u32 s72, s72, s73
    v_lshrrev_b32 v2, 3, v1
    s_lshl_b32 s100, s72, 3
    v_add_u32 v2, s100, v2
    v_lshrrev_b32 v3, 1, v2
    v_and_b32 v3, 7, v3
    v_and_b32 v4, 7, v1
    v_xor_b32 v3, v3, v4
    v_lshlrev_b32 v3, 4, v3
    s_mov_b32 s100, 4608
    v_mul_lo_u32 v2, v2, s100
    v_add_u32 v16, v2, v3
    s_mul_i32 s73, s62, 663552
    s_add_u32 s73, s73, s74
    v_add_u32 v16, s73, v16
    s_add_u32 s72, s60, 20
    s_cmp_ge_u32 s72, 18
    s_cselect_b32 s73, 18, 0
    s_cselect_b32 s74, 128, 0
    s_sub_u32 s72, s72, s73
    v_lshrrev_b32 v2, 3, v1
    s_lshl_b32 s100, s72, 3
    v_add_u32 v2, s100, v2
    v_lshrrev_b32 v3, 1, v2
    v_and_b32 v3, 7, v3
    v_and_b32 v4, 7, v1
    v_xor_b32 v3, v3, v4
    v_lshlrev_b32 v3, 4, v3
    s_mov_b32 s100, 4608
    v_mul_lo_u32 v2, v2, s100
    v_add_u32 v17, v2, v3
    s_mul_i32 s73, s62, 663552
    s_add_u32 s73, s73, s74
    v_add_u32 v17, s73, v17
    s_add_u32 s72, s60, 24
    s_cmp_ge_u32 s72, 18
    s_cselect_b32 s73, 18, 0
    s_cselect_b32 s74, 128, 0
    s_sub_u32 s72, s72, s73
    v_lshrrev_b32 v2, 3, v1
    s_lshl_b32 s100, s72, 3
    v_add_u32 v2, s100, v2
    v_lshrrev_b32 v3, 1, v2
    v_and_b32 v3, 7, v3
    v_and_b32 v4, 7, v1
    v_xor_b32 v3, v3, v4
    v_lshlrev_b32 v3, 4, v3
    s_mov_b32 s100, 4608
    v_mul_lo_u32 v2, v2, s100
    v_add_u32 v18, v2, v3
    s_mul_i32 s73, s62, 663552
    s_add_u32 s73, s73, s74
    v_add_u32 v18, s73, v18
    s_add_u32 s72, s60, 28
    s_cmp_ge_u32 s72, 18
    s_cselect_b32 s73, 18, 0
    s_cselect_b32 s74, 128, 0
    s_sub_u32 s72, s72, s73
    v_lshrrev_b32 v2, 3, v1
    s_lshl_b32 s100, s72, 3
    v_add_u32 v2, s100, v2
    v_lshrrev_b32 v3, 1, v2
    v_and_b32 v3, 7, v3
    v_and_b32 v4, 7, v1
    v_xor_b32 v3, v3, v4
    v_lshlrev_b32 v3, 4, v3
    s_mov_b32 s100, 4608
    v_mul_lo_u32 v2, v2, s100
    v_add_u32 v19, v2, v3
    s_mul_i32 s73, s62, 663552
    s_add_u32 s73, s73, s74
    v_add_u32 v19, s73, v19
    s_add_u32 s72, s60, 32
    s_cmp_ge_u32 s72, 18
    s_cselect_b32 s73, 18, 0
    s_cselect_b32 s74, 128, 0
    s_sub_u32 s72, s72, s73
    v_lshrrev_b32 v2, 3, v1
    s_lshl_b32 s100, s72, 3
    v_add_u32 v2, s100, v2
    v_lshrrev_b32 v3, 1, v2
    v_and_b32 v3, 7, v3
    v_and_b32 v4, 7, v1
    v_xor_b32 v3, v3, v4
    v_lshlrev_b32 v3, 4, v3
    s_mov_b32 s100, 4608
    v_mul_lo_u32 v2, v2, s100
    v_add_u32 v20, v2, v3
    s_mul_i32 s73, s62, 663552
    s_add_u32 s73, s73, s74
    v_add_u32 v20, s73, v20
    s_mov_b32 s63, 0
    s_mov_b32 s64, 0
    s_lshl_b32 s65, s60, 10
    s_add_u32 m0, s65, 0
    s_nop 0
    buffer_load_dwordx4 v10, s[40:43], s63 offen lds
    s_add_u32 m0, s65, 4096
    s_nop 0
    buffer_load_dwordx4 v11, s[40:43], s63 offen lds
    s_add_u32 m0, s65, 8192
    s_nop 0
    buffer_load_dwordx4 v12, s[44:47], s64 offen lds
    s_add_u32 m0, s65, 12288
    s_nop 0
    buffer_load_dwordx4 v13, s[44:47], s64 offen lds
    s_add_u32 m0, s65, 16384
    s_nop 0
    buffer_load_dwordx4 v14, s[44:47], s64 offen lds
    s_add_u32 m0, s65, 20480
    s_nop 0
    buffer_load_dwordx4 v15, s[44:47], s64 offen lds
    s_add_u32 m0, s65, 24576
    s_nop 0
    buffer_load_dwordx4 v16, s[44:47], s64 offen lds
    s_add_u32 m0, s65, 28672
    s_nop 0
    buffer_load_dwordx4 v17, s[44:47], s64 offen lds
    s_add_u32 m0, s65, 32768
    s_nop 0
    buffer_load_dwordx4 v18, s[44:47], s64 offen lds
    s_add_u32 m0, s65, 36864
    s_nop 0
    buffer_load_dwordx4 v19, s[44:47], s64 offen lds
    s_add_u32 m0, s65, 40960
    s_nop 0
    buffer_load_dwordx4 v20, s[44:47], s64 offen lds
    s_add_u32 s63, s63, 256
    s_add_u32 s64, s64, 256
    s_add_u32 s65, s65, 45056
    s_cmp_ge_u32 s65, 135168
    s_cselect_b32 s68, 135168, 0
    s_sub_u32 s65, s65, s68
    s_add_u32 m0, s65, 0
    s_nop 0
    buffer_load_dwordx4 v10, s[40:43], s63 offen lds
    s_add_u32 m0, s65, 4096
    s_nop 0
    buffer_load_dwordx4 v11, s[40:43], s63 offen lds
    s_add_u32 m0, s65, 8192
    s_nop 0
    buffer_load_dwordx4 v12, s[44:47], s64 offen lds
    s_add_u32 m0, s65, 12288
    s_nop 0
    buffer_load_dwordx4 v13, s[44:47], s64 offen lds
    s_add_u32 m0, s65, 16384
    s_nop 0
    buffer_load_dwordx4 v14, s[44:47], s64 offen lds
    s_add_u32 m0, s65, 20480
    s_nop 0
    buffer_load_dwordx4 v15, s[44:47], s64 offen lds
    s_add_u32 m0, s65, 24576
    s_nop 0
    buffer_load_dwordx4 v16, s[44:47], s64 offen lds
    s_add_u32 m0, s65, 28672
    s_nop 0
    buffer_load_dwordx4 v17, s[44:47], s64 offen lds
    s_add_u32 m0, s65, 32768
    s_nop 0
    buffer_load_dwordx4 v18, s[44:47], s64 offen lds
    s_add_u32 m0, s65, 36864
    s_nop 0
    buffer_load_dwordx4 v19, s[44:47], s64 offen lds
    s_add_u32 m0, s65, 40960
    s_nop 0
    buffer_load_dwordx4 v20, s[44:47], s64 offen lds
    s_add_u32 s63, s63, 256
    s_add_u32 s64, s64, 256
    s_add_u32 s65, s65, 45056
    s_cmp_ge_u32 s65, 135168
    s_cselect_b32 s68, 135168, 0
    s_sub_u32 s65, s65, s68
    s_add_u32 m0, s65, 0
    s_nop 0
    buffer_load_dwordx4 v10, s[40:43], s63 offen lds
    s_add_u32 m0, s65, 4096
    s_nop 0
    buffer_load_dwordx4 v11, s[40:43], s63 offen lds
    s_add_u32 m0, s65, 8192
    s_nop 0
    buffer_load_dwordx4 v12, s[44:47], s64 offen lds
    s_add_u32 m0, s65, 12288
    s_nop 0
    buffer_load_dwordx4 v13, s[44:47], s64 offen lds
    s_add_u32 m0, s65, 16384
    s_nop 0
    buffer_load_dwordx4 v14, s[44:47], s64 offen lds
    s_add_u32 m0, s65, 20480
    s_nop 0
    buffer_load_dwordx4 v15, s[44:47], s64 offen lds
    s_add_u32 m0, s65, 24576
    s_nop 0
    buffer_load_dwordx4 v16, s[44:47], s64 offen lds
    s_add_u32 m0, s65, 28672
    s_nop 0
    buffer_load_dwordx4 v17, s[44:47], s64 offen lds
    s_add_u32 m0, s65, 32768
    s_nop 0
    buffer_load_dwordx4 v18, s[44:47], s64 offen lds
    s_add_u32 m0, s65, 36864
    s_nop 0
    buffer_load_dwordx4 v19, s[44:47], s64 offen lds
    s_add_u32 m0, s65, 40960
    s_nop 0
    buffer_load_dwordx4 v20, s[44:47], s64 offen lds
    s_add_u32 s63, s63, 256
    s_add_u32 s64, s64, 256
    s_add_u32 s65, s65, 45056
    s_cmp_ge_u32 s65, 135168
    s_cselect_b32 s68, 135168, 0
    s_sub_u32 s65, s65, s68
    s_waitcnt vmcnt(22)
    s_barrier
    s_mov_b32 s67, 0
b3_kernel_lloop:
    s_waitcnt vmcnt(11)
    s_barrier
    s_add_u32 m0, s65, 0
    s_nop 0
    buffer_load_dwordx4 v10, s[40:43], s63 offen lds
    s_add_u32 m0, s65, 4096
    s_nop 0
    buffer_load_dwordx4 v11, s[40:43], s63 offen lds
    s_add_u32 m0, s65, 8192
    s_nop 0
    buffer_load_dwordx4 v12, s[44:47], s64 offen lds
    s_add_u32 m0, s65, 12288
    s_nop 0
    buffer_load_dwordx4 v13, s[44:47], s64 offen lds
    s_add_u32 m0, s65, 16384
    s_nop 0
    buffer_load_dwordx4 v14, s[44:47], s64 offen lds
    s_add_u32 m0, s65, 20480
    s_nop 0
    buffer_load_dwordx4 v15, s[44:47], s64 offen lds
    s_add_u32 m0, s65, 24576
    s_nop 0
    buffer_load_dwordx4 v16, s[44:47], s64 offen lds
    s_add_u32 m0, s65, 28672
    s_nop 0
    buffer_load_dwordx4 v17, s[44:47], s64 offen lds
    s_add_u32 m0, s65, 32768
    s_nop 0
    buffer_load_dwordx4 v18, s[44:47], s64 offen lds
    s_add_u32 m0, s65, 36864
    s_nop 0
    buffer_load_dwordx4 v19, s[44:47], s64 offen lds
    s_add_u32 m0, s65, 40960
    s_nop 0
    buffer_load_dwordx4 v20, s[44:47], s64 offen lds
    s_add_u32 s63, s63, 256
    s_add_u32 s64, s64, 256
    s_add_u32 s65, s65, 45056
    s_cmp_ge_u32 s65, 135168
    s_cselect_b32 s68, 135168, 0
    s_sub_u32 s65, s65, s68
    s_add_u32 s67, s67, 1
    s_cmp_lt_u32 s67, 18
    s_cbranch_scc1 b3_kernel_lloop
    s_waitcnt vmcnt(0)
    s_barrier
    s_barrier
    s_endpgm
b3_kernel_comp:
    v_and_b32 v2, 15, v1
    s_lshl_b32 s68, s61, 5
    v_add_u32 v2, s68, v2
    v_mul_u32_u24 v2, 1152, v2
    v_lshrrev_b32 v3, 4, v1
    v_lshlrev_b32 v3, 3, v3
    v_add_u32 v2, v2, v3
    s_mul_i32 s68, s62, 288
    v_add_u32 v2, s68, v2
    s_and_b32 s72, s60, 1
    s_mul_i32 s72, s72, 18432
    s_lshr_b32 s73, s60, 1
    s_lshl_b32 s73, s73, 5
    s_add_u32 s72, s72, s73
    v_add_u32 v8, s72, v2
    buffer_load_dwordx2 v[200:201], v8, s[48:51], 0 offen offset:0
    buffer_load_dwordx2 v[202:203], v8, s[48:51], 0 offen offset:64
    buffer_load_dwordx2 v[204:205], v8, s[48:51], 0 offen offset:128
    buffer_load_dwordx2 v[206:207], v8, s[48:51], 0 offen offset:192
    buffer_load_dwordx2 v[208:209], v8, s[48:51], 0 offen offset:256
    v_and_b32 v2, 15, v1
    v_lshlrev_b32 v2, 3, v2
    v_lshrrev_b32 v3, 4, v1
    v_lshrrev_b32 v4, 1, v1
    v_and_b32 v4, 7, v4
    v_xor_b32 v3, v3, v4
    v_add_u32 v2, v2, v3
    v_lshlrev_b32 v20, 4, v2
    v_xor_b32 v21, 64, v20
    s_and_b32 s72, s60, 1
    s_cmp_eq_u32 s72, 1
    s_cselect_b64 vcc, -1, 0
    v_cndmask_b32 v20, v20, v21, vcc
    s_lshr_b32 s73, s60, 1
    s_lshl_b32 s74, s73, 12
    v_add_u32 v20, s74, v20
    s_mul_i32 s75, s73, 18432
    s_sub_u32 s75, s75, s74
    v_add_u32 v26, s75, v20
    v_mov_b32 v128, 0
    v_mov_b32 v129, 0
    v_mov_b32 v130, 0
    v_mov_b32 v131, 0
    v_mov_b32 v132, 0
    v_mov_b32 v133, 0
    v_mov_b32 v134, 0
    v_mov_b32 v135, 0
    v_mov_b32 v136, 0
    v_mov_b32 v137, 0
    v_mov_b32 v138, 0
    v_mov_b32 v139, 0
    v_mov_b32 v140, 0
    v_mov_b32 v141, 0
    v_mov_b32 v142, 0
    v_mov_b32 v143, 0
    v_mov_b32 v144, 0
    v_mov_b32 v145, 0
    v_mov_b32 v146, 0
    v_mov_b32 v147, 0
    v_mov_b32 v148, 0
    v_mov_b32 v149, 0
    v_mov_b32 v150, 0
    v_mov_b32 v151, 0
    v_mov_b32 v152, 0
    v_mov_b32 v153, 0
    v_mov_b32 v154, 0
    v_mov_b32 v155, 0
    v_mov_b32 v156, 0
    v_mov_b32 v157, 0
    v_mov_b32 v158, 0
    v_mov_b32 v159, 0
    v_mov_b32 v160, 0
    v_mov_b32 v161, 0
    v_mov_b32 v162, 0
    v_mov_b32 v163, 0
    v_mov_b32 v164, 0
    v_mov_b32 v165, 0
    v_mov_b32 v166, 0
    v_mov_b32 v167, 0
    v_mov_b32 v168, 0
    v_mov_b32 v169, 0
    v_mov_b32 v170, 0
    v_mov_b32 v171, 0
    v_mov_b32 v172, 0
    v_mov_b32 v173, 0
    v_mov_b32 v174, 0
    v_mov_b32 v175, 0
    v_mov_b32 v176, 0
    v_mov_b32 v177, 0
    v_mov_b32 v178, 0
    v_mov_b32 v179, 0
    v_mov_b32 v180, 0
    v_mov_b32 v181, 0
    v_mov_b32 v182, 0
    v_mov_b32 v183, 0
    v_mov_b32 v184, 0
    v_mov_b32 v185, 0
    v_mov_b32 v186, 0
    v_mov_b32 v187, 0
    v_mov_b32 v188, 0
    v_mov_b32 v189, 0
    v_mov_b32 v190, 0
    v_mov_b32 v191, 0
    v_mov_b32 v192, 0
    v_mov_b32 v193, 0
    v_mov_b32 v194, 0
    v_mov_b32 v195, 0
    v_mov_b32 v196, 0
    v_mov_b32 v197, 0
    v_mov_b32 v198, 0
    v_mov_b32 v199, 0
    s_mov_b32 s66, 0
    v_add_u32 v22, s66, v20
    v_add_u32 v28, s66, v26
    s_barrier
    ds_read_b128 v[32:35], v22 offset:0
    ds_read_b128 v[36:39], v22 offset:2048
    ds_read_b128 v[40:43], v28 offset:8192
    ds_read_b128 v[44:47], v28 offset:10240
    ds_read_b128 v[48:51], v28 offset:12288
    ds_read_b128 v[52:55], v28 offset:14336
    ds_read_b128 v[56:59], v28 offset:16384
    ds_read_b128 v[60:63], v28 offset:18432
    ds_read_b128 v[64:67], v28 offset:20480
    ds_read_b128 v[68:71], v28 offset:22528
    ds_read_b128 v[72:75], v28 offset:24576
    s_mov_b32 s67, 0
b3_kernel_loop:
    s_add_u32 s66, s66, 45056
    s_cmp_ge_u32 s66, 135168
    s_cselect_b32 s68, 135168, 0
    s_sub_u32 s66, s66, s68
    s_waitcnt lgkmcnt(0)
    v_add_u32 v22, s66, v20
    v_add_u32 v28, s66, v26
    s_barrier
    ds_read_b128 v[76:79], v22 offset:0
    ds_read_b128 v[80:83], v22 offset:2048
    v_mfma_f32_16x16x32_bf16 v[128:131], v[40:43], v[32:35], v[128:131]
    ds_read_b128 v[84:87], v28 offset:8192
    ds_read_b128 v[88:91], v28 offset:10240
    v_mfma_f32_16x16x32_bf16 v[132:135], v[40:43], v[36:39], v[132:135]
    ds_read_b128 v[92:95], v28 offset:12288
    ds_read_b128 v[96:99], v28 offset:14336
    v_mfma_f32_16x16x32_bf16 v[136:139], v[44:47], v[32:35], v[136:139]
    ds_read_b128 v[100:103], v28 offset:16384
    ds_read_b128 v[104:107], v28 offset:18432
    v_mfma_f32_16x16x32_bf16 v[140:143], v[44:47], v[36:39], v[140:143]
    ds_read_b128 v[108:111], v28 offset:20480
    ds_read_b128 v[112:115], v28 offset:22528
    v_mfma_f32_16x16x32_bf16 v[144:147], v[48:51], v[32:35], v[144:147]
    ds_read_b128 v[116:119], v28 offset:24576
    v_mfma_f32_16x16x32_bf16 v[148:151], v[48:51], v[36:39], v[148:151]
    v_mfma_f32_16x16x32_bf16 v[152:155], v[52:55], v[32:35], v[152:155]
    v_mfma_f32_16x16x32_bf16 v[156:159], v[52:55], v[36:39], v[156:159]
    v_mfma_f32_16x16x32_bf16 v[160:163], v[56:59], v[32:35], v[160:163]
    v_mfma_f32_16x16x32_bf16 v[164:167], v[56:59], v[36:39], v[164:167]
    v_mfma_f32_16x16x32_bf16 v[168:171], v[60:63], v[32:35], v[168:171]
    v_mfma_f32_16x16x32_bf16 v[172:175], v[60:63], v[36:39], v[172:175]
    v_mfma_f32_16x16x32_bf16 v[176:179], v[64:67], v[32:35], v[176:179]
    v_mfma_f32_16x16x32_bf16 v[180:183], v[64:67], v[36:39], v[180:183]
    v_mfma_f32_16x16x32_bf16 v[184:187], v[68:71], v[32:35], v[184:187]
    v_mfma_f32_16x16x32_bf16 v[188:191], v[68:71], v[36:39], v[188:191]
    v_mfma_f32_16x16x32_bf16 v[192:195], v[72:75], v[32:35], v[192:195]
    v_mfma_f32_16x16x32_bf16 v[196:199], v[72:75], v[36:39], v[196:199]
    s_add_u32 s66, s66, 45056
    s_cmp_ge_u32 s66, 135168
    s_cselect_b32 s68, 135168, 0
    s_sub_u32 s66, s66, s68
    s_waitcnt lgkmcnt(0)
    v_add_u32 v22, s66, v20
    v_add_u32 v28, s66, v26
    s_barrier
    ds_read_b128 v[32:35], v22 offset:0
    ds_read_b128 v[36:39], v22 offset:2048
    v_mfma_f32_16x16x32_bf16 v[128:131], v[84:87], v[76:79], v[128:131]
    ds_read_b128 v[40:43], v28 offset:8192
    ds_read_b128 v[44:47], v28 offset:10240
    v_mfma_f32_16x16x32_bf16 v[132:135], v[84:87], v[80:83], v[132:135]
    ds_read_b128 v[48:51], v28 offset:12288
    ds_read_b128 v[52:55], v28 offset:14336
    v_mfma_f32_16x16x32_bf16 v[136:139], v[88:91], v[76:79], v[136:139]
    ds_read_b128 v[56:59], v28 offset:16384
    ds_read_b128 v[60:63], v28 offset:18432
    v_mfma_f32_16x16x32_bf16 v[140:143], v[88:91], v[80:83], v[140:143]
    ds_read_b128 v[64:67], v28 offset:20480
    ds_read_b128 v[68:71], v28 offset:22528
    v_mfma_f32_16x16x32_bf16 v[144:147], v[92:95], v[76:79], v[144:147]
    ds_read_b128 v[72:75], v28 offset:24576
    v_mfma_f32_16x16x32_bf16 v[148:151], v[92:95], v[80:83], v[148:151]
    v_mfma_f32_16x16x32_bf16 v[152:155], v[96:99], v[76:79], v[152:155]
    v_mfma_f32_16x16x32_bf16 v[156:159], v[96:99], v[80:83], v[156:159]
    v_mfma_f32_16x16x32_bf16 v[160:163], v[100:103], v[76:79], v[160:163]
    v_mfma_f32_16x16x32_bf16 v[164:167], v[100:103], v[80:83], v[164:167]
    v_mfma_f32_16x16x32_bf16 v[168:171], v[104:107], v[76:79], v[168:171]
    v_mfma_f32_16x16x32_bf16 v[172:175], v[104:107], v[80:83], v[172:175]
    v_mfma_f32_16x16x32_bf16 v[176:179], v[108:111], v[76:79], v[176:179]
    v_mfma_f32_16x16x32_bf16 v[180:183], v[108:111], v[80:83], v[180:183]
    v_mfma_f32_16x16x32_bf16 v[184:187], v[112:115], v[76:79], v[184:187]
    v_mfma_f32_16x16x32_bf16 v[188:191], v[112:115], v[80:83], v[188:191]
    v_mfma_f32_16x16x32_bf16 v[192:195], v[116:119], v[76:79], v[192:195]
    v_mfma_f32_16x16x32_bf16 v[196:199], v[116:119], v[80:83], v[196:199]
    s_add_u32 s67, s67, 2
    s_cmp_lt_u32 s67, 18
    s_cbranch_scc1 b3_kernel_loop
    s_waitcnt lgkmcnt(0)
    s_barrier
    v_lshlrev_b32 v3, 4, v1
    s_mul_i32 s72, s60, 18432
    v_add_u32 v4, s72, v3
    ds_write_b128 v4, v[128:131] offset:0
    ds_write_b128 v4, v[132:135] offset:1024
    ds_write_b128 v4, v[136:139] offset:2048
    ds_write_b128 v4, v[140:143] offset:3072
    ds_write_b128 v4, v[144:147] offset:4096
    ds_write_b128 v4, v[148:151] offset:5120
    ds_write_b128 v4, v[152:155] offset:6144
    ds_write_b128 v4, v[156:159] offset:7168
    ds_write_b128 v4, v[160:163] offset:8192
    ds_write_b128 v4, v[164:167] offset:9216
    ds_write_b128 v4, v[168:171] offset:10240
    ds_write_b128 v4, v[172:175] offset:11264
    ds_write_b128 v4, v[176:179] offset:12288
    ds_write_b128 v4, v[180:183] offset:13312
    ds_write_b128 v4, v[184:187] offset:14336
    ds_write_b128 v4, v[188:191] offset:15360
    ds_write_b128 v4, v[192:195] offset:16384
    ds_write_b128 v4, v[196:199] offset:17408
    s_waitcnt lgkmcnt(0)
    s_barrier
    s_lshl_b32 s72, s60, 10
    v_add_u32 v4, s72, v3
    v_add_u32 v7, 36864, v4
    ds_read_b128 v[32:35], v4 offset:0
    ds_read_b128 v[36:39], v4 offset:18432
    ds_read_b128 v[40:43], v7 offset:0
    ds_read_b128 v[44:47], v7 offset:18432
    ds_read_b128 v[48:51], v4 offset:4096
    ds_read_b128 v[52:55], v4 offset:22528
    ds_read_b128 v[56:59], v7 offset:4096
    ds_read_b128 v[60:63], v7 offset:22528
    ds_read_b128 v[64:67], v4 offset:8192
    ds_read_b128 v[68:71], v4 offset:26624
    ds_read_b128 v[72:75], v7 offset:8192
    ds_read_b128 v[76:79], v7 offset:26624
    ds_read_b128 v[80:83], v4 offset:12288
    ds_read_b128 v[84:87], v4 offset:30720
    ds_read_b128 v[88:91], v7 offset:12288
    ds_read_b128 v[92:95], v7 offset:30720
    ds_read_b128 v[96:99], v4 offset:16384
    ds_read_b128 v[100:103], v4 offset:34816
    ds_read_b128 v[104:107], v7 offset:16384
    ds_read_b128 v[108:111], v7 offset:34816
    s_waitcnt vmcnt(0)
    s_waitcnt lgkmcnt(15)
    v_add_f32 v32, v32, v36
    v_add_f32 v40, v40, v44
    v_add_f32 v32, v32, v40
    v_add_f32 v33, v33, v37
    v_add_f32 v41, v41, v45
    v_add_f32 v33, v33, v41
    v_add_f32 v34, v34, v38
    v_add_f32 v42, v42, v46
    v_add_f32 v34, v34, v42
    v_add_f32 v35, v35, v39
    v_add_f32 v43, v43, v47
    v_add_f32 v35, v35, v43
    v_lshlrev_b32 v5, 16, v200
    v_and_b32 v6, 0xffff0000, v200
    v_add_f32 v32, v32, v5
    v_add_f32 v33, v33, v6
    v_lshlrev_b32 v5, 16, v201
    v_and_b32 v6, 0xffff0000, v201
    v_add_f32 v34, v34, v5
    v_add_f32 v35, v35, v6
    v_cvt_pk_bf16_f32 v32, v32, v33
    v_cvt_pk_bf16_f32 v33, v34, v35
    buffer_store_dwordx2 v[32:33], v8, s[52:55], 0 offen offset:0
    s_waitcnt lgkmcnt(12)
    v_add_f32 v48, v48, v52
    v_add_f32 v56, v56, v60
    v_add_f32 v48, v48, v56
    v_add_f32 v49, v49, v53
    v_add_f32 v57, v57, v61
    v_add_f32 v49, v49, v57
    v_add_f32 v50, v50, v54
    v_add_f32 v58, v58, v62
    v_add_f32 v50, v50, v58
    v_add_f32 v51, v51, v55
    v_add_f32 v59, v59, v63
    v_add_f32 v51, v51, v59
    v_lshlrev_b32 v5, 16, v202
    v_and_b32 v6, 0xffff0000, v202
    v_add_f32 v48, v48, v5
    v_add_f32 v49, v49, v6
    v_lshlrev_b32 v5, 16, v203
    v_and_b32 v6, 0xffff0000, v203
    v_add_f32 v50, v50, v5
    v_add_f32 v51, v51, v6
    v_cvt_pk_bf16_f32 v48, v48, v49
    v_cvt_pk_bf16_f32 v49, v50, v51
    buffer_store_dwordx2 v[48:49], v8, s[52:55], 0 offen offset:64
    s_waitcnt lgkmcnt(8)
    v_add_f32 v64, v64, v68
    v_add_f32 v72, v72, v76
    v_add_f32 v64, v64, v72
    v_add_f32 v65, v65, v69
    v_add_f32 v73, v73, v77
    v_add_f32 v65, v65, v73
    v_add_f32 v66, v66, v70
    v_add_f32 v74, v74, v78
    v_add_f32 v66, v66, v74
    v_add_f32 v67, v67, v71
    v_add_f32 v75, v75, v79
    v_add_f32 v67, v67, v75
    v_lshlrev_b32 v5, 16, v204
    v_and_b32 v6, 0xffff0000, v204
    v_add_f32 v64, v64, v5
    v_add_f32 v65, v65, v6
    v_lshlrev_b32 v5, 16, v205
    v_and_b32 v6, 0xffff0000, v205
    v_add_f32 v66, v66, v5
    v_add_f32 v67, v67, v6
    v_cvt_pk_bf16_f32 v64, v64, v65
    v_cvt_pk_bf16_f32 v65, v66, v67
    buffer_store_dwordx2 v[64:65], v8, s[52:55], 0 offen offset:128
    s_waitcnt lgkmcnt(4)
    v_add_f32 v80, v80, v84
    v_add_f32 v88, v88, v92
    v_add_f32 v80, v80, v88
    v_add_f32 v81, v81, v85
    v_add_f32 v89, v89, v93
    v_add_f32 v81, v81, v89
    v_add_f32 v82, v82, v86
    v_add_f32 v90, v90, v94
    v_add_f32 v82, v82, v90
    v_add_f32 v83, v83, v87
    v_add_f32 v91, v91, v95
    v_add_f32 v83, v83, v91
    v_lshlrev_b32 v5, 16, v206
    v_and_b32 v6, 0xffff0000, v206
    v_add_f32 v80, v80, v5
    v_add_f32 v81, v81, v6
    v_lshlrev_b32 v5, 16, v207
    v_and_b32 v6, 0xffff0000, v207
    v_add_f32 v82, v82, v5
    v_add_f32 v83, v83, v6
    v_cvt_pk_bf16_f32 v80, v80, v81
    v_cvt_pk_bf16_f32 v81, v82, v83
    buffer_store_dwordx2 v[80:81], v8, s[52:55], 0 offen offset:192
    s_cmp_ge_u32 s60, 2
    s_cbranch_scc1 b3_kernel_end
    s_waitcnt lgkmcnt(0)
    v_add_f32 v96, v96, v100
    v_add_f32 v104, v104, v108
    v_add_f32 v96, v96, v104
    v_add_f32 v97, v97, v101
    v_add_f32 v105, v105, v109
    v_add_f32 v97, v97, v105
    v_add_f32 v98, v98, v102
    v_add_f32 v106, v106, v110
    v_add_f32 v98, v98, v106
    v_add_f32 v99, v99, v103
    v_add_f32 v107, v107, v111
    v_add_f32 v99, v99, v107
    v_lshlrev_b32 v5, 16, v208
    v_and_b32 v6, 0xffff0000, v208
    v_add_f32 v96, v96, v5
    v_add_f32 v97, v97, v6
    v_lshlrev_b32 v5, 16, v209
    v_and_b32 v6, 0xffff0000, v209
    v_add_f32 v98, v98, v5
    v_add_f32 v99, v99, v6
    v_cvt_pk_bf16_f32 v96, v96, v97
    v_cvt_pk_bf16_f32 v97, v98, v99
    buffer_store_dwordx2 v[96:97], v8, s[52:55], 0 offen offset:256
b3_kernel_end:
    s_endpgm
.section .rodata,"a"
.p2align 6
.amdhsa_kernel b3_kernel
  .amdhsa_next_free_vgpr 216
  .amdhsa_next_free_sgpr 102
  .amdhsa_accum_offset 216
  .amdhsa_group_segment_fixed_size 0
  .amdhsa_kernarg_size 96
  .amdhsa_user_sgpr_count 2
  .amdhsa_user_sgpr_kernarg_segment_ptr 1
  .amdhsa_system_sgpr_workgroup_id_x 1
  .amdhsa_float_denorm_mode_32 3
.end_amdhsa_kernel
.text
```
